```python
import torch

def _softmax(x, axis=-1):
    return torch.softmax(x, dim=axis)
def _gelu(x):
    return torch.nn.functional.gelu(x, approximate="tanh")
def _silu(x):
    return torch.nn.functional.silu(x)
def _sigmoid(x):
    return torch.sigmoid(x)
def _layernorm(x, axis=-1, eps=1e-5):
    m = x.mean(dim=axis, keepdim=True)
    v = x.var(dim=axis, keepdim=True, unbiased=False)
    return (x - m) / torch.sqrt(v + eps)
def _scatter_add(tgt, idx, src, axis=0):
    return tgt.clone().index_add_(axis, idx, src)
def _segment_sum(src, seg, n):
    out = torch.zeros((n,) + src.shape[1:], dtype=src.dtype)
    return out.index_add_(0, seg, src)
def _pad(x, pw):
    flat = tuple(v for pair in reversed(pw) for v in pair)
    return torch.nn.functional.pad(x, flat)

kernel_name = 'parallel_sum__linear_attn_block__glu_gated_swiglu__prompt'

def setup_inputs():

    _w = (lambda a: (lambda t: t.to(torch.bfloat16) if t.is_floating_point() else t)(torch.as_tensor(a)))
    def _A_setup():
        B, S, D = 1, 2048, 576
        return {
            "x": _w((lambda *s: torch.randn(*s, dtype=torch.bfloat16) * 0.05)(B, S, D)),
            "wqkv": _w((lambda *s: torch.randn(*s, dtype=torch.bfloat16) * 0.05)(D, 3 * D)),
            "wo": _w((lambda *s: torch.randn(*s, dtype=torch.bfloat16) * 0.05)(D, D)),
        }
    _A_in = _A_setup()

    def _B_setup():
        B, S, D, F = 1, 2048, 576, 4608
        return {
            "x": _w((lambda *s: torch.randn(*s, dtype=torch.bfloat16) * 0.05)(B, S, D)),
            "w1": _w((lambda *s: torch.randn(*s, dtype=torch.bfloat16) * 0.2)(D, F) * (2.0 / D) ** 0.5),
            "w3": _w((lambda *s: torch.randn(*s, dtype=torch.bfloat16) * 0.2)(D, F) * (2.0 / D) ** 0.5),
            "w2": _w((lambda *s: torch.randn(*s, dtype=torch.bfloat16) * 0.2)(F, D) * (2.0 / F) ** 0.5),
        }
    _B_in = _B_setup()

    return {
        "A_x": _A_in["x"],
        "A_wqkv": _A_in["wqkv"],
        "A_wo": _A_in["wo"],
        "B_x": _B_in["x"],
        "B_w1": _B_in["w1"],
        "B_w3": _B_in["w3"],
        "B_w2": _B_in["w2"],
    }

def reference(A_x, A_wqkv, A_wo, B_x, B_w1, B_w3, B_w2):
    def _A_ref(x, wqkv, wo):
        B, S, D = x.shape
        H = 32; Dh = D // H
        qkv = (lambda x, *d: x.permute(*d))((x @ wqkv).reshape(B, S, 3, H, Dh), 2, 0, 3, 1, 4)
        q, k, v = qkv[0], qkv[1], qkv[2]
        phi = lambda t: torch.where(t > 0, t + 1, torch.exp(t)) + 1e-6
        pq, pk = phi(q), phi(k)
        kv = torch.einsum("bhsd,bhse->bhde", pk, v)
        z = torch.einsum("bhsd->bhd", pk)
        num = torch.einsum("bhqd,bhde->bhqe", pq, kv)
        den = torch.einsum("bhqd,bhd->bhq", pq, z)[..., None] + 1e-6
        o = num / den
        return (lambda x, *d: x.permute(*d))(o, 0, 2, 1, 3).reshape(B, S, D) @ wo

    def _B_ref(x, w1, w3, w2):
        gate = torch.einsum("bsd,df->bsf", x, w1)
        up = torch.einsum("bsd,df->bsf", x, w3)
        h = _silu(gate) * up
        out = torch.einsum("bsf,fd->bsd", h, w2)
        return out

    x = A_x
    xn = _layernorm(x, axis=-1)
    return x + _A_ref(xn, A_wqkv, A_wo) + _B_ref(xn, B_w1, B_w3, B_w2)
```

```asm
; @launch grid=(256,1,1) block=(256,1,1) lds=163840
.amdgcn_target "amdgcn-amd-amdhsa--gfx950"
.text
.globl parallel_sum__linear_attn_block__glu_gated_swiglu__prompt_kernel
.p2align 8
.type parallel_sum__linear_attn_block__glu_gated_swiglu__prompt_kernel,@function
parallel_sum__linear_attn_block__glu_gated_swiglu__prompt_kernel:
s_cmp_ge_u32 s2, 256
s_cbranch_scc1 k1_end
s_load_dwordx4 s[4:7], s[0:1], 0
s_load_dwordx2 s[54:55], s[0:1], 16
s_load_dwordx8 s[44:51], s[0:1], 32
s_load_dwordx4 s[56:59], s[0:1], 64
s_and_b32 s22, s2, 7
s_lshr_b32 s23, s2, 3
s_lshr_b32 s77, s23, 2
s_mul_i32 s77, s77, 3
s_and_b32 s24, s23, 3
s_add_u32 s77, s77, s24
s_sub_u32 s77, s77, 7
s_lshl_b32 s77, s77, 3
s_add_u32 s77, s77, s22
s_cmp_eq_u32 s24, 0
s_cselect_b32 s77, 128, s77
s_min_u32 s77, s77, 128
s_mul_i32 s3, s77, 18432
v_lshrrev_b32 v65, 4, v0
v_and_b32 v66, 15, v0
v_mul_u32_u24 v67, 1152, v65
v_lshl_add_u32 v67, v66, 3, v67
v_add_u32 v67, s3, v67
s_and_b32 s18, s22, 1
s_lshl_b32 s18, s18, 2
s_add_u32 s18, s18, s24
s_lshr_b32 s22, s22, 1
s_lshr_b32 s23, s23, 2
v_readfirstlane_b32 s16, v0
v_and_b32 v1, 63, v0
s_nop 0
s_lshr_b32 s16, s16, 6
s_waitcnt lgkmcnt(0)
s_mov_b32 s64, s4
s_and_b32 s65, s5, 0xffff
s_mov_b32 s66, 2359296
s_mov_b32 s67, 0x20000
buffer_load_dwordx2 v[72:73], v67, s[64:67], 0 offen offset:0
buffer_load_dwordx2 v[74:75], v67, s[64:67], 0 offen offset:128
buffer_load_dwordx2 v[76:77], v67, s[64:67], 0 offen offset:256
buffer_load_dwordx2 v[78:79], v67, s[64:67], 0 offen offset:384
buffer_load_dwordx2 v[80:81], v67, s[64:67], 0 offen offset:512
buffer_load_dwordx2 v[82:83], v67, s[64:67], 0 offen offset:640
buffer_load_dwordx2 v[84:85], v67, s[64:67], 0 offen offset:768
buffer_load_dwordx2 v[86:87], v67, s[64:67], 0 offen offset:896
buffer_load_dwordx2 v[88:89], v67, s[64:67], 0 offen offset:1024
s_mov_b32 s72, s56
s_and_b32 s73, s57, 0xffff
s_mov_b32 s74, 256
s_mov_b32 s75, 0x20000
s_mov_b32 s24, s23
s_add_u32 s1, s18, s24
s_sub_u32 s24, s1, 9
s_min_u32 s1, s1, s24
s_sub_u32 s24, s1, 9
s_min_u32 s1, s1, s24
s_xor_b32 s24, s2, 0
s_or_b32 s24, s24, s16
s_cmp_lg_u32 s24, 0
s_cbranch_scc1 no_tag
s_memrealtime s[24:25]
v_lshlrev_b32 v2, 8, v1
s_waitcnt lgkmcnt(0)
s_or_b32 s24, s24, 1
v_mov_b32 v3, s24
buffer_store_dword v3, v2, s[72:75], 0 offen sc1
no_tag:
s_lshr_b32 s60, s2, 3
s_lshl_b32 s60, s60, 2
s_add_u32 s60, s60, s16
s_lshl_b32 s60, s60, 13
s_cmp_lt_u32 s60, code_end-parallel_sum__linear_attn_block__glu_gated_swiglu__prompt_kernel
s_cselect_b32 s61, code_end-parallel_sum__linear_attn_block__glu_gated_swiglu__prompt_kernel-4, 0
s_getpc_b64 s[62:63]
pc_c:
s_sub_u32 s62, s62, pc_c-parallel_sum__linear_attn_block__glu_gated_swiglu__prompt_kernel
s_subb_u32 s63, s63, 0
v_lshlrev_b32 v64, 7, v1
v_add_u32 v64, s60, v64
v_min_u32 v64, s61, v64
v_mov_b32 v113, s63
v_add_co_u32 v112, vcc, s62, v64
s_nop 1
v_addc_co_u32 v113, vcc, 0, v113, vcc
global_load_dword v64, v[112:113], off
s_mov_b32 s12, s58
s_and_b32 s13, s59, 0xffff
s_mov_b32 s14, 268435456
s_mov_b32 s15, 0x20000
s_mul_i32 s19, s22, 6
s_add_u32 s19, s19, s23
s_sub_u32 s19, s19, 2
s_mul_i32 s20, s19, 384
s_lshl_b32 s22, s22, 1
s_add_u32 s22, s22, s23
s_mul_i32 s23, s22, 144
s_add_u32 s23, s23, 1152
s_movk_i32 s79, 9216
s_mov_b32 s10, 5308416
s_cmp_lt_u32 s2, 64
s_cselect_b32 s19, s22, s19
s_cselect_b32 s20, s23, s20
s_cselect_b32 s79, 3456, s79
s_cselect_b32 s8, s6, s44
s_cselect_b32 s9, s7, s45
s_cselect_b32 s10, 1990656, s10
s_and_b32 s9, s9, 0xffff
s_mov_b32 s11, 0x20000
v_mov_b32 v28, 1073741824
v_cmp_eq_u32 vcc, 0, v1
s_nop 1
v_cndmask_b32 v28, v28, 0, vcc
v_lshrrev_b32 v32, 3, v1
v_and_b32 v2, 6, v32
v_and_b32 v33, 7, v1
v_xor_b32 v2, v2, v33
v_lshlrev_b32 v2, 4, v2
v_lshrrev_b32 v33, 2, v32
v_and_b32 v32, 3, v32
v_lshl_add_u32 v32, v33, 3, v32
s_and_b32 s22, s16, 1
s_lshl_b32 s22, s22, 4
s_lshr_b32 s23, s16, 1
s_lshl_b32 s23, s23, 2
s_add_u32 s22, s22, s23
v_add_u32 v32, s22, v32
v_mul_u32_u24 v32, s79, v32
v_add_u32 v2, v2, v32
v_lshlrev_b32 v4, 4, v1
v_add_u32 v5, 18432, v4
v_add_u32 v6, 36864, v4
v_add_u32 v7, 55296, v4
s_lshl_b32 s17, s16, 10
s_lshl_b32 s22, s18, 4
s_lshl_b32 s23, s16, 2
s_add_u32 s22, s22, s23
s_mul_i32 s32, s22, 18432
s_mul_i32 s40, s22, 165888
s_add_u32 s40, s40, 4194304
s_lshl_b32 s60, s79, 6
s_lshl_b32 s79, s79, 5
s_add_u32 s22, s1, 0
s_sub_u32 s23, s22, 9
s_min_u32 s22, s22, s23
s_mul_i32 s22, s22, s60
s_add_u32 s33, s22, s20
s_add_u32 s22, s1, 1
s_sub_u32 s23, s22, 9
s_min_u32 s22, s22, s23
s_mul_i32 s22, s22, s60
s_add_u32 s34, s22, s20
s_add_u32 s22, s1, 2
s_sub_u32 s23, s22, 9
s_min_u32 s22, s22, s23
s_mul_i32 s22, s22, s60
s_add_u32 s35, s22, s20
s_add_u32 s22, s1, 3
s_sub_u32 s23, s22, 9
s_min_u32 s22, s22, s23
s_mul_i32 s22, s22, s60
s_add_u32 s36, s22, s20
s_add_u32 s22, s1, 4
s_sub_u32 s23, s22, 9
s_min_u32 s22, s22, s23
s_mul_i32 s22, s22, s60
s_add_u32 s38, s22, s20
s_add_u32 s22, s1, 5
s_sub_u32 s23, s22, 9
s_min_u32 s22, s22, s23
s_mul_i32 s22, s22, s60
s_add_u32 s39, s22, s20
s_add_u32 s22, s1, 6
s_sub_u32 s23, s22, 9
s_min_u32 s22, s22, s23
s_mul_i32 s22, s22, s60
s_add_u32 s42, s22, s20
s_add_u32 s22, s1, 7
s_sub_u32 s23, s22, 9
s_min_u32 s22, s22, s23
s_mul_i32 s22, s22, s60
s_add_u32 s43, s22, s20
s_add_u32 s22, s1, 8
s_sub_u32 s23, s22, 9
s_min_u32 s22, s22, s23
s_mul_i32 s22, s22, s60
s_add_u32 s0, s22, s20
s_mov_b32 s5, s77
s_cmp_lt_u32 s77, 128
s_cbranch_scc1 do_ln
s_add_u32 m0, s17, 0
s_add_u32 s21, s33, 0
buffer_load_dwordx4 v2, s[8:11], s21 offen lds
s_add_u32 m0, s17, 4096
s_add_u32 s21, s33, s79
buffer_load_dwordx4 v2, s[8:11], s21 offen lds
s_add_u32 m0, s17, 8192
s_add_u32 s21, s34, 0
buffer_load_dwordx4 v2, s[8:11], s21 offen lds
s_add_u32 m0, s17, 12288
s_add_u32 s21, s34, s79
buffer_load_dwordx4 v2, s[8:11], s21 offen lds
s_add_u32 m0, s17, 16384
s_add_u32 s21, s35, 0
buffer_load_dwordx4 v2, s[8:11], s21 offen lds
s_add_u32 m0, s17, 20480
s_add_u32 s21, s35, s79
buffer_load_dwordx4 v2, s[8:11], s21 offen lds
s_add_u32 m0, s17, 24576
s_add_u32 s21, s36, 0
buffer_load_dwordx4 v2, s[8:11], s21 offen lds
s_add_u32 m0, s17, 28672
s_add_u32 s21, s36, s79
buffer_load_dwordx4 v2, s[8:11], s21 offen lds
s_add_u32 m0, s17, 32768
s_add_u32 s21, s38, 0
buffer_load_dwordx4 v2, s[8:11], s21 offen lds
s_add_u32 m0, s17, 36864
s_add_u32 s21, s38, s79
buffer_load_dwordx4 v2, s[8:11], s21 offen lds
s_add_u32 m0, s17, 40960
s_add_u32 s21, s39, 0
buffer_load_dwordx4 v2, s[8:11], s21 offen lds
s_add_u32 m0, s17, 45056
s_add_u32 s21, s39, s79
buffer_load_dwordx4 v2, s[8:11], s21 offen lds
s_branch skip_ln
do_ln:
s_add_u32 m0, s17, 0
s_add_u32 s21, s33, 0
buffer_load_dwordx4 v2, s[8:11], s21 offen lds
s_add_u32 m0, s17, 4096
s_add_u32 s21, s33, s79
buffer_load_dwordx4 v2, s[8:11], s21 offen lds
s_add_u32 m0, s17, 8192
s_add_u32 s21, s34, 0
buffer_load_dwordx4 v2, s[8:11], s21 offen lds
v_lshrrev_b32 v68, 1, v66
v_mul_u32_u24 v68, 272, v68
v_lshl_add_u32 v68, v65, 4, v68
v_and_b32 v69, 1, v66
v_lshl_add_u32 v68, v69, 3, v68
v_add_u32 v68, 122880, v68
v_mul_u32_u24 v71, 272, v65
v_lshl_add_u32 v71, v66, 4, v71
v_add_u32 v71, 122880, v71
v_lshlrev_b32 v69, 4, v0
v_mov_b32 v70, 1073741824
v_cmp_gt_u32 vcc, 128, v0
s_nop 1
v_cndmask_b32 v70, v70, v69, vcc
s_lshl_b32 s3, s77, 2
s_add_u32 s3, s3, s16
s_lshl_b32 s3, s3, 7
s_add_u32 s3, s3, 58785792
s_mul_i32 s77, s77, 18432
s_add_u32 s77, s77, 0
s_mov_b32 s78, 0x3f803f80
s_waitcnt vmcnt(12)
v_dot2_f32_bf16 v90, v72, s78, 0
v_lshlrev_b32 v96, 16, v72
v_and_b32 v97, 0xffff0000, v72
v_dot2_f32_bf16 v91, v73, s78, 0
v_lshlrev_b32 v98, 16, v73
v_and_b32 v99, 0xffff0000, v73
s_waitcnt vmcnt(11)
v_dot2_f32_bf16 v90, v74, s78, v90
v_lshlrev_b32 v100, 16, v74
v_and_b32 v101, 0xffff0000, v74
v_dot2_f32_bf16 v91, v75, s78, v91
v_lshlrev_b32 v102, 16, v75
v_and_b32 v103, 0xffff0000, v75
s_waitcnt vmcnt(10)
v_dot2_f32_bf16 v90, v76, s78, v90
v_lshlrev_b32 v104, 16, v76
v_and_b32 v105, 0xffff0000, v76
v_dot2_f32_bf16 v91, v77, s78, v91
v_lshlrev_b32 v106, 16, v77
v_and_b32 v107, 0xffff0000, v77
s_waitcnt vmcnt(9)
v_dot2_f32_bf16 v90, v78, s78, v90
v_lshlrev_b32 v108, 16, v78
v_and_b32 v109, 0xffff0000, v78
v_dot2_f32_bf16 v91, v79, s78, v91
v_lshlrev_b32 v110, 16, v79
v_and_b32 v111, 0xffff0000, v79
s_waitcnt vmcnt(8)
v_dot2_f32_bf16 v90, v80, s78, v90
v_lshlrev_b32 v112, 16, v80
v_and_b32 v113, 0xffff0000, v80
v_dot2_f32_bf16 v91, v81, s78, v91
v_lshlrev_b32 v114, 16, v81
v_and_b32 v115, 0xffff0000, v81
s_waitcnt vmcnt(7)
v_dot2_f32_bf16 v90, v82, s78, v90
v_lshlrev_b32 v116, 16, v82
v_and_b32 v117, 0xffff0000, v82
v_dot2_f32_bf16 v91, v83, s78, v91
s_waitcnt vmcnt(6)
v_dot2_f32_bf16 v90, v84, s78, v90
v_dot2_f32_bf16 v91, v85, s78, v91
s_waitcnt vmcnt(5)
v_dot2_f32_bf16 v90, v86, s78, v90
v_dot2_f32_bf16 v91, v87, s78, v91
s_waitcnt vmcnt(4)
v_dot2_f32_bf16 v90, v88, s78, v90
v_dot2_f32_bf16 v91, v89, s78, v91
v_mov_b32 v31, 0
buffer_load_dword v55, v31, s[72:75], 0 offen sc1
v_lshlrev_b32 v118, 16, v83
v_and_b32 v119, 0xffff0000, v83
v_add_f32 v90, v90, v91
v_lshlrev_b32 v120, 16, v84
v_and_b32 v121, 0xffff0000, v84
v_add_f32 v90, v90, v90 quad_perm:[1,0,3,2] row_mask:0xf bank_mask:0xf
v_lshlrev_b32 v122, 16, v85
v_and_b32 v123, 0xffff0000, v85
v_add_f32 v90, v90, v90 quad_perm:[2,3,0,1] row_mask:0xf bank_mask:0xf
v_lshlrev_b32 v124, 16, v86
v_and_b32 v125, 0xffff0000, v86
v_add_f32 v90, v90, v90 row_half_mirror row_mask:0xf bank_mask:0xf
v_lshlrev_b32 v126, 16, v87
v_and_b32 v127, 0xffff0000, v87
v_add_f32 v90, v90, v90 row_mirror row_mask:0xf bank_mask:0xf
v_lshlrev_b32 v128, 16, v88
v_and_b32 v129, 0xffff0000, v88
v_mul_f32 v90, 0x3ae38e39, v90
v_lshlrev_b32 v130, 16, v89
v_and_b32 v131, 0xffff0000, v89
v_sub_f32 v96, v96, v90
v_sub_f32 v97, v97, v90
v_mul_f32 v92, v96, v96
v_sub_f32 v98, v98, v90
v_mul_f32 v93, v97, v97
v_sub_f32 v99, v99, v90
v_fmac_f32 v92, v98, v98
v_sub_f32 v100, v100, v90
v_fmac_f32 v93, v99, v99
v_sub_f32 v101, v101, v90
v_fmac_f32 v92, v100, v100
v_sub_f32 v102, v102, v90
v_fmac_f32 v93, v101, v101
v_sub_f32 v103, v103, v90
v_fmac_f32 v92, v102, v102
v_sub_f32 v104, v104, v90
v_fmac_f32 v93, v103, v103
v_sub_f32 v105, v105, v90
v_fmac_f32 v92, v104, v104
v_sub_f32 v106, v106, v90
v_fmac_f32 v93, v105, v105
v_sub_f32 v107, v107, v90
v_fmac_f32 v92, v106, v106
v_sub_f32 v108, v108, v90
v_fmac_f32 v93, v107, v107
v_sub_f32 v109, v109, v90
v_fmac_f32 v92, v108, v108
v_sub_f32 v110, v110, v90
v_fmac_f32 v93, v109, v109
v_sub_f32 v111, v111, v90
v_fmac_f32 v92, v110, v110
v_sub_f32 v112, v112, v90
v_fmac_f32 v93, v111, v111
v_sub_f32 v113, v113, v90
v_fmac_f32 v92, v112, v112
v_sub_f32 v114, v114, v90
v_fmac_f32 v93, v113, v113
v_sub_f32 v115, v115, v90
v_fmac_f32 v92, v114, v114
v_sub_f32 v116, v116, v90
v_fmac_f32 v93, v115, v115
v_sub_f32 v117, v117, v90
v_fmac_f32 v92, v116, v116
v_sub_f32 v118, v118, v90
v_fmac_f32 v93, v117, v117
v_sub_f32 v119, v119, v90
v_fmac_f32 v92, v118, v118
v_sub_f32 v120, v120, v90
v_fmac_f32 v93, v119, v119
v_sub_f32 v121, v121, v90
v_fmac_f32 v92, v120, v120
v_sub_f32 v122, v122, v90
v_fmac_f32 v93, v121, v121
v_sub_f32 v123, v123, v90
v_fmac_f32 v92, v122, v122
v_sub_f32 v124, v124, v90
v_fmac_f32 v93, v123, v123
v_sub_f32 v125, v125, v90
v_fmac_f32 v92, v124, v124
v_sub_f32 v126, v126, v90
v_fmac_f32 v93, v125, v125
v_sub_f32 v127, v127, v90
v_fmac_f32 v92, v126, v126
v_sub_f32 v128, v128, v90
v_fmac_f32 v93, v127, v127
v_sub_f32 v129, v129, v90
v_fmac_f32 v92, v128, v128
v_sub_f32 v130, v130, v90
v_fmac_f32 v93, v129, v129
v_sub_f32 v131, v131, v90
v_fmac_f32 v92, v130, v130
v_fmac_f32 v93, v131, v131
v_cvt_pk_bf16_f32 v91, v90, v90
v_add_f32 v92, v92, v93
v_lshlrev_b32 v91, 16, v91
v_sub_f32 v90, v91, v90
v_add_f32 v92, v92, v92 quad_perm:[1,0,3,2] row_mask:0xf bank_mask:0xf
s_nop 1
v_add_f32 v92, v92, v92 quad_perm:[2,3,0,1] row_mask:0xf bank_mask:0xf
s_nop 1
v_add_f32 v92, v92, v92 row_half_mirror row_mask:0xf bank_mask:0xf
s_nop 1
v_add_f32 v92, v92, v92 row_mirror row_mask:0xf bank_mask:0xf
v_mul_f32 v92, 0x3ae38e39, v92
v_cvt_pk_bf16_f32 v92, v92, v92
v_lshlrev_b32 v92, 16, v92
v_add_f32 v92, 0x3727c5ac, v92
v_cvt_pk_bf16_f32 v92, v92, v92
v_lshlrev_b32 v92, 16, v92
v_sqrt_f32 v92, v92
s_nop 0
v_cvt_pk_bf16_f32 v92, v92, v92
v_lshlrev_b32 v92, 16, v92
v_rcp_f32 v92, v92
s_nop 0
v_mul_f32 v92, 0x3fb8aa3b, v92
v_mul_f32 v90, v90, v92
v_fma_f32 v96, v96, v92, -v90
v_fma_f32 v97, v97, v92, -v90
v_cvt_pk_bf16_f32 v72, v96, v97
v_fma_f32 v98, v98, v92, -v90
v_fma_f32 v99, v99, v92, -v90
v_cvt_pk_bf16_f32 v73, v98, v99
ds_write_b64 v68, v[72:73] offset:0
v_fma_f32 v100, v100, v92, -v90
v_fma_f32 v101, v101, v92, -v90
v_cvt_pk_bf16_f32 v74, v100, v101
v_fma_f32 v102, v102, v92, -v90
v_fma_f32 v103, v103, v92, -v90
v_cvt_pk_bf16_f32 v75, v102, v103
ds_write_b64 v68, v[74:75] offset:2176
v_fma_f32 v104, v104, v92, -v90
v_fma_f32 v105, v105, v92, -v90
v_cvt_pk_bf16_f32 v76, v104, v105
v_fma_f32 v106, v106, v92, -v90
v_fma_f32 v107, v107, v92, -v90
v_cvt_pk_bf16_f32 v77, v106, v107
ds_write_b64 v68, v[76:77] offset:4352
v_fma_f32 v108, v108, v92, -v90
v_fma_f32 v109, v109, v92, -v90
v_cvt_pk_bf16_f32 v78, v108, v109
v_fma_f32 v110, v110, v92, -v90
v_fma_f32 v111, v111, v92, -v90
v_cvt_pk_bf16_f32 v79, v110, v111
ds_write_b64 v68, v[78:79] offset:6528
v_fma_f32 v112, v112, v92, -v90
v_fma_f32 v113, v113, v92, -v90
v_cvt_pk_bf16_f32 v80, v112, v113
v_fma_f32 v114, v114, v92, -v90
v_fma_f32 v115, v115, v92, -v90
v_cvt_pk_bf16_f32 v81, v114, v115
ds_write_b64 v68, v[80:81] offset:8704
v_fma_f32 v116, v116, v92, -v90
v_fma_f32 v117, v117, v92, -v90
v_cvt_pk_bf16_f32 v82, v116, v117
v_fma_f32 v118, v118, v92, -v90
v_fma_f32 v119, v119, v92, -v90
v_cvt_pk_bf16_f32 v83, v118, v119
ds_write_b64 v68, v[82:83] offset:10880
v_fma_f32 v120, v120, v92, -v90
v_fma_f32 v121, v121, v92, -v90
v_cvt_pk_bf16_f32 v84, v120, v121
v_fma_f32 v122, v122, v92, -v90
v_fma_f32 v123, v123, v92, -v90
v_cvt_pk_bf16_f32 v85, v122, v123
ds_write_b64 v68, v[84:85] offset:13056
v_fma_f32 v124, v124, v92, -v90
v_fma_f32 v125, v125, v92, -v90
v_cvt_pk_bf16_f32 v86, v124, v125
v_fma_f32 v126, v126, v92, -v90
v_fma_f32 v127, v127, v92, -v90
v_cvt_pk_bf16_f32 v87, v126, v127
ds_write_b64 v68, v[86:87] offset:15232
v_fma_f32 v128, v128, v92, -v90
v_fma_f32 v129, v129, v92, -v90
v_cvt_pk_bf16_f32 v88, v128, v129
v_fma_f32 v130, v130, v92, -v90
v_fma_f32 v131, v131, v92, -v90
v_cvt_pk_bf16_f32 v89, v130, v131
ds_write_b64 v68, v[88:89] offset:17408
s_waitcnt lgkmcnt(0)
s_barrier
ds_read_b128 v[96:99], v71 offset:0
ds_read_b128 v[100:103], v71 offset:4352
ds_read_b128 v[104:107], v71 offset:8704
ds_read_b128 v[108:111], v71 offset:13056
ds_read_b128 v[112:115], v71 offset:17408
s_waitcnt lgkmcnt(4)
buffer_store_dwordx4 v[96:99], v69, s[12:15], s77 offen sc1
s_add_u32 s77, s77, 4096
s_waitcnt lgkmcnt(3)
buffer_store_dwordx4 v[100:103], v69, s[12:15], s77 offen sc1
s_add_u32 s77, s77, 4096
s_waitcnt lgkmcnt(2)
buffer_store_dwordx4 v[104:107], v69, s[12:15], s77 offen sc1
s_add_u32 s77, s77, 4096
s_waitcnt lgkmcnt(1)
buffer_store_dwordx4 v[108:111], v69, s[12:15], s77 offen sc1
s_add_u32 s77, s77, 4096
s_waitcnt lgkmcnt(0)
buffer_store_dwordx4 v[112:115], v70, s[12:15], s77 offen sc1
s_waitcnt vmcnt(5)
v_readfirstlane_b32 s76, v55
s_nop 1
s_cmp_eq_u32 s76, 0
s_cbranch_scc1 slow_tagl
back_tagl:
v_mov_b32 v31, s76
s_waitcnt vmcnt(0)
buffer_store_dword v31, v28, s[12:15], s3 offen sc1
s_add_u32 m0, s17, 12288
s_add_u32 s21, s34, s79
buffer_load_dwordx4 v2, s[8:11], s21 offen lds
s_add_u32 m0, s17, 16384
s_add_u32 s21, s35, 0
buffer_load_dwordx4 v2, s[8:11], s21 offen lds
s_add_u32 m0, s17, 20480
s_add_u32 s21, s35, s79
buffer_load_dwordx4 v2, s[8:11], s21 offen lds
s_add_u32 m0, s17, 24576
s_add_u32 s21, s36, 0
buffer_load_dwordx4 v2, s[8:11], s21 offen lds
s_add_u32 m0, s17, 28672
s_add_u32 s21, s36, s79
buffer_load_dwordx4 v2, s[8:11], s21 offen lds
s_add_u32 m0, s17, 32768
s_add_u32 s21, s38, 0
buffer_load_dwordx4 v2, s[8:11], s21 offen lds
s_add_u32 m0, s17, 36864
s_add_u32 s21, s38, s79
buffer_load_dwordx4 v2, s[8:11], s21 offen lds
s_add_u32 m0, s17, 40960
s_add_u32 s21, s39, 0
buffer_load_dwordx4 v2, s[8:11], s21 offen lds
s_add_u32 m0, s17, 45056
s_add_u32 s21, s39, s79
buffer_load_dwordx4 v2, s[8:11], s21 offen lds
skip_ln:
s_mov_b32 s24, s46
s_and_b32 s25, s47, 0xffff
s_mov_b32 s26, 5308416
s_mov_b32 s27, 0x20000
s_mov_b32 s28, s48
s_and_b32 s29, s49, 0xffff
s_mov_b32 s30, 5308416
s_mov_b32 s31, 0x20000
s_mov_b32 s68, s50
s_and_b32 s69, s51, 0xffff
s_mov_b32 s70, 2359296
s_mov_b32 s71, 0x20000
s_mov_b32 s56, s54
s_and_b32 s57, s55, 0xffff
s_mov_b32 s58, 663552
s_mov_b32 s59, 0x20000
s_add_u32 s22, s1, 0
s_sub_u32 s23, s22, 9
s_min_u32 s22, s22, s23
s_mul_i32 s22, s22, 2048
s_add_u32 s44, s22, s32
s_add_u32 s22, s1, 1
s_sub_u32 s23, s22, 9
s_min_u32 s22, s22, s23
s_mul_i32 s22, s22, 2048
s_add_u32 s45, s22, s32
s_add_u32 s22, s1, 2
s_sub_u32 s23, s22, 9
s_min_u32 s22, s22, s23
s_mul_i32 s22, s22, 2048
s_add_u32 s46, s22, s32
s_add_u32 s22, s1, 3
s_sub_u32 s23, s22, 9
s_min_u32 s22, s22, s23
s_mul_i32 s22, s22, 2048
s_add_u32 s47, s22, s32
s_add_u32 s22, s1, 4
s_sub_u32 s23, s22, 9
s_min_u32 s22, s22, s23
s_mul_i32 s22, s22, 2048
s_add_u32 s48, s22, s32
s_add_u32 s22, s1, 5
s_sub_u32 s23, s22, 9
s_min_u32 s22, s22, s23
s_mul_i32 s22, s22, 2048
s_add_u32 s49, s22, s32
s_add_u32 s22, s1, 6
s_sub_u32 s23, s22, 9
s_min_u32 s22, s22, s23
s_mul_i32 s22, s22, 2048
s_add_u32 s50, s22, s32
s_add_u32 s22, s1, 7
s_sub_u32 s23, s22, 9
s_min_u32 s22, s22, s23
s_mul_i32 s22, s22, 2048
s_add_u32 s51, s22, s32
s_add_u32 s22, s1, 8
s_sub_u32 s23, s22, 9
s_min_u32 s22, s22, s23
s_mul_i32 s22, s22, 2048
s_add_u32 s32, s22, s32
s_lshl_b32 s6, s18, 2
s_add_u32 s6, s6, s16
s_lshl_b32 s6, s6, 11
s_add_u32 s6, s6, 58785792
v_and_b32 v39, 15, v1
v_lshlrev_b32 v39, 7, v39
v_bfe_u32 v32, v1, 2, 3
v_lshrrev_b32 v33, 5, v1
v_lshlrev_b32 v33, 10, v33
v_lshl_add_u32 v33, v32, 7, v33
v_and_b32 v34, 3, v1
v_lshl_add_u32 v33, v34, 3, v33
v_lshrrev_b32 v32, 1, v32
v_xor_b32 v34, 0, v32
v_lshl_add_u32 v12, v34, 5, v33
v_add_u32 v16, 49152, v12
v_add_u32 v20, 98304, v12
v_xor_b32 v34, 1, v32
v_lshl_add_u32 v13, v34, 5, v33
v_add_u32 v17, 49152, v13
v_add_u32 v21, 98304, v13
v_xor_b32 v34, 2, v32
v_lshl_add_u32 v14, v34, 5, v33
v_add_u32 v18, 49152, v14
v_add_u32 v22, 98304, v14
v_xor_b32 v34, 3, v32
v_lshl_add_u32 v15, v34, 5, v33
v_add_u32 v19, 49152, v15
v_add_u32 v23, 98304, v15
s_cmp_lt_u32 s2, 64
s_cbranch_scc1 k1_att
s_add_u32 m0, s17, 49152
s_add_u32 s21, s42, 0
buffer_load_dwordx4 v2, s[8:11], s21 offen lds
s_add_u32 m0, s17, 53248
s_add_u32 s21, s42, 294912
buffer_load_dwordx4 v2, s[8:11], s21 offen lds
s_add_u32 m0, s17, 57344
s_add_u32 s21, s43, 0
buffer_load_dwordx4 v2, s[8:11], s21 offen lds
s_add_u32 m0, s17, 61440
s_add_u32 s21, s43, 294912
buffer_load_dwordx4 v2, s[8:11], s21 offen lds
s_add_u32 m0, s17, 65536
s_add_u32 s21, s0, 0
buffer_load_dwordx4 v2, s[8:11], s21 offen lds
s_add_u32 m0, s17, 69632
s_add_u32 s21, s0, 294912
buffer_load_dwordx4 v2, s[8:11], s21 offen lds
v_mov_b32 v31, 0
buffer_load_dword v38, v31, s[72:75], 0 offen sc1
buffer_load_dword v55, v39, s[12:15], s6 offen offset:0 sc1
s_waitcnt vmcnt(1)
v_readfirstlane_b32 s76, v38
s_nop 1
s_cmp_eq_u32 s76, 0
s_cbranch_scc1 slow_tagf
back_tagf:
v_mov_b32 v31, s76
s_waitcnt vmcnt(0)
v_cmp_ne_u32 vcc, s76, v55
s_nop 1
s_cbranch_vccnz slow_f0
back_f0:
buffer_load_dwordx4 a[0:3], v4, s[12:15], s44 offen offset:0 sc1
buffer_load_dwordx4 a[4:7], v5, s[12:15], s44 offen offset:0 sc1
buffer_load_dwordx4 a[8:11], v6, s[12:15], s44 offen offset:0 sc1
buffer_load_dwordx4 a[12:15], v7, s[12:15], s44 offen offset:0 sc1
buffer_load_dwordx4 a[16:19], v4, s[12:15], s44 offen offset:1024 sc1
buffer_load_dwordx4 a[20:23], v5, s[12:15], s44 offen offset:1024 sc1
buffer_load_dwordx4 a[24:27], v6, s[12:15], s44 offen offset:1024 sc1
buffer_load_dwordx4 a[28:31], v7, s[12:15], s44 offen offset:1024 sc1
buffer_load_dwordx4 a[32:35], v4, s[12:15], s45 offen offset:0 sc1
buffer_load_dwordx4 a[36:39], v5, s[12:15], s45 offen offset:0 sc1
buffer_load_dwordx4 a[40:43], v6, s[12:15], s45 offen offset:0 sc1
buffer_load_dwordx4 a[44:47], v7, s[12:15], s45 offen offset:0 sc1
buffer_load_dwordx4 a[48:51], v4, s[12:15], s45 offen offset:1024 sc1
buffer_load_dwordx4 a[52:55], v5, s[12:15], s45 offen offset:1024 sc1
buffer_load_dwordx4 a[56:59], v6, s[12:15], s45 offen offset:1024 sc1
buffer_load_dwordx4 a[60:63], v7, s[12:15], s45 offen offset:1024 sc1
buffer_load_dwordx4 a[64:67], v4, s[12:15], s46 offen offset:0 sc1
buffer_load_dwordx4 a[68:71], v5, s[12:15], s46 offen offset:0 sc1
buffer_load_dwordx4 a[72:75], v6, s[12:15], s46 offen offset:0 sc1
buffer_load_dwordx4 a[76:79], v7, s[12:15], s46 offen offset:0 sc1
buffer_load_dwordx4 a[80:83], v4, s[12:15], s46 offen offset:1024 sc1
buffer_load_dwordx4 a[84:87], v5, s[12:15], s46 offen offset:1024 sc1
buffer_load_dwordx4 a[88:91], v6, s[12:15], s46 offen offset:1024 sc1
buffer_load_dwordx4 a[92:95], v7, s[12:15], s46 offen offset:1024 sc1
s_barrier
ds_read_b64_tr_b16 v[200:201], v12 offset:0
ds_read_b64_tr_b16 v[202:203], v12 offset:2048
ds_read_b64_tr_b16 v[204:205], v12 offset:4096
ds_read_b64_tr_b16 v[206:207], v12 offset:6144
ds_read_b64_tr_b16 v[208:209], v13 offset:0
ds_read_b64_tr_b16 v[210:211], v13 offset:2048
ds_read_b64_tr_b16 v[212:213], v13 offset:4096
ds_read_b64_tr_b16 v[214:215], v13 offset:6144
s_waitcnt lgkmcnt(4) vmcnt(23)
v_mfma_f32_16x16x32_bf16 v[56:59], v[200:203], a[0:3], 0
s_waitcnt vmcnt(19)
ds_read_b64_tr_b16 v[216:217], v14 offset:0
v_mfma_f32_16x16x32_bf16 v[56:59], v[204:207], a[16:19], v[56:59]
v_mfma_f32_16x16x32_bf16 v[60:63], v[200:203], a[4:7], 0
s_waitcnt vmcnt(18)
ds_read_b64_tr_b16 v[218:219], v14 offset:2048
v_mfma_f32_16x16x32_bf16 v[60:63], v[204:207], a[20:23], v[60:63]
v_mfma_f32_16x16x32_bf16 v[64:67], v[200:203], a[8:11], 0
s_waitcnt vmcnt(17)
ds_read_b64_tr_b16 v[220:221], v14 offset:4096
v_mfma_f32_16x16x32_bf16 v[64:67], v[204:207], a[24:27], v[64:67]
v_mfma_f32_16x16x32_bf16 v[68:71], v[200:203], a[12:15], 0
s_waitcnt vmcnt(16)
ds_read_b64_tr_b16 v[222:223], v14 offset:6144
v_mfma_f32_16x16x32_bf16 v[68:71], v[204:207], a[28:31], v[68:71]
s_waitcnt lgkmcnt(4)
v_mfma_f32_16x16x32_bf16 v[72:75], v[208:211], a[0:3], 0
ds_read_b64_tr_b16 v[200:201], v15 offset:0
v_mfma_f32_16x16x32_bf16 v[72:75], v[212:215], a[16:19], v[72:75]
buffer_load_dwordx4 a[96:99], v4, s[12:15], s47 offen offset:0 sc1
v_mfma_f32_16x16x32_bf16 v[76:79], v[208:211], a[4:7], 0
ds_read_b64_tr_b16 v[202:203], v15 offset:2048
v_mfma_f32_16x16x32_bf16 v[76:79], v[212:215], a[20:23], v[76:79]
buffer_load_dwordx4 a[100:103], v5, s[12:15], s47 offen offset:0 sc1
v_mfma_f32_16x16x32_bf16 v[80:83], v[208:211], a[8:11], 0
ds_read_b64_tr_b16 v[204:205], v15 offset:4096
v_mfma_f32_16x16x32_bf16 v[80:83], v[212:215], a[24:27], v[80:83]
buffer_load_dwordx4 a[104:107], v6, s[12:15], s47 offen offset:0 sc1
v_mfma_f32_16x16x32_bf16 v[84:87], v[208:211], a[12:15], 0
ds_read_b64_tr_b16 v[206:207], v15 offset:6144
v_mfma_f32_16x16x32_bf16 v[84:87], v[212:215], a[28:31], v[84:87]
s_waitcnt lgkmcnt(4)
v_mfma_f32_16x16x32_bf16 v[88:91], v[216:219], a[0:3], 0
ds_read_b64_tr_b16 v[208:209], v12 offset:8192
v_mfma_f32_16x16x32_bf16 v[88:91], v[220:223], a[16:19], v[88:91]
buffer_load_dwordx4 a[108:111], v7, s[12:15], s47 offen offset:0 sc1
v_mfma_f32_16x16x32_bf16 v[92:95], v[216:219], a[4:7], 0
ds_read_b64_tr_b16 v[210:211], v12 offset:10240
v_mfma_f32_16x16x32_bf16 v[92:95], v[220:223], a[20:23], v[92:95]
buffer_load_dwordx4 a[112:115], v4, s[12:15], s47 offen offset:1024 sc1
v_mfma_f32_16x16x32_bf16 v[96:99], v[216:219], a[8:11], 0
ds_read_b64_tr_b16 v[212:213], v12 offset:12288
v_mfma_f32_16x16x32_bf16 v[96:99], v[220:223], a[24:27], v[96:99]
buffer_load_dwordx4 a[116:119], v5, s[12:15], s47 offen offset:1024 sc1
v_mfma_f32_16x16x32_bf16 v[100:103], v[216:219], a[12:15], 0
ds_read_b64_tr_b16 v[214:215], v12 offset:14336
v_mfma_f32_16x16x32_bf16 v[100:103], v[220:223], a[28:31], v[100:103]
s_waitcnt lgkmcnt(4)
v_mfma_f32_16x16x32_bf16 v[104:107], v[200:203], a[0:3], 0
ds_read_b64_tr_b16 v[216:217], v13 offset:8192
v_mfma_f32_16x16x32_bf16 v[104:107], v[204:207], a[16:19], v[104:107]
buffer_load_dwordx4 a[120:123], v6, s[12:15], s47 offen offset:1024 sc1
v_mfma_f32_16x16x32_bf16 v[108:111], v[200:203], a[4:7], 0
ds_read_b64_tr_b16 v[218:219], v13 offset:10240
v_mfma_f32_16x16x32_bf16 v[108:111], v[204:207], a[20:23], v[108:111]
buffer_load_dwordx4 a[124:127], v7, s[12:15], s47 offen offset:1024 sc1
v_mfma_f32_16x16x32_bf16 v[112:115], v[200:203], a[8:11], 0
ds_read_b64_tr_b16 v[220:221], v13 offset:12288
v_mfma_f32_16x16x32_bf16 v[112:115], v[204:207], a[24:27], v[112:115]
v_mfma_f32_16x16x32_bf16 v[116:119], v[200:203], a[12:15], 0
ds_read_b64_tr_b16 v[222:223], v13 offset:14336
v_mfma_f32_16x16x32_bf16 v[116:119], v[204:207], a[28:31], v[116:119]
s_waitcnt lgkmcnt(4) vmcnt(23)
v_mfma_f32_16x16x32_bf16 v[56:59], v[208:211], a[32:35], v[56:59]
s_waitcnt vmcnt(19)
ds_read_b64_tr_b16 v[200:201], v14 offset:8192
v_mfma_f32_16x16x32_bf16 v[56:59], v[212:215], a[48:51], v[56:59]
v_mfma_f32_16x16x32_bf16 v[60:63], v[208:211], a[36:39], v[60:63]
s_waitcnt vmcnt(18)
ds_read_b64_tr_b16 v[202:203], v14 offset:10240
v_mfma_f32_16x16x32_bf16 v[60:63], v[212:215], a[52:55], v[60:63]
v_mfma_f32_16x16x32_bf16 v[64:67], v[208:211], a[40:43], v[64:67]
s_waitcnt vmcnt(17)
ds_read_b64_tr_b16 v[204:205], v14 offset:12288
v_mfma_f32_16x16x32_bf16 v[64:67], v[212:215], a[56:59], v[64:67]
v_mfma_f32_16x16x32_bf16 v[68:71], v[208:211], a[44:47], v[68:71]
s_waitcnt vmcnt(16)
ds_read_b64_tr_b16 v[206:207], v14 offset:14336
v_mfma_f32_16x16x32_bf16 v[68:71], v[212:215], a[60:63], v[68:71]
s_waitcnt lgkmcnt(4)
v_mfma_f32_16x16x32_bf16 v[72:75], v[216:219], a[32:35], v[72:75]
ds_read_b64_tr_b16 v[208:209], v15 offset:8192
v_mfma_f32_16x16x32_bf16 v[72:75], v[220:223], a[48:51], v[72:75]
buffer_load_dwordx4 a[128:131], v4, s[12:15], s48 offen offset:0 sc1
v_mfma_f32_16x16x32_bf16 v[76:79], v[216:219], a[36:39], v[76:79]
ds_read_b64_tr_b16 v[210:211], v15 offset:10240
v_mfma_f32_16x16x32_bf16 v[76:79], v[220:223], a[52:55], v[76:79]
buffer_load_dwordx4 a[132:135], v5, s[12:15], s48 offen offset:0 sc1
v_mfma_f32_16x16x32_bf16 v[80:83], v[216:219], a[40:43], v[80:83]
ds_read_b64_tr_b16 v[212:213], v15 offset:12288
v_mfma_f32_16x16x32_bf16 v[80:83], v[220:223], a[56:59], v[80:83]
buffer_load_dwordx4 a[136:139], v6, s[12:15], s48 offen offset:0 sc1
v_mfma_f32_16x16x32_bf16 v[84:87], v[216:219], a[44:47], v[84:87]
ds_read_b64_tr_b16 v[214:215], v15 offset:14336
v_mfma_f32_16x16x32_bf16 v[84:87], v[220:223], a[60:63], v[84:87]
s_waitcnt lgkmcnt(4)
v_mfma_f32_16x16x32_bf16 v[88:91], v[200:203], a[32:35], v[88:91]
ds_read_b64_tr_b16 v[216:217], v12 offset:16384
v_mfma_f32_16x16x32_bf16 v[88:91], v[204:207], a[48:51], v[88:91]
buffer_load_dwordx4 a[140:143], v7, s[12:15], s48 offen offset:0 sc1
v_mfma_f32_16x16x32_bf16 v[92:95], v[200:203], a[36:39], v[92:95]
ds_read_b64_tr_b16 v[218:219], v12 offset:18432
v_mfma_f32_16x16x32_bf16 v[92:95], v[204:207], a[52:55], v[92:95]
buffer_load_dwordx4 a[144:147], v4, s[12:15], s48 offen offset:1024 sc1
v_mfma_f32_16x16x32_bf16 v[96:99], v[200:203], a[40:43], v[96:99]
ds_read_b64_tr_b16 v[220:221], v12 offset:20480
v_mfma_f32_16x16x32_bf16 v[96:99], v[204:207], a[56:59], v[96:99]
buffer_load_dwordx4 a[148:151], v5, s[12:15], s48 offen offset:1024 sc1
v_mfma_f32_16x16x32_bf16 v[100:103], v[200:203], a[44:47], v[100:103]
ds_read_b64_tr_b16 v[222:223], v12 offset:22528
v_mfma_f32_16x16x32_bf16 v[100:103], v[204:207], a[60:63], v[100:103]
s_waitcnt lgkmcnt(4)
v_mfma_f32_16x16x32_bf16 v[104:107], v[208:211], a[32:35], v[104:107]
ds_read_b64_tr_b16 v[200:201], v13 offset:16384
v_mfma_f32_16x16x32_bf16 v[104:107], v[212:215], a[48:51], v[104:107]
buffer_load_dwordx4 a[152:155], v6, s[12:15], s48 offen offset:1024 sc1
v_mfma_f32_16x16x32_bf16 v[108:111], v[208:211], a[36:39], v[108:111]
ds_read_b64_tr_b16 v[202:203], v13 offset:18432
v_mfma_f32_16x16x32_bf16 v[108:111], v[212:215], a[52:55], v[108:111]
buffer_load_dwordx4 a[156:159], v7, s[12:15], s48 offen offset:1024 sc1
v_mfma_f32_16x16x32_bf16 v[112:115], v[208:211], a[40:43], v[112:115]
ds_read_b64_tr_b16 v[204:205], v13 offset:20480
v_mfma_f32_16x16x32_bf16 v[112:115], v[212:215], a[56:59], v[112:115]
v_mfma_f32_16x16x32_bf16 v[116:119], v[208:211], a[44:47], v[116:119]
ds_read_b64_tr_b16 v[206:207], v13 offset:22528
v_mfma_f32_16x16x32_bf16 v[116:119], v[212:215], a[60:63], v[116:119]
s_waitcnt lgkmcnt(4) vmcnt(23)
v_mfma_f32_16x16x32_bf16 v[56:59], v[216:219], a[64:67], v[56:59]
s_waitcnt vmcnt(19)
ds_read_b64_tr_b16 v[208:209], v14 offset:16384
v_mfma_f32_16x16x32_bf16 v[56:59], v[220:223], a[80:83], v[56:59]
v_mfma_f32_16x16x32_bf16 v[60:63], v[216:219], a[68:71], v[60:63]
s_waitcnt vmcnt(18)
ds_read_b64_tr_b16 v[210:211], v14 offset:18432
v_mfma_f32_16x16x32_bf16 v[60:63], v[220:223], a[84:87], v[60:63]
v_mfma_f32_16x16x32_bf16 v[64:67], v[216:219], a[72:75], v[64:67]
s_waitcnt vmcnt(17)
ds_read_b64_tr_b16 v[212:213], v14 offset:20480
v_mfma_f32_16x16x32_bf16 v[64:67], v[220:223], a[88:91], v[64:67]
v_mfma_f32_16x16x32_bf16 v[68:71], v[216:219], a[76:79], v[68:71]
s_waitcnt vmcnt(16)
ds_read_b64_tr_b16 v[214:215], v14 offset:22528
v_mfma_f32_16x16x32_bf16 v[68:71], v[220:223], a[92:95], v[68:71]
s_waitcnt lgkmcnt(4)
v_mfma_f32_16x16x32_bf16 v[72:75], v[200:203], a[64:67], v[72:75]
ds_read_b64_tr_b16 v[216:217], v15 offset:16384
v_mfma_f32_16x16x32_bf16 v[72:75], v[204:207], a[80:83], v[72:75]
buffer_load_dwordx4 a[160:163], v4, s[12:15], s49 offen offset:0 sc1
v_mfma_f32_16x16x32_bf16 v[76:79], v[200:203], a[68:71], v[76:79]
ds_read_b64_tr_b16 v[218:219], v15 offset:18432
v_mfma_f32_16x16x32_bf16 v[76:79], v[204:207], a[84:87], v[76:79]
buffer_load_dwordx4 a[164:167], v5, s[12:15], s49 offen offset:0 sc1
v_mfma_f32_16x16x32_bf16 v[80:83], v[200:203], a[72:75], v[80:83]
ds_read_b64_tr_b16 v[220:221], v15 offset:20480
v_mfma_f32_16x16x32_bf16 v[80:83], v[204:207], a[88:91], v[80:83]
buffer_load_dwordx4 a[168:171], v6, s[12:15], s49 offen offset:0 sc1
v_mfma_f32_16x16x32_bf16 v[84:87], v[200:203], a[76:79], v[84:87]
ds_read_b64_tr_b16 v[222:223], v15 offset:22528
v_mfma_f32_16x16x32_bf16 v[84:87], v[204:207], a[92:95], v[84:87]
s_waitcnt lgkmcnt(4)
v_mfma_f32_16x16x32_bf16 v[88:91], v[208:211], a[64:67], v[88:91]
s_barrier
v_mfma_f32_16x16x32_bf16 v[88:91], v[212:215], a[80:83], v[88:91]
ds_read_b64_tr_b16 v[200:201], v12 offset:24576
v_mfma_f32_16x16x32_bf16 v[92:95], v[208:211], a[68:71], v[92:95]
ds_read_b64_tr_b16 v[202:203], v12 offset:26624
v_mfma_f32_16x16x32_bf16 v[92:95], v[212:215], a[84:87], v[92:95]
buffer_load_dwordx4 a[172:175], v7, s[12:15], s49 offen offset:0 sc1
v_mfma_f32_16x16x32_bf16 v[96:99], v[208:211], a[72:75], v[96:99]
ds_read_b64_tr_b16 v[204:205], v12 offset:28672
v_mfma_f32_16x16x32_bf16 v[96:99], v[212:215], a[88:91], v[96:99]
buffer_load_dwordx4 a[176:179], v4, s[12:15], s49 offen offset:1024 sc1
v_mfma_f32_16x16x32_bf16 v[100:103], v[208:211], a[76:79], v[100:103]
ds_read_b64_tr_b16 v[206:207], v12 offset:30720
v_mfma_f32_16x16x32_bf16 v[100:103], v[212:215], a[92:95], v[100:103]
s_waitcnt lgkmcnt(4)
v_mfma_f32_16x16x32_bf16 v[104:107], v[216:219], a[64:67], v[104:107]
ds_read_b64_tr_b16 v[208:209], v13 offset:24576
v_mfma_f32_16x16x32_bf16 v[104:107], v[220:223], a[80:83], v[104:107]
buffer_load_dwordx4 a[180:183], v5, s[12:15], s49 offen offset:1024 sc1
v_mfma_f32_16x16x32_bf16 v[108:111], v[216:219], a[68:71], v[108:111]
ds_read_b64_tr_b16 v[210:211], v13 offset:26624
v_mfma_f32_16x16x32_bf16 v[108:111], v[220:223], a[84:87], v[108:111]
buffer_load_dwordx4 a[184:187], v6, s[12:15], s49 offen offset:1024 sc1
v_mfma_f32_16x16x32_bf16 v[112:115], v[216:219], a[72:75], v[112:115]
ds_read_b64_tr_b16 v[212:213], v13 offset:28672
v_mfma_f32_16x16x32_bf16 v[112:115], v[220:223], a[88:91], v[112:115]
buffer_load_dwordx4 a[188:191], v7, s[12:15], s49 offen offset:1024 sc1
v_mfma_f32_16x16x32_bf16 v[116:119], v[216:219], a[76:79], v[116:119]
ds_read_b64_tr_b16 v[214:215], v13 offset:30720
v_mfma_f32_16x16x32_bf16 v[116:119], v[220:223], a[92:95], v[116:119]
s_waitcnt lgkmcnt(4) vmcnt(23)
v_mfma_f32_16x16x32_bf16 v[56:59], v[200:203], a[96:99], v[56:59]
s_waitcnt vmcnt(19)
ds_read_b64_tr_b16 v[216:217], v14 offset:24576
v_mfma_f32_16x16x32_bf16 v[56:59], v[204:207], a[112:115], v[56:59]
v_mfma_f32_16x16x32_bf16 v[60:63], v[200:203], a[100:103], v[60:63]
s_waitcnt vmcnt(18)
ds_read_b64_tr_b16 v[218:219], v14 offset:26624
v_mfma_f32_16x16x32_bf16 v[60:63], v[204:207], a[116:119], v[60:63]
v_mfma_f32_16x16x32_bf16 v[64:67], v[200:203], a[104:107], v[64:67]
s_waitcnt vmcnt(17)
ds_read_b64_tr_b16 v[220:221], v14 offset:28672
v_mfma_f32_16x16x32_bf16 v[64:67], v[204:207], a[120:123], v[64:67]
v_mfma_f32_16x16x32_bf16 v[68:71], v[200:203], a[108:111], v[68:71]
s_waitcnt vmcnt(16)
ds_read_b64_tr_b16 v[222:223], v14 offset:30720
v_mfma_f32_16x16x32_bf16 v[68:71], v[204:207], a[124:127], v[68:71]
s_waitcnt lgkmcnt(4)
v_mfma_f32_16x16x32_bf16 v[72:75], v[208:211], a[96:99], v[72:75]
ds_read_b64_tr_b16 v[200:201], v15 offset:24576
v_mfma_f32_16x16x32_bf16 v[72:75], v[212:215], a[112:115], v[72:75]
buffer_load_dwordx4 a[192:195], v4, s[12:15], s50 offen offset:0 sc1
v_mfma_f32_16x16x32_bf16 v[76:79], v[208:211], a[100:103], v[76:79]
ds_read_b64_tr_b16 v[202:203], v15 offset:26624
v_mfma_f32_16x16x32_bf16 v[76:79], v[212:215], a[116:119], v[76:79]
buffer_load_dwordx4 a[196:199], v5, s[12:15], s50 offen offset:0 sc1
v_mfma_f32_16x16x32_bf16 v[80:83], v[208:211], a[104:107], v[80:83]
ds_read_b64_tr_b16 v[204:205], v15 offset:28672
v_mfma_f32_16x16x32_bf16 v[80:83], v[212:215], a[120:123], v[80:83]
buffer_load_dwordx4 a[200:203], v6, s[12:15], s50 offen offset:0 sc1
v_mfma_f32_16x16x32_bf16 v[84:87], v[208:211], a[108:111], v[84:87]
ds_read_b64_tr_b16 v[206:207], v15 offset:30720
v_mfma_f32_16x16x32_bf16 v[84:87], v[212:215], a[124:127], v[84:87]
s_waitcnt lgkmcnt(4)
v_mfma_f32_16x16x32_bf16 v[88:91], v[216:219], a[96:99], v[88:91]
ds_read_b64_tr_b16 v[208:209], v12 offset:32768
v_mfma_f32_16x16x32_bf16 v[88:91], v[220:223], a[112:115], v[88:91]
buffer_load_dwordx4 a[204:207], v7, s[12:15], s50 offen offset:0 sc1
v_mfma_f32_16x16x32_bf16 v[92:95], v[216:219], a[100:103], v[92:95]
ds_read_b64_tr_b16 v[210:211], v12 offset:34816
v_mfma_f32_16x16x32_bf16 v[92:95], v[220:223], a[116:119], v[92:95]
buffer_load_dwordx4 a[208:211], v4, s[12:15], s50 offen offset:1024 sc1
v_mfma_f32_16x16x32_bf16 v[96:99], v[216:219], a[104:107], v[96:99]
ds_read_b64_tr_b16 v[212:213], v12 offset:36864
v_mfma_f32_16x16x32_bf16 v[96:99], v[220:223], a[120:123], v[96:99]
buffer_load_dwordx4 a[212:215], v5, s[12:15], s50 offen offset:1024 sc1
v_mfma_f32_16x16x32_bf16 v[100:103], v[216:219], a[108:111], v[100:103]
ds_read_b64_tr_b16 v[214:215], v12 offset:38912
v_mfma_f32_16x16x32_bf16 v[100:103], v[220:223], a[124:127], v[100:103]
s_waitcnt lgkmcnt(4)
v_mfma_f32_16x16x32_bf16 v[104:107], v[200:203], a[96:99], v[104:107]
ds_read_b64_tr_b16 v[216:217], v13 offset:32768
v_mfma_f32_16x16x32_bf16 v[104:107], v[204:207], a[112:115], v[104:107]
buffer_load_dwordx4 a[216:219], v6, s[12:15], s50 offen offset:1024 sc1
v_mfma_f32_16x16x32_bf16 v[108:111], v[200:203], a[100:103], v[108:111]
ds_read_b64_tr_b16 v[218:219], v13 offset:34816
v_mfma_f32_16x16x32_bf16 v[108:111], v[204:207], a[116:119], v[108:111]
buffer_load_dwordx4 a[220:223], v7, s[12:15], s50 offen offset:1024 sc1
v_mfma_f32_16x16x32_bf16 v[112:115], v[200:203], a[104:107], v[112:115]
ds_read_b64_tr_b16 v[220:221], v13 offset:36864
v_mfma_f32_16x16x32_bf16 v[112:115], v[204:207], a[120:123], v[112:115]
v_mfma_f32_16x16x32_bf16 v[116:119], v[200:203], a[108:111], v[116:119]
ds_read_b64_tr_b16 v[222:223], v13 offset:38912
v_mfma_f32_16x16x32_bf16 v[116:119], v[204:207], a[124:127], v[116:119]
s_waitcnt lgkmcnt(4) vmcnt(23)
v_mfma_f32_16x16x32_bf16 v[56:59], v[208:211], a[128:131], v[56:59]
s_waitcnt vmcnt(19)
ds_read_b64_tr_b16 v[200:201], v14 offset:32768
v_mfma_f32_16x16x32_bf16 v[56:59], v[212:215], a[144:147], v[56:59]
v_mfma_f32_16x16x32_bf16 v[60:63], v[208:211], a[132:135], v[60:63]
s_waitcnt vmcnt(18)
ds_read_b64_tr_b16 v[202:203], v14 offset:34816
v_mfma_f32_16x16x32_bf16 v[60:63], v[212:215], a[148:151], v[60:63]
v_mfma_f32_16x16x32_bf16 v[64:67], v[208:211], a[136:139], v[64:67]
s_waitcnt vmcnt(17)
ds_read_b64_tr_b16 v[204:205], v14 offset:36864
v_mfma_f32_16x16x32_bf16 v[64:67], v[212:215], a[152:155], v[64:67]
v_mfma_f32_16x16x32_bf16 v[68:71], v[208:211], a[140:143], v[68:71]
s_waitcnt vmcnt(16)
ds_read_b64_tr_b16 v[206:207], v14 offset:38912
v_mfma_f32_16x16x32_bf16 v[68:71], v[212:215], a[156:159], v[68:71]
s_waitcnt lgkmcnt(4)
v_mfma_f32_16x16x32_bf16 v[72:75], v[216:219], a[128:131], v[72:75]
ds_read_b64_tr_b16 v[208:209], v15 offset:32768
v_mfma_f32_16x16x32_bf16 v[72:75], v[220:223], a[144:147], v[72:75]
buffer_load_dwordx4 a[224:227], v4, s[12:15], s51 offen offset:0 sc1
v_mfma_f32_16x16x32_bf16 v[76:79], v[216:219], a[132:135], v[76:79]
ds_read_b64_tr_b16 v[210:211], v15 offset:34816
v_mfma_f32_16x16x32_bf16 v[76:79], v[220:223], a[148:151], v[76:79]
buffer_load_dwordx4 a[228:231], v5, s[12:15], s51 offen offset:0 sc1
v_mfma_f32_16x16x32_bf16 v[80:83], v[216:219], a[136:139], v[80:83]
ds_read_b64_tr_b16 v[212:213], v15 offset:36864
v_mfma_f32_16x16x32_bf16 v[80:83], v[220:223], a[152:155], v[80:83]
buffer_load_dwordx4 a[232:235], v6, s[12:15], s51 offen offset:0 sc1
v_mfma_f32_16x16x32_bf16 v[84:87], v[216:219], a[140:143], v[84:87]
ds_read_b64_tr_b16 v[214:215], v15 offset:38912
v_mfma_f32_16x16x32_bf16 v[84:87], v[220:223], a[156:159], v[84:87]
s_waitcnt lgkmcnt(4)
v_mfma_f32_16x16x32_bf16 v[88:91], v[200:203], a[128:131], v[88:91]
ds_read_b64_tr_b16 v[216:217], v12 offset:40960
v_mfma_f32_16x16x32_bf16 v[88:91], v[204:207], a[144:147], v[88:91]
buffer_load_dwordx4 a[236:239], v7, s[12:15], s51 offen offset:0 sc1
v_mfma_f32_16x16x32_bf16 v[92:95], v[200:203], a[132:135], v[92:95]
ds_read_b64_tr_b16 v[218:219], v12 offset:43008
v_mfma_f32_16x16x32_bf16 v[92:95], v[204:207], a[148:151], v[92:95]
buffer_load_dwordx4 a[240:243], v4, s[12:15], s51 offen offset:1024 sc1
v_mfma_f32_16x16x32_bf16 v[96:99], v[200:203], a[136:139], v[96:99]
ds_read_b64_tr_b16 v[220:221], v12 offset:45056
v_mfma_f32_16x16x32_bf16 v[96:99], v[204:207], a[152:155], v[96:99]
buffer_load_dwordx4 a[244:247], v5, s[12:15], s51 offen offset:1024 sc1
v_mfma_f32_16x16x32_bf16 v[100:103], v[200:203], a[140:143], v[100:103]
ds_read_b64_tr_b16 v[222:223], v12 offset:47104
v_mfma_f32_16x16x32_bf16 v[100:103], v[204:207], a[156:159], v[100:103]
s_waitcnt lgkmcnt(4)
v_mfma_f32_16x16x32_bf16 v[104:107], v[208:211], a[128:131], v[104:107]
ds_read_b64_tr_b16 v[200:201], v13 offset:40960
v_mfma_f32_16x16x32_bf16 v[104:107], v[212:215], a[144:147], v[104:107]
buffer_load_dwordx4 a[248:251], v6, s[12:15], s51 offen offset:1024 sc1
v_mfma_f32_16x16x32_bf16 v[108:111], v[208:211], a[132:135], v[108:111]
ds_read_b64_tr_b16 v[202:203], v13 offset:43008
v_mfma_f32_16x16x32_bf16 v[108:111], v[212:215], a[148:151], v[108:111]
buffer_load_dwordx4 a[252:255], v7, s[12:15], s51 offen offset:1024 sc1
v_mfma_f32_16x16x32_bf16 v[112:115], v[208:211], a[136:139], v[112:115]
ds_read_b64_tr_b16 v[204:205], v13 offset:45056
v_mfma_f32_16x16x32_bf16 v[112:115], v[212:215], a[152:155], v[112:115]
v_mfma_f32_16x16x32_bf16 v[116:119], v[208:211], a[140:143], v[116:119]
ds_read_b64_tr_b16 v[206:207], v13 offset:47104
v_mfma_f32_16x16x32_bf16 v[116:119], v[212:215], a[156:159], v[116:119]
s_waitcnt lgkmcnt(4) vmcnt(23)
v_mfma_f32_16x16x32_bf16 v[56:59], v[216:219], a[160:163], v[56:59]
s_waitcnt vmcnt(19)
ds_read_b64_tr_b16 v[208:209], v14 offset:40960
v_mfma_f32_16x16x32_bf16 v[56:59], v[220:223], a[176:179], v[56:59]
v_mfma_f32_16x16x32_bf16 v[60:63], v[216:219], a[164:167], v[60:63]
s_waitcnt vmcnt(18)
ds_read_b64_tr_b16 v[210:211], v14 offset:43008
v_mfma_f32_16x16x32_bf16 v[60:63], v[220:223], a[180:183], v[60:63]
v_mfma_f32_16x16x32_bf16 v[64:67], v[216:219], a[168:171], v[64:67]
s_waitcnt vmcnt(17)
ds_read_b64_tr_b16 v[212:213], v14 offset:45056
v_mfma_f32_16x16x32_bf16 v[64:67], v[220:223], a[184:187], v[64:67]
v_mfma_f32_16x16x32_bf16 v[68:71], v[216:219], a[172:175], v[68:71]
s_waitcnt vmcnt(16)
ds_read_b64_tr_b16 v[214:215], v14 offset:47104
v_mfma_f32_16x16x32_bf16 v[68:71], v[220:223], a[188:191], v[68:71]
s_waitcnt lgkmcnt(4)
v_mfma_f32_16x16x32_bf16 v[72:75], v[200:203], a[160:163], v[72:75]
ds_read_b64_tr_b16 v[216:217], v15 offset:40960
v_mfma_f32_16x16x32_bf16 v[72:75], v[204:207], a[176:179], v[72:75]
buffer_load_dwordx4 v[224:227], v4, s[12:15], s32 offen offset:0 sc1
v_mfma_f32_16x16x32_bf16 v[76:79], v[200:203], a[164:167], v[76:79]
ds_read_b64_tr_b16 v[218:219], v15 offset:43008
v_mfma_f32_16x16x32_bf16 v[76:79], v[204:207], a[180:183], v[76:79]
buffer_load_dwordx4 v[228:231], v5, s[12:15], s32 offen offset:0 sc1
v_mfma_f32_16x16x32_bf16 v[80:83], v[200:203], a[168:171], v[80:83]
ds_read_b64_tr_b16 v[220:221], v15 offset:45056
v_mfma_f32_16x16x32_bf16 v[80:83], v[204:207], a[184:187], v[80:83]
buffer_load_dwordx4 v[232:235], v6, s[12:15], s32 offen offset:0 sc1
v_mfma_f32_16x16x32_bf16 v[84:87], v[200:203], a[172:175], v[84:87]
ds_read_b64_tr_b16 v[222:223], v15 offset:47104
v_mfma_f32_16x16x32_bf16 v[84:87], v[204:207], a[188:191], v[84:87]
s_waitcnt lgkmcnt(4)
v_mfma_f32_16x16x32_bf16 v[88:91], v[208:211], a[160:163], v[88:91]
s_barrier
v_mfma_f32_16x16x32_bf16 v[88:91], v[212:215], a[176:179], v[88:91]
ds_read_b64_tr_b16 v[200:201], v16 offset:0
v_mfma_f32_16x16x32_bf16 v[92:95], v[208:211], a[164:167], v[92:95]
ds_read_b64_tr_b16 v[202:203], v16 offset:2048
v_mfma_f32_16x16x32_bf16 v[92:95], v[212:215], a[180:183], v[92:95]
buffer_load_dwordx4 v[236:239], v7, s[12:15], s32 offen offset:0 sc1
v_mfma_f32_16x16x32_bf16 v[96:99], v[208:211], a[168:171], v[96:99]
ds_read_b64_tr_b16 v[204:205], v16 offset:4096
v_mfma_f32_16x16x32_bf16 v[96:99], v[212:215], a[184:187], v[96:99]
buffer_load_dwordx4 v[240:243], v4, s[12:15], s32 offen offset:1024 sc1
v_mfma_f32_16x16x32_bf16 v[100:103], v[208:211], a[172:175], v[100:103]
ds_read_b64_tr_b16 v[206:207], v16 offset:6144
v_mfma_f32_16x16x32_bf16 v[100:103], v[212:215], a[188:191], v[100:103]
s_waitcnt lgkmcnt(4)
v_mfma_f32_16x16x32_bf16 v[104:107], v[216:219], a[160:163], v[104:107]
ds_read_b64_tr_b16 v[208:209], v17 offset:0
v_mfma_f32_16x16x32_bf16 v[104:107], v[220:223], a[176:179], v[104:107]
buffer_load_dwordx4 v[244:247], v5, s[12:15], s32 offen offset:1024 sc1
v_mfma_f32_16x16x32_bf16 v[108:111], v[216:219], a[164:167], v[108:111]
ds_read_b64_tr_b16 v[210:211], v17 offset:2048
v_mfma_f32_16x16x32_bf16 v[108:111], v[220:223], a[180:183], v[108:111]
buffer_load_dwordx4 v[248:251], v6, s[12:15], s32 offen offset:1024 sc1
v_mfma_f32_16x16x32_bf16 v[112:115], v[216:219], a[168:171], v[112:115]
ds_read_b64_tr_b16 v[212:213], v17 offset:4096
v_mfma_f32_16x16x32_bf16 v[112:115], v[220:223], a[184:187], v[112:115]
buffer_load_dwordx4 v[252:255], v7, s[12:15], s32 offen offset:1024 sc1
v_mfma_f32_16x16x32_bf16 v[116:119], v[216:219], a[172:175], v[116:119]
ds_read_b64_tr_b16 v[214:215], v17 offset:6144
v_mfma_f32_16x16x32_bf16 v[116:119], v[220:223], a[188:191], v[116:119]
s_waitcnt lgkmcnt(4) vmcnt(23)
v_mfma_f32_16x16x32_bf16 v[56:59], v[200:203], a[192:195], v[56:59]
s_waitcnt vmcnt(19)
ds_read_b64_tr_b16 v[216:217], v18 offset:0
v_mfma_f32_16x16x32_bf16 v[56:59], v[204:207], a[208:211], v[56:59]
s_add_u32 m0, s17, 73728
s_add_u32 s21, s33, 0
v_mfma_f32_16x16x32_bf16 v[60:63], v[200:203], a[196:199], v[60:63]
s_waitcnt vmcnt(18)
ds_read_b64_tr_b16 v[218:219], v18 offset:2048
v_mfma_f32_16x16x32_bf16 v[60:63], v[204:207], a[212:215], v[60:63]
v_mfma_f32_16x16x32_bf16 v[64:67], v[200:203], a[200:203], v[64:67]
s_waitcnt vmcnt(17)
ds_read_b64_tr_b16 v[220:221], v18 offset:4096
v_mfma_f32_16x16x32_bf16 v[64:67], v[204:207], a[216:219], v[64:67]
v_mfma_f32_16x16x32_bf16 v[68:71], v[200:203], a[204:207], v[68:71]
s_waitcnt vmcnt(16)
ds_read_b64_tr_b16 v[222:223], v18 offset:6144
v_mfma_f32_16x16x32_bf16 v[68:71], v[204:207], a[220:223], v[68:71]
s_waitcnt lgkmcnt(4)
v_mfma_f32_16x16x32_bf16 v[72:75], v[208:211], a[192:195], v[72:75]
ds_read_b64_tr_b16 v[200:201], v19 offset:0
v_mfma_f32_16x16x32_bf16 v[72:75], v[212:215], a[208:211], v[72:75]
buffer_load_dwordx4 v2, s[24:27], s21 offen lds
v_mfma_f32_16x16x32_bf16 v[76:79], v[208:211], a[196:199], v[76:79]
s_add_u32 m0, s17, 77824
ds_read_b64_tr_b16 v[202:203], v19 offset:2048
v_mfma_f32_16x16x32_bf16 v[76:79], v[212:215], a[212:215], v[76:79]
s_add_u32 s21, s33, 294912
v_mfma_f32_16x16x32_bf16 v[80:83], v[208:211], a[200:203], v[80:83]
ds_read_b64_tr_b16 v[204:205], v19 offset:4096
v_mfma_f32_16x16x32_bf16 v[80:83], v[212:215], a[216:219], v[80:83]
buffer_load_dwordx4 v2, s[24:27], s21 offen lds
v_mfma_f32_16x16x32_bf16 v[84:87], v[208:211], a[204:207], v[84:87]
s_add_u32 m0, s17, 81920
ds_read_b64_tr_b16 v[206:207], v19 offset:6144
v_mfma_f32_16x16x32_bf16 v[84:87], v[212:215], a[220:223], v[84:87]
s_waitcnt lgkmcnt(4)
s_add_u32 s21, s34, 0
s_mul_i32 s22, s19, 6144
v_mfma_f32_16x16x32_bf16 v[88:91], v[216:219], a[192:195], v[88:91]
s_add_u32 s40, s40, s22
ds_read_b64_tr_b16 v[208:209], v16 offset:8192
v_mfma_f32_16x16x32_bf16 v[88:91], v[220:223], a[208:211], v[88:91]
buffer_load_dwordx4 v2, s[24:27], s21 offen lds
v_mfma_f32_16x16x32_bf16 v[92:95], v[216:219], a[196:199], v[92:95]
s_add_u32 m0, s17, 86016
ds_read_b64_tr_b16 v[210:211], v16 offset:10240
v_mfma_f32_16x16x32_bf16 v[92:95], v[220:223], a[212:215], v[92:95]
s_add_u32 s21, s34, 294912
s_add_u32 s41, s40, 4096
s_lshr_b32 s22, s2, 3
v_mfma_f32_16x16x32_bf16 v[96:99], v[216:219], a[200:203], v[96:99]
s_sub_u32 s22, s22, 8
ds_read_b64_tr_b16 v[212:213], v16 offset:12288
v_mfma_f32_16x16x32_bf16 v[96:99], v[220:223], a[216:219], v[96:99]
buffer_load_dwordx4 v2, s[24:27], s21 offen lds
v_mfma_f32_16x16x32_bf16 v[100:103], v[216:219], a[204:207], v[100:103]
s_add_u32 m0, s17, 90112
ds_read_b64_tr_b16 v[214:215], v16 offset:14336
v_mfma_f32_16x16x32_bf16 v[100:103], v[220:223], a[220:223], v[100:103]
s_waitcnt lgkmcnt(4)
s_add_u32 s21, s35, 0
s_mul_i32 s44, s22, 171
v_mfma_f32_16x16x32_bf16 v[104:107], v[200:203], a[192:195], v[104:107]
s_lshr_b32 s44, s44, 9
ds_read_b64_tr_b16 v[216:217], v16 offset:16384
v_mfma_f32_16x16x32_bf16 v[104:107], v[204:207], a[208:211], v[104:107]
buffer_load_dwordx4 v2, s[24:27], s21 offen lds
v_mfma_f32_16x16x32_bf16 v[108:111], v[200:203], a[196:199], v[108:111]
s_add_u32 m0, s17, 94208
ds_read_b64_tr_b16 v[218:219], v16 offset:18432
v_mfma_f32_16x16x32_bf16 v[108:111], v[204:207], a[212:215], v[108:111]
s_add_u32 s21, s35, 294912
s_mul_i32 s45, s44, 3
s_sub_u32 s45, s22, s45
v_mfma_f32_16x16x32_bf16 v[112:115], v[200:203], a[200:203], v[112:115]
s_and_b32 s22, s2, 1
ds_read_b64_tr_b16 v[220:221], v16 offset:20480
v_mfma_f32_16x16x32_bf16 v[112:115], v[204:207], a[216:219], v[112:115]
buffer_load_dwordx4 v2, s[24:27], s21 offen lds
v_mfma_f32_16x16x32_bf16 v[116:119], v[200:203], a[204:207], v[116:119]
s_lshl_b32 s22, s22, 3
ds_read_b64_tr_b16 v[222:223], v16 offset:22528
v_mfma_f32_16x16x32_bf16 v[116:119], v[204:207], a[220:223], v[116:119]
s_waitcnt lgkmcnt(4) vmcnt(21)
s_add_u32 s44, s44, s22
s_bfe_u32 s46, s2, 0x20001
v_mfma_f32_16x16x32_bf16 v[56:59], v[208:211], a[224:227], v[56:59]
s_waitcnt vmcnt(17)
ds_read_b64_tr_b16 v[200:201], v17 offset:8192
v_mfma_f32_16x16x32_bf16 v[56:59], v[212:215], a[240:243], v[56:59]
v_lshrrev_b32 v42, 3, v1
v_and_b32 v3, 6, v42
v_mfma_f32_16x16x32_bf16 v[60:63], v[208:211], a[228:231], v[60:63]
s_waitcnt vmcnt(16)
ds_read_b64_tr_b16 v[202:203], v17 offset:10240
v_mfma_f32_16x16x32_bf16 v[60:63], v[212:215], a[244:247], v[60:63]
v_and_b32 v43, 7, v1
v_xor_b32 v3, v3, v43
v_mfma_f32_16x16x32_bf16 v[64:67], v[208:211], a[232:235], v[64:67]
s_waitcnt vmcnt(15)
ds_read_b64_tr_b16 v[204:205], v17 offset:12288
v_mfma_f32_16x16x32_bf16 v[64:67], v[212:215], a[248:251], v[64:67]
s_add_u32 m0, s17, 98304
v_lshlrev_b32 v3, 4, v3
v_mfma_f32_16x16x32_bf16 v[68:71], v[208:211], a[236:239], v[68:71]
s_waitcnt vmcnt(14)
ds_read_b64_tr_b16 v[206:207], v17 offset:14336
v_mfma_f32_16x16x32_bf16 v[68:71], v[212:215], a[252:255], v[68:71]
s_waitcnt lgkmcnt(4) vmcnt(13)
s_add_u32 s21, s36, 0
s_mov_b32 s78, s46
v_mfma_f32_16x16x32_bf16 v[56:59], v[216:219], v[224:227], v[56:59]
s_waitcnt vmcnt(9)
ds_read_b64_tr_b16 v[208:209], v17 offset:16384
v_mfma_f32_16x16x32_bf16 v[56:59], v[220:223], v[240:243], v[56:59]
s_xor_b32 s49, s46, 3
s_lshl_b32 s47, s49, 5
v_mfma_f32_16x16x32_bf16 v[60:63], v[216:219], v[228:231], v[60:63]
s_waitcnt vmcnt(8)
ds_read_b64_tr_b16 v[210:211], v17 offset:18432
v_mfma_f32_16x16x32_bf16 v[60:63], v[220:223], v[244:247], v[60:63]
s_and_b32 s47, s47, 64
v_xor_b32 v3, s47, v3
v_mfma_f32_16x16x32_bf16 v[64:67], v[216:219], v[232:235], v[64:67]
s_waitcnt vmcnt(7)
ds_read_b64_tr_b16 v[212:213], v17 offset:20480
v_mfma_f32_16x16x32_bf16 v[64:67], v[220:223], v[248:251], v[64:67]
s_lshl_b32 s47, s16, 3
v_add_u32 v42, s47, v42
v_mfma_f32_16x16x32_bf16 v[68:71], v[216:219], v[236:239], v[68:71]
s_waitcnt vmcnt(6)
ds_read_b64_tr_b16 v[214:215], v17 offset:22528
v_mfma_f32_16x16x32_bf16 v[68:71], v[220:223], v[252:255], v[68:71]
s_waitcnt lgkmcnt(4)
v_mul_u32_u24 v42, 1152, v42
v_add_u32 v3, v3, v42
v_mfma_f32_16x16x32_bf16 v[72:75], v[200:203], a[224:227], v[72:75]
ds_read_b64_tr_b16 v[216:217], v18 offset:8192
v_lshlrev_b32 v8, 4, v1
v_mfma_f32_16x16x32_bf16 v[72:75], v[204:207], a[240:243], v[72:75]
buffer_load_dwordx4 v2, s[24:27], s21 offen lds
v_mfma_f32_16x16x32_bf16 v[76:79], v[200:203], a[228:231], v[76:79]
ds_read_b64_tr_b16 v[218:219], v18 offset:10240
v_add_u32 v9, 165888, v8
v_mfma_f32_16x16x32_bf16 v[76:79], v[204:207], a[244:247], v[76:79]
s_add_u32 m0, s17, 102400
v_exp_f32 v32, -v56
v_mfma_f32_16x16x32_bf16 v[80:83], v[200:203], a[232:235], v[80:83]
s_add_u32 s21, s36, 294912
ds_read_b64_tr_b16 v[220:221], v18 offset:12288
v_mfma_f32_16x16x32_bf16 v[80:83], v[204:207], a[248:251], v[80:83]
buffer_load_dwordx4 v2, s[24:27], s21 offen lds
v_mfma_f32_16x16x32_bf16 v[84:87], v[200:203], a[236:239], v[84:87]
s_add_u32 m0, s17, 106496
ds_read_b64_tr_b16 v[222:223], v18 offset:14336
v_mfma_f32_16x16x32_bf16 v[84:87], v[204:207], a[252:255], v[84:87]
s_waitcnt lgkmcnt(4)
v_exp_f32 v33, -v57
v_mfma_f32_16x16x32_bf16 v[72:75], v[208:211], v[224:227], v[72:75]
ds_read_b64_tr_b16 v[200:201], v18 offset:16384
v_add_f32 v32, 1.0, v32
v_mfma_f32_16x16x32_bf16 v[72:75], v[212:215], v[240:243], v[72:75]
s_add_u32 s21, s38, 0
v_exp_f32 v34, -v58
v_mfma_f32_16x16x32_bf16 v[76:79], v[208:211], v[228:231], v[76:79]
ds_read_b64_tr_b16 v[202:203], v18 offset:18432
v_add_f32 v33, 1.0, v33
v_mfma_f32_16x16x32_bf16 v[76:79], v[212:215], v[244:247], v[76:79]
buffer_load_dwordx4 v2, s[24:27], s21 offen lds
v_mfma_f32_16x16x32_bf16 v[80:83], v[208:211], v[232:235], v[80:83]
s_add_u32 m0, s17, 110592
ds_read_b64_tr_b16 v[204:205], v18 offset:20480
v_mfma_f32_16x16x32_bf16 v[80:83], v[212:215], v[248:251], v[80:83]
s_add_u32 s21, s38, 294912
v_rcp_f32 v32, v32
v_mfma_f32_16x16x32_bf16 v[84:87], v[208:211], v[236:239], v[84:87]
s_and_b32 s47, s49, 1
ds_read_b64_tr_b16 v[206:207], v18 offset:22528
v_mfma_f32_16x16x32_bf16 v[84:87], v[212:215], v[252:255], v[84:87]
s_waitcnt lgkmcnt(4)
v_exp_f32 v35, -v59
v_mfma_f32_16x16x32_bf16 v[88:91], v[216:219], a[224:227], v[88:91]
ds_read_b64_tr_b16 v[208:209], v19 offset:8192
v_add_f32 v34, 1.0, v34
v_mfma_f32_16x16x32_bf16 v[88:91], v[220:223], a[240:243], v[88:91]
buffer_load_dwordx4 v2, s[24:27], s21 offen lds
v_mfma_f32_16x16x32_bf16 v[92:95], v[216:219], a[228:231], v[92:95]
s_add_u32 m0, s17, 114688
ds_read_b64_tr_b16 v[210:211], v19 offset:10240
v_mfma_f32_16x16x32_bf16 v[92:95], v[220:223], a[244:247], v[92:95]
s_add_u32 s21, s39, 0
v_rcp_f32 v33, v33
v_mfma_f32_16x16x32_bf16 v[96:99], v[216:219], a[232:235], v[96:99]
ds_read_b64_tr_b16 v[212:213], v19 offset:12288
v_mul_f32 v56, v56, v32
v_mfma_f32_16x16x32_bf16 v[96:99], v[220:223], a[248:251], v[96:99]
buffer_load_dwordx4 v2, s[24:27], s21 offen lds
v_mfma_f32_16x16x32_bf16 v[100:103], v[216:219], a[236:239], v[100:103]
s_add_u32 m0, s17, 118784
ds_read_b64_tr_b16 v[214:215], v19 offset:14336
v_mfma_f32_16x16x32_bf16 v[100:103], v[220:223], a[252:255], v[100:103]
s_waitcnt lgkmcnt(4)
v_exp_f32 v36, -v60
v_mfma_f32_16x16x32_bf16 v[88:91], v[200:203], v[224:227], v[88:91]
ds_read_b64_tr_b16 v[216:217], v19 offset:16384
v_add_f32 v35, 1.0, v35
v_mfma_f32_16x16x32_bf16 v[88:91], v[204:207], v[240:243], v[88:91]
s_add_u32 s21, s39, 294912
v_rcp_f32 v34, v34
v_mfma_f32_16x16x32_bf16 v[92:95], v[200:203], v[228:231], v[92:95]
ds_read_b64_tr_b16 v[218:219], v19 offset:18432
v_mul_f32 v57, v57, v33
v_mfma_f32_16x16x32_bf16 v[92:95], v[204:207], v[244:247], v[92:95]
buffer_load_dwordx4 v2, s[24:27], s21 offen lds
v_mfma_f32_16x16x32_bf16 v[96:99], v[200:203], v[232:235], v[96:99]
s_add_u32 m0, s17, 122880
ds_read_b64_tr_b16 v[220:221], v19 offset:20480
v_mfma_f32_16x16x32_bf16 v[96:99], v[204:207], v[248:251], v[96:99]
s_add_u32 s21, s42, 0
v_exp_f32 v37, -v61
v_mfma_f32_16x16x32_bf16 v[100:103], v[200:203], v[236:239], v[100:103]
ds_read_b64_tr_b16 v[222:223], v19 offset:22528
v_add_f32 v36, 1.0, v36
v_mfma_f32_16x16x32_bf16 v[100:103], v[204:207], v[252:255], v[100:103]
s_waitcnt lgkmcnt(4)
v_rcp_f32 v35, v35
v_mfma_f32_16x16x32_bf16 v[104:107], v[208:211], a[224:227], v[104:107]
s_waitcnt vmcnt(6)
s_barrier
v_mul_f32 v58, v58, v34
v_mfma_f32_16x16x32_bf16 v[104:107], v[212:215], a[240:243], v[104:107]
s_mul_i32 s47, s47, 165888
ds_read_b64_tr_b16 v[200:201], v16 offset:24576
v_mfma_f32_16x16x32_bf16 v[108:111], v[208:211], a[228:231], v[108:111]
ds_read_b64_tr_b16 v[202:203], v16 offset:26624
v_add_u32 v45, s47, v8
v_mfma_f32_16x16x32_bf16 v[108:111], v[212:215], a[244:247], v[108:111]
buffer_load_dwordx4 v2, s[24:27], s21 offen lds
v_mfma_f32_16x16x32_bf16 v[112:115], v[208:211], a[232:235], v[112:115]
ds_read_b64_tr_b16 v[204:205], v16 offset:28672
v_subrev_u32 v46, s47, v9
v_mfma_f32_16x16x32_bf16 v[112:115], v[212:215], a[248:251], v[112:115]
s_add_u32 m0, s17, 126976
v_exp_f32 v38, -v62
v_mfma_f32_16x16x32_bf16 v[116:119], v[208:211], a[236:239], v[116:119]
ds_read_b64_tr_b16 v[206:207], v16 offset:30720
v_add_f32 v37, 1.0, v37
v_mfma_f32_16x16x32_bf16 v[116:119], v[212:215], a[252:255], v[116:119]
s_waitcnt lgkmcnt(4)
v_rcp_f32 v36, v36
v_mfma_f32_16x16x32_bf16 v[104:107], v[216:219], v[224:227], v[104:107]
ds_read_b64_tr_b16 v[208:209], v17 offset:24576
v_mul_f32 v59, v59, v35
v_mfma_f32_16x16x32_bf16 v[104:107], v[220:223], v[240:243], v[104:107]
s_add_u32 s21, s42, 294912
v_exp_f32 v39, -v63
v_mfma_f32_16x16x32_bf16 v[108:111], v[216:219], v[228:231], v[108:111]
ds_read_b64_tr_b16 v[210:211], v17 offset:26624
v_add_f32 v38, 1.0, v38
v_mfma_f32_16x16x32_bf16 v[108:111], v[220:223], v[244:247], v[108:111]
buffer_load_dwordx4 v2, s[24:27], s21 offen lds
v_mfma_f32_16x16x32_bf16 v[112:115], v[216:219], v[232:235], v[112:115]
s_add_u32 m0, s17, 131072
ds_read_b64_tr_b16 v[212:213], v17 offset:28672
v_mfma_f32_16x16x32_bf16 v[112:115], v[220:223], v[248:251], v[112:115]
s_add_u32 s21, s43, 0
v_rcp_f32 v37, v37
v_mfma_f32_16x16x32_bf16 v[116:119], v[216:219], v[236:239], v[116:119]
ds_read_b64_tr_b16 v[214:215], v17 offset:30720
v_mul_f32 v60, v60, v36
v_mfma_f32_16x16x32_bf16 v[116:119], v[220:223], v[252:255], v[116:119]
s_waitcnt lgkmcnt(4)
v_exp_f32 v32, -v64
v_mfma_f32_16x16x32_bf16 v[120:123], v[200:203], a[0:3], 0
ds_read_b64_tr_b16 v[216:217], v18 offset:24576
v_add_f32 v39, 1.0, v39
v_mfma_f32_16x16x32_bf16 v[120:123], v[204:207], a[16:19], v[120:123]
buffer_load_dwordx4 v2, s[24:27], s21 offen lds
v_mfma_f32_16x16x32_bf16 v[124:127], v[200:203], a[4:7], 0
s_add_u32 m0, s17, 135168
ds_read_b64_tr_b16 v[218:219], v18 offset:26624
v_mfma_f32_16x16x32_bf16 v[124:127], v[204:207], a[20:23], v[124:127]
s_add_u32 s21, s43, 294912
v_rcp_f32 v38, v38
v_mfma_f32_16x16x32_bf16 v[128:131], v[200:203], a[8:11], 0
ds_read_b64_tr_b16 v[220:221], v18 offset:28672
v_mul_f32 v61, v61, v37
v_mfma_f32_16x16x32_bf16 v[128:131], v[204:207], a[24:27], v[128:131]
buffer_load_dwordx4 v2, s[24:27], s21 offen lds
v_mfma_f32_16x16x32_bf16 v[132:135], v[200:203], a[12:15], 0
s_add_u32 m0, s17, 139264
ds_read_b64_tr_b16 v[222:223], v18 offset:30720
v_mfma_f32_16x16x32_bf16 v[132:135], v[204:207], a[28:31], v[132:135]
s_waitcnt lgkmcnt(4)
v_exp_f32 v33, -v65
v_mfma_f32_16x16x32_bf16 v[136:139], v[208:211], a[0:3], 0
ds_read_b64_tr_b16 v[200:201], v19 offset:24576
v_add_f32 v32, 1.0, v32
v_mfma_f32_16x16x32_bf16 v[136:139], v[212:215], a[16:19], v[136:139]
s_add_u32 s21, s0, 0
v_rcp_f32 v39, v39
v_mfma_f32_16x16x32_bf16 v[140:143], v[208:211], a[4:7], 0
ds_read_b64_tr_b16 v[202:203], v19 offset:26624
v_mul_f32 v62, v62, v38
v_mfma_f32_16x16x32_bf16 v[140:143], v[212:215], a[20:23], v[140:143]
buffer_load_dwordx4 v2, s[24:27], s21 offen lds
v_mfma_f32_16x16x32_bf16 v[144:147], v[208:211], a[8:11], 0
s_add_u32 m0, s17, 143360
s_add_u32 s21, s0, 294912
buffer_load_dwordx4 v2, s[24:27], s21 offen lds
v_mfma_f32_16x16x32_bf16 v[144:147], v[212:215], a[24:27], v[144:147]
s_add_u32 m0, s17, 0
ds_read_b64_tr_b16 v[204:205], v19 offset:28672
v_mfma_f32_16x16x32_bf16 v[148:151], v[208:211], a[12:15], 0
s_add_u32 s21, s33, 128
ds_read_b64_tr_b16 v[206:207], v19 offset:30720
v_mfma_f32_16x16x32_bf16 v[148:151], v[212:215], a[28:31], v[148:151]
s_waitcnt lgkmcnt(4)
v_exp_f32 v34, -v66
v_mfma_f32_16x16x32_bf16 v[152:155], v[216:219], a[0:3], 0
ds_read_b64_tr_b16 v[208:209], v16 offset:32768
v_add_f32 v33, 1.0, v33
v_mfma_f32_16x16x32_bf16 v[152:155], v[220:223], a[16:19], v[152:155]
buffer_load_dwordx4 v2, s[8:11], s21 offen lds
v_mfma_f32_16x16x32_bf16 v[156:159], v[216:219], a[4:7], 0
s_add_u32 m0, s17, 4096
ds_read_b64_tr_b16 v[210:211], v16 offset:34816
v_mfma_f32_16x16x32_bf16 v[156:159], v[220:223], a[20:23], v[156:159]
s_add_u32 s21, s33, 295040
v_rcp_f32 v32, v32
v_mfma_f32_16x16x32_bf16 v[160:163], v[216:219], a[8:11], 0
ds_read_b64_tr_b16 v[212:213], v16 offset:36864
v_mul_f32 v63, v63, v39
v_mfma_f32_16x16x32_bf16 v[160:163], v[220:223], a[24:27], v[160:163]
buffer_load_dwordx4 v2, s[8:11], s21 offen lds
v_mfma_f32_16x16x32_bf16 v[164:167], v[216:219], a[12:15], 0
s_add_u32 m0, s17, 8192
ds_read_b64_tr_b16 v[214:215], v16 offset:38912
v_mfma_f32_16x16x32_bf16 v[164:167], v[220:223], a[28:31], v[164:167]
s_waitcnt lgkmcnt(4)
v_exp_f32 v35, -v67
v_mfma_f32_16x16x32_bf16 v[168:171], v[200:203], a[0:3], 0
ds_read_b64_tr_b16 v[216:217], v17 offset:32768
v_add_f32 v34, 1.0, v34
v_mfma_f32_16x16x32_bf16 v[168:171], v[204:207], a[16:19], v[168:171]
s_add_u32 s21, s34, 128
v_rcp_f32 v33, v33
v_mfma_f32_16x16x32_bf16 v[172:175], v[200:203], a[4:7], 0
ds_read_b64_tr_b16 v[218:219], v17 offset:34816
v_mul_f32 v64, v64, v32
v_mfma_f32_16x16x32_bf16 v[172:175], v[204:207], a[20:23], v[172:175]
buffer_load_dwordx4 v2, s[8:11], s21 offen lds
v_mfma_f32_16x16x32_bf16 v[176:179], v[200:203], a[8:11], 0
s_mul_i32 s62, s45, 384
ds_read_b64_tr_b16 v[220:221], v17 offset:36864
v_mfma_f32_16x16x32_bf16 v[176:179], v[204:207], a[24:27], v[176:179]
s_mul_i32 s54, s44, 3
v_exp_f32 v36, -v68
v_mfma_f32_16x16x32_bf16 v[180:183], v[200:203], a[12:15], 0
ds_read_b64_tr_b16 v[222:223], v17 offset:38912
v_add_f32 v35, 1.0, v35
v_mfma_f32_16x16x32_bf16 v[180:183], v[204:207], a[28:31], v[180:183]
s_waitcnt lgkmcnt(4)
v_rcp_f32 v34, v34
v_mfma_f32_16x16x32_bf16 v[120:123], v[208:211], a[32:35], v[120:123]
ds_read_b64_tr_b16 v[200:201], v18 offset:32768
v_mul_f32 v65, v65, v33
v_mfma_f32_16x16x32_bf16 v[120:123], v[212:215], a[48:51], v[120:123]
s_add_u32 m0, s17, 12288
v_exp_f32 v37, -v69
v_mfma_f32_16x16x32_bf16 v[124:127], v[208:211], a[36:39], v[124:127]
ds_read_b64_tr_b16 v[202:203], v18 offset:34816
v_add_f32 v36, 1.0, v36
v_mfma_f32_16x16x32_bf16 v[124:127], v[212:215], a[52:55], v[124:127]
s_add_u32 s21, s34, 295040
v_rcp_f32 v35, v35
v_mfma_f32_16x16x32_bf16 v[128:131], v[208:211], a[40:43], v[128:131]
ds_read_b64_tr_b16 v[204:205], v18 offset:36864
v_mul_f32 v66, v66, v34
v_mfma_f32_16x16x32_bf16 v[128:131], v[212:215], a[56:59], v[128:131]
s_add_u32 s54, s54, s45
v_exp_f32 v38, -v70
v_mfma_f32_16x16x32_bf16 v[132:135], v[208:211], a[44:47], v[132:135]
ds_read_b64_tr_b16 v[206:207], v18 offset:38912
v_add_f32 v37, 1.0, v37
v_mfma_f32_16x16x32_bf16 v[132:135], v[212:215], a[60:63], v[132:135]
s_waitcnt lgkmcnt(4)
v_rcp_f32 v36, v36
v_mfma_f32_16x16x32_bf16 v[136:139], v[216:219], a[32:35], v[136:139]
ds_read_b64_tr_b16 v[208:209], v19 offset:32768
v_mul_f32 v67, v67, v35
v_mfma_f32_16x16x32_bf16 v[136:139], v[220:223], a[48:51], v[136:139]
buffer_load_dwordx4 v2, s[8:11], s21 offen lds
v_mfma_f32_16x16x32_bf16 v[140:143], v[216:219], a[36:39], v[140:143]
s_add_u32 m0, s17, 16384
ds_read_b64_tr_b16 v[210:211], v19 offset:34816
v_mfma_f32_16x16x32_bf16 v[140:143], v[220:223], a[52:55], v[140:143]
s_lshl_b32 s54, s54, 2
v_exp_f32 v39, -v71
v_mfma_f32_16x16x32_bf16 v[144:147], v[216:219], a[40:43], v[144:147]
ds_read_b64_tr_b16 v[212:213], v19 offset:36864
v_add_f32 v38, 1.0, v38
v_mfma_f32_16x16x32_bf16 v[144:147], v[220:223], a[56:59], v[144:147]
s_add_u32 s21, s35, 128
v_rcp_f32 v37, v37
v_mfma_f32_16x16x32_bf16 v[148:151], v[216:219], a[44:47], v[148:151]
ds_read_b64_tr_b16 v[214:215], v19 offset:38912
v_mul_f32 v68, v68, v36
v_mfma_f32_16x16x32_bf16 v[148:151], v[220:223], a[60:63], v[148:151]
s_waitcnt lgkmcnt(4)
v_exp_f32 v32, -v72
v_mfma_f32_16x16x32_bf16 v[152:155], v[200:203], a[32:35], v[152:155]
ds_read_b64_tr_b16 v[216:217], v16 offset:40960
v_add_f32 v39, 1.0, v39
v_mfma_f32_16x16x32_bf16 v[152:155], v[204:207], a[48:51], v[152:155]
buffer_load_dwordx4 v2, s[8:11], s21 offen lds
v_mfma_f32_16x16x32_bf16 v[156:159], v[200:203], a[36:39], v[156:159]
s_add_u32 s54, s54, s16
ds_read_b64_tr_b16 v[218:219], v16 offset:43008
v_mfma_f32_16x16x32_bf16 v[156:159], v[204:207], a[52:55], v[156:159]
s_lshl_b32 s54, s54, 14
v_rcp_f32 v38, v38
v_mfma_f32_16x16x32_bf16 v[160:163], v[200:203], a[40:43], v[160:163]
ds_read_b64_tr_b16 v[220:221], v16 offset:45056
v_mul_f32 v69, v69, v37
v_mfma_f32_16x16x32_bf16 v[160:163], v[204:207], a[56:59], v[160:163]
s_add_u32 m0, s17, 20480
v_exp_f32 v33, -v73
v_mfma_f32_16x16x32_bf16 v[164:167], v[200:203], a[44:47], v[164:167]
ds_read_b64_tr_b16 v[222:223], v16 offset:47104
v_add_f32 v32, 1.0, v32
v_mfma_f32_16x16x32_bf16 v[164:167], v[204:207], a[60:63], v[164:167]
s_waitcnt lgkmcnt(4)
v_rcp_f32 v39, v39
v_mfma_f32_16x16x32_bf16 v[168:171], v[208:211], a[32:35], v[168:171]
ds_read_b64_tr_b16 v[200:201], v17 offset:40960
v_mul_f32 v70, v70, v38
v_mfma_f32_16x16x32_bf16 v[168:171], v[212:215], a[48:51], v[168:171]
s_add_u32 s21, s35, 295040
v_exp_f32 v34, -v74
v_mfma_f32_16x16x32_bf16 v[172:175], v[208:211], a[36:39], v[172:175]
ds_read_b64_tr_b16 v[202:203], v17 offset:43008
v_add_f32 v33, 1.0, v33
v_mfma_f32_16x16x32_bf16 v[172:175], v[212:215], a[52:55], v[172:175]
buffer_load_dwordx4 v2, s[8:11], s21 offen lds
v_mfma_f32_16x16x32_bf16 v[176:179], v[208:211], a[40:43], v[176:179]
s_add_u32 s54, s54, 67108864
ds_read_b64_tr_b16 v[204:205], v17 offset:45056
v_mfma_f32_16x16x32_bf16 v[176:179], v[212:215], a[56:59], v[176:179]
s_mul_i32 s48, s46, 3145728
v_rcp_f32 v32, v32
v_mfma_f32_16x16x32_bf16 v[180:183], v[208:211], a[44:47], v[180:183]
ds_read_b64_tr_b16 v[206:207], v17 offset:47104
v_mul_f32 v71, v71, v39
v_mfma_f32_16x16x32_bf16 v[180:183], v[212:215], a[60:63], v[180:183]
s_waitcnt lgkmcnt(4)
v_exp_f32 v35, -v75
v_mfma_f32_16x16x32_bf16 v[120:123], v[216:219], a[64:67], v[120:123]
ds_read_b64_tr_b16 v[208:209], v18 offset:40960
v_add_f32 v34, 1.0, v34
v_mfma_f32_16x16x32_bf16 v[120:123], v[220:223], a[80:83], v[120:123]
s_add_u32 m0, s17, 24576
v_rcp_f32 v33, v33
v_mfma_f32_16x16x32_bf16 v[124:127], v[216:219], a[68:71], v[124:127]
ds_read_b64_tr_b16 v[210:211], v18 offset:43008
v_mul_f32 v72, v72, v32
v_mfma_f32_16x16x32_bf16 v[124:127], v[220:223], a[84:87], v[124:127]
s_add_u32 s21, s36, 128
v_exp_f32 v36, -v76
v_mfma_f32_16x16x32_bf16 v[128:131], v[216:219], a[72:75], v[128:131]
ds_read_b64_tr_b16 v[212:213], v18 offset:45056
v_add_f32 v35, 1.0, v35
v_mfma_f32_16x16x32_bf16 v[128:131], v[220:223], a[88:91], v[128:131]
s_add_u32 s48, s48, s54
v_rcp_f32 v34, v34
v_mfma_f32_16x16x32_bf16 v[132:135], v[216:219], a[76:79], v[132:135]
ds_read_b64_tr_b16 v[214:215], v18 offset:47104
v_mul_f32 v73, v73, v33
v_mfma_f32_16x16x32_bf16 v[132:135], v[220:223], a[92:95], v[132:135]
s_waitcnt lgkmcnt(4)
v_exp_f32 v37, -v77
v_mfma_f32_16x16x32_bf16 v[136:139], v[200:203], a[64:67], v[136:139]
ds_read_b64_tr_b16 v[216:217], v19 offset:40960
v_add_f32 v36, 1.0, v36
v_mfma_f32_16x16x32_bf16 v[136:139], v[204:207], a[80:83], v[136:139]
buffer_load_dwordx4 v2, s[8:11], s21 offen lds
v_mfma_f32_16x16x32_bf16 v[140:143], v[200:203], a[68:71], v[140:143]
s_add_u32 m0, s17, 28672
ds_read_b64_tr_b16 v[218:219], v19 offset:43008
v_mfma_f32_16x16x32_bf16 v[140:143], v[204:207], a[84:87], v[140:143]
s_xor_b32 s47, s49, 0
v_rcp_f32 v35, v35
v_mfma_f32_16x16x32_bf16 v[144:147], v[200:203], a[72:75], v[144:147]
ds_read_b64_tr_b16 v[220:221], v19 offset:45056
v_mul_f32 v74, v74, v34
v_mfma_f32_16x16x32_bf16 v[144:147], v[204:207], a[88:91], v[144:147]
s_add_u32 s21, s36, 295040
v_exp_f32 v38, -v78
v_mfma_f32_16x16x32_bf16 v[148:151], v[200:203], a[76:79], v[148:151]
ds_read_b64_tr_b16 v[222:223], v19 offset:47104
v_add_f32 v37, 1.0, v37
v_mfma_f32_16x16x32_bf16 v[148:151], v[204:207], a[92:95], v[148:151]
s_waitcnt lgkmcnt(4)
v_rcp_f32 v36, v36
v_mfma_f32_16x16x32_bf16 v[152:155], v[208:211], a[64:67], v[152:155]
s_waitcnt vmcnt(13)
s_barrier
v_mul_f32 v75, v75, v35
v_mfma_f32_16x16x32_bf16 v[152:155], v[212:215], a[80:83], v[152:155]
s_lshl_b32 s47, s47, 12
ds_read_b64_tr_b16 v[200:201], v20 offset:0
v_mfma_f32_16x16x32_bf16 v[156:159], v[208:211], a[68:71], v[156:159]
s_add_u32 s7, s48, s47
ds_read_b64_tr_b16 v[202:203], v20 offset:2048
v_mfma_f32_16x16x32_bf16 v[156:159], v[212:215], a[84:87], v[156:159]
buffer_load_dwordx4 v2, s[8:11], s21 offen lds
v_mfma_f32_16x16x32_bf16 v[160:163], v[208:211], a[72:75], v[160:163]
s_add_u32 m0, s17, 32768
ds_read_b64_tr_b16 v[204:205], v20 offset:4096
v_mfma_f32_16x16x32_bf16 v[160:163], v[212:215], a[88:91], v[160:163]
s_xor_b32 s47, s49, 1
v_exp_f32 v39, -v79
v_mfma_f32_16x16x32_bf16 v[164:167], v[208:211], a[76:79], v[164:167]
ds_read_b64_tr_b16 v[206:207], v20 offset:6144
v_add_f32 v38, 1.0, v38
v_mfma_f32_16x16x32_bf16 v[164:167], v[212:215], a[92:95], v[164:167]
s_waitcnt lgkmcnt(4)
v_rcp_f32 v37, v37
v_mfma_f32_16x16x32_bf16 v[168:171], v[216:219], a[64:67], v[168:171]
ds_read_b64_tr_b16 v[208:209], v21 offset:0
v_mul_f32 v76, v76, v36
v_mfma_f32_16x16x32_bf16 v[168:171], v[220:223], a[80:83], v[168:171]
s_add_u32 s21, s38, 128
v_exp_f32 v32, -v80
v_mfma_f32_16x16x32_bf16 v[172:175], v[216:219], a[68:71], v[172:175]
ds_read_b64_tr_b16 v[210:211], v21 offset:2048
v_add_f32 v39, 1.0, v39
v_mfma_f32_16x16x32_bf16 v[172:175], v[220:223], a[84:87], v[172:175]
buffer_load_dwordx4 v2, s[8:11], s21 offen lds
v_mfma_f32_16x16x32_bf16 v[176:179], v[216:219], a[72:75], v[176:179]
s_lshl_b32 s47, s47, 12
ds_read_b64_tr_b16 v[212:213], v21 offset:4096
v_mfma_f32_16x16x32_bf16 v[176:179], v[220:223], a[88:91], v[176:179]
s_add_u32 s52, s48, s47
v_rcp_f32 v38, v38
v_mfma_f32_16x16x32_bf16 v[180:183], v[216:219], a[76:79], v[180:183]
ds_read_b64_tr_b16 v[214:215], v21 offset:6144
v_mul_f32 v77, v77, v37
v_mfma_f32_16x16x32_bf16 v[180:183], v[220:223], a[92:95], v[180:183]
s_waitcnt lgkmcnt(4)
v_exp_f32 v33, -v81
v_mfma_f32_16x16x32_bf16 v[120:123], v[200:203], a[96:99], v[120:123]
ds_read_b64_tr_b16 v[216:217], v22 offset:0
v_add_f32 v32, 1.0, v32
v_mfma_f32_16x16x32_bf16 v[120:123], v[204:207], a[112:115], v[120:123]
s_add_u32 m0, s17, 36864
v_rcp_f32 v39, v39
v_mfma_f32_16x16x32_bf16 v[124:127], v[200:203], a[100:103], v[124:127]
ds_read_b64_tr_b16 v[218:219], v22 offset:2048
v_mul_f32 v78, v78, v38
v_mfma_f32_16x16x32_bf16 v[124:127], v[204:207], a[116:119], v[124:127]
s_add_u32 s21, s38, 295040
v_exp_f32 v34, -v82
v_mfma_f32_16x16x32_bf16 v[128:131], v[200:203], a[104:107], v[128:131]
ds_read_b64_tr_b16 v[220:221], v22 offset:4096
v_add_f32 v33, 1.0, v33
v_mfma_f32_16x16x32_bf16 v[128:131], v[204:207], a[120:123], v[128:131]
s_xor_b32 s47, s49, 2
v_rcp_f32 v32, v32
v_mfma_f32_16x16x32_bf16 v[132:135], v[200:203], a[108:111], v[132:135]
ds_read_b64_tr_b16 v[222:223], v22 offset:6144
v_mul_f32 v79, v79, v39
v_mfma_f32_16x16x32_bf16 v[132:135], v[204:207], a[124:127], v[132:135]
s_waitcnt lgkmcnt(4)
v_exp_f32 v35, -v83
v_mfma_f32_16x16x32_bf16 v[136:139], v[208:211], a[96:99], v[136:139]
ds_read_b64_tr_b16 v[200:201], v23 offset:0
v_add_f32 v34, 1.0, v34
v_mfma_f32_16x16x32_bf16 v[136:139], v[212:215], a[112:115], v[136:139]
buffer_load_dwordx4 v2, s[8:11], s21 offen lds
v_mfma_f32_16x16x32_bf16 v[140:143], v[208:211], a[100:103], v[140:143]
s_add_u32 m0, s17, 40960
ds_read_b64_tr_b16 v[202:203], v23 offset:2048
v_mfma_f32_16x16x32_bf16 v[140:143], v[212:215], a[116:119], v[140:143]
s_lshl_b32 s47, s47, 12
v_rcp_f32 v33, v33
v_mfma_f32_16x16x32_bf16 v[144:147], v[208:211], a[104:107], v[144:147]
ds_read_b64_tr_b16 v[204:205], v23 offset:4096
v_mul_f32 v80, v80, v32
v_mfma_f32_16x16x32_bf16 v[144:147], v[212:215], a[120:123], v[144:147]
s_add_u32 s21, s39, 128
v_exp_f32 v36, -v84
v_mfma_f32_16x16x32_bf16 v[148:151], v[208:211], a[108:111], v[148:151]
ds_read_b64_tr_b16 v[206:207], v23 offset:6144
v_add_f32 v35, 1.0, v35
v_mfma_f32_16x16x32_bf16 v[148:151], v[212:215], a[124:127], v[148:151]
s_waitcnt lgkmcnt(4)
v_rcp_f32 v34, v34
v_mfma_f32_16x16x32_bf16 v[152:155], v[216:219], a[96:99], v[152:155]
ds_read_b64_tr_b16 v[208:209], v20 offset:8192
v_mul_f32 v81, v81, v33
v_mfma_f32_16x16x32_bf16 v[152:155], v[220:223], a[112:115], v[152:155]
buffer_load_dwordx4 v2, s[8:11], s21 offen lds
v_mfma_f32_16x16x32_bf16 v[156:159], v[216:219], a[100:103], v[156:159]
s_add_u32 s53, s48, s47
ds_read_b64_tr_b16 v[210:211], v20 offset:10240
v_mfma_f32_16x16x32_bf16 v[156:159], v[220:223], a[116:119], v[156:159]
s_xor_b32 s47, s49, 3
v_exp_f32 v37, -v85
v_mfma_f32_16x16x32_bf16 v[160:163], v[216:219], a[104:107], v[160:163]
ds_read_b64_tr_b16 v[212:213], v20 offset:12288
v_add_f32 v36, 1.0, v36
v_mfma_f32_16x16x32_bf16 v[160:163], v[220:223], a[120:123], v[160:163]
s_add_u32 m0, s17, 45056
v_rcp_f32 v35, v35
v_mfma_f32_16x16x32_bf16 v[164:167], v[216:219], a[108:111], v[164:167]
ds_read_b64_tr_b16 v[214:215], v20 offset:14336
v_mul_f32 v82, v82, v34
v_mfma_f32_16x16x32_bf16 v[164:167], v[220:223], a[124:127], v[164:167]
s_waitcnt lgkmcnt(4)
v_exp_f32 v38, -v86
v_mfma_f32_16x16x32_bf16 v[168:171], v[200:203], a[96:99], v[168:171]
ds_read_b64_tr_b16 v[216:217], v21 offset:8192
v_add_f32 v37, 1.0, v37
v_mfma_f32_16x16x32_bf16 v[168:171], v[204:207], a[112:115], v[168:171]
s_add_u32 s21, s39, 295040
v_rcp_f32 v36, v36
v_mfma_f32_16x16x32_bf16 v[172:175], v[200:203], a[100:103], v[172:175]
ds_read_b64_tr_b16 v[218:219], v21 offset:10240
v_mul_f32 v83, v83, v35
v_mfma_f32_16x16x32_bf16 v[172:175], v[204:207], a[116:119], v[172:175]
buffer_load_dwordx4 v2, s[8:11], s21 offen lds
v_mfma_f32_16x16x32_bf16 v[176:179], v[200:203], a[104:107], v[176:179]
s_lshl_b32 s47, s47, 12
ds_read_b64_tr_b16 v[220:221], v21 offset:12288
v_mfma_f32_16x16x32_bf16 v[176:179], v[204:207], a[120:123], v[176:179]
s_add_u32 s79, s48, s47
v_exp_f32 v39, -v87
v_mfma_f32_16x16x32_bf16 v[180:183], v[200:203], a[108:111], v[180:183]
ds_read_b64_tr_b16 v[222:223], v21 offset:14336
v_add_f32 v38, 1.0, v38
v_mfma_f32_16x16x32_bf16 v[180:183], v[204:207], a[124:127], v[180:183]
s_waitcnt lgkmcnt(4)
v_rcp_f32 v37, v37
v_mfma_f32_16x16x32_bf16 v[120:123], v[208:211], a[128:131], v[120:123]
ds_read_b64_tr_b16 v[200:201], v22 offset:8192
v_mul_f32 v84, v84, v36
v_mfma_f32_16x16x32_bf16 v[120:123], v[212:215], a[144:147], v[120:123]
s_add_u32 m0, s17, 49152
v_exp_f32 v32, -v88
v_mfma_f32_16x16x32_bf16 v[124:127], v[208:211], a[132:135], v[124:127]
ds_read_b64_tr_b16 v[202:203], v22 offset:10240
v_add_f32 v39, 1.0, v39
v_mfma_f32_16x16x32_bf16 v[124:127], v[212:215], a[148:151], v[124:127]
s_add_u32 s21, s42, 128
v_rcp_f32 v38, v38
v_mfma_f32_16x16x32_bf16 v[128:131], v[208:211], a[136:139], v[128:131]
ds_read_b64_tr_b16 v[204:205], v22 offset:12288
v_mul_f32 v85, v85, v37
v_mfma_f32_16x16x32_bf16 v[128:131], v[212:215], a[152:155], v[128:131]
s_lshl_b32 s47, s46, 12
v_exp_f32 v33, -v89
v_mfma_f32_16x16x32_bf16 v[132:135], v[208:211], a[140:143], v[132:135]
ds_read_b64_tr_b16 v[206:207], v22 offset:14336
v_add_f32 v32, 1.0, v32
v_mfma_f32_16x16x32_bf16 v[132:135], v[212:215], a[156:159], v[132:135]
s_waitcnt lgkmcnt(4)
v_rcp_f32 v39, v39
v_mfma_f32_16x16x32_bf16 v[136:139], v[216:219], a[128:131], v[136:139]
ds_read_b64_tr_b16 v[208:209], v23 offset:8192
v_mul_f32 v86, v86, v38
v_mfma_f32_16x16x32_bf16 v[136:139], v[220:223], a[144:147], v[136:139]
buffer_load_dwordx4 v2, s[8:11], s21 offen lds
v_mfma_f32_16x16x32_bf16 v[140:143], v[216:219], a[132:135], v[140:143]
s_add_u32 m0, s17, 53248
ds_read_b64_tr_b16 v[210:211], v23 offset:10240
v_mfma_f32_16x16x32_bf16 v[140:143], v[220:223], a[148:151], v[140:143]
s_add_u32 s54, s54, s47
v_exp_f32 v34, -v90
v_mfma_f32_16x16x32_bf16 v[144:147], v[216:219], a[136:139], v[144:147]
ds_read_b64_tr_b16 v[212:213], v23 offset:12288
v_add_f32 v33, 1.0, v33
v_mfma_f32_16x16x32_bf16 v[144:147], v[220:223], a[152:155], v[144:147]
s_add_u32 s21, s42, 295040
v_rcp_f32 v32, v32
v_mfma_f32_16x16x32_bf16 v[148:151], v[216:219], a[140:143], v[148:151]
ds_read_b64_tr_b16 v[214:215], v23 offset:14336
v_mul_f32 v87, v87, v39
v_mfma_f32_16x16x32_bf16 v[148:151], v[220:223], a[156:159], v[148:151]
s_waitcnt lgkmcnt(4)
v_exp_f32 v35, -v91
v_mfma_f32_16x16x32_bf16 v[152:155], v[200:203], a[128:131], v[152:155]
ds_read_b64_tr_b16 v[216:217], v20 offset:16384
v_add_f32 v34, 1.0, v34
v_mfma_f32_16x16x32_bf16 v[152:155], v[204:207], a[144:147], v[152:155]
buffer_load_dwordx4 v2, s[8:11], s21 offen lds
v_mfma_f32_16x16x32_bf16 v[156:159], v[200:203], a[132:135], v[156:159]
s_lshl_b32 s47, s44, 3
ds_read_b64_tr_b16 v[218:219], v20 offset:18432
v_mfma_f32_16x16x32_bf16 v[156:159], v[204:207], a[148:151], v[156:159]
s_lshl_b32 s48, s16, 1
v_rcp_f32 v33, v33
v_mfma_f32_16x16x32_bf16 v[160:163], v[200:203], a[136:139], v[160:163]
ds_read_b64_tr_b16 v[220:221], v20 offset:20480
v_mul_f32 v88, v88, v32
v_mfma_f32_16x16x32_bf16 v[160:163], v[204:207], a[152:155], v[160:163]
s_add_u32 m0, s17, 57344
v_exp_f32 v36, -v92
v_mfma_f32_16x16x32_bf16 v[164:167], v[200:203], a[140:143], v[164:167]
ds_read_b64_tr_b16 v[222:223], v20 offset:22528
v_add_f32 v35, 1.0, v35
v_mfma_f32_16x16x32_bf16 v[164:167], v[204:207], a[156:159], v[164:167]
s_waitcnt lgkmcnt(4)
v_rcp_f32 v34, v34
v_mfma_f32_16x16x32_bf16 v[168:171], v[208:211], a[128:131], v[168:171]
ds_read_b64_tr_b16 v[200:201], v21 offset:16384
v_mul_f32 v89, v89, v33
v_mfma_f32_16x16x32_bf16 v[168:171], v[212:215], a[144:147], v[168:171]
s_add_u32 s21, s43, 128
v_exp_f32 v37, -v93
v_mfma_f32_16x16x32_bf16 v[172:175], v[208:211], a[132:135], v[172:175]
ds_read_b64_tr_b16 v[202:203], v21 offset:18432
v_add_f32 v36, 1.0, v36
v_mfma_f32_16x16x32_bf16 v[172:175], v[212:215], a[148:151], v[172:175]
buffer_load_dwordx4 v2, s[8:11], s21 offen lds
v_mfma_f32_16x16x32_bf16 v[176:179], v[208:211], a[136:139], v[176:179]
s_add_u32 s47, s47, s48
ds_read_b64_tr_b16 v[204:205], v21 offset:20480
v_mfma_f32_16x16x32_bf16 v[176:179], v[212:215], a[152:155], v[176:179]
s_mul_i32 s60, s47, 165888
v_rcp_f32 v35, v35
v_mfma_f32_16x16x32_bf16 v[180:183], v[208:211], a[140:143], v[180:183]
ds_read_b64_tr_b16 v[206:207], v21 offset:22528
v_mul_f32 v90, v90, v34
v_mfma_f32_16x16x32_bf16 v[180:183], v[212:215], a[156:159], v[180:183]
s_waitcnt lgkmcnt(4)
v_exp_f32 v38, -v94
v_mfma_f32_16x16x32_bf16 v[120:123], v[216:219], a[160:163], v[120:123]
ds_read_b64_tr_b16 v[208:209], v22 offset:16384
v_add_f32 v37, 1.0, v37
v_mfma_f32_16x16x32_bf16 v[120:123], v[220:223], a[176:179], v[120:123]
s_add_u32 m0, s17, 61440
v_rcp_f32 v36, v36
v_mfma_f32_16x16x32_bf16 v[124:127], v[216:219], a[164:167], v[124:127]
ds_read_b64_tr_b16 v[210:211], v22 offset:18432
v_mul_f32 v91, v91, v35
v_mfma_f32_16x16x32_bf16 v[124:127], v[220:223], a[180:183], v[124:127]
s_add_u32 s21, s43, 295040
v_exp_f32 v39, -v95
v_mfma_f32_16x16x32_bf16 v[128:131], v[216:219], a[168:171], v[128:131]
ds_read_b64_tr_b16 v[212:213], v22 offset:20480
v_add_f32 v38, 1.0, v38
v_mfma_f32_16x16x32_bf16 v[128:131], v[220:223], a[184:187], v[128:131]
s_add_u32 s60, s60, 4194304
v_rcp_f32 v37, v37
v_mfma_f32_16x16x32_bf16 v[132:135], v[216:219], a[172:175], v[132:135]
ds_read_b64_tr_b16 v[214:215], v22 offset:22528
v_mul_f32 v92, v92, v36
v_mfma_f32_16x16x32_bf16 v[132:135], v[220:223], a[188:191], v[132:135]
s_waitcnt lgkmcnt(4)
v_exp_f32 v32, -v96
v_mfma_f32_16x16x32_bf16 v[136:139], v[200:203], a[160:163], v[136:139]
ds_read_b64_tr_b16 v[216:217], v23 offset:16384
v_add_f32 v39, 1.0, v39
v_mfma_f32_16x16x32_bf16 v[136:139], v[204:207], a[176:179], v[136:139]
buffer_load_dwordx4 v2, s[8:11], s21 offen lds
v_mfma_f32_16x16x32_bf16 v[140:143], v[200:203], a[164:167], v[140:143]
s_add_u32 m0, s17, 65536
ds_read_b64_tr_b16 v[218:219], v23 offset:18432
v_mfma_f32_16x16x32_bf16 v[140:143], v[204:207], a[180:183], v[140:143]
s_and_b32 s48, s46, 1
v_rcp_f32 v38, v38
v_mfma_f32_16x16x32_bf16 v[144:147], v[200:203], a[168:171], v[144:147]
ds_read_b64_tr_b16 v[220:221], v23 offset:20480
v_mul_f32 v93, v93, v37
v_mfma_f32_16x16x32_bf16 v[144:147], v[204:207], a[184:187], v[144:147]
s_add_u32 s21, s0, 128
v_exp_f32 v33, -v97
v_mfma_f32_16x16x32_bf16 v[148:151], v[200:203], a[172:175], v[148:151]
ds_read_b64_tr_b16 v[222:223], v23 offset:22528
v_add_f32 v32, 1.0, v32
v_mfma_f32_16x16x32_bf16 v[148:151], v[204:207], a[188:191], v[148:151]
s_waitcnt lgkmcnt(4)
v_rcp_f32 v39, v39
v_mfma_f32_16x16x32_bf16 v[152:155], v[208:211], a[160:163], v[152:155]
s_waitcnt vmcnt(16)
s_barrier
v_mul_f32 v94, v94, v38
v_mfma_f32_16x16x32_bf16 v[152:155], v[212:215], a[176:179], v[152:155]
s_add_u32 s48, s48, s47
ds_read_b64_tr_b16 v[200:201], v20 offset:24576
v_mfma_f32_16x16x32_bf16 v[156:159], v[208:211], a[164:167], v[156:159]
s_mul_i32 s55, s48, 18432
ds_read_b64_tr_b16 v[202:203], v20 offset:26624
v_mfma_f32_16x16x32_bf16 v[156:159], v[212:215], a[180:183], v[156:159]
buffer_load_dwordx4 v2, s[8:11], s21 offen lds
v_mfma_f32_16x16x32_bf16 v[160:163], v[208:211], a[168:171], v[160:163]
s_add_u32 m0, s17, 69632
ds_read_b64_tr_b16 v[204:205], v20 offset:28672
v_mfma_f32_16x16x32_bf16 v[160:163], v[212:215], a[184:187], v[160:163]
s_lshr_b32 s48, s46, 1
v_exp_f32 v34, -v98
v_mfma_f32_16x16x32_bf16 v[164:167], v[208:211], a[172:175], v[164:167]
ds_read_b64_tr_b16 v[206:207], v20 offset:30720
v_add_f32 v33, 1.0, v33
v_mfma_f32_16x16x32_bf16 v[164:167], v[212:215], a[188:191], v[164:167]
s_waitcnt lgkmcnt(4)
v_rcp_f32 v32, v32
v_mfma_f32_16x16x32_bf16 v[168:171], v[216:219], a[160:163], v[168:171]
ds_read_b64_tr_b16 v[208:209], v20 offset:32768
v_mul_f32 v95, v95, v39
v_mfma_f32_16x16x32_bf16 v[168:171], v[220:223], a[176:179], v[168:171]
s_add_u32 s21, s0, 295040
v_exp_f32 v35, -v99
v_mfma_f32_16x16x32_bf16 v[172:175], v[216:219], a[164:167], v[172:175]
ds_read_b64_tr_b16 v[210:211], v20 offset:34816
v_add_f32 v34, 1.0, v34
v_mfma_f32_16x16x32_bf16 v[172:175], v[220:223], a[180:183], v[172:175]
buffer_load_dwordx4 v2, s[8:11], s21 offen lds
v_mfma_f32_16x16x32_bf16 v[176:179], v[216:219], a[168:171], v[176:179]
s_lshl_b32 s48, s48, 6
ds_read_b64_tr_b16 v[212:213], v20 offset:36864
v_mfma_f32_16x16x32_bf16 v[176:179], v[220:223], a[184:187], v[176:179]
s_add_u32 s55, s55, s48
v_rcp_f32 v33, v33
v_mfma_f32_16x16x32_bf16 v[180:183], v[216:219], a[172:175], v[180:183]
ds_read_b64_tr_b16 v[214:215], v20 offset:38912
v_mul_f32 v96, v96, v32
v_mfma_f32_16x16x32_bf16 v[180:183], v[220:223], a[188:191], v[180:183]
s_waitcnt lgkmcnt(4)
v_exp_f32 v36, -v100
v_mfma_f32_16x16x32_bf16 v[120:123], v[200:203], a[192:195], v[120:123]
ds_read_b64_tr_b16 v[216:217], v20 offset:40960
v_add_f32 v35, 1.0, v35
v_mfma_f32_16x16x32_bf16 v[120:123], v[204:207], a[208:211], v[120:123]
s_add_u32 m0, s17, 73728
v_rcp_f32 v34, v34
v_mfma_f32_16x16x32_bf16 v[124:127], v[200:203], a[196:199], v[124:127]
ds_read_b64_tr_b16 v[218:219], v20 offset:43008
v_mul_f32 v97, v97, v33
v_mfma_f32_16x16x32_bf16 v[124:127], v[204:207], a[212:215], v[124:127]
s_add_u32 s55, s55, s62
v_exp_f32 v37, -v101
v_mfma_f32_16x16x32_bf16 v[128:131], v[200:203], a[200:203], v[128:131]
ds_read_b64_tr_b16 v[220:221], v20 offset:45056
v_add_f32 v36, 1.0, v36
v_mfma_f32_16x16x32_bf16 v[128:131], v[204:207], a[216:219], v[128:131]
s_add_u32 s21, s33, 128
v_rcp_f32 v35, v35
v_mfma_f32_16x16x32_bf16 v[132:135], v[200:203], a[204:207], v[132:135]
ds_read_b64_tr_b16 v[222:223], v20 offset:47104
v_mul_f32 v98, v98, v34
v_mfma_f32_16x16x32_bf16 v[132:135], v[204:207], a[220:223], v[132:135]
s_waitcnt lgkmcnt(4)
v_exp_f32 v38, -v102
v_mfma_f32_16x16x32_bf16 v[120:123], v[208:211], a[224:227], v[120:123]
ds_read_b64_tr_b16 v[200:201], v21 offset:24576
v_add_f32 v37, 1.0, v37
v_mfma_f32_16x16x32_bf16 v[120:123], v[212:215], a[240:243], v[120:123]
s_lshr_b32 s47, s47, 2
v_rcp_f32 v36, v36
v_mfma_f32_16x16x32_bf16 v[124:127], v[208:211], a[228:231], v[124:127]
ds_read_b64_tr_b16 v[202:203], v21 offset:26624
v_mul_f32 v99, v99, v35
v_mfma_f32_16x16x32_bf16 v[124:127], v[212:215], a[244:247], v[124:127]
buffer_load_dwordx4 v2, s[24:27], s21 offen lds
v_mfma_f32_16x16x32_bf16 v[128:131], v[208:211], a[232:235], v[128:131]
s_lshl_b32 s5, s47, 9
ds_read_b64_tr_b16 v[204:205], v21 offset:28672
v_mfma_f32_16x16x32_bf16 v[128:131], v[212:215], a[248:251], v[128:131]
s_add_u32 s5, s5, 58720256
v_exp_f32 v39, -v103
v_mfma_f32_16x16x32_bf16 v[132:135], v[208:211], a[236:239], v[132:135]
ds_read_b64_tr_b16 v[206:207], v21 offset:30720
v_add_f32 v38, 1.0, v38
v_mfma_f32_16x16x32_bf16 v[132:135], v[212:215], a[252:255], v[132:135]
s_waitcnt lgkmcnt(4)
v_rcp_f32 v37, v37
v_mfma_f32_16x16x32_bf16 v[120:123], v[216:219], v[224:227], v[120:123]
ds_read_b64_tr_b16 v[208:209], v21 offset:32768
v_mul_f32 v100, v100, v36
v_mfma_f32_16x16x32_bf16 v[120:123], v[220:223], v[240:243], v[120:123]
s_add_u32 m0, s17, 77824
v_exp_f32 v32, -v104
v_mfma_f32_16x16x32_bf16 v[124:127], v[216:219], v[228:231], v[124:127]
ds_read_b64_tr_b16 v[210:211], v21 offset:34816
v_add_f32 v39, 1.0, v39
v_mfma_f32_16x16x32_bf16 v[124:127], v[220:223], v[244:247], v[124:127]
s_lshl_b32 s47, s18, 2
v_rcp_f32 v38, v38
v_mfma_f32_16x16x32_bf16 v[128:131], v[216:219], v[232:235], v[128:131]
ds_read_b64_tr_b16 v[212:213], v21 offset:36864
v_mul_f32 v101, v101, v37
v_mfma_f32_16x16x32_bf16 v[128:131], v[220:223], v[248:251], v[128:131]
s_add_u32 s21, s33, 295040
v_exp_f32 v33, -v105
v_mfma_f32_16x16x32_bf16 v[132:135], v[216:219], v[236:239], v[132:135]
ds_read_b64_tr_b16 v[214:215], v21 offset:38912
v_add_f32 v32, 1.0, v32
v_mfma_f32_16x16x32_bf16 v[132:135], v[220:223], v[252:255], v[132:135]
s_waitcnt lgkmcnt(4)
v_rcp_f32 v39, v39
v_mfma_f32_16x16x32_bf16 v[136:139], v[200:203], a[192:195], v[136:139]
ds_read_b64_tr_b16 v[216:217], v21 offset:40960
v_mul_f32 v102, v102, v38
v_mfma_f32_16x16x32_bf16 v[136:139], v[204:207], a[208:211], v[136:139]
buffer_load_dwordx4 v2, s[24:27], s21 offen lds
v_mfma_f32_16x16x32_bf16 v[140:143], v[200:203], a[196:199], v[140:143]
s_add_u32 s47, s47, s16
ds_read_b64_tr_b16 v[218:219], v21 offset:43008
v_mfma_f32_16x16x32_bf16 v[140:143], v[204:207], a[212:215], v[140:143]
s_lshl_b32 s37, s47, 9
v_exp_f32 v34, -v106
v_mfma_f32_16x16x32_bf16 v[144:147], v[200:203], a[200:203], v[144:147]
ds_read_b64_tr_b16 v[220:221], v21 offset:45056
v_add_f32 v33, 1.0, v33
v_mfma_f32_16x16x32_bf16 v[144:147], v[204:207], a[216:219], v[144:147]
s_lshl_b32 s47, s19, 2
v_rcp_f32 v32, v32
v_mfma_f32_16x16x32_bf16 v[148:151], v[200:203], a[204:207], v[148:151]
ds_read_b64_tr_b16 v[222:223], v21 offset:47104
v_mul_f32 v103, v103, v39
v_mfma_f32_16x16x32_bf16 v[148:151], v[204:207], a[220:223], v[148:151]
s_waitcnt lgkmcnt(4)
v_exp_f32 v35, -v107
v_mfma_f32_16x16x32_bf16 v[136:139], v[208:211], a[224:227], v[136:139]
ds_read_b64_tr_b16 v[200:201], v22 offset:24576
v_add_f32 v34, 1.0, v34
v_mfma_f32_16x16x32_bf16 v[136:139], v[212:215], a[240:243], v[136:139]
s_add_u32 m0, s17, 81920
v_rcp_f32 v33, v33
v_mfma_f32_16x16x32_bf16 v[140:143], v[208:211], a[228:231], v[140:143]
ds_read_b64_tr_b16 v[202:203], v22 offset:26624
v_mul_f32 v104, v104, v32
v_mfma_f32_16x16x32_bf16 v[140:143], v[212:215], a[244:247], v[140:143]
s_add_u32 s37, s37, s47
v_exp_f32 v36, -v108
v_mfma_f32_16x16x32_bf16 v[144:147], v[208:211], a[232:235], v[144:147]
ds_read_b64_tr_b16 v[204:205], v22 offset:28672
v_add_f32 v35, 1.0, v35
v_mfma_f32_16x16x32_bf16 v[144:147], v[212:215], a[248:251], v[144:147]
s_add_u32 s21, s34, 128
v_rcp_f32 v34, v34
v_mfma_f32_16x16x32_bf16 v[148:151], v[208:211], a[236:239], v[148:151]
ds_read_b64_tr_b16 v[206:207], v22 offset:30720
v_mul_f32 v105, v105, v33
v_mfma_f32_16x16x32_bf16 v[148:151], v[212:215], a[252:255], v[148:151]
s_waitcnt lgkmcnt(4)
v_exp_f32 v37, -v109
v_mfma_f32_16x16x32_bf16 v[136:139], v[216:219], v[224:227], v[136:139]
ds_read_b64_tr_b16 v[208:209], v22 offset:32768
v_add_f32 v36, 1.0, v36
v_mfma_f32_16x16x32_bf16 v[136:139], v[220:223], v[240:243], v[136:139]
s_add_u32 s37, s37, 58720256
v_rcp_f32 v35, v35
v_mfma_f32_16x16x32_bf16 v[140:143], v[216:219], v[228:231], v[140:143]
ds_read_b64_tr_b16 v[210:211], v22 offset:34816
v_mul_f32 v106, v106, v34
v_mfma_f32_16x16x32_bf16 v[140:143], v[220:223], v[244:247], v[140:143]
buffer_load_dwordx4 v2, s[24:27], s21 offen lds
v_mfma_f32_16x16x32_bf16 v[144:147], v[216:219], v[232:235], v[144:147]
ds_read_b64_tr_b16 v[212:213], v22 offset:36864
v_mul_f32 v120, v56, v120
v_mfma_f32_16x16x32_bf16 v[144:147], v[220:223], v[248:251], v[144:147]
v_exp_f32 v38, -v110
v_mfma_f32_16x16x32_bf16 v[148:151], v[216:219], v[236:239], v[148:151]
ds_read_b64_tr_b16 v[214:215], v22 offset:38912
v_add_f32 v37, 1.0, v37
v_mfma_f32_16x16x32_bf16 v[148:151], v[220:223], v[252:255], v[148:151]
s_waitcnt lgkmcnt(4)
v_rcp_f32 v36, v36
v_mfma_f32_16x16x32_bf16 v[152:155], v[200:203], a[192:195], v[152:155]
ds_read_b64_tr_b16 v[216:217], v22 offset:40960
v_mul_f32 v107, v107, v35
v_mfma_f32_16x16x32_bf16 v[152:155], v[204:207], a[208:211], v[152:155]
s_add_u32 m0, s17, 86016
v_exp_f32 v39, -v111
v_mfma_f32_16x16x32_bf16 v[156:159], v[200:203], a[196:199], v[156:159]
ds_read_b64_tr_b16 v[218:219], v22 offset:43008
v_add_f32 v38, 1.0, v38
v_mfma_f32_16x16x32_bf16 v[156:159], v[204:207], a[212:215], v[156:159]
v_rcp_f32 v37, v37
v_mfma_f32_16x16x32_bf16 v[160:163], v[200:203], a[200:203], v[160:163]
ds_read_b64_tr_b16 v[220:221], v22 offset:45056
v_mul_f32 v108, v108, v36
v_mfma_f32_16x16x32_bf16 v[160:163], v[204:207], a[216:219], v[160:163]
s_add_u32 s21, s34, 295040
v_exp_f32 v32, -v112
v_mfma_f32_16x16x32_bf16 v[164:167], v[200:203], a[204:207], v[164:167]
ds_read_b64_tr_b16 v[222:223], v22 offset:47104
v_add_f32 v39, 1.0, v39
v_mfma_f32_16x16x32_bf16 v[164:167], v[204:207], a[220:223], v[164:167]
s_waitcnt lgkmcnt(4)
v_rcp_f32 v38, v38
v_mfma_f32_16x16x32_bf16 v[152:155], v[208:211], a[224:227], v[152:155]
ds_read_b64_tr_b16 v[200:201], v23 offset:24576
v_mul_f32 v109, v109, v37
v_mfma_f32_16x16x32_bf16 v[152:155], v[212:215], a[240:243], v[152:155]
buffer_load_dwordx4 v2, s[24:27], s21 offen lds
v_mfma_f32_16x16x32_bf16 v[156:159], v[208:211], a[228:231], v[156:159]
ds_read_b64_tr_b16 v[202:203], v23 offset:26624
v_mul_f32 v121, v57, v121
v_mfma_f32_16x16x32_bf16 v[156:159], v[212:215], a[244:247], v[156:159]
v_exp_f32 v33, -v113
v_mfma_f32_16x16x32_bf16 v[160:163], v[208:211], a[232:235], v[160:163]
ds_read_b64_tr_b16 v[204:205], v23 offset:28672
v_add_f32 v32, 1.0, v32
v_mfma_f32_16x16x32_bf16 v[160:163], v[212:215], a[248:251], v[160:163]
v_rcp_f32 v39, v39
v_mfma_f32_16x16x32_bf16 v[164:167], v[208:211], a[236:239], v[164:167]
ds_read_b64_tr_b16 v[206:207], v23 offset:30720
v_mul_f32 v110, v110, v38
v_mfma_f32_16x16x32_bf16 v[164:167], v[212:215], a[252:255], v[164:167]
s_waitcnt lgkmcnt(4)
v_exp_f32 v34, -v114
v_mfma_f32_16x16x32_bf16 v[152:155], v[216:219], v[224:227], v[152:155]
ds_read_b64_tr_b16 v[208:209], v23 offset:32768
v_add_f32 v33, 1.0, v33
v_mfma_f32_16x16x32_bf16 v[152:155], v[220:223], v[240:243], v[152:155]
s_add_u32 m0, s17, 90112
v_rcp_f32 v32, v32
v_mfma_f32_16x16x32_bf16 v[156:159], v[216:219], v[228:231], v[156:159]
ds_read_b64_tr_b16 v[210:211], v23 offset:34816
v_mul_f32 v111, v111, v39
v_mfma_f32_16x16x32_bf16 v[156:159], v[220:223], v[244:247], v[156:159]
v_exp_f32 v35, -v115
v_mfma_f32_16x16x32_bf16 v[160:163], v[216:219], v[232:235], v[160:163]
ds_read_b64_tr_b16 v[212:213], v23 offset:36864
v_add_f32 v34, 1.0, v34
v_mfma_f32_16x16x32_bf16 v[160:163], v[220:223], v[248:251], v[160:163]
s_add_u32 s21, s35, 128
v_rcp_f32 v33, v33
v_mfma_f32_16x16x32_bf16 v[164:167], v[216:219], v[236:239], v[164:167]
ds_read_b64_tr_b16 v[214:215], v23 offset:38912
v_mul_f32 v112, v112, v32
v_mfma_f32_16x16x32_bf16 v[164:167], v[220:223], v[252:255], v[164:167]
s_waitcnt lgkmcnt(4)
v_exp_f32 v36, -v116
v_mfma_f32_16x16x32_bf16 v[168:171], v[200:203], a[192:195], v[168:171]
ds_read_b64_tr_b16 v[216:217], v23 offset:40960
v_add_f32 v35, 1.0, v35
v_mfma_f32_16x16x32_bf16 v[168:171], v[204:207], a[208:211], v[168:171]
v_rcp_f32 v34, v34
v_mfma_f32_16x16x32_bf16 v[172:175], v[200:203], a[196:199], v[172:175]
ds_read_b64_tr_b16 v[218:219], v23 offset:43008
v_mul_f32 v113, v113, v33
v_mfma_f32_16x16x32_bf16 v[172:175], v[204:207], a[212:215], v[172:175]
buffer_load_dwordx4 v2, s[24:27], s21 offen lds
v_mfma_f32_16x16x32_bf16 v[176:179], v[200:203], a[200:203], v[176:179]
ds_read_b64_tr_b16 v[220:221], v23 offset:45056
v_mul_f32 v122, v58, v122
v_mfma_f32_16x16x32_bf16 v[176:179], v[204:207], a[216:219], v[176:179]
v_exp_f32 v37, -v117
v_mfma_f32_16x16x32_bf16 v[180:183], v[200:203], a[204:207], v[180:183]
ds_read_b64_tr_b16 v[222:223], v23 offset:47104
v_add_f32 v36, 1.0, v36
v_mfma_f32_16x16x32_bf16 v[180:183], v[204:207], a[220:223], v[180:183]
s_waitcnt lgkmcnt(4)
v_rcp_f32 v35, v35
v_mfma_f32_16x16x32_bf16 v[168:171], v[208:211], a[224:227], v[168:171]
s_waitcnt vmcnt(17)
s_barrier
v_mul_f32 v114, v114, v34
v_mfma_f32_16x16x32_bf16 v[168:171], v[212:215], a[240:243], v[168:171]
ds_read_b64_tr_b16 v[200:201], v12 offset:0
v_mul_f32 v123, v59, v123
v_mfma_f32_16x16x32_bf16 v[172:175], v[208:211], a[228:231], v[172:175]
ds_read_b64_tr_b16 v[202:203], v12 offset:2048
v_mul_f32 v124, v60, v124
v_mfma_f32_16x16x32_bf16 v[172:175], v[212:215], a[244:247], v[172:175]
s_add_u32 m0, s17, 94208
v_exp_f32 v38, -v118
v_mfma_f32_16x16x32_bf16 v[176:179], v[208:211], a[232:235], v[176:179]
ds_read_b64_tr_b16 v[204:205], v12 offset:4096
v_add_f32 v37, 1.0, v37
v_mfma_f32_16x16x32_bf16 v[176:179], v[212:215], a[248:251], v[176:179]
s_add_u32 s21, s35, 295040
v_rcp_f32 v36, v36
v_mfma_f32_16x16x32_bf16 v[180:183], v[208:211], a[236:239], v[180:183]
ds_read_b64_tr_b16 v[206:207], v12 offset:6144
v_mul_f32 v115, v115, v35
v_mfma_f32_16x16x32_bf16 v[180:183], v[212:215], a[252:255], v[180:183]
s_waitcnt lgkmcnt(4)
v_exp_f32 v39, -v119
v_mfma_f32_16x16x32_bf16 v[168:171], v[216:219], v[224:227], v[168:171]
ds_read_b64_tr_b16 v[208:209], v13 offset:0
v_add_f32 v38, 1.0, v38
v_mfma_f32_16x16x32_bf16 v[168:171], v[220:223], v[240:243], v[168:171]
buffer_load_dwordx4 v2, s[24:27], s21 offen lds
v_mfma_f32_16x16x32_bf16 v[172:175], v[216:219], v[228:231], v[172:175]
ds_read_b64_tr_b16 v[210:211], v13 offset:2048
v_mul_f32 v125, v61, v125
v_mfma_f32_16x16x32_bf16 v[172:175], v[220:223], v[244:247], v[172:175]
v_rcp_f32 v37, v37
v_mfma_f32_16x16x32_bf16 v[176:179], v[216:219], v[232:235], v[176:179]
ds_read_b64_tr_b16 v[212:213], v13 offset:4096
v_mul_f32 v116, v116, v36
v_mfma_f32_16x16x32_bf16 v[176:179], v[220:223], v[248:251], v[176:179]
v_add_f32 v39, 1.0, v39
v_mul_f32 v126, v62, v126
v_mfma_f32_16x16x32_bf16 v[180:183], v[216:219], v[236:239], v[180:183]
v_mul_f32 v127, v63, v127
v_mul_f32 v128, v64, v128
v_mul_f32 v129, v65, v129
v_mul_f32 v130, v66, v130
v_mul_f32 v131, v67, v131
v_mul_f32 v132, v68, v132
v_mul_f32 v133, v69, v133
v_mul_f32 v134, v70, v134
v_mul_f32 v135, v71, v135
v_mfma_f32_16x16x32_bf16 v[180:183], v[220:223], v[252:255], v[180:183]
s_waitcnt lgkmcnt(3)
ds_read_b64_tr_b16 v[214:215], v13 offset:6144
v_mfma_f32_16x16x32_bf16 v[56:59], v[200:203], a[0:3], 0
ds_read_b64_tr_b16 v[216:217], v14 offset:0
v_mul_f32 v136, v72, v136
v_mfma_f32_16x16x32_bf16 v[56:59], v[204:207], a[16:19], v[56:59]
s_add_u32 m0, s17, 98304
v_rcp_f32 v38, v38
v_mfma_f32_16x16x32_bf16 v[60:63], v[200:203], a[4:7], 0
v_mul_f32 v117, v117, v37
v_rcp_f32 v39, v39
v_mul_f32 v118, v118, v38
v_mul_f32 v119, v119, v39
v_mfma_f32_16x16x32_bf16 v[60:63], v[204:207], a[20:23], v[60:63]
ds_read_b64_tr_b16 v[218:219], v14 offset:2048
v_mul_f32 v137, v73, v137
v_mfma_f32_16x16x32_bf16 v[64:67], v[200:203], a[8:11], 0
ds_read_b64_tr_b16 v[220:221], v14 offset:4096
v_mul_f32 v138, v74, v138
v_mfma_f32_16x16x32_bf16 v[64:67], v[204:207], a[24:27], v[64:67]
s_add_u32 s21, s36, 128
v_mul_f32 v139, v75, v139
v_mul_f32 v140, v76, v140
v_mfma_f32_16x16x32_bf16 v[68:71], v[200:203], a[12:15], 0
v_mul_f32 v141, v77, v141
v_mul_f32 v142, v78, v142
v_mul_f32 v143, v79, v143
v_mul_f32 v144, v80, v144
v_mul_f32 v145, v81, v145
v_mul_f32 v146, v82, v146
v_mul_f32 v147, v83, v147
v_mul_f32 v148, v84, v148
v_mul_f32 v149, v85, v149
v_mul_f32 v150, v86, v150
v_mul_f32 v151, v87, v151
v_mfma_f32_16x16x32_bf16 v[68:71], v[204:207], a[28:31], v[68:71]
s_waitcnt lgkmcnt(3)
ds_read_b64_tr_b16 v[222:223], v14 offset:6144
v_mfma_f32_16x16x32_bf16 v[72:75], v[208:211], a[0:3], 0
ds_read_b64_tr_b16 v[200:201], v15 offset:0
v_mul_f32 v152, v88, v152
v_mfma_f32_16x16x32_bf16 v[72:75], v[212:215], a[16:19], v[72:75]
v_mul_f32 v153, v89, v153
v_mul_f32 v154, v90, v154
v_mfma_f32_16x16x32_bf16 v[76:79], v[208:211], a[4:7], 0
ds_read_b64_tr_b16 v[202:203], v15 offset:2048
v_mul_f32 v155, v91, v155
v_mfma_f32_16x16x32_bf16 v[76:79], v[212:215], a[20:23], v[76:79]
buffer_load_dwordx4 v2, s[24:27], s21 offen lds
v_mfma_f32_16x16x32_bf16 v[80:83], v[208:211], a[8:11], 0
ds_read_b64_tr_b16 v[204:205], v15 offset:4096
v_mul_f32 v156, v92, v156
v_mfma_f32_16x16x32_bf16 v[80:83], v[212:215], a[24:27], v[80:83]
v_mul_f32 v157, v93, v157
v_mul_f32 v158, v94, v158
v_mfma_f32_16x16x32_bf16 v[84:87], v[208:211], a[12:15], 0
v_mul_f32 v159, v95, v159
v_mul_f32 v160, v96, v160
v_mul_f32 v161, v97, v161
v_mul_f32 v162, v98, v162
v_mul_f32 v163, v99, v163
v_mul_f32 v164, v100, v164
v_mul_f32 v165, v101, v165
v_mul_f32 v166, v102, v166
v_mul_f32 v167, v103, v167
v_mfma_f32_16x16x32_bf16 v[84:87], v[212:215], a[28:31], v[84:87]
s_waitcnt lgkmcnt(3)
ds_read_b64_tr_b16 v[206:207], v15 offset:6144
v_mfma_f32_16x16x32_bf16 v[88:91], v[216:219], a[0:3], 0
ds_read_b64_tr_b16 v[208:209], v12 offset:8192
v_mul_f32 v168, v104, v168
v_mfma_f32_16x16x32_bf16 v[88:91], v[220:223], a[16:19], v[88:91]
s_add_u32 m0, s17, 102400
v_mul_f32 v169, v105, v169
v_mul_f32 v170, v106, v170
v_mfma_f32_16x16x32_bf16 v[92:95], v[216:219], a[4:7], 0
ds_read_b64_tr_b16 v[210:211], v12 offset:10240
v_mul_f32 v171, v107, v171
v_mfma_f32_16x16x32_bf16 v[92:95], v[220:223], a[20:23], v[92:95]
v_mul_f32 v172, v108, v172
v_mul_f32 v173, v109, v173
v_mfma_f32_16x16x32_bf16 v[96:99], v[216:219], a[8:11], 0
ds_read_b64_tr_b16 v[212:213], v12 offset:12288
v_mul_f32 v174, v110, v174
v_mfma_f32_16x16x32_bf16 v[96:99], v[220:223], a[24:27], v[96:99]
s_add_u32 s21, s36, 295040
v_mul_f32 v175, v111, v175
v_mul_f32 v176, v112, v176
v_mfma_f32_16x16x32_bf16 v[100:103], v[216:219], a[12:15], 0
v_mul_f32 v177, v113, v177
v_mul_f32 v178, v114, v178
v_mul_f32 v179, v115, v179
v_mul_f32 v180, v116, v180
v_mul_f32 v181, v117, v181
v_mul_f32 v182, v118, v182
v_mul_f32 v183, v119, v183
v_mfma_f32_16x16x32_bf16 v[100:103], v[220:223], a[28:31], v[100:103]
s_waitcnt lgkmcnt(3)
ds_read_b64_tr_b16 v[214:215], v12 offset:14336
v_mfma_f32_16x16x32_bf16 v[104:107], v[200:203], a[0:3], 0
ds_read_b64_tr_b16 v[216:217], v13 offset:8192
v_add_u32 v10, 331776, v8
v_mfma_f32_16x16x32_bf16 v[104:107], v[204:207], a[16:19], v[104:107]
buffer_load_dwordx4 v2, s[24:27], s21 offen lds
v_mfma_f32_16x16x32_bf16 v[108:111], v[200:203], a[4:7], 0
ds_read_b64_tr_b16 v[218:219], v13 offset:10240
v_add_u32 v11, 497664, v8
v_mfma_f32_16x16x32_bf16 v[108:111], v[204:207], a[20:23], v[108:111]
s_mul_i32 s47, s46, 6144
s_add_u32 s61, s60, s47
s_mul_i32 s47, s46, 221184
v_mfma_f32_16x16x32_bf16 v[112:115], v[200:203], a[8:11], 0
s_add_u32 s63, s62, s47
ds_read_b64_tr_b16 v[220:221], v13 offset:12288
v_mfma_f32_16x16x32_bf16 v[112:115], v[204:207], a[24:27], v[112:115]
s_mul_i32 s47, s46, 30720
s_add_u32 s60, s60, s47
s_mul_i32 s47, s46, 1105920
v_mfma_f32_16x16x32_bf16 v[116:119], v[200:203], a[12:15], 0
ds_read_b64_tr_b16 v[222:223], v13 offset:14336
v_cvt_pk_bf16_f32 v120, v120, v121
v_mfma_f32_16x16x32_bf16 v[116:119], v[204:207], a[28:31], v[116:119]
s_waitcnt lgkmcnt(4)
s_add_u32 s62, s62, s47
s_mul_i32 s47, s46, 5
v_mfma_f32_16x16x32_bf16 v[56:59], v[208:211], a[32:35], v[56:59]
ds_read_b64_tr_b16 v[200:201], v14 offset:8192
v_min_u32 v26, 4, v1
v_mfma_f32_16x16x32_bf16 v[56:59], v[212:215], a[48:51], v[56:59]
s_add_u32 m0, s17, 106496
v_add_u32 v26, s47, v26
s_add_u32 s47, s46, 20
v_mfma_f32_16x16x32_bf16 v[60:63], v[208:211], a[36:39], v[60:63]
ds_read_b64_tr_b16 v[202:203], v14 offset:10240
v_cvt_pk_bf16_f32 v121, v122, v123
v_mfma_f32_16x16x32_bf16 v[60:63], v[212:215], a[52:55], v[60:63]
v_mov_b32 v42, s47
v_cmp_lt_u32 vcc, 4, v1
v_mfma_f32_16x16x32_bf16 v[64:67], v[208:211], a[40:43], v[64:67]
ds_read_b64_tr_b16 v[204:205], v14 offset:12288
v_cndmask_b32 v26, v26, v42, vcc
v_mfma_f32_16x16x32_bf16 v[64:67], v[212:215], a[56:59], v[64:67]
s_add_u32 s21, s38, 128
v_lshlrev_b32 v26, 2, v26
s_sub_u32 s22, s2, 64
v_mfma_f32_16x16x32_bf16 v[68:71], v[208:211], a[44:47], v[68:71]
ds_read_b64_tr_b16 v[206:207], v14 offset:14336
v_cvt_pk_bf16_f32 v122, v136, v137
v_mfma_f32_16x16x32_bf16 v[68:71], v[212:215], a[60:63], v[68:71]
s_waitcnt lgkmcnt(4)
s_lshl_b32 s22, s22, 2
s_add_u32 s22, s22, s16
v_mfma_f32_16x16x32_bf16 v[72:75], v[216:219], a[32:35], v[72:75]
s_lshl_b32 s22, s22, 13
ds_read_b64_tr_b16 v[208:209], v15 offset:8192
v_mfma_f32_16x16x32_bf16 v[72:75], v[220:223], a[48:51], v[72:75]
v_lshlrev_b32 v41, 5, v1
v_add_u32 v41, s22, v41
v_mfma_f32_16x16x32_bf16 v[76:79], v[216:219], a[36:39], v[76:79]
ds_read_b64_tr_b16 v[210:211], v15 offset:10240
v_cvt_pk_bf16_f32 v123, v138, v139
v_mfma_f32_16x16x32_bf16 v[76:79], v[220:223], a[52:55], v[76:79]
buffer_load_dwordx4 v2, s[24:27], s21 offen lds
v_mfma_f32_16x16x32_bf16 v[80:83], v[216:219], a[40:43], v[80:83]
ds_read_b64_tr_b16 v[212:213], v15 offset:12288
v_mfma_f32_16x16x32_bf16 v[80:83], v[220:223], a[56:59], v[80:83]
v_mfma_f32_16x16x32_bf16 v[84:87], v[216:219], a[44:47], v[84:87]
ds_read_b64_tr_b16 v[214:215], v15 offset:14336
v_mfma_f32_16x16x32_bf16 v[84:87], v[220:223], a[60:63], v[84:87]
s_waitcnt lgkmcnt(4)
s_add_u32 m0, s17, 110592
v_mfma_f32_16x16x32_bf16 v[88:91], v[200:203], a[32:35], v[88:91]
ds_read_b64_tr_b16 v[216:217], v12 offset:16384
v_mfma_f32_16x16x32_bf16 v[88:91], v[204:207], a[48:51], v[88:91]
buffer_store_dwordx4 v[120:123], v8, s[12:15], s40 offen offset:0 sc1
v_mfma_f32_16x16x32_bf16 v[92:95], v[200:203], a[36:39], v[92:95]
ds_read_b64_tr_b16 v[218:219], v12 offset:18432
v_cvt_pk_bf16_f32 v124, v124, v125
v_mfma_f32_16x16x32_bf16 v[92:95], v[204:207], a[52:55], v[92:95]
v_mfma_f32_16x16x32_bf16 v[96:99], v[200:203], a[40:43], v[96:99]
s_add_u32 s21, s38, 295040
ds_read_b64_tr_b16 v[220:221], v12 offset:20480
v_mfma_f32_16x16x32_bf16 v[96:99], v[204:207], a[56:59], v[96:99]
v_mfma_f32_16x16x32_bf16 v[100:103], v[200:203], a[44:47], v[100:103]
ds_read_b64_tr_b16 v[222:223], v12 offset:22528
v_cvt_pk_bf16_f32 v125, v126, v127
v_mfma_f32_16x16x32_bf16 v[100:103], v[204:207], a[60:63], v[100:103]
s_waitcnt lgkmcnt(4)
v_mfma_f32_16x16x32_bf16 v[104:107], v[208:211], a[32:35], v[104:107]
ds_read_b64_tr_b16 v[200:201], v13 offset:16384
v_mfma_f32_16x16x32_bf16 v[104:107], v[212:215], a[48:51], v[104:107]
buffer_load_dwordx4 v2, s[24:27], s21 offen lds
v_mfma_f32_16x16x32_bf16 v[108:111], v[208:211], a[36:39], v[108:111]
ds_read_b64_tr_b16 v[202:203], v13 offset:18432
v_cvt_pk_bf16_f32 v126, v140, v141
v_mfma_f32_16x16x32_bf16 v[108:111], v[212:215], a[52:55], v[108:111]
v_mfma_f32_16x16x32_bf16 v[112:115], v[208:211], a[40:43], v[112:115]
ds_read_b64_tr_b16 v[204:205], v13 offset:20480
v_mfma_f32_16x16x32_bf16 v[112:115], v[212:215], a[56:59], v[112:115]
v_mfma_f32_16x16x32_bf16 v[116:119], v[208:211], a[44:47], v[116:119]
ds_read_b64_tr_b16 v[206:207], v13 offset:22528
v_cvt_pk_bf16_f32 v127, v142, v143
v_mfma_f32_16x16x32_bf16 v[116:119], v[212:215], a[60:63], v[116:119]
s_waitcnt lgkmcnt(4)
v_mfma_f32_16x16x32_bf16 v[56:59], v[216:219], a[64:67], v[56:59]
s_add_u32 m0, s17, 114688
ds_read_b64_tr_b16 v[208:209], v14 offset:16384
v_mfma_f32_16x16x32_bf16 v[56:59], v[220:223], a[80:83], v[56:59]
v_mfma_f32_16x16x32_bf16 v[60:63], v[216:219], a[68:71], v[60:63]
ds_read_b64_tr_b16 v[210:211], v14 offset:18432
v_mfma_f32_16x16x32_bf16 v[60:63], v[220:223], a[84:87], v[60:63]
buffer_store_dwordx4 v[124:127], v9, s[12:15], s40 offen offset:0 sc1
v_mfma_f32_16x16x32_bf16 v[64:67], v[216:219], a[72:75], v[64:67]
s_add_u32 s21, s39, 128
ds_read_b64_tr_b16 v[212:213], v14 offset:20480
v_mfma_f32_16x16x32_bf16 v[64:67], v[220:223], a[88:91], v[64:67]
v_mfma_f32_16x16x32_bf16 v[68:71], v[216:219], a[76:79], v[68:71]
ds_read_b64_tr_b16 v[214:215], v14 offset:22528
v_cvt_pk_bf16_f32 v128, v128, v129
v_mfma_f32_16x16x32_bf16 v[68:71], v[220:223], a[92:95], v[68:71]
s_waitcnt lgkmcnt(4)
v_mfma_f32_16x16x32_bf16 v[72:75], v[200:203], a[64:67], v[72:75]
ds_read_b64_tr_b16 v[216:217], v15 offset:16384
v_mfma_f32_16x16x32_bf16 v[72:75], v[204:207], a[80:83], v[72:75]
buffer_load_dwordx4 v2, s[24:27], s21 offen lds
v_mfma_f32_16x16x32_bf16 v[76:79], v[200:203], a[68:71], v[76:79]
ds_read_b64_tr_b16 v[218:219], v15 offset:18432
v_cvt_pk_bf16_f32 v129, v130, v131
v_mfma_f32_16x16x32_bf16 v[76:79], v[204:207], a[84:87], v[76:79]
v_mfma_f32_16x16x32_bf16 v[80:83], v[200:203], a[72:75], v[80:83]
s_add_u32 m0, s17, 118784
ds_read_b64_tr_b16 v[220:221], v15 offset:20480
v_mfma_f32_16x16x32_bf16 v[80:83], v[204:207], a[88:91], v[80:83]
v_mfma_f32_16x16x32_bf16 v[84:87], v[200:203], a[76:79], v[84:87]
ds_read_b64_tr_b16 v[222:223], v15 offset:22528
v_cvt_pk_bf16_f32 v130, v144, v145
v_mfma_f32_16x16x32_bf16 v[84:87], v[204:207], a[92:95], v[84:87]
s_waitcnt lgkmcnt(4)
v_mfma_f32_16x16x32_bf16 v[88:91], v[208:211], a[64:67], v[88:91]
s_waitcnt vmcnt(19)
s_barrier
v_mfma_f32_16x16x32_bf16 v[88:91], v[212:215], a[80:83], v[88:91]
s_add_u32 s21, s39, 295040
ds_read_b64_tr_b16 v[200:201], v12 offset:24576
v_mfma_f32_16x16x32_bf16 v[92:95], v[208:211], a[68:71], v[92:95]
ds_read_b64_tr_b16 v[202:203], v12 offset:26624
v_cvt_pk_bf16_f32 v131, v146, v147
v_mfma_f32_16x16x32_bf16 v[92:95], v[212:215], a[84:87], v[92:95]
v_mfma_f32_16x16x32_bf16 v[96:99], v[208:211], a[72:75], v[96:99]
ds_read_b64_tr_b16 v[204:205], v12 offset:28672
v_mfma_f32_16x16x32_bf16 v[96:99], v[212:215], a[88:91], v[96:99]
buffer_load_dwordx4 v2, s[24:27], s21 offen lds
v_mfma_f32_16x16x32_bf16 v[100:103], v[208:211], a[76:79], v[100:103]
ds_read_b64_tr_b16 v[206:207], v12 offset:30720
v_mfma_f32_16x16x32_bf16 v[100:103], v[212:215], a[92:95], v[100:103]
s_waitcnt lgkmcnt(4)
v_mfma_f32_16x16x32_bf16 v[104:107], v[216:219], a[64:67], v[104:107]
ds_read_b64_tr_b16 v[208:209], v13 offset:24576
v_mfma_f32_16x16x32_bf16 v[104:107], v[220:223], a[80:83], v[104:107]
buffer_load_dword v40, v41, s[28:31], 0 offen offset:0
v_mfma_f32_16x16x32_bf16 v[108:111], v[216:219], a[68:71], v[108:111]
ds_read_b64_tr_b16 v[210:211], v13 offset:26624
v_mfma_f32_16x16x32_bf16 v[108:111], v[220:223], a[84:87], v[108:111]
buffer_store_dwordx4 v[128:131], v10, s[12:15], s40 offen offset:0 sc1
v_mfma_f32_16x16x32_bf16 v[112:115], v[216:219], a[72:75], v[112:115]
ds_read_b64_tr_b16 v[212:213], v13 offset:28672
v_cvt_pk_bf16_f32 v132, v132, v133
v_mfma_f32_16x16x32_bf16 v[112:115], v[220:223], a[88:91], v[112:115]
v_mfma_f32_16x16x32_bf16 v[116:119], v[216:219], a[76:79], v[116:119]
ds_read_b64_tr_b16 v[214:215], v13 offset:30720
v_cvt_pk_bf16_f32 v133, v134, v135
v_mfma_f32_16x16x32_bf16 v[116:119], v[220:223], a[92:95], v[116:119]
s_waitcnt lgkmcnt(4)
v_mfma_f32_16x16x32_bf16 v[56:59], v[200:203], a[96:99], v[56:59]
s_add_u32 m0, s17, 122880
ds_read_b64_tr_b16 v[216:217], v14 offset:24576
v_mfma_f32_16x16x32_bf16 v[56:59], v[204:207], a[112:115], v[56:59]
v_mfma_f32_16x16x32_bf16 v[60:63], v[200:203], a[100:103], v[60:63]
ds_read_b64_tr_b16 v[218:219], v14 offset:26624
v_cvt_pk_bf16_f32 v134, v148, v149
v_mfma_f32_16x16x32_bf16 v[60:63], v[204:207], a[116:119], v[60:63]
v_mfma_f32_16x16x32_bf16 v[64:67], v[200:203], a[104:107], v[64:67]
ds_read_b64_tr_b16 v[220:221], v14 offset:28672
v_mfma_f32_16x16x32_bf16 v[64:67], v[204:207], a[120:123], v[64:67]
s_add_u32 s21, s42, 128
v_mfma_f32_16x16x32_bf16 v[68:71], v[200:203], a[108:111], v[68:71]
ds_read_b64_tr_b16 v[222:223], v14 offset:30720
v_cvt_pk_bf16_f32 v135, v150, v151
v_mfma_f32_16x16x32_bf16 v[68:71], v[204:207], a[124:127], v[68:71]
s_waitcnt lgkmcnt(4)
v_mfma_f32_16x16x32_bf16 v[72:75], v[208:211], a[96:99], v[72:75]
ds_read_b64_tr_b16 v[200:201], v15 offset:24576
v_mfma_f32_16x16x32_bf16 v[72:75], v[212:215], a[112:115], v[72:75]
v_mfma_f32_16x16x32_bf16 v[76:79], v[208:211], a[100:103], v[76:79]
ds_read_b64_tr_b16 v[202:203], v15 offset:26624
v_mfma_f32_16x16x32_bf16 v[76:79], v[212:215], a[116:119], v[76:79]
buffer_load_dwordx4 v2, s[24:27], s21 offen lds
v_mfma_f32_16x16x32_bf16 v[80:83], v[208:211], a[104:107], v[80:83]
ds_read_b64_tr_b16 v[204:205], v15 offset:28672
v_mfma_f32_16x16x32_bf16 v[80:83], v[212:215], a[120:123], v[80:83]
buffer_store_dwordx4 v[132:135], v11, s[12:15], s40 offen offset:0 sc1
v_mfma_f32_16x16x32_bf16 v[84:87], v[208:211], a[108:111], v[84:87]
ds_read_b64_tr_b16 v[206:207], v15 offset:30720
v_cvt_pk_bf16_f32 v152, v152, v153
v_mfma_f32_16x16x32_bf16 v[84:87], v[212:215], a[124:127], v[84:87]
s_waitcnt lgkmcnt(4)
s_add_u32 m0, s17, 126976
v_mfma_f32_16x16x32_bf16 v[88:91], v[216:219], a[96:99], v[88:91]
ds_read_b64_tr_b16 v[208:209], v12 offset:32768
v_mfma_f32_16x16x32_bf16 v[88:91], v[220:223], a[112:115], v[88:91]
v_mfma_f32_16x16x32_bf16 v[92:95], v[216:219], a[100:103], v[92:95]
ds_read_b64_tr_b16 v[210:211], v12 offset:34816
v_cvt_pk_bf16_f32 v153, v154, v155
v_mfma_f32_16x16x32_bf16 v[92:95], v[220:223], a[116:119], v[92:95]
v_mfma_f32_16x16x32_bf16 v[96:99], v[216:219], a[104:107], v[96:99]
s_add_u32 s21, s42, 295040
ds_read_b64_tr_b16 v[212:213], v12 offset:36864
v_mfma_f32_16x16x32_bf16 v[96:99], v[220:223], a[120:123], v[96:99]
v_mfma_f32_16x16x32_bf16 v[100:103], v[216:219], a[108:111], v[100:103]
ds_read_b64_tr_b16 v[214:215], v12 offset:38912
v_cvt_pk_bf16_f32 v154, v168, v169
v_mfma_f32_16x16x32_bf16 v[100:103], v[220:223], a[124:127], v[100:103]
s_waitcnt lgkmcnt(4)
v_mfma_f32_16x16x32_bf16 v[104:107], v[200:203], a[96:99], v[104:107]
ds_read_b64_tr_b16 v[216:217], v13 offset:32768
v_mfma_f32_16x16x32_bf16 v[104:107], v[204:207], a[112:115], v[104:107]
buffer_load_dwordx4 v2, s[24:27], s21 offen lds
v_mfma_f32_16x16x32_bf16 v[108:111], v[200:203], a[100:103], v[108:111]
ds_read_b64_tr_b16 v[218:219], v13 offset:34816
v_cvt_pk_bf16_f32 v155, v170, v171
v_mfma_f32_16x16x32_bf16 v[108:111], v[204:207], a[116:119], v[108:111]
v_mfma_f32_16x16x32_bf16 v[112:115], v[200:203], a[104:107], v[112:115]
ds_read_b64_tr_b16 v[220:221], v13 offset:36864
v_mfma_f32_16x16x32_bf16 v[112:115], v[204:207], a[120:123], v[112:115]
v_mfma_f32_16x16x32_bf16 v[116:119], v[200:203], a[108:111], v[116:119]
ds_read_b64_tr_b16 v[222:223], v13 offset:38912
v_mfma_f32_16x16x32_bf16 v[116:119], v[204:207], a[124:127], v[116:119]
s_waitcnt lgkmcnt(4)
v_mfma_f32_16x16x32_bf16 v[56:59], v[208:211], a[128:131], v[56:59]
s_add_u32 m0, s17, 131072
ds_read_b64_tr_b16 v[200:201], v14 offset:32768
v_mfma_f32_16x16x32_bf16 v[56:59], v[212:215], a[144:147], v[56:59]
buffer_store_dwordx4 v[152:155], v8, s[12:15], s40 offen offset:1024 sc1
v_mfma_f32_16x16x32_bf16 v[60:63], v[208:211], a[132:135], v[60:63]
ds_read_b64_tr_b16 v[202:203], v14 offset:34816
v_cvt_pk_bf16_f32 v156, v156, v157
v_mfma_f32_16x16x32_bf16 v[60:63], v[212:215], a[148:151], v[60:63]
v_mfma_f32_16x16x32_bf16 v[64:67], v[208:211], a[136:139], v[64:67]
ds_read_b64_tr_b16 v[204:205], v14 offset:36864
v_mfma_f32_16x16x32_bf16 v[64:67], v[212:215], a[152:155], v[64:67]
s_add_u32 s21, s43, 128
v_mfma_f32_16x16x32_bf16 v[68:71], v[208:211], a[140:143], v[68:71]
ds_read_b64_tr_b16 v[206:207], v14 offset:38912
v_cvt_pk_bf16_f32 v157, v158, v159
v_mfma_f32_16x16x32_bf16 v[68:71], v[212:215], a[156:159], v[68:71]
s_waitcnt lgkmcnt(4)
v_mfma_f32_16x16x32_bf16 v[72:75], v[216:219], a[128:131], v[72:75]
ds_read_b64_tr_b16 v[208:209], v15 offset:32768
v_mfma_f32_16x16x32_bf16 v[72:75], v[220:223], a[144:147], v[72:75]
v_mfma_f32_16x16x32_bf16 v[76:79], v[216:219], a[132:135], v[76:79]
ds_read_b64_tr_b16 v[210:211], v15 offset:34816
v_cvt_pk_bf16_f32 v158, v172, v173
v_mfma_f32_16x16x32_bf16 v[76:79], v[220:223], a[148:151], v[76:79]
buffer_load_dwordx4 v2, s[24:27], s21 offen lds
v_mfma_f32_16x16x32_bf16 v[80:83], v[216:219], a[136:139], v[80:83]
ds_read_b64_tr_b16 v[212:213], v15 offset:36864
v_mfma_f32_16x16x32_bf16 v[80:83], v[220:223], a[152:155], v[80:83]
v_mfma_f32_16x16x32_bf16 v[84:87], v[216:219], a[140:143], v[84:87]
ds_read_b64_tr_b16 v[214:215], v15 offset:38912
v_cvt_pk_bf16_f32 v159, v174, v175
v_mfma_f32_16x16x32_bf16 v[84:87], v[220:223], a[156:159], v[84:87]
s_waitcnt lgkmcnt(4)
s_add_u32 m0, s17, 135168
v_mfma_f32_16x16x32_bf16 v[88:91], v[200:203], a[128:131], v[88:91]
ds_read_b64_tr_b16 v[216:217], v12 offset:40960
v_mfma_f32_16x16x32_bf16 v[88:91], v[204:207], a[144:147], v[88:91]
v_mfma_f32_16x16x32_bf16 v[92:95], v[200:203], a[132:135], v[92:95]
ds_read_b64_tr_b16 v[218:219], v12 offset:43008
v_mfma_f32_16x16x32_bf16 v[92:95], v[204:207], a[148:151], v[92:95]
buffer_store_dwordx4 v[156:159], v9, s[12:15], s40 offen offset:1024 sc1
v_mfma_f32_16x16x32_bf16 v[96:99], v[200:203], a[136:139], v[96:99]
s_add_u32 s21, s43, 295040
ds_read_b64_tr_b16 v[220:221], v12 offset:45056
v_mfma_f32_16x16x32_bf16 v[96:99], v[204:207], a[152:155], v[96:99]
v_mfma_f32_16x16x32_bf16 v[100:103], v[200:203], a[140:143], v[100:103]
ds_read_b64_tr_b16 v[222:223], v12 offset:47104
v_cvt_pk_bf16_f32 v160, v160, v161
v_mfma_f32_16x16x32_bf16 v[100:103], v[204:207], a[156:159], v[100:103]
s_waitcnt lgkmcnt(4)
v_mfma_f32_16x16x32_bf16 v[104:107], v[208:211], a[128:131], v[104:107]
ds_read_b64_tr_b16 v[200:201], v13 offset:40960
v_mfma_f32_16x16x32_bf16 v[104:107], v[212:215], a[144:147], v[104:107]
buffer_load_dwordx4 v2, s[24:27], s21 offen lds
v_mfma_f32_16x16x32_bf16 v[108:111], v[208:211], a[132:135], v[108:111]
ds_read_b64_tr_b16 v[202:203], v13 offset:43008
v_cvt_pk_bf16_f32 v161, v162, v163
v_mfma_f32_16x16x32_bf16 v[108:111], v[212:215], a[148:151], v[108:111]
v_mfma_f32_16x16x32_bf16 v[112:115], v[208:211], a[136:139], v[112:115]
ds_read_b64_tr_b16 v[204:205], v13 offset:45056
v_mfma_f32_16x16x32_bf16 v[112:115], v[212:215], a[152:155], v[112:115]
v_mfma_f32_16x16x32_bf16 v[116:119], v[208:211], a[140:143], v[116:119]
ds_read_b64_tr_b16 v[206:207], v13 offset:47104
v_cvt_pk_bf16_f32 v162, v176, v177
v_mfma_f32_16x16x32_bf16 v[116:119], v[212:215], a[156:159], v[116:119]
s_waitcnt lgkmcnt(4)
v_mfma_f32_16x16x32_bf16 v[56:59], v[216:219], a[160:163], v[56:59]
s_add_u32 m0, s17, 139264
ds_read_b64_tr_b16 v[208:209], v14 offset:40960
v_mfma_f32_16x16x32_bf16 v[56:59], v[220:223], a[176:179], v[56:59]
v_mfma_f32_16x16x32_bf16 v[60:63], v[216:219], a[164:167], v[60:63]
ds_read_b64_tr_b16 v[210:211], v14 offset:43008
v_cvt_pk_bf16_f32 v163, v178, v179
v_mfma_f32_16x16x32_bf16 v[60:63], v[220:223], a[180:183], v[60:63]
s_add_u32 s21, s0, 128
v_mfma_f32_16x16x32_bf16 v[64:67], v[216:219], a[168:171], v[64:67]
ds_read_b64_tr_b16 v[212:213], v14 offset:45056
v_mfma_f32_16x16x32_bf16 v[64:67], v[220:223], a[184:187], v[64:67]
v_mfma_f32_16x16x32_bf16 v[68:71], v[216:219], a[172:175], v[68:71]
ds_read_b64_tr_b16 v[214:215], v14 offset:47104
v_mfma_f32_16x16x32_bf16 v[68:71], v[220:223], a[188:191], v[68:71]
s_waitcnt lgkmcnt(4)
v_mfma_f32_16x16x32_bf16 v[72:75], v[200:203], a[160:163], v[72:75]
ds_read_b64_tr_b16 v[216:217], v15 offset:40960
v_mfma_f32_16x16x32_bf16 v[72:75], v[204:207], a[176:179], v[72:75]
buffer_load_dwordx4 v2, s[24:27], s21 offen lds
v_mfma_f32_16x16x32_bf16 v[76:79], v[200:203], a[164:167], v[76:79]
ds_read_b64_tr_b16 v[218:219], v15 offset:43008
v_mfma_f32_16x16x32_bf16 v[76:79], v[204:207], a[180:183], v[76:79]
buffer_store_dwordx4 v[160:163], v10, s[12:15], s40 offen offset:1024 sc1
v_mfma_f32_16x16x32_bf16 v[80:83], v[200:203], a[168:171], v[80:83]
ds_read_b64_tr_b16 v[220:221], v15 offset:45056
v_cvt_pk_bf16_f32 v164, v164, v165
v_mfma_f32_16x16x32_bf16 v[80:83], v[204:207], a[184:187], v[80:83]
s_add_u32 m0, s17, 143360
v_mfma_f32_16x16x32_bf16 v[84:87], v[200:203], a[172:175], v[84:87]
ds_read_b64_tr_b16 v[222:223], v15 offset:47104
v_cvt_pk_bf16_f32 v165, v166, v167
v_mfma_f32_16x16x32_bf16 v[84:87], v[204:207], a[188:191], v[84:87]
s_waitcnt lgkmcnt(4)
s_add_u32 s21, s0, 295040
v_mfma_f32_16x16x32_bf16 v[88:91], v[208:211], a[160:163], v[88:91]
s_waitcnt vmcnt(25)
s_barrier
v_mfma_f32_16x16x32_bf16 v[88:91], v[212:215], a[176:179], v[88:91]
ds_read_b64_tr_b16 v[200:201], v16 offset:0
v_mfma_f32_16x16x32_bf16 v[92:95], v[208:211], a[164:167], v[92:95]
ds_read_b64_tr_b16 v[202:203], v16 offset:2048
v_cvt_pk_bf16_f32 v166, v180, v181
v_mfma_f32_16x16x32_bf16 v[92:95], v[212:215], a[180:183], v[92:95]
buffer_load_dwordx4 v2, s[24:27], s21 offen lds
v_mfma_f32_16x16x32_bf16 v[96:99], v[208:211], a[168:171], v[96:99]
ds_read_b64_tr_b16 v[204:205], v16 offset:4096
v_mfma_f32_16x16x32_bf16 v[96:99], v[212:215], a[184:187], v[96:99]
v_mfma_f32_16x16x32_bf16 v[100:103], v[208:211], a[172:175], v[100:103]
ds_read_b64_tr_b16 v[206:207], v16 offset:6144
v_cvt_pk_bf16_f32 v167, v182, v183
v_mfma_f32_16x16x32_bf16 v[100:103], v[212:215], a[188:191], v[100:103]
s_waitcnt lgkmcnt(4)
v_mfma_f32_16x16x32_bf16 v[104:107], v[216:219], a[160:163], v[104:107]
ds_read_b64_tr_b16 v[208:209], v16 offset:8192
v_mfma_f32_16x16x32_bf16 v[104:107], v[220:223], a[176:179], v[104:107]
buffer_load_dword v40, v41, s[28:31], 0 offen offset:2048
v_mfma_f32_16x16x32_bf16 v[108:111], v[216:219], a[164:167], v[108:111]
ds_read_b64_tr_b16 v[210:211], v16 offset:10240
v_add_u32 v41, 4096, v41
v_mfma_f32_16x16x32_bf16 v[108:111], v[220:223], a[180:183], v[108:111]
buffer_store_dwordx4 v[164:167], v11, s[12:15], s40 offen offset:1024 sc1
v_mfma_f32_16x16x32_bf16 v[112:115], v[216:219], a[168:171], v[112:115]
ds_read_b64_tr_b16 v[212:213], v16 offset:12288
v_mfma_f32_16x16x32_bf16 v[112:115], v[220:223], a[184:187], v[112:115]
v_mfma_f32_16x16x32_bf16 v[116:119], v[216:219], a[172:175], v[116:119]
ds_read_b64_tr_b16 v[214:215], v16 offset:14336
v_mfma_f32_16x16x32_bf16 v[116:119], v[220:223], a[188:191], v[116:119]
s_waitcnt lgkmcnt(4)
v_mfma_f32_16x16x32_bf16 v[56:59], v[200:203], a[192:195], v[56:59]
s_add_u32 m0, s17, 0
ds_read_b64_tr_b16 v[216:217], v16 offset:16384
v_mfma_f32_16x16x32_bf16 v[56:59], v[204:207], a[208:211], v[56:59]
v_mfma_f32_16x16x32_bf16 v[60:63], v[200:203], a[196:199], v[60:63]
ds_read_b64_tr_b16 v[218:219], v16 offset:18432
v_mfma_f32_16x16x32_bf16 v[60:63], v[204:207], a[212:215], v[60:63]
v_mfma_f32_16x16x32_bf16 v[64:67], v[200:203], a[200:203], v[64:67]
ds_read_b64_tr_b16 v[220:221], v16 offset:20480
v_mfma_f32_16x16x32_bf16 v[64:67], v[204:207], a[216:219], v[64:67]
s_add_u32 s21, s33, 256
v_mfma_f32_16x16x32_bf16 v[68:71], v[200:203], a[204:207], v[68:71]
ds_read_b64_tr_b16 v[222:223], v16 offset:22528
v_mfma_f32_16x16x32_bf16 v[68:71], v[204:207], a[220:223], v[68:71]
s_waitcnt lgkmcnt(4)
v_mfma_f32_16x16x32_bf16 v[56:59], v[208:211], a[224:227], v[56:59]
ds_read_b64_tr_b16 v[200:201], v17 offset:0
v_mfma_f32_16x16x32_bf16 v[56:59], v[212:215], a[240:243], v[56:59]
v_mfma_f32_16x16x32_bf16 v[60:63], v[208:211], a[228:231], v[60:63]
ds_read_b64_tr_b16 v[202:203], v17 offset:2048
v_mfma_f32_16x16x32_bf16 v[60:63], v[212:215], a[244:247], v[60:63]
buffer_load_dwordx4 v2, s[8:11], s21 offen lds
v_mfma_f32_16x16x32_bf16 v[64:67], v[208:211], a[232:235], v[64:67]
ds_read_b64_tr_b16 v[204:205], v17 offset:4096
v_mfma_f32_16x16x32_bf16 v[64:67], v[212:215], a[248:251], v[64:67]
v_mfma_f32_16x16x32_bf16 v[68:71], v[208:211], a[236:239], v[68:71]
ds_read_b64_tr_b16 v[206:207], v17 offset:6144
v_mfma_f32_16x16x32_bf16 v[68:71], v[212:215], a[252:255], v[68:71]
s_waitcnt lgkmcnt(4)
s_add_u32 m0, s17, 4096
v_mfma_f32_16x16x32_bf16 v[56:59], v[216:219], v[224:227], v[56:59]
ds_read_b64_tr_b16 v[208:209], v17 offset:8192
v_mfma_f32_16x16x32_bf16 v[56:59], v[220:223], v[240:243], v[56:59]
v_mfma_f32_16x16x32_bf16 v[60:63], v[216:219], v[228:231], v[60:63]
ds_read_b64_tr_b16 v[210:211], v17 offset:10240
v_mfma_f32_16x16x32_bf16 v[60:63], v[220:223], v[244:247], v[60:63]
v_mfma_f32_16x16x32_bf16 v[64:67], v[216:219], v[232:235], v[64:67]
s_add_u32 s21, s33, 295168
ds_read_b64_tr_b16 v[212:213], v17 offset:12288
v_mfma_f32_16x16x32_bf16 v[64:67], v[220:223], v[248:251], v[64:67]
v_mfma_f32_16x16x32_bf16 v[68:71], v[216:219], v[236:239], v[68:71]
ds_read_b64_tr_b16 v[214:215], v17 offset:14336
v_mfma_f32_16x16x32_bf16 v[68:71], v[220:223], v[252:255], v[68:71]
s_waitcnt lgkmcnt(4)
v_mfma_f32_16x16x32_bf16 v[72:75], v[200:203], a[192:195], v[72:75]
ds_read_b64_tr_b16 v[216:217], v17 offset:16384
v_mfma_f32_16x16x32_bf16 v[72:75], v[204:207], a[208:211], v[72:75]
buffer_load_dwordx4 v2, s[8:11], s21 offen lds
v_mfma_f32_16x16x32_bf16 v[76:79], v[200:203], a[196:199], v[76:79]
ds_read_b64_tr_b16 v[218:219], v17 offset:18432
v_mfma_f32_16x16x32_bf16 v[76:79], v[204:207], a[212:215], v[76:79]
v_exp_f32 v32, -v56
v_mfma_f32_16x16x32_bf16 v[80:83], v[200:203], a[200:203], v[80:83]
ds_read_b64_tr_b16 v[220:221], v17 offset:20480
v_mfma_f32_16x16x32_bf16 v[80:83], v[204:207], a[216:219], v[80:83]
v_exp_f32 v33, -v57
v_mfma_f32_16x16x32_bf16 v[84:87], v[200:203], a[204:207], v[84:87]
ds_read_b64_tr_b16 v[222:223], v17 offset:22528
v_add_f32 v32, 1.0, v32
v_mfma_f32_16x16x32_bf16 v[84:87], v[204:207], a[220:223], v[84:87]
s_waitcnt lgkmcnt(4)
v_exp_f32 v34, -v58
v_mfma_f32_16x16x32_bf16 v[72:75], v[208:211], a[224:227], v[72:75]
ds_read_b64_tr_b16 v[200:201], v18 offset:0
v_add_f32 v33, 1.0, v33
v_mfma_f32_16x16x32_bf16 v[72:75], v[212:215], a[240:243], v[72:75]
s_add_u32 m0, s17, 8192
v_rcp_f32 v32, v32
v_mfma_f32_16x16x32_bf16 v[76:79], v[208:211], a[228:231], v[76:79]
ds_read_b64_tr_b16 v[202:203], v18 offset:2048
v_mfma_f32_16x16x32_bf16 v[76:79], v[212:215], a[244:247], v[76:79]
v_exp_f32 v35, -v59
v_mfma_f32_16x16x32_bf16 v[80:83], v[208:211], a[232:235], v[80:83]
ds_read_b64_tr_b16 v[204:205], v18 offset:4096
v_add_f32 v34, 1.0, v34
v_mfma_f32_16x16x32_bf16 v[80:83], v[212:215], a[248:251], v[80:83]
s_add_u32 s21, s34, 256
v_rcp_f32 v33, v33
v_mfma_f32_16x16x32_bf16 v[84:87], v[208:211], a[236:239], v[84:87]
ds_read_b64_tr_b16 v[206:207], v18 offset:6144
v_mul_f32 v56, v56, v32
v_mfma_f32_16x16x32_bf16 v[84:87], v[212:215], a[252:255], v[84:87]
s_waitcnt lgkmcnt(4)
v_exp_f32 v36, -v60
v_mfma_f32_16x16x32_bf16 v[72:75], v[216:219], v[224:227], v[72:75]
ds_read_b64_tr_b16 v[208:209], v18 offset:8192
v_add_f32 v35, 1.0, v35
v_mfma_f32_16x16x32_bf16 v[72:75], v[220:223], v[240:243], v[72:75]
v_rcp_f32 v34, v34
v_mfma_f32_16x16x32_bf16 v[76:79], v[216:219], v[228:231], v[76:79]
ds_read_b64_tr_b16 v[210:211], v18 offset:10240
v_mul_f32 v57, v57, v33
v_mfma_f32_16x16x32_bf16 v[76:79], v[220:223], v[244:247], v[76:79]
buffer_load_dwordx4 v2, s[8:11], s21 offen lds
v_mfma_f32_16x16x32_bf16 v[80:83], v[216:219], v[232:235], v[80:83]
ds_read_b64_tr_b16 v[212:213], v18 offset:12288
v_mfma_f32_16x16x32_bf16 v[80:83], v[220:223], v[248:251], v[80:83]
v_exp_f32 v37, -v61
v_mfma_f32_16x16x32_bf16 v[84:87], v[216:219], v[236:239], v[84:87]
ds_read_b64_tr_b16 v[214:215], v18 offset:14336
v_add_f32 v36, 1.0, v36
v_mfma_f32_16x16x32_bf16 v[84:87], v[220:223], v[252:255], v[84:87]
s_waitcnt lgkmcnt(4)
v_rcp_f32 v35, v35
v_mfma_f32_16x16x32_bf16 v[88:91], v[200:203], a[192:195], v[88:91]
ds_read_b64_tr_b16 v[216:217], v18 offset:16384
v_mul_f32 v58, v58, v34
v_mfma_f32_16x16x32_bf16 v[88:91], v[204:207], a[208:211], v[88:91]
s_add_u32 m0, s17, 12288
v_exp_f32 v38, -v62
v_mfma_f32_16x16x32_bf16 v[92:95], v[200:203], a[196:199], v[92:95]
ds_read_b64_tr_b16 v[218:219], v18 offset:18432
v_add_f32 v37, 1.0, v37
v_mfma_f32_16x16x32_bf16 v[92:95], v[204:207], a[212:215], v[92:95]
v_rcp_f32 v36, v36
v_mfma_f32_16x16x32_bf16 v[96:99], v[200:203], a[200:203], v[96:99]
ds_read_b64_tr_b16 v[220:221], v18 offset:20480
v_mul_f32 v59, v59, v35
v_mfma_f32_16x16x32_bf16 v[96:99], v[204:207], a[216:219], v[96:99]
s_add_u32 s21, s34, 295168
v_exp_f32 v39, -v63
v_mfma_f32_16x16x32_bf16 v[100:103], v[200:203], a[204:207], v[100:103]
ds_read_b64_tr_b16 v[222:223], v18 offset:22528
v_add_f32 v38, 1.0, v38
v_mfma_f32_16x16x32_bf16 v[100:103], v[204:207], a[220:223], v[100:103]
s_waitcnt lgkmcnt(4)
v_rcp_f32 v37, v37
v_mfma_f32_16x16x32_bf16 v[88:91], v[208:211], a[224:227], v[88:91]
ds_read_b64_tr_b16 v[200:201], v19 offset:0
v_mul_f32 v60, v60, v36
v_mfma_f32_16x16x32_bf16 v[88:91], v[212:215], a[240:243], v[88:91]
buffer_load_dwordx4 v2, s[8:11], s21 offen lds
v_mfma_f32_16x16x32_bf16 v[92:95], v[208:211], a[228:231], v[92:95]
ds_read_b64_tr_b16 v[202:203], v19 offset:2048
v_mfma_f32_16x16x32_bf16 v[92:95], v[212:215], a[244:247], v[92:95]
v_exp_f32 v32, -v64
v_mfma_f32_16x16x32_bf16 v[96:99], v[208:211], a[232:235], v[96:99]
ds_read_b64_tr_b16 v[204:205], v19 offset:4096
v_add_f32 v39, 1.0, v39
v_mfma_f32_16x16x32_bf16 v[96:99], v[212:215], a[248:251], v[96:99]
v_rcp_f32 v38, v38
v_mfma_f32_16x16x32_bf16 v[100:103], v[208:211], a[236:239], v[100:103]
ds_read_b64_tr_b16 v[206:207], v19 offset:6144
v_mul_f32 v61, v61, v37
v_mfma_f32_16x16x32_bf16 v[100:103], v[212:215], a[252:255], v[100:103]
s_waitcnt lgkmcnt(4)
v_exp_f32 v33, -v65
v_mfma_f32_16x16x32_bf16 v[88:91], v[216:219], v[224:227], v[88:91]
ds_read_b64_tr_b16 v[208:209], v19 offset:8192
v_add_f32 v32, 1.0, v32
v_mfma_f32_16x16x32_bf16 v[88:91], v[220:223], v[240:243], v[88:91]
s_add_u32 m0, s17, 16384
v_rcp_f32 v39, v39
v_mfma_f32_16x16x32_bf16 v[92:95], v[216:219], v[228:231], v[92:95]
ds_read_b64_tr_b16 v[210:211], v19 offset:10240
v_mul_f32 v62, v62, v38
v_mfma_f32_16x16x32_bf16 v[92:95], v[220:223], v[244:247], v[92:95]
v_exp_f32 v34, -v66
v_mfma_f32_16x16x32_bf16 v[96:99], v[216:219], v[232:235], v[96:99]
ds_read_b64_tr_b16 v[212:213], v19 offset:12288
v_add_f32 v33, 1.0, v33
v_mfma_f32_16x16x32_bf16 v[96:99], v[220:223], v[248:251], v[96:99]
s_add_u32 s21, s35, 256
v_rcp_f32 v32, v32
v_mfma_f32_16x16x32_bf16 v[100:103], v[216:219], v[236:239], v[100:103]
ds_read_b64_tr_b16 v[214:215], v19 offset:14336
v_mul_f32 v63, v63, v39
v_mfma_f32_16x16x32_bf16 v[100:103], v[220:223], v[252:255], v[100:103]
s_waitcnt lgkmcnt(4)
v_exp_f32 v35, -v67
v_mfma_f32_16x16x32_bf16 v[104:107], v[200:203], a[192:195], v[104:107]
ds_read_b64_tr_b16 v[216:217], v19 offset:16384
v_add_f32 v34, 1.0, v34
v_mfma_f32_16x16x32_bf16 v[104:107], v[204:207], a[208:211], v[104:107]
buffer_load_dwordx4 v2, s[8:11], s21 offen lds
v_mfma_f32_16x16x32_bf16 v[108:111], v[200:203], a[196:199], v[108:111]
ds_read_b64_tr_b16 v[218:219], v19 offset:18432
v_mfma_f32_16x16x32_bf16 v[108:111], v[204:207], a[212:215], v[108:111]
v_rcp_f32 v33, v33
v_mfma_f32_16x16x32_bf16 v[112:115], v[200:203], a[200:203], v[112:115]
ds_read_b64_tr_b16 v[220:221], v19 offset:20480
v_mul_f32 v64, v64, v32
v_mfma_f32_16x16x32_bf16 v[112:115], v[204:207], a[216:219], v[112:115]
s_add_u32 m0, s17, 20480
v_exp_f32 v36, -v68
v_mfma_f32_16x16x32_bf16 v[116:119], v[200:203], a[204:207], v[116:119]
ds_read_b64_tr_b16 v[222:223], v19 offset:22528
v_add_f32 v35, 1.0, v35
v_mfma_f32_16x16x32_bf16 v[116:119], v[204:207], a[220:223], v[116:119]
s_waitcnt lgkmcnt(4)
v_rcp_f32 v34, v34
v_mfma_f32_16x16x32_bf16 v[104:107], v[208:211], a[224:227], v[104:107]
s_waitcnt vmcnt(27)
s_barrier
v_mul_f32 v65, v65, v33
v_mfma_f32_16x16x32_bf16 v[104:107], v[212:215], a[240:243], v[104:107]
s_add_u32 s21, s35, 295168
ds_read_b64_tr_b16 v[200:201], v16 offset:24576
v_mfma_f32_16x16x32_bf16 v[108:111], v[208:211], a[228:231], v[108:111]
ds_read_b64_tr_b16 v[202:203], v16 offset:26624
v_mfma_f32_16x16x32_bf16 v[108:111], v[212:215], a[244:247], v[108:111]
v_exp_f32 v37, -v69
v_mfma_f32_16x16x32_bf16 v[112:115], v[208:211], a[232:235], v[112:115]
ds_read_b64_tr_b16 v[204:205], v16 offset:28672
v_add_f32 v36, 1.0, v36
v_mfma_f32_16x16x32_bf16 v[112:115], v[212:215], a[248:251], v[112:115]
buffer_load_dwordx4 v2, s[8:11], s21 offen lds
v_mfma_f32_16x16x32_bf16 v[116:119], v[208:211], a[236:239], v[116:119]
ds_read_b64_tr_b16 v[206:207], v16 offset:30720
v_mfma_f32_16x16x32_bf16 v[116:119], v[212:215], a[252:255], v[116:119]
s_waitcnt lgkmcnt(4)
v_rcp_f32 v35, v35
v_mfma_f32_16x16x32_bf16 v[104:107], v[216:219], v[224:227], v[104:107]
ds_read_b64_tr_b16 v[208:209], v17 offset:24576
v_mul_f32 v66, v66, v34
v_mfma_f32_16x16x32_bf16 v[104:107], v[220:223], v[240:243], v[104:107]
buffer_load_dword v40, v41, s[28:31], 0 offen offset:0
v_mfma_f32_16x16x32_bf16 v[108:111], v[216:219], v[228:231], v[108:111]
ds_read_b64_tr_b16 v[210:211], v17 offset:26624
v_mfma_f32_16x16x32_bf16 v[108:111], v[220:223], v[244:247], v[108:111]
v_exp_f32 v38, -v70
v_mfma_f32_16x16x32_bf16 v[112:115], v[216:219], v[232:235], v[112:115]
ds_read_b64_tr_b16 v[212:213], v17 offset:28672
v_add_f32 v37, 1.0, v37
v_mfma_f32_16x16x32_bf16 v[112:115], v[220:223], v[248:251], v[112:115]
v_rcp_f32 v36, v36
v_mfma_f32_16x16x32_bf16 v[116:119], v[216:219], v[236:239], v[116:119]
ds_read_b64_tr_b16 v[214:215], v17 offset:30720
v_mul_f32 v67, v67, v35
v_mfma_f32_16x16x32_bf16 v[116:119], v[220:223], v[252:255], v[116:119]
s_waitcnt lgkmcnt(4)
v_exp_f32 v39, -v71
v_mfma_f32_16x16x32_bf16 v[120:123], v[200:203], a[0:3], 0
ds_read_b64_tr_b16 v[216:217], v18 offset:24576
v_add_f32 v38, 1.0, v38
v_mfma_f32_16x16x32_bf16 v[120:123], v[204:207], a[16:19], v[120:123]
s_add_u32 m0, s17, 24576
v_rcp_f32 v37, v37
v_mfma_f32_16x16x32_bf16 v[124:127], v[200:203], a[4:7], 0
ds_read_b64_tr_b16 v[218:219], v18 offset:26624
v_mul_f32 v68, v68, v36
v_mfma_f32_16x16x32_bf16 v[124:127], v[204:207], a[20:23], v[124:127]
v_exp_f32 v32, -v72
v_mfma_f32_16x16x32_bf16 v[128:131], v[200:203], a[8:11], 0
ds_read_b64_tr_b16 v[220:221], v18 offset:28672
v_add_f32 v39, 1.0, v39
v_mfma_f32_16x16x32_bf16 v[128:131], v[204:207], a[24:27], v[128:131]
s_add_u32 s21, s36, 256
v_rcp_f32 v38, v38
v_mfma_f32_16x16x32_bf16 v[132:135], v[200:203], a[12:15], 0
ds_read_b64_tr_b16 v[222:223], v18 offset:30720
v_mul_f32 v69, v69, v37
v_mfma_f32_16x16x32_bf16 v[132:135], v[204:207], a[28:31], v[132:135]
s_waitcnt lgkmcnt(4)
v_exp_f32 v33, -v73
v_mfma_f32_16x16x32_bf16 v[136:139], v[208:211], a[0:3], 0
ds_read_b64_tr_b16 v[200:201], v19 offset:24576
v_add_f32 v32, 1.0, v32
v_mfma_f32_16x16x32_bf16 v[136:139], v[212:215], a[16:19], v[136:139]
v_rcp_f32 v39, v39
v_mfma_f32_16x16x32_bf16 v[140:143], v[208:211], a[4:7], 0
ds_read_b64_tr_b16 v[202:203], v19 offset:26624
v_mul_f32 v70, v70, v38
v_mfma_f32_16x16x32_bf16 v[140:143], v[212:215], a[20:23], v[140:143]
buffer_load_dwordx4 v2, s[8:11], s21 offen lds
v_mfma_f32_16x16x32_bf16 v[144:147], v[208:211], a[8:11], 0
ds_read_b64_tr_b16 v[204:205], v19 offset:28672
v_mfma_f32_16x16x32_bf16 v[144:147], v[212:215], a[24:27], v[144:147]
v_exp_f32 v34, -v74
v_mfma_f32_16x16x32_bf16 v[148:151], v[208:211], a[12:15], 0
ds_read_b64_tr_b16 v[206:207], v19 offset:30720
v_add_f32 v33, 1.0, v33
v_mfma_f32_16x16x32_bf16 v[148:151], v[212:215], a[28:31], v[148:151]
s_waitcnt lgkmcnt(4)
v_rcp_f32 v32, v32
v_mfma_f32_16x16x32_bf16 v[152:155], v[216:219], a[0:3], 0
ds_read_b64_tr_b16 v[208:209], v16 offset:32768
v_mul_f32 v71, v71, v39
v_mfma_f32_16x16x32_bf16 v[152:155], v[220:223], a[16:19], v[152:155]
s_add_u32 m0, s17, 28672
v_exp_f32 v35, -v75
v_mfma_f32_16x16x32_bf16 v[156:159], v[216:219], a[4:7], 0
ds_read_b64_tr_b16 v[210:211], v16 offset:34816
v_add_f32 v34, 1.0, v34
v_mfma_f32_16x16x32_bf16 v[156:159], v[220:223], a[20:23], v[156:159]
v_rcp_f32 v33, v33
v_mfma_f32_16x16x32_bf16 v[160:163], v[216:219], a[8:11], 0
ds_read_b64_tr_b16 v[212:213], v16 offset:36864
v_mul_f32 v72, v72, v32
v_mfma_f32_16x16x32_bf16 v[160:163], v[220:223], a[24:27], v[160:163]
s_add_u32 s21, s36, 295168
v_exp_f32 v36, -v76
v_mfma_f32_16x16x32_bf16 v[164:167], v[216:219], a[12:15], 0
ds_read_b64_tr_b16 v[214:215], v16 offset:38912
v_add_f32 v35, 1.0, v35
v_mfma_f32_16x16x32_bf16 v[164:167], v[220:223], a[28:31], v[164:167]
s_waitcnt lgkmcnt(4)
v_rcp_f32 v34, v34
v_mfma_f32_16x16x32_bf16 v[168:171], v[200:203], a[0:3], 0
ds_read_b64_tr_b16 v[216:217], v17 offset:32768
v_mul_f32 v73, v73, v33
v_mfma_f32_16x16x32_bf16 v[168:171], v[204:207], a[16:19], v[168:171]
buffer_load_dwordx4 v2, s[8:11], s21 offen lds
v_mfma_f32_16x16x32_bf16 v[172:175], v[200:203], a[4:7], 0
ds_read_b64_tr_b16 v[218:219], v17 offset:34816
v_mfma_f32_16x16x32_bf16 v[172:175], v[204:207], a[20:23], v[172:175]
v_exp_f32 v37, -v77
v_mfma_f32_16x16x32_bf16 v[176:179], v[200:203], a[8:11], 0
ds_read_b64_tr_b16 v[220:221], v17 offset:36864
v_add_f32 v36, 1.0, v36
v_mfma_f32_16x16x32_bf16 v[176:179], v[204:207], a[24:27], v[176:179]
v_rcp_f32 v35, v35
v_mfma_f32_16x16x32_bf16 v[180:183], v[200:203], a[12:15], 0
ds_read_b64_tr_b16 v[222:223], v17 offset:38912
v_mul_f32 v74, v74, v34
v_mfma_f32_16x16x32_bf16 v[180:183], v[204:207], a[28:31], v[180:183]
s_waitcnt lgkmcnt(4)
v_exp_f32 v38, -v78
v_mfma_f32_16x16x32_bf16 v[120:123], v[208:211], a[32:35], v[120:123]
ds_read_b64_tr_b16 v[200:201], v18 offset:32768
v_add_f32 v37, 1.0, v37
v_mfma_f32_16x16x32_bf16 v[120:123], v[212:215], a[48:51], v[120:123]
s_add_u32 m0, s17, 32768
v_rcp_f32 v36, v36
v_mfma_f32_16x16x32_bf16 v[124:127], v[208:211], a[36:39], v[124:127]
ds_read_b64_tr_b16 v[202:203], v18 offset:34816
v_mul_f32 v75, v75, v35
v_mfma_f32_16x16x32_bf16 v[124:127], v[212:215], a[52:55], v[124:127]
v_exp_f32 v39, -v79
v_mfma_f32_16x16x32_bf16 v[128:131], v[208:211], a[40:43], v[128:131]
ds_read_b64_tr_b16 v[204:205], v18 offset:36864
v_add_f32 v38, 1.0, v38
v_mfma_f32_16x16x32_bf16 v[128:131], v[212:215], a[56:59], v[128:131]
s_add_u32 s21, s38, 256
v_rcp_f32 v37, v37
v_mfma_f32_16x16x32_bf16 v[132:135], v[208:211], a[44:47], v[132:135]
ds_read_b64_tr_b16 v[206:207], v18 offset:38912
v_mul_f32 v76, v76, v36
v_mfma_f32_16x16x32_bf16 v[132:135], v[212:215], a[60:63], v[132:135]
s_waitcnt lgkmcnt(4)
v_exp_f32 v32, -v80
v_mfma_f32_16x16x32_bf16 v[136:139], v[216:219], a[32:35], v[136:139]
ds_read_b64_tr_b16 v[208:209], v19 offset:32768
v_add_f32 v39, 1.0, v39
v_mfma_f32_16x16x32_bf16 v[136:139], v[220:223], a[48:51], v[136:139]
v_rcp_f32 v38, v38
v_mfma_f32_16x16x32_bf16 v[140:143], v[216:219], a[36:39], v[140:143]
ds_read_b64_tr_b16 v[210:211], v19 offset:34816
v_mul_f32 v77, v77, v37
v_mfma_f32_16x16x32_bf16 v[140:143], v[220:223], a[52:55], v[140:143]
buffer_load_dwordx4 v2, s[8:11], s21 offen lds
v_mfma_f32_16x16x32_bf16 v[144:147], v[216:219], a[40:43], v[144:147]
ds_read_b64_tr_b16 v[212:213], v19 offset:36864
v_mfma_f32_16x16x32_bf16 v[144:147], v[220:223], a[56:59], v[144:147]
v_exp_f32 v33, -v81
v_mfma_f32_16x16x32_bf16 v[148:151], v[216:219], a[44:47], v[148:151]
ds_read_b64_tr_b16 v[214:215], v19 offset:38912
v_add_f32 v32, 1.0, v32
v_mfma_f32_16x16x32_bf16 v[148:151], v[220:223], a[60:63], v[148:151]
s_waitcnt lgkmcnt(4)
v_rcp_f32 v39, v39
v_mfma_f32_16x16x32_bf16 v[152:155], v[200:203], a[32:35], v[152:155]
ds_read_b64_tr_b16 v[216:217], v16 offset:40960
v_mul_f32 v78, v78, v38
v_mfma_f32_16x16x32_bf16 v[152:155], v[204:207], a[48:51], v[152:155]
s_add_u32 m0, s17, 36864
v_exp_f32 v34, -v82
v_mfma_f32_16x16x32_bf16 v[156:159], v[200:203], a[36:39], v[156:159]
ds_read_b64_tr_b16 v[218:219], v16 offset:43008
v_add_f32 v33, 1.0, v33
v_mfma_f32_16x16x32_bf16 v[156:159], v[204:207], a[52:55], v[156:159]
v_rcp_f32 v32, v32
v_mfma_f32_16x16x32_bf16 v[160:163], v[200:203], a[40:43], v[160:163]
ds_read_b64_tr_b16 v[220:221], v16 offset:45056
v_mul_f32 v79, v79, v39
v_mfma_f32_16x16x32_bf16 v[160:163], v[204:207], a[56:59], v[160:163]
s_add_u32 s21, s38, 295168
v_exp_f32 v35, -v83
v_mfma_f32_16x16x32_bf16 v[164:167], v[200:203], a[44:47], v[164:167]
ds_read_b64_tr_b16 v[222:223], v16 offset:47104
v_add_f32 v34, 1.0, v34
v_mfma_f32_16x16x32_bf16 v[164:167], v[204:207], a[60:63], v[164:167]
s_waitcnt lgkmcnt(4)
v_rcp_f32 v33, v33
v_mfma_f32_16x16x32_bf16 v[168:171], v[208:211], a[32:35], v[168:171]
ds_read_b64_tr_b16 v[200:201], v17 offset:40960
v_mul_f32 v80, v80, v32
v_mfma_f32_16x16x32_bf16 v[168:171], v[212:215], a[48:51], v[168:171]
buffer_load_dwordx4 v2, s[8:11], s21 offen lds
v_mfma_f32_16x16x32_bf16 v[172:175], v[208:211], a[36:39], v[172:175]
ds_read_b64_tr_b16 v[202:203], v17 offset:43008
v_mfma_f32_16x16x32_bf16 v[172:175], v[212:215], a[52:55], v[172:175]
v_exp_f32 v36, -v84
v_mfma_f32_16x16x32_bf16 v[176:179], v[208:211], a[40:43], v[176:179]
ds_read_b64_tr_b16 v[204:205], v17 offset:45056
v_add_f32 v35, 1.0, v35
v_mfma_f32_16x16x32_bf16 v[176:179], v[212:215], a[56:59], v[176:179]
v_rcp_f32 v34, v34
v_mfma_f32_16x16x32_bf16 v[180:183], v[208:211], a[44:47], v[180:183]
ds_read_b64_tr_b16 v[206:207], v17 offset:47104
v_mul_f32 v81, v81, v33
v_mfma_f32_16x16x32_bf16 v[180:183], v[212:215], a[60:63], v[180:183]
s_waitcnt lgkmcnt(4)
v_exp_f32 v37, -v85
v_mfma_f32_16x16x32_bf16 v[120:123], v[216:219], a[64:67], v[120:123]
ds_read_b64_tr_b16 v[208:209], v18 offset:40960
v_add_f32 v36, 1.0, v36
v_mfma_f32_16x16x32_bf16 v[120:123], v[220:223], a[80:83], v[120:123]
s_add_u32 m0, s17, 40960
v_rcp_f32 v35, v35
v_mfma_f32_16x16x32_bf16 v[124:127], v[216:219], a[68:71], v[124:127]
ds_read_b64_tr_b16 v[210:211], v18 offset:43008
v_mul_f32 v82, v82, v34
v_mfma_f32_16x16x32_bf16 v[124:127], v[220:223], a[84:87], v[124:127]
v_exp_f32 v38, -v86
v_mfma_f32_16x16x32_bf16 v[128:131], v[216:219], a[72:75], v[128:131]
ds_read_b64_tr_b16 v[212:213], v18 offset:45056
v_add_f32 v37, 1.0, v37
v_mfma_f32_16x16x32_bf16 v[128:131], v[220:223], a[88:91], v[128:131]
s_add_u32 s21, s39, 256
v_rcp_f32 v36, v36
v_mfma_f32_16x16x32_bf16 v[132:135], v[216:219], a[76:79], v[132:135]
ds_read_b64_tr_b16 v[214:215], v18 offset:47104
v_mul_f32 v83, v83, v35
v_mfma_f32_16x16x32_bf16 v[132:135], v[220:223], a[92:95], v[132:135]
s_waitcnt lgkmcnt(4)
v_exp_f32 v39, -v87
v_mfma_f32_16x16x32_bf16 v[136:139], v[200:203], a[64:67], v[136:139]
ds_read_b64_tr_b16 v[216:217], v19 offset:40960
v_add_f32 v38, 1.0, v38
v_mfma_f32_16x16x32_bf16 v[136:139], v[204:207], a[80:83], v[136:139]
v_rcp_f32 v37, v37
v_mfma_f32_16x16x32_bf16 v[140:143], v[200:203], a[68:71], v[140:143]
ds_read_b64_tr_b16 v[218:219], v19 offset:43008
v_mul_f32 v84, v84, v36
v_mfma_f32_16x16x32_bf16 v[140:143], v[204:207], a[84:87], v[140:143]
buffer_load_dwordx4 v2, s[8:11], s21 offen lds
v_mfma_f32_16x16x32_bf16 v[144:147], v[200:203], a[72:75], v[144:147]
ds_read_b64_tr_b16 v[220:221], v19 offset:45056
v_mfma_f32_16x16x32_bf16 v[144:147], v[204:207], a[88:91], v[144:147]
v_exp_f32 v32, -v88
v_mfma_f32_16x16x32_bf16 v[148:151], v[200:203], a[76:79], v[148:151]
ds_read_b64_tr_b16 v[222:223], v19 offset:47104
v_add_f32 v39, 1.0, v39
v_mfma_f32_16x16x32_bf16 v[148:151], v[204:207], a[92:95], v[148:151]
s_waitcnt lgkmcnt(4)
v_rcp_f32 v38, v38
v_mfma_f32_16x16x32_bf16 v[152:155], v[208:211], a[64:67], v[152:155]
s_waitcnt vmcnt(26)
s_barrier
v_mul_f32 v85, v85, v37
v_mfma_f32_16x16x32_bf16 v[152:155], v[212:215], a[80:83], v[152:155]
s_add_u32 m0, s17, 45056
ds_read_b64_tr_b16 v[200:201], v20 offset:0
v_mfma_f32_16x16x32_bf16 v[156:159], v[208:211], a[68:71], v[156:159]
ds_read_b64_tr_b16 v[202:203], v20 offset:2048
v_mfma_f32_16x16x32_bf16 v[156:159], v[212:215], a[84:87], v[156:159]
v_exp_f32 v33, -v89
v_mfma_f32_16x16x32_bf16 v[160:163], v[208:211], a[72:75], v[160:163]
ds_read_b64_tr_b16 v[204:205], v20 offset:4096
v_add_f32 v32, 1.0, v32
v_mfma_f32_16x16x32_bf16 v[160:163], v[212:215], a[88:91], v[160:163]
s_add_u32 s21, s39, 295168
v_rcp_f32 v39, v39
v_mfma_f32_16x16x32_bf16 v[164:167], v[208:211], a[76:79], v[164:167]
ds_read_b64_tr_b16 v[206:207], v20 offset:6144
v_mul_f32 v86, v86, v38
v_mfma_f32_16x16x32_bf16 v[164:167], v[212:215], a[92:95], v[164:167]
s_waitcnt lgkmcnt(4)
v_exp_f32 v34, -v90
v_mfma_f32_16x16x32_bf16 v[168:171], v[216:219], a[64:67], v[168:171]
ds_read_b64_tr_b16 v[208:209], v21 offset:0
v_add_f32 v33, 1.0, v33
v_mfma_f32_16x16x32_bf16 v[168:171], v[220:223], a[80:83], v[168:171]
buffer_load_dwordx4 v2, s[8:11], s21 offen lds
v_mfma_f32_16x16x32_bf16 v[172:175], v[216:219], a[68:71], v[172:175]
ds_read_b64_tr_b16 v[210:211], v21 offset:2048
v_mfma_f32_16x16x32_bf16 v[172:175], v[220:223], a[84:87], v[172:175]
v_rcp_f32 v32, v32
v_mfma_f32_16x16x32_bf16 v[176:179], v[216:219], a[72:75], v[176:179]
ds_read_b64_tr_b16 v[212:213], v21 offset:4096
v_mul_f32 v87, v87, v39
v_mfma_f32_16x16x32_bf16 v[176:179], v[220:223], a[88:91], v[176:179]
v_exp_f32 v35, -v91
v_mfma_f32_16x16x32_bf16 v[180:183], v[216:219], a[76:79], v[180:183]
ds_read_b64_tr_b16 v[214:215], v21 offset:6144
v_add_f32 v34, 1.0, v34
v_mfma_f32_16x16x32_bf16 v[180:183], v[220:223], a[92:95], v[180:183]
s_waitcnt lgkmcnt(4)
v_rcp_f32 v33, v33
v_mfma_f32_16x16x32_bf16 v[120:123], v[200:203], a[96:99], v[120:123]
ds_read_b64_tr_b16 v[216:217], v22 offset:0
v_mul_f32 v88, v88, v32
v_mfma_f32_16x16x32_bf16 v[120:123], v[204:207], a[112:115], v[120:123]
s_add_u32 m0, s17, 49152
v_exp_f32 v36, -v92
v_mfma_f32_16x16x32_bf16 v[124:127], v[200:203], a[100:103], v[124:127]
ds_read_b64_tr_b16 v[218:219], v22 offset:2048
v_add_f32 v35, 1.0, v35
v_mfma_f32_16x16x32_bf16 v[124:127], v[204:207], a[116:119], v[124:127]
v_rcp_f32 v34, v34
v_mfma_f32_16x16x32_bf16 v[128:131], v[200:203], a[104:107], v[128:131]
ds_read_b64_tr_b16 v[220:221], v22 offset:4096
v_mul_f32 v89, v89, v33
v_mfma_f32_16x16x32_bf16 v[128:131], v[204:207], a[120:123], v[128:131]
s_add_u32 s21, s42, 256
v_exp_f32 v37, -v93
v_mfma_f32_16x16x32_bf16 v[132:135], v[200:203], a[108:111], v[132:135]
ds_read_b64_tr_b16 v[222:223], v22 offset:6144
v_add_f32 v36, 1.0, v36
v_mfma_f32_16x16x32_bf16 v[132:135], v[204:207], a[124:127], v[132:135]
s_waitcnt lgkmcnt(4)
v_rcp_f32 v35, v35
v_mfma_f32_16x16x32_bf16 v[136:139], v[208:211], a[96:99], v[136:139]
ds_read_b64_tr_b16 v[200:201], v23 offset:0
v_mul_f32 v90, v90, v34
v_mfma_f32_16x16x32_bf16 v[136:139], v[212:215], a[112:115], v[136:139]
v_exp_f32 v38, -v94
v_mfma_f32_16x16x32_bf16 v[140:143], v[208:211], a[100:103], v[140:143]
ds_read_b64_tr_b16 v[202:203], v23 offset:2048
v_add_f32 v37, 1.0, v37
v_mfma_f32_16x16x32_bf16 v[140:143], v[212:215], a[116:119], v[140:143]
buffer_load_dwordx4 v2, s[8:11], s21 offen lds
v_mfma_f32_16x16x32_bf16 v[144:147], v[208:211], a[104:107], v[144:147]
ds_read_b64_tr_b16 v[204:205], v23 offset:4096
v_mfma_f32_16x16x32_bf16 v[144:147], v[212:215], a[120:123], v[144:147]
v_rcp_f32 v36, v36
v_mfma_f32_16x16x32_bf16 v[148:151], v[208:211], a[108:111], v[148:151]
ds_read_b64_tr_b16 v[206:207], v23 offset:6144
v_mul_f32 v91, v91, v35
v_mfma_f32_16x16x32_bf16 v[148:151], v[212:215], a[124:127], v[148:151]
s_waitcnt lgkmcnt(4)
v_exp_f32 v39, -v95
v_mfma_f32_16x16x32_bf16 v[152:155], v[216:219], a[96:99], v[152:155]
ds_read_b64_tr_b16 v[208:209], v20 offset:8192
v_add_f32 v38, 1.0, v38
v_mfma_f32_16x16x32_bf16 v[152:155], v[220:223], a[112:115], v[152:155]
s_add_u32 m0, s17, 53248
v_rcp_f32 v37, v37
v_mfma_f32_16x16x32_bf16 v[156:159], v[216:219], a[100:103], v[156:159]
ds_read_b64_tr_b16 v[210:211], v20 offset:10240
v_mul_f32 v92, v92, v36
v_mfma_f32_16x16x32_bf16 v[156:159], v[220:223], a[116:119], v[156:159]
v_exp_f32 v32, -v96
v_mfma_f32_16x16x32_bf16 v[160:163], v[216:219], a[104:107], v[160:163]
ds_read_b64_tr_b16 v[212:213], v20 offset:12288
v_add_f32 v39, 1.0, v39
v_mfma_f32_16x16x32_bf16 v[160:163], v[220:223], a[120:123], v[160:163]
s_add_u32 s21, s42, 295168
v_rcp_f32 v38, v38
v_mfma_f32_16x16x32_bf16 v[164:167], v[216:219], a[108:111], v[164:167]
ds_read_b64_tr_b16 v[214:215], v20 offset:14336
v_mul_f32 v93, v93, v37
v_mfma_f32_16x16x32_bf16 v[164:167], v[220:223], a[124:127], v[164:167]
s_waitcnt lgkmcnt(4)
v_exp_f32 v33, -v97
v_mfma_f32_16x16x32_bf16 v[168:171], v[200:203], a[96:99], v[168:171]
ds_read_b64_tr_b16 v[216:217], v21 offset:8192
v_add_f32 v32, 1.0, v32
v_mfma_f32_16x16x32_bf16 v[168:171], v[204:207], a[112:115], v[168:171]
buffer_load_dwordx4 v2, s[8:11], s21 offen lds
v_mfma_f32_16x16x32_bf16 v[172:175], v[200:203], a[100:103], v[172:175]
ds_read_b64_tr_b16 v[218:219], v21 offset:10240
v_mfma_f32_16x16x32_bf16 v[172:175], v[204:207], a[116:119], v[172:175]
v_rcp_f32 v39, v39
v_mfma_f32_16x16x32_bf16 v[176:179], v[200:203], a[104:107], v[176:179]
ds_read_b64_tr_b16 v[220:221], v21 offset:12288
v_mul_f32 v94, v94, v38
v_mfma_f32_16x16x32_bf16 v[176:179], v[204:207], a[120:123], v[176:179]
v_exp_f32 v34, -v98
v_mfma_f32_16x16x32_bf16 v[180:183], v[200:203], a[108:111], v[180:183]
ds_read_b64_tr_b16 v[222:223], v21 offset:14336
v_add_f32 v33, 1.0, v33
v_mfma_f32_16x16x32_bf16 v[180:183], v[204:207], a[124:127], v[180:183]
s_waitcnt lgkmcnt(4)
v_rcp_f32 v32, v32
v_mfma_f32_16x16x32_bf16 v[120:123], v[208:211], a[128:131], v[120:123]
ds_read_b64_tr_b16 v[200:201], v22 offset:8192
v_mul_f32 v95, v95, v39
v_mfma_f32_16x16x32_bf16 v[120:123], v[212:215], a[144:147], v[120:123]
s_add_u32 m0, s17, 57344
v_exp_f32 v35, -v99
v_mfma_f32_16x16x32_bf16 v[124:127], v[208:211], a[132:135], v[124:127]
ds_read_b64_tr_b16 v[202:203], v22 offset:10240
v_add_f32 v34, 1.0, v34
v_mfma_f32_16x16x32_bf16 v[124:127], v[212:215], a[148:151], v[124:127]
v_rcp_f32 v33, v33
v_mfma_f32_16x16x32_bf16 v[128:131], v[208:211], a[136:139], v[128:131]
ds_read_b64_tr_b16 v[204:205], v22 offset:12288
v_mul_f32 v96, v96, v32
v_mfma_f32_16x16x32_bf16 v[128:131], v[212:215], a[152:155], v[128:131]
s_add_u32 s21, s43, 256
v_exp_f32 v36, -v100
v_mfma_f32_16x16x32_bf16 v[132:135], v[208:211], a[140:143], v[132:135]
ds_read_b64_tr_b16 v[206:207], v22 offset:14336
v_add_f32 v35, 1.0, v35
v_mfma_f32_16x16x32_bf16 v[132:135], v[212:215], a[156:159], v[132:135]
s_waitcnt lgkmcnt(4)
v_rcp_f32 v34, v34
v_mfma_f32_16x16x32_bf16 v[136:139], v[216:219], a[128:131], v[136:139]
ds_read_b64_tr_b16 v[208:209], v23 offset:8192
v_mul_f32 v97, v97, v33
v_mfma_f32_16x16x32_bf16 v[136:139], v[220:223], a[144:147], v[136:139]
v_exp_f32 v37, -v101
v_mfma_f32_16x16x32_bf16 v[140:143], v[216:219], a[132:135], v[140:143]
ds_read_b64_tr_b16 v[210:211], v23 offset:10240
v_add_f32 v36, 1.0, v36
v_mfma_f32_16x16x32_bf16 v[140:143], v[220:223], a[148:151], v[140:143]
buffer_load_dwordx4 v2, s[8:11], s21 offen lds
v_mfma_f32_16x16x32_bf16 v[144:147], v[216:219], a[136:139], v[144:147]
ds_read_b64_tr_b16 v[212:213], v23 offset:12288
v_mfma_f32_16x16x32_bf16 v[144:147], v[220:223], a[152:155], v[144:147]
v_rcp_f32 v35, v35
v_mfma_f32_16x16x32_bf16 v[148:151], v[216:219], a[140:143], v[148:151]
ds_read_b64_tr_b16 v[214:215], v23 offset:14336
v_mul_f32 v98, v98, v34
v_mfma_f32_16x16x32_bf16 v[148:151], v[220:223], a[156:159], v[148:151]
s_waitcnt lgkmcnt(4)
v_exp_f32 v38, -v102
v_mfma_f32_16x16x32_bf16 v[152:155], v[200:203], a[128:131], v[152:155]
ds_read_b64_tr_b16 v[216:217], v20 offset:16384
v_add_f32 v37, 1.0, v37
v_mfma_f32_16x16x32_bf16 v[152:155], v[204:207], a[144:147], v[152:155]
s_add_u32 m0, s17, 61440
v_rcp_f32 v36, v36
v_mfma_f32_16x16x32_bf16 v[156:159], v[200:203], a[132:135], v[156:159]
ds_read_b64_tr_b16 v[218:219], v20 offset:18432
v_mul_f32 v99, v99, v35
v_mfma_f32_16x16x32_bf16 v[156:159], v[204:207], a[148:151], v[156:159]
v_exp_f32 v39, -v103
v_mfma_f32_16x16x32_bf16 v[160:163], v[200:203], a[136:139], v[160:163]
ds_read_b64_tr_b16 v[220:221], v20 offset:20480
v_add_f32 v38, 1.0, v38
v_mfma_f32_16x16x32_bf16 v[160:163], v[204:207], a[152:155], v[160:163]
s_add_u32 s21, s43, 295168
v_rcp_f32 v37, v37
v_mfma_f32_16x16x32_bf16 v[164:167], v[200:203], a[140:143], v[164:167]
ds_read_b64_tr_b16 v[222:223], v20 offset:22528
v_mul_f32 v100, v100, v36
v_mfma_f32_16x16x32_bf16 v[164:167], v[204:207], a[156:159], v[164:167]
s_waitcnt lgkmcnt(4)
v_exp_f32 v32, -v104
v_mfma_f32_16x16x32_bf16 v[168:171], v[208:211], a[128:131], v[168:171]
ds_read_b64_tr_b16 v[200:201], v21 offset:16384
v_add_f32 v39, 1.0, v39
v_mfma_f32_16x16x32_bf16 v[168:171], v[212:215], a[144:147], v[168:171]
buffer_load_dwordx4 v2, s[8:11], s21 offen lds
v_mfma_f32_16x16x32_bf16 v[172:175], v[208:211], a[132:135], v[172:175]
ds_read_b64_tr_b16 v[202:203], v21 offset:18432
v_mfma_f32_16x16x32_bf16 v[172:175], v[212:215], a[148:151], v[172:175]
v_rcp_f32 v38, v38
v_mfma_f32_16x16x32_bf16 v[176:179], v[208:211], a[136:139], v[176:179]
ds_read_b64_tr_b16 v[204:205], v21 offset:20480
v_mul_f32 v101, v101, v37
v_mfma_f32_16x16x32_bf16 v[176:179], v[212:215], a[152:155], v[176:179]
v_exp_f32 v33, -v105
v_mfma_f32_16x16x32_bf16 v[180:183], v[208:211], a[140:143], v[180:183]
ds_read_b64_tr_b16 v[206:207], v21 offset:22528
v_add_f32 v32, 1.0, v32
v_mfma_f32_16x16x32_bf16 v[180:183], v[212:215], a[156:159], v[180:183]
s_waitcnt lgkmcnt(4)
v_rcp_f32 v39, v39
v_mfma_f32_16x16x32_bf16 v[120:123], v[216:219], a[160:163], v[120:123]
ds_read_b64_tr_b16 v[208:209], v22 offset:16384
v_mul_f32 v102, v102, v38
v_mfma_f32_16x16x32_bf16 v[120:123], v[220:223], a[176:179], v[120:123]
s_add_u32 m0, s17, 65536
v_exp_f32 v34, -v106
v_mfma_f32_16x16x32_bf16 v[124:127], v[216:219], a[164:167], v[124:127]
ds_read_b64_tr_b16 v[210:211], v22 offset:18432
v_add_f32 v33, 1.0, v33
v_mfma_f32_16x16x32_bf16 v[124:127], v[220:223], a[180:183], v[124:127]
v_rcp_f32 v32, v32
v_mfma_f32_16x16x32_bf16 v[128:131], v[216:219], a[168:171], v[128:131]
ds_read_b64_tr_b16 v[212:213], v22 offset:20480
v_mul_f32 v103, v103, v39
v_mfma_f32_16x16x32_bf16 v[128:131], v[220:223], a[184:187], v[128:131]
s_add_u32 s21, s0, 256
v_exp_f32 v35, -v107
v_mfma_f32_16x16x32_bf16 v[132:135], v[216:219], a[172:175], v[132:135]
ds_read_b64_tr_b16 v[214:215], v22 offset:22528
v_add_f32 v34, 1.0, v34
v_mfma_f32_16x16x32_bf16 v[132:135], v[220:223], a[188:191], v[132:135]
s_waitcnt lgkmcnt(4)
v_rcp_f32 v33, v33
v_mfma_f32_16x16x32_bf16 v[136:139], v[200:203], a[160:163], v[136:139]
ds_read_b64_tr_b16 v[216:217], v23 offset:16384
v_mul_f32 v104, v104, v32
v_mfma_f32_16x16x32_bf16 v[136:139], v[204:207], a[176:179], v[136:139]
buffer_load_dwordx4 v2, s[8:11], s21 offen lds
v_mfma_f32_16x16x32_bf16 v[140:143], v[200:203], a[164:167], v[140:143]
ds_read_b64_tr_b16 v[218:219], v23 offset:18432
v_mfma_f32_16x16x32_bf16 v[140:143], v[204:207], a[180:183], v[140:143]
v_exp_f32 v36, -v108
v_mfma_f32_16x16x32_bf16 v[144:147], v[200:203], a[168:171], v[144:147]
ds_read_b64_tr_b16 v[220:221], v23 offset:20480
v_add_f32 v35, 1.0, v35
v_mfma_f32_16x16x32_bf16 v[144:147], v[204:207], a[184:187], v[144:147]
s_add_u32 m0, s17, 69632
v_rcp_f32 v34, v34
v_mfma_f32_16x16x32_bf16 v[148:151], v[200:203], a[172:175], v[148:151]
ds_read_b64_tr_b16 v[222:223], v23 offset:22528
v_mul_f32 v105, v105, v33
v_mfma_f32_16x16x32_bf16 v[148:151], v[204:207], a[188:191], v[148:151]
s_waitcnt lgkmcnt(4)
v_exp_f32 v37, -v109
v_mfma_f32_16x16x32_bf16 v[152:155], v[208:211], a[160:163], v[152:155]
s_waitcnt vmcnt(20)
s_barrier
v_add_f32 v36, 1.0, v36
v_mfma_f32_16x16x32_bf16 v[152:155], v[212:215], a[176:179], v[152:155]
s_add_u32 s21, s0, 295168
ds_read_b64_tr_b16 v[200:201], v20 offset:24576
v_mfma_f32_16x16x32_bf16 v[156:159], v[208:211], a[164:167], v[156:159]
ds_read_b64_tr_b16 v[202:203], v20 offset:26624
v_mfma_f32_16x16x32_bf16 v[156:159], v[212:215], a[180:183], v[156:159]
v_rcp_f32 v35, v35
v_mfma_f32_16x16x32_bf16 v[160:163], v[208:211], a[168:171], v[160:163]
ds_read_b64_tr_b16 v[204:205], v20 offset:28672
v_mul_f32 v106, v106, v34
v_mfma_f32_16x16x32_bf16 v[160:163], v[212:215], a[184:187], v[160:163]
buffer_load_dwordx4 v2, s[8:11], s21 offen lds
v_mfma_f32_16x16x32_bf16 v[164:167], v[208:211], a[172:175], v[164:167]
ds_read_b64_tr_b16 v[206:207], v20 offset:30720
v_mfma_f32_16x16x32_bf16 v[164:167], v[212:215], a[188:191], v[164:167]
s_waitcnt lgkmcnt(4)
v_exp_f32 v38, -v110
v_mfma_f32_16x16x32_bf16 v[168:171], v[216:219], a[160:163], v[168:171]
ds_read_b64_tr_b16 v[208:209], v20 offset:32768
v_add_f32 v37, 1.0, v37
v_mfma_f32_16x16x32_bf16 v[168:171], v[220:223], a[176:179], v[168:171]
s_waitcnt vmcnt(19)
buffer_store_dword v31, v28, s[12:15], s37 offen offset:0 sc1
v_mfma_f32_16x16x32_bf16 v[172:175], v[216:219], a[164:167], v[172:175]
ds_read_b64_tr_b16 v[210:211], v20 offset:34816
v_mfma_f32_16x16x32_bf16 v[172:175], v[220:223], a[180:183], v[172:175]
v_rcp_f32 v36, v36
v_mfma_f32_16x16x32_bf16 v[176:179], v[216:219], a[168:171], v[176:179]
ds_read_b64_tr_b16 v[212:213], v20 offset:36864
v_mul_f32 v107, v107, v35
v_mfma_f32_16x16x32_bf16 v[176:179], v[220:223], a[184:187], v[176:179]
v_exp_f32 v39, -v111
v_mfma_f32_16x16x32_bf16 v[180:183], v[216:219], a[172:175], v[180:183]
ds_read_b64_tr_b16 v[214:215], v20 offset:38912
v_add_f32 v38, 1.0, v38
v_mfma_f32_16x16x32_bf16 v[180:183], v[220:223], a[188:191], v[180:183]
s_waitcnt lgkmcnt(4)
v_rcp_f32 v37, v37
v_mfma_f32_16x16x32_bf16 v[120:123], v[200:203], a[192:195], v[120:123]
ds_read_b64_tr_b16 v[216:217], v20 offset:40960
v_mul_f32 v108, v108, v36
v_mfma_f32_16x16x32_bf16 v[120:123], v[204:207], a[208:211], v[120:123]
s_add_u32 m0, s17, 73728
v_exp_f32 v32, -v112
v_mfma_f32_16x16x32_bf16 v[124:127], v[200:203], a[196:199], v[124:127]
ds_read_b64_tr_b16 v[218:219], v20 offset:43008
v_add_f32 v39, 1.0, v39
v_mfma_f32_16x16x32_bf16 v[124:127], v[204:207], a[212:215], v[124:127]
v_rcp_f32 v38, v38
v_mfma_f32_16x16x32_bf16 v[128:131], v[200:203], a[200:203], v[128:131]
ds_read_b64_tr_b16 v[220:221], v20 offset:45056
v_mul_f32 v109, v109, v37
v_mfma_f32_16x16x32_bf16 v[128:131], v[204:207], a[216:219], v[128:131]
s_add_u32 s21, s33, 256
v_exp_f32 v33, -v113
v_mfma_f32_16x16x32_bf16 v[132:135], v[200:203], a[204:207], v[132:135]
ds_read_b64_tr_b16 v[222:223], v20 offset:47104
v_add_f32 v32, 1.0, v32
v_mfma_f32_16x16x32_bf16 v[132:135], v[204:207], a[220:223], v[132:135]
s_waitcnt lgkmcnt(4)
v_rcp_f32 v39, v39
v_mfma_f32_16x16x32_bf16 v[120:123], v[208:211], a[224:227], v[120:123]
ds_read_b64_tr_b16 v[200:201], v21 offset:24576
v_mul_f32 v110, v110, v38
v_mfma_f32_16x16x32_bf16 v[120:123], v[212:215], a[240:243], v[120:123]
v_exp_f32 v34, -v114
v_mfma_f32_16x16x32_bf16 v[124:127], v[208:211], a[228:231], v[124:127]
ds_read_b64_tr_b16 v[202:203], v21 offset:26624
v_add_f32 v33, 1.0, v33
v_mfma_f32_16x16x32_bf16 v[124:127], v[212:215], a[244:247], v[124:127]
buffer_load_dwordx4 v2, s[24:27], s21 offen lds
v_mfma_f32_16x16x32_bf16 v[128:131], v[208:211], a[232:235], v[128:131]
ds_read_b64_tr_b16 v[204:205], v21 offset:28672
v_mfma_f32_16x16x32_bf16 v[128:131], v[212:215], a[248:251], v[128:131]
v_rcp_f32 v32, v32
v_mfma_f32_16x16x32_bf16 v[132:135], v[208:211], a[236:239], v[132:135]
ds_read_b64_tr_b16 v[206:207], v21 offset:30720
v_mul_f32 v111, v111, v39
v_mfma_f32_16x16x32_bf16 v[132:135], v[212:215], a[252:255], v[132:135]
s_waitcnt lgkmcnt(4)
v_exp_f32 v35, -v115
v_mfma_f32_16x16x32_bf16 v[120:123], v[216:219], v[224:227], v[120:123]
ds_read_b64_tr_b16 v[208:209], v21 offset:32768
v_add_f32 v34, 1.0, v34
v_mfma_f32_16x16x32_bf16 v[120:123], v[220:223], v[240:243], v[120:123]
s_add_u32 m0, s17, 77824
v_rcp_f32 v33, v33
v_mfma_f32_16x16x32_bf16 v[124:127], v[216:219], v[228:231], v[124:127]
ds_read_b64_tr_b16 v[210:211], v21 offset:34816
v_mul_f32 v112, v112, v32
v_mfma_f32_16x16x32_bf16 v[124:127], v[220:223], v[244:247], v[124:127]
v_exp_f32 v36, -v116
v_mfma_f32_16x16x32_bf16 v[128:131], v[216:219], v[232:235], v[128:131]
ds_read_b64_tr_b16 v[212:213], v21 offset:36864
v_add_f32 v35, 1.0, v35
v_mfma_f32_16x16x32_bf16 v[128:131], v[220:223], v[248:251], v[128:131]
s_add_u32 s21, s33, 295168
v_rcp_f32 v34, v34
v_mfma_f32_16x16x32_bf16 v[132:135], v[216:219], v[236:239], v[132:135]
ds_read_b64_tr_b16 v[214:215], v21 offset:38912
v_mul_f32 v113, v113, v33
v_mfma_f32_16x16x32_bf16 v[132:135], v[220:223], v[252:255], v[132:135]
s_waitcnt lgkmcnt(4)
v_exp_f32 v37, -v117
v_mfma_f32_16x16x32_bf16 v[136:139], v[200:203], a[192:195], v[136:139]
ds_read_b64_tr_b16 v[216:217], v21 offset:40960
v_add_f32 v36, 1.0, v36
v_mfma_f32_16x16x32_bf16 v[136:139], v[204:207], a[208:211], v[136:139]
buffer_load_dwordx4 v2, s[24:27], s21 offen lds
v_mfma_f32_16x16x32_bf16 v[140:143], v[200:203], a[196:199], v[140:143]
ds_read_b64_tr_b16 v[218:219], v21 offset:43008
v_mfma_f32_16x16x32_bf16 v[140:143], v[204:207], a[212:215], v[140:143]
v_rcp_f32 v35, v35
v_mfma_f32_16x16x32_bf16 v[144:147], v[200:203], a[200:203], v[144:147]
ds_read_b64_tr_b16 v[220:221], v21 offset:45056
v_mul_f32 v114, v114, v34
v_mfma_f32_16x16x32_bf16 v[144:147], v[204:207], a[216:219], v[144:147]
v_exp_f32 v38, -v118
v_mfma_f32_16x16x32_bf16 v[148:151], v[200:203], a[204:207], v[148:151]
ds_read_b64_tr_b16 v[222:223], v21 offset:47104
v_add_f32 v37, 1.0, v37
v_mfma_f32_16x16x32_bf16 v[148:151], v[204:207], a[220:223], v[148:151]
s_waitcnt lgkmcnt(4)
v_rcp_f32 v36, v36
v_mfma_f32_16x16x32_bf16 v[136:139], v[208:211], a[224:227], v[136:139]
ds_read_b64_tr_b16 v[200:201], v22 offset:24576
v_mul_f32 v115, v115, v35
v_mfma_f32_16x16x32_bf16 v[136:139], v[212:215], a[240:243], v[136:139]
s_add_u32 m0, s17, 81920
v_exp_f32 v39, -v119
v_mfma_f32_16x16x32_bf16 v[140:143], v[208:211], a[228:231], v[140:143]
ds_read_b64_tr_b16 v[202:203], v22 offset:26624
v_add_f32 v38, 1.0, v38
v_mfma_f32_16x16x32_bf16 v[140:143], v[212:215], a[244:247], v[140:143]
v_rcp_f32 v37, v37
v_mfma_f32_16x16x32_bf16 v[144:147], v[208:211], a[232:235], v[144:147]
ds_read_b64_tr_b16 v[204:205], v22 offset:28672
v_mul_f32 v116, v116, v36
v_mfma_f32_16x16x32_bf16 v[144:147], v[212:215], a[248:251], v[144:147]
s_add_u32 s21, s34, 256
v_add_f32 v39, 1.0, v39
v_mul_f32 v120, v56, v120
v_mfma_f32_16x16x32_bf16 v[148:151], v[208:211], a[236:239], v[148:151]
ds_read_b64_tr_b16 v[206:207], v22 offset:30720
v_mul_f32 v121, v57, v121
v_mfma_f32_16x16x32_bf16 v[148:151], v[212:215], a[252:255], v[148:151]
s_waitcnt lgkmcnt(4)
v_rcp_f32 v38, v38
v_mfma_f32_16x16x32_bf16 v[136:139], v[216:219], v[224:227], v[136:139]
ds_read_b64_tr_b16 v[208:209], v22 offset:32768
v_mul_f32 v117, v117, v37
v_mfma_f32_16x16x32_bf16 v[136:139], v[220:223], v[240:243], v[136:139]
v_rcp_f32 v39, v39
v_mfma_f32_16x16x32_bf16 v[140:143], v[216:219], v[228:231], v[140:143]
ds_read_b64_tr_b16 v[210:211], v22 offset:34816
v_mul_f32 v118, v118, v38
v_mfma_f32_16x16x32_bf16 v[140:143], v[220:223], v[244:247], v[140:143]
buffer_load_dwordx4 v2, s[24:27], s21 offen lds
v_mfma_f32_16x16x32_bf16 v[144:147], v[216:219], v[232:235], v[144:147]
ds_read_b64_tr_b16 v[212:213], v22 offset:36864
v_mul_f32 v119, v119, v39
v_mfma_f32_16x16x32_bf16 v[144:147], v[220:223], v[248:251], v[144:147]
v_mul_f32 v122, v58, v122
v_mul_f32 v123, v59, v123
v_mfma_f32_16x16x32_bf16 v[148:151], v[216:219], v[236:239], v[148:151]
ds_read_b64_tr_b16 v[214:215], v22 offset:38912
v_mul_f32 v124, v60, v124
v_mfma_f32_16x16x32_bf16 v[148:151], v[220:223], v[252:255], v[148:151]
s_waitcnt lgkmcnt(4)
v_mul_f32 v125, v61, v125
v_mul_f32 v126, v62, v126
v_mfma_f32_16x16x32_bf16 v[152:155], v[200:203], a[192:195], v[152:155]
ds_read_b64_tr_b16 v[216:217], v22 offset:40960
v_mul_f32 v127, v63, v127
v_mfma_f32_16x16x32_bf16 v[152:155], v[204:207], a[208:211], v[152:155]
s_add_u32 m0, s17, 86016
v_mul_f32 v128, v64, v128
v_mul_f32 v129, v65, v129
v_mfma_f32_16x16x32_bf16 v[156:159], v[200:203], a[196:199], v[156:159]
ds_read_b64_tr_b16 v[218:219], v22 offset:43008
v_mul_f32 v130, v66, v130
v_mfma_f32_16x16x32_bf16 v[156:159], v[204:207], a[212:215], v[156:159]
v_mul_f32 v131, v67, v131
v_mul_f32 v132, v68, v132
v_mfma_f32_16x16x32_bf16 v[160:163], v[200:203], a[200:203], v[160:163]
ds_read_b64_tr_b16 v[220:221], v22 offset:45056
v_mul_f32 v133, v69, v133
v_mfma_f32_16x16x32_bf16 v[160:163], v[204:207], a[216:219], v[160:163]
s_add_u32 s21, s34, 295168
v_mul_f32 v134, v70, v134
v_mul_f32 v135, v71, v135
v_mfma_f32_16x16x32_bf16 v[164:167], v[200:203], a[204:207], v[164:167]
ds_read_b64_tr_b16 v[222:223], v22 offset:47104
v_mul_f32 v136, v72, v136
v_mfma_f32_16x16x32_bf16 v[164:167], v[204:207], a[220:223], v[164:167]
s_waitcnt lgkmcnt(4)
v_mul_f32 v137, v73, v137
v_mul_f32 v138, v74, v138
v_mfma_f32_16x16x32_bf16 v[152:155], v[208:211], a[224:227], v[152:155]
ds_read_b64_tr_b16 v[200:201], v23 offset:24576
v_mul_f32 v139, v75, v139
v_mfma_f32_16x16x32_bf16 v[152:155], v[212:215], a[240:243], v[152:155]
buffer_load_dwordx4 v2, s[24:27], s21 offen lds
v_mfma_f32_16x16x32_bf16 v[156:159], v[208:211], a[228:231], v[156:159]
ds_read_b64_tr_b16 v[202:203], v23 offset:26624
v_mul_f32 v140, v76, v140
v_mfma_f32_16x16x32_bf16 v[156:159], v[212:215], a[244:247], v[156:159]
v_mul_f32 v141, v77, v141
v_mul_f32 v142, v78, v142
v_mfma_f32_16x16x32_bf16 v[160:163], v[208:211], a[232:235], v[160:163]
ds_read_b64_tr_b16 v[204:205], v23 offset:28672
v_mul_f32 v143, v79, v143
v_mfma_f32_16x16x32_bf16 v[160:163], v[212:215], a[248:251], v[160:163]
v_mul_f32 v144, v80, v144
v_mul_f32 v145, v81, v145
v_mfma_f32_16x16x32_bf16 v[164:167], v[208:211], a[236:239], v[164:167]
ds_read_b64_tr_b16 v[206:207], v23 offset:30720
v_mul_f32 v146, v82, v146
v_mfma_f32_16x16x32_bf16 v[164:167], v[212:215], a[252:255], v[164:167]
s_waitcnt lgkmcnt(4)
v_mul_f32 v147, v83, v147
v_mul_f32 v148, v84, v148
v_mfma_f32_16x16x32_bf16 v[152:155], v[216:219], v[224:227], v[152:155]
ds_read_b64_tr_b16 v[208:209], v23 offset:32768
v_mul_f32 v149, v85, v149
v_mfma_f32_16x16x32_bf16 v[152:155], v[220:223], v[240:243], v[152:155]
s_add_u32 m0, s17, 90112
v_mul_f32 v150, v86, v150
v_mul_f32 v151, v87, v151
v_mfma_f32_16x16x32_bf16 v[156:159], v[216:219], v[228:231], v[156:159]
ds_read_b64_tr_b16 v[210:211], v23 offset:34816
v_mfma_f32_16x16x32_bf16 v[156:159], v[220:223], v[244:247], v[156:159]
v_mfma_f32_16x16x32_bf16 v[160:163], v[216:219], v[232:235], v[160:163]
ds_read_b64_tr_b16 v[212:213], v23 offset:36864
v_mfma_f32_16x16x32_bf16 v[160:163], v[220:223], v[248:251], v[160:163]
s_add_u32 s21, s35, 256
v_mfma_f32_16x16x32_bf16 v[164:167], v[216:219], v[236:239], v[164:167]
ds_read_b64_tr_b16 v[214:215], v23 offset:38912
v_mfma_f32_16x16x32_bf16 v[164:167], v[220:223], v[252:255], v[164:167]
s_waitcnt lgkmcnt(4)
v_mfma_f32_16x16x32_bf16 v[168:171], v[200:203], a[192:195], v[168:171]
ds_read_b64_tr_b16 v[216:217], v23 offset:40960
v_mfma_f32_16x16x32_bf16 v[168:171], v[204:207], a[208:211], v[168:171]
v_mfma_f32_16x16x32_bf16 v[172:175], v[200:203], a[196:199], v[172:175]
ds_read_b64_tr_b16 v[218:219], v23 offset:43008
v_mfma_f32_16x16x32_bf16 v[172:175], v[204:207], a[212:215], v[172:175]
buffer_load_dwordx4 v2, s[24:27], s21 offen lds
v_mfma_f32_16x16x32_bf16 v[176:179], v[200:203], a[200:203], v[176:179]
ds_read_b64_tr_b16 v[220:221], v23 offset:45056
v_mul_f32 v152, v88, v152
v_mfma_f32_16x16x32_bf16 v[176:179], v[204:207], a[216:219], v[176:179]
v_mul_f32 v153, v89, v153
v_mul_f32 v154, v90, v154
v_mfma_f32_16x16x32_bf16 v[180:183], v[200:203], a[204:207], v[180:183]
ds_read_b64_tr_b16 v[222:223], v23 offset:47104
v_mul_f32 v155, v91, v155
v_mfma_f32_16x16x32_bf16 v[180:183], v[204:207], a[220:223], v[180:183]
s_waitcnt lgkmcnt(4)
v_mul_f32 v156, v92, v156
v_mul_f32 v157, v93, v157
v_mfma_f32_16x16x32_bf16 v[168:171], v[208:211], a[224:227], v[168:171]
s_waitcnt vmcnt(19)
s_barrier
v_mul_f32 v158, v94, v158
v_mfma_f32_16x16x32_bf16 v[168:171], v[212:215], a[240:243], v[168:171]
ds_read_b64_tr_b16 v[200:201], v12 offset:0
v_mul_f32 v159, v95, v159
v_mfma_f32_16x16x32_bf16 v[172:175], v[208:211], a[228:231], v[172:175]
ds_read_b64_tr_b16 v[202:203], v12 offset:2048
v_mul_f32 v160, v96, v160
v_mfma_f32_16x16x32_bf16 v[172:175], v[212:215], a[244:247], v[172:175]
s_add_u32 m0, s17, 94208
v_mul_f32 v161, v97, v161
v_mul_f32 v162, v98, v162
v_mfma_f32_16x16x32_bf16 v[176:179], v[208:211], a[232:235], v[176:179]
ds_read_b64_tr_b16 v[204:205], v12 offset:4096
v_mul_f32 v163, v99, v163
v_mfma_f32_16x16x32_bf16 v[176:179], v[212:215], a[248:251], v[176:179]
s_add_u32 s21, s35, 295168
v_mul_f32 v164, v100, v164
v_mul_f32 v165, v101, v165
v_mfma_f32_16x16x32_bf16 v[180:183], v[208:211], a[236:239], v[180:183]
ds_read_b64_tr_b16 v[206:207], v12 offset:6144
v_mul_f32 v166, v102, v166
v_mfma_f32_16x16x32_bf16 v[180:183], v[212:215], a[252:255], v[180:183]
s_waitcnt lgkmcnt(4)
v_mul_f32 v167, v103, v167
v_mfma_f32_16x16x32_bf16 v[168:171], v[216:219], v[224:227], v[168:171]
ds_read_b64_tr_b16 v[208:209], v13 offset:0
v_mfma_f32_16x16x32_bf16 v[168:171], v[220:223], v[240:243], v[168:171]
buffer_load_dwordx4 v2, s[24:27], s21 offen lds
v_mfma_f32_16x16x32_bf16 v[172:175], v[216:219], v[228:231], v[172:175]
ds_read_b64_tr_b16 v[210:211], v13 offset:2048
v_mfma_f32_16x16x32_bf16 v[172:175], v[220:223], v[244:247], v[172:175]
v_mfma_f32_16x16x32_bf16 v[176:179], v[216:219], v[232:235], v[176:179]
ds_read_b64_tr_b16 v[212:213], v13 offset:4096
v_mfma_f32_16x16x32_bf16 v[176:179], v[220:223], v[248:251], v[176:179]
v_mfma_f32_16x16x32_bf16 v[180:183], v[216:219], v[236:239], v[180:183]
ds_read_b64_tr_b16 v[214:215], v13 offset:6144
v_mfma_f32_16x16x32_bf16 v[180:183], v[220:223], v[252:255], v[180:183]
s_waitcnt lgkmcnt(4)
v_mfma_f32_16x16x32_bf16 v[56:59], v[200:203], a[0:3], 0
s_add_u32 m0, s17, 98304
ds_read_b64_tr_b16 v[216:217], v14 offset:0
v_mfma_f32_16x16x32_bf16 v[56:59], v[204:207], a[16:19], v[56:59]
v_mfma_f32_16x16x32_bf16 v[60:63], v[200:203], a[4:7], 0
ds_read_b64_tr_b16 v[218:219], v14 offset:2048
v_mfma_f32_16x16x32_bf16 v[60:63], v[204:207], a[20:23], v[60:63]
v_mul_f32 v168, v104, v168
v_mul_f32 v169, v105, v169
v_mfma_f32_16x16x32_bf16 v[64:67], v[200:203], a[8:11], 0
ds_read_b64_tr_b16 v[220:221], v14 offset:4096
v_mul_f32 v170, v106, v170
v_mfma_f32_16x16x32_bf16 v[64:67], v[204:207], a[24:27], v[64:67]
s_add_u32 s21, s36, 256
v_mul_f32 v171, v107, v171
v_mul_f32 v172, v108, v172
v_mfma_f32_16x16x32_bf16 v[68:71], v[200:203], a[12:15], 0
ds_read_b64_tr_b16 v[222:223], v14 offset:6144
v_mul_f32 v173, v109, v173
v_mfma_f32_16x16x32_bf16 v[68:71], v[204:207], a[28:31], v[68:71]
s_waitcnt lgkmcnt(4)
v_mul_f32 v174, v110, v174
v_mul_f32 v175, v111, v175
v_mfma_f32_16x16x32_bf16 v[72:75], v[208:211], a[0:3], 0
ds_read_b64_tr_b16 v[200:201], v15 offset:0
v_mul_f32 v176, v112, v176
v_mfma_f32_16x16x32_bf16 v[72:75], v[212:215], a[16:19], v[72:75]
v_mul_f32 v177, v113, v177
v_mul_f32 v178, v114, v178
v_mfma_f32_16x16x32_bf16 v[76:79], v[208:211], a[4:7], 0
ds_read_b64_tr_b16 v[202:203], v15 offset:2048
v_mul_f32 v179, v115, v179
v_mfma_f32_16x16x32_bf16 v[76:79], v[212:215], a[20:23], v[76:79]
buffer_load_dwordx4 v2, s[24:27], s21 offen lds
v_mfma_f32_16x16x32_bf16 v[80:83], v[208:211], a[8:11], 0
ds_read_b64_tr_b16 v[204:205], v15 offset:4096
v_mul_f32 v180, v116, v180
v_mfma_f32_16x16x32_bf16 v[80:83], v[212:215], a[24:27], v[80:83]
v_mul_f32 v181, v117, v181
v_mul_f32 v182, v118, v182
v_mfma_f32_16x16x32_bf16 v[84:87], v[208:211], a[12:15], 0
ds_read_b64_tr_b16 v[206:207], v15 offset:6144
v_mul_f32 v183, v119, v183
v_mfma_f32_16x16x32_bf16 v[84:87], v[212:215], a[28:31], v[84:87]
s_waitcnt lgkmcnt(4)
s_add_u32 m0, s17, 102400
v_mfma_f32_16x16x32_bf16 v[88:91], v[216:219], a[0:3], 0
ds_read_b64_tr_b16 v[208:209], v12 offset:8192
v_mfma_f32_16x16x32_bf16 v[88:91], v[220:223], a[16:19], v[88:91]
v_mfma_f32_16x16x32_bf16 v[92:95], v[216:219], a[4:7], 0
ds_read_b64_tr_b16 v[210:211], v12 offset:10240
v_mfma_f32_16x16x32_bf16 v[92:95], v[220:223], a[20:23], v[92:95]
v_mfma_f32_16x16x32_bf16 v[96:99], v[216:219], a[8:11], 0
s_add_u32 s21, s36, 295168
ds_read_b64_tr_b16 v[212:213], v12 offset:12288
v_mfma_f32_16x16x32_bf16 v[96:99], v[220:223], a[24:27], v[96:99]
v_mfma_f32_16x16x32_bf16 v[100:103], v[216:219], a[12:15], 0
ds_read_b64_tr_b16 v[214:215], v12 offset:14336
v_mfma_f32_16x16x32_bf16 v[100:103], v[220:223], a[28:31], v[100:103]
s_waitcnt lgkmcnt(4)
v_mfma_f32_16x16x32_bf16 v[104:107], v[200:203], a[0:3], 0
ds_read_b64_tr_b16 v[216:217], v13 offset:8192
v_mfma_f32_16x16x32_bf16 v[104:107], v[204:207], a[16:19], v[104:107]
buffer_load_dwordx4 v2, s[24:27], s21 offen lds
v_mfma_f32_16x16x32_bf16 v[108:111], v[200:203], a[4:7], 0
ds_read_b64_tr_b16 v[218:219], v13 offset:10240
v_mfma_f32_16x16x32_bf16 v[108:111], v[204:207], a[20:23], v[108:111]
v_mfma_f32_16x16x32_bf16 v[112:115], v[200:203], a[8:11], 0
ds_read_b64_tr_b16 v[220:221], v13 offset:12288
v_mfma_f32_16x16x32_bf16 v[112:115], v[204:207], a[24:27], v[112:115]
v_mfma_f32_16x16x32_bf16 v[116:119], v[200:203], a[12:15], 0
ds_read_b64_tr_b16 v[222:223], v13 offset:14336
v_cvt_pk_bf16_f32 v120, v120, v121
v_mfma_f32_16x16x32_bf16 v[116:119], v[204:207], a[28:31], v[116:119]
s_waitcnt lgkmcnt(4)
v_mfma_f32_16x16x32_bf16 v[56:59], v[208:211], a[32:35], v[56:59]
s_add_u32 m0, s17, 106496
ds_read_b64_tr_b16 v[200:201], v14 offset:8192
v_mfma_f32_16x16x32_bf16 v[56:59], v[212:215], a[48:51], v[56:59]
v_mfma_f32_16x16x32_bf16 v[60:63], v[208:211], a[36:39], v[60:63]
ds_read_b64_tr_b16 v[202:203], v14 offset:10240
v_cvt_pk_bf16_f32 v121, v122, v123
v_mfma_f32_16x16x32_bf16 v[60:63], v[212:215], a[52:55], v[60:63]
v_mfma_f32_16x16x32_bf16 v[64:67], v[208:211], a[40:43], v[64:67]
s_add_u32 s21, s38, 256
ds_read_b64_tr_b16 v[204:205], v14 offset:12288
v_mfma_f32_16x16x32_bf16 v[64:67], v[212:215], a[56:59], v[64:67]
v_mfma_f32_16x16x32_bf16 v[68:71], v[208:211], a[44:47], v[68:71]
ds_read_b64_tr_b16 v[206:207], v14 offset:14336
v_cvt_pk_bf16_f32 v122, v136, v137
v_mfma_f32_16x16x32_bf16 v[68:71], v[212:215], a[60:63], v[68:71]
s_waitcnt lgkmcnt(4)
v_mfma_f32_16x16x32_bf16 v[72:75], v[216:219], a[32:35], v[72:75]
ds_read_b64_tr_b16 v[208:209], v15 offset:8192
v_mfma_f32_16x16x32_bf16 v[72:75], v[220:223], a[48:51], v[72:75]
buffer_load_dwordx4 v2, s[24:27], s21 offen lds
v_mfma_f32_16x16x32_bf16 v[76:79], v[216:219], a[36:39], v[76:79]
ds_read_b64_tr_b16 v[210:211], v15 offset:10240
v_cvt_pk_bf16_f32 v123, v138, v139
v_mfma_f32_16x16x32_bf16 v[76:79], v[220:223], a[52:55], v[76:79]
v_mfma_f32_16x16x32_bf16 v[80:83], v[216:219], a[40:43], v[80:83]
s_add_u32 m0, s17, 110592
ds_read_b64_tr_b16 v[212:213], v15 offset:12288
v_mfma_f32_16x16x32_bf16 v[80:83], v[220:223], a[56:59], v[80:83]
v_mfma_f32_16x16x32_bf16 v[84:87], v[216:219], a[44:47], v[84:87]
ds_read_b64_tr_b16 v[214:215], v15 offset:14336
v_mfma_f32_16x16x32_bf16 v[84:87], v[220:223], a[60:63], v[84:87]
s_waitcnt lgkmcnt(4)
v_mfma_f32_16x16x32_bf16 v[88:91], v[200:203], a[32:35], v[88:91]
ds_read_b64_tr_b16 v[216:217], v12 offset:16384
v_mfma_f32_16x16x32_bf16 v[88:91], v[204:207], a[48:51], v[88:91]
buffer_store_dwordx4 v[120:123], v8, s[12:15], s40 offen offset:2048 sc1
v_mfma_f32_16x16x32_bf16 v[92:95], v[200:203], a[36:39], v[92:95]
ds_read_b64_tr_b16 v[218:219], v12 offset:18432
v_cvt_pk_bf16_f32 v124, v124, v125
v_mfma_f32_16x16x32_bf16 v[92:95], v[204:207], a[52:55], v[92:95]
s_add_u32 s21, s38, 295168
v_mfma_f32_16x16x32_bf16 v[96:99], v[200:203], a[40:43], v[96:99]
ds_read_b64_tr_b16 v[220:221], v12 offset:20480
v_mfma_f32_16x16x32_bf16 v[96:99], v[204:207], a[56:59], v[96:99]
buffer_load_dwordx4 v2, s[24:27], s21 offen lds
v_mfma_f32_16x16x32_bf16 v[100:103], v[200:203], a[44:47], v[100:103]
ds_read_b64_tr_b16 v[222:223], v12 offset:22528
v_cvt_pk_bf16_f32 v125, v126, v127
v_mfma_f32_16x16x32_bf16 v[100:103], v[204:207], a[60:63], v[100:103]
s_waitcnt lgkmcnt(4)
v_mfma_f32_16x16x32_bf16 v[104:107], v[208:211], a[32:35], v[104:107]
ds_read_b64_tr_b16 v[200:201], v13 offset:16384
v_mfma_f32_16x16x32_bf16 v[104:107], v[212:215], a[48:51], v[104:107]
buffer_load_dword v40, v41, s[28:31], 0 offen offset:2048
v_mfma_f32_16x16x32_bf16 v[108:111], v[208:211], a[36:39], v[108:111]
ds_read_b64_tr_b16 v[202:203], v13 offset:18432
v_cvt_pk_bf16_f32 v126, v140, v141
v_mfma_f32_16x16x32_bf16 v[108:111], v[212:215], a[52:55], v[108:111]
v_mfma_f32_16x16x32_bf16 v[112:115], v[208:211], a[40:43], v[112:115]
ds_read_b64_tr_b16 v[204:205], v13 offset:20480
v_mfma_f32_16x16x32_bf16 v[112:115], v[212:215], a[56:59], v[112:115]
v_mfma_f32_16x16x32_bf16 v[116:119], v[208:211], a[44:47], v[116:119]
ds_read_b64_tr_b16 v[206:207], v13 offset:22528
v_cvt_pk_bf16_f32 v127, v142, v143
v_mfma_f32_16x16x32_bf16 v[116:119], v[212:215], a[60:63], v[116:119]
s_waitcnt lgkmcnt(4)
v_mfma_f32_16x16x32_bf16 v[56:59], v[216:219], a[64:67], v[56:59]
s_add_u32 m0, s17, 114688
ds_read_b64_tr_b16 v[208:209], v14 offset:16384
v_mfma_f32_16x16x32_bf16 v[56:59], v[220:223], a[80:83], v[56:59]
v_mfma_f32_16x16x32_bf16 v[60:63], v[216:219], a[68:71], v[60:63]
ds_read_b64_tr_b16 v[210:211], v14 offset:18432
v_mfma_f32_16x16x32_bf16 v[60:63], v[220:223], a[84:87], v[60:63]
buffer_store_dwordx4 v[124:127], v9, s[12:15], s40 offen offset:2048 sc1
v_mfma_f32_16x16x32_bf16 v[64:67], v[216:219], a[72:75], v[64:67]
ds_read_b64_tr_b16 v[212:213], v14 offset:20480
v_mfma_f32_16x16x32_bf16 v[64:67], v[220:223], a[88:91], v[64:67]
s_add_u32 s21, s39, 256
v_mfma_f32_16x16x32_bf16 v[68:71], v[216:219], a[76:79], v[68:71]
ds_read_b64_tr_b16 v[214:215], v14 offset:22528
v_cvt_pk_bf16_f32 v128, v128, v129
v_mfma_f32_16x16x32_bf16 v[68:71], v[220:223], a[92:95], v[68:71]
s_waitcnt lgkmcnt(4)
v_mfma_f32_16x16x32_bf16 v[72:75], v[200:203], a[64:67], v[72:75]
ds_read_b64_tr_b16 v[216:217], v15 offset:16384
v_mfma_f32_16x16x32_bf16 v[72:75], v[204:207], a[80:83], v[72:75]
v_mfma_f32_16x16x32_bf16 v[76:79], v[200:203], a[68:71], v[76:79]
ds_read_b64_tr_b16 v[218:219], v15 offset:18432
v_cvt_pk_bf16_f32 v129, v130, v131
v_mfma_f32_16x16x32_bf16 v[76:79], v[204:207], a[84:87], v[76:79]
buffer_load_dwordx4 v2, s[24:27], s21 offen lds
v_mfma_f32_16x16x32_bf16 v[80:83], v[200:203], a[72:75], v[80:83]
ds_read_b64_tr_b16 v[220:221], v15 offset:20480
v_mfma_f32_16x16x32_bf16 v[80:83], v[204:207], a[88:91], v[80:83]
v_mfma_f32_16x16x32_bf16 v[84:87], v[200:203], a[76:79], v[84:87]
ds_read_b64_tr_b16 v[222:223], v15 offset:22528
v_cvt_pk_bf16_f32 v130, v144, v145
v_mfma_f32_16x16x32_bf16 v[84:87], v[204:207], a[92:95], v[84:87]
s_waitcnt lgkmcnt(4)
s_add_u32 m0, s17, 118784
v_mfma_f32_16x16x32_bf16 v[88:91], v[208:211], a[64:67], v[88:91]
s_waitcnt vmcnt(21)
s_barrier
v_mfma_f32_16x16x32_bf16 v[88:91], v[212:215], a[80:83], v[88:91]
ds_read_b64_tr_b16 v[200:201], v12 offset:24576
v_mfma_f32_16x16x32_bf16 v[92:95], v[208:211], a[68:71], v[92:95]
ds_read_b64_tr_b16 v[202:203], v12 offset:26624
v_cvt_pk_bf16_f32 v131, v146, v147
v_mfma_f32_16x16x32_bf16 v[92:95], v[212:215], a[84:87], v[92:95]
v_mfma_f32_16x16x32_bf16 v[96:99], v[208:211], a[72:75], v[96:99]
s_add_u32 s21, s39, 295168
ds_read_b64_tr_b16 v[204:205], v12 offset:28672
v_mfma_f32_16x16x32_bf16 v[96:99], v[212:215], a[88:91], v[96:99]
v_mfma_f32_16x16x32_bf16 v[100:103], v[208:211], a[76:79], v[100:103]
ds_read_b64_tr_b16 v[206:207], v12 offset:30720
v_mfma_f32_16x16x32_bf16 v[100:103], v[212:215], a[92:95], v[100:103]
s_waitcnt lgkmcnt(4)
v_mfma_f32_16x16x32_bf16 v[104:107], v[216:219], a[64:67], v[104:107]
ds_read_b64_tr_b16 v[208:209], v13 offset:24576
v_mfma_f32_16x16x32_bf16 v[104:107], v[220:223], a[80:83], v[104:107]
buffer_load_dwordx4 v2, s[24:27], s21 offen lds
v_mfma_f32_16x16x32_bf16 v[108:111], v[216:219], a[68:71], v[108:111]
ds_read_b64_tr_b16 v[210:211], v13 offset:26624
v_mfma_f32_16x16x32_bf16 v[108:111], v[220:223], a[84:87], v[108:111]
buffer_store_dwordx4 v[128:131], v10, s[12:15], s40 offen offset:2048 sc1
v_mfma_f32_16x16x32_bf16 v[112:115], v[216:219], a[72:75], v[112:115]
ds_read_b64_tr_b16 v[212:213], v13 offset:28672
v_cvt_pk_bf16_f32 v132, v132, v133
v_mfma_f32_16x16x32_bf16 v[112:115], v[220:223], a[88:91], v[112:115]
v_mfma_f32_16x16x32_bf16 v[116:119], v[216:219], a[76:79], v[116:119]
ds_read_b64_tr_b16 v[214:215], v13 offset:30720
v_cvt_pk_bf16_f32 v133, v134, v135
v_mfma_f32_16x16x32_bf16 v[116:119], v[220:223], a[92:95], v[116:119]
s_waitcnt lgkmcnt(4)
v_mfma_f32_16x16x32_bf16 v[56:59], v[200:203], a[96:99], v[56:59]
s_add_u32 m0, s17, 122880
ds_read_b64_tr_b16 v[216:217], v14 offset:24576
v_mfma_f32_16x16x32_bf16 v[56:59], v[204:207], a[112:115], v[56:59]
v_mfma_f32_16x16x32_bf16 v[60:63], v[200:203], a[100:103], v[60:63]
ds_read_b64_tr_b16 v[218:219], v14 offset:26624
v_cvt_pk_bf16_f32 v134, v148, v149
v_mfma_f32_16x16x32_bf16 v[60:63], v[204:207], a[116:119], v[60:63]
v_mfma_f32_16x16x32_bf16 v[64:67], v[200:203], a[104:107], v[64:67]
ds_read_b64_tr_b16 v[220:221], v14 offset:28672
v_mfma_f32_16x16x32_bf16 v[64:67], v[204:207], a[120:123], v[64:67]
s_add_u32 s21, s42, 256
v_mfma_f32_16x16x32_bf16 v[68:71], v[200:203], a[108:111], v[68:71]
ds_read_b64_tr_b16 v[222:223], v14 offset:30720
v_cvt_pk_bf16_f32 v135, v150, v151
v_mfma_f32_16x16x32_bf16 v[68:71], v[204:207], a[124:127], v[68:71]
s_waitcnt lgkmcnt(4)
v_mfma_f32_16x16x32_bf16 v[72:75], v[208:211], a[96:99], v[72:75]
ds_read_b64_tr_b16 v[200:201], v15 offset:24576
v_mfma_f32_16x16x32_bf16 v[72:75], v[212:215], a[112:115], v[72:75]
v_mfma_f32_16x16x32_bf16 v[76:79], v[208:211], a[100:103], v[76:79]
ds_read_b64_tr_b16 v[202:203], v15 offset:26624
v_mfma_f32_16x16x32_bf16 v[76:79], v[212:215], a[116:119], v[76:79]
buffer_load_dwordx4 v2, s[24:27], s21 offen lds
v_mfma_f32_16x16x32_bf16 v[80:83], v[208:211], a[104:107], v[80:83]
ds_read_b64_tr_b16 v[204:205], v15 offset:28672
v_mfma_f32_16x16x32_bf16 v[80:83], v[212:215], a[120:123], v[80:83]
buffer_store_dwordx4 v[132:135], v11, s[12:15], s40 offen offset:2048 sc1
v_mfma_f32_16x16x32_bf16 v[84:87], v[208:211], a[108:111], v[84:87]
ds_read_b64_tr_b16 v[206:207], v15 offset:30720
v_cvt_pk_bf16_f32 v152, v152, v153
v_mfma_f32_16x16x32_bf16 v[84:87], v[212:215], a[124:127], v[84:87]
s_waitcnt lgkmcnt(4)
s_add_u32 m0, s17, 126976
v_mfma_f32_16x16x32_bf16 v[88:91], v[216:219], a[96:99], v[88:91]
ds_read_b64_tr_b16 v[208:209], v12 offset:32768
v_mfma_f32_16x16x32_bf16 v[88:91], v[220:223], a[112:115], v[88:91]
v_mfma_f32_16x16x32_bf16 v[92:95], v[216:219], a[100:103], v[92:95]
ds_read_b64_tr_b16 v[210:211], v12 offset:34816
v_cvt_pk_bf16_f32 v153, v154, v155
v_mfma_f32_16x16x32_bf16 v[92:95], v[220:223], a[116:119], v[92:95]
v_mfma_f32_16x16x32_bf16 v[96:99], v[216:219], a[104:107], v[96:99]
s_add_u32 s21, s42, 295168
ds_read_b64_tr_b16 v[212:213], v12 offset:36864
v_mfma_f32_16x16x32_bf16 v[96:99], v[220:223], a[120:123], v[96:99]
v_mfma_f32_16x16x32_bf16 v[100:103], v[216:219], a[108:111], v[100:103]
ds_read_b64_tr_b16 v[214:215], v12 offset:38912
v_cvt_pk_bf16_f32 v154, v168, v169
v_mfma_f32_16x16x32_bf16 v[100:103], v[220:223], a[124:127], v[100:103]
s_waitcnt lgkmcnt(4)
v_mfma_f32_16x16x32_bf16 v[104:107], v[200:203], a[96:99], v[104:107]
ds_read_b64_tr_b16 v[216:217], v13 offset:32768
v_mfma_f32_16x16x32_bf16 v[104:107], v[204:207], a[112:115], v[104:107]
buffer_load_dwordx4 v2, s[24:27], s21 offen lds
v_mfma_f32_16x16x32_bf16 v[108:111], v[200:203], a[100:103], v[108:111]
ds_read_b64_tr_b16 v[218:219], v13 offset:34816
v_cvt_pk_bf16_f32 v155, v170, v171
v_mfma_f32_16x16x32_bf16 v[108:111], v[204:207], a[116:119], v[108:111]
v_mfma_f32_16x16x32_bf16 v[112:115], v[200:203], a[104:107], v[112:115]
ds_read_b64_tr_b16 v[220:221], v13 offset:36864
v_mfma_f32_16x16x32_bf16 v[112:115], v[204:207], a[120:123], v[112:115]
v_mfma_f32_16x16x32_bf16 v[116:119], v[200:203], a[108:111], v[116:119]
ds_read_b64_tr_b16 v[222:223], v13 offset:38912
v_mfma_f32_16x16x32_bf16 v[116:119], v[204:207], a[124:127], v[116:119]
s_waitcnt lgkmcnt(4)
v_mfma_f32_16x16x32_bf16 v[56:59], v[208:211], a[128:131], v[56:59]
s_add_u32 m0, s17, 131072
ds_read_b64_tr_b16 v[200:201], v14 offset:32768
v_mfma_f32_16x16x32_bf16 v[56:59], v[212:215], a[144:147], v[56:59]
buffer_store_dwordx4 v[152:155], v8, s[12:15], s40 offen offset:3072 sc1
v_mfma_f32_16x16x32_bf16 v[60:63], v[208:211], a[132:135], v[60:63]
ds_read_b64_tr_b16 v[202:203], v14 offset:34816
v_cvt_pk_bf16_f32 v156, v156, v157
v_mfma_f32_16x16x32_bf16 v[60:63], v[212:215], a[148:151], v[60:63]
s_add_u32 s21, s43, 256
v_mfma_f32_16x16x32_bf16 v[64:67], v[208:211], a[136:139], v[64:67]
ds_read_b64_tr_b16 v[204:205], v14 offset:36864
v_mfma_f32_16x16x32_bf16 v[64:67], v[212:215], a[152:155], v[64:67]
buffer_load_dwordx4 v2, s[24:27], s21 offen lds
v_mfma_f32_16x16x32_bf16 v[68:71], v[208:211], a[140:143], v[68:71]
ds_read_b64_tr_b16 v[206:207], v14 offset:38912
v_cvt_pk_bf16_f32 v157, v158, v159
v_mfma_f32_16x16x32_bf16 v[68:71], v[212:215], a[156:159], v[68:71]
s_waitcnt lgkmcnt(4)
s_add_u32 m0, s17, 135168
v_mfma_f32_16x16x32_bf16 v[72:75], v[216:219], a[128:131], v[72:75]
ds_read_b64_tr_b16 v[208:209], v15 offset:32768
v_mfma_f32_16x16x32_bf16 v[72:75], v[220:223], a[144:147], v[72:75]
s_add_u32 s21, s43, 295168
v_mfma_f32_16x16x32_bf16 v[76:79], v[216:219], a[132:135], v[76:79]
ds_read_b64_tr_b16 v[210:211], v15 offset:34816
v_cvt_pk_bf16_f32 v158, v172, v173
v_mfma_f32_16x16x32_bf16 v[76:79], v[220:223], a[148:151], v[76:79]
buffer_load_dwordx4 v2, s[24:27], s21 offen lds
v_mfma_f32_16x16x32_bf16 v[80:83], v[216:219], a[136:139], v[80:83]
ds_read_b64_tr_b16 v[212:213], v15 offset:36864
v_mfma_f32_16x16x32_bf16 v[80:83], v[220:223], a[152:155], v[80:83]
s_add_u32 s6, s62, 0
v_mfma_f32_16x16x32_bf16 v[84:87], v[216:219], a[140:143], v[84:87]
ds_read_b64_tr_b16 v[214:215], v15 offset:38912
v_cvt_pk_bf16_f32 v159, v174, v175
v_mfma_f32_16x16x32_bf16 v[84:87], v[220:223], a[156:159], v[84:87]
s_waitcnt lgkmcnt(4)
v_mfma_f32_16x16x32_bf16 v[88:91], v[200:203], a[128:131], v[88:91]
s_add_u32 m0, s17, 0
ds_read_b64_tr_b16 v[216:217], v12 offset:40960
v_mfma_f32_16x16x32_bf16 v[88:91], v[204:207], a[144:147], v[88:91]
v_mfma_f32_16x16x32_bf16 v[92:95], v[200:203], a[132:135], v[92:95]
ds_read_b64_tr_b16 v[218:219], v12 offset:43008
v_mfma_f32_16x16x32_bf16 v[92:95], v[204:207], a[148:151], v[92:95]
buffer_load_dwordx4 v3, s[28:31], s6 offen offset:0 lds
v_mfma_f32_16x16x32_bf16 v[96:99], v[200:203], a[136:139], v[96:99]
s_add_u32 m0, s17, 3968
ds_read_b64_tr_b16 v[220:221], v12 offset:45056
v_mfma_f32_16x16x32_bf16 v[96:99], v[204:207], a[152:155], v[96:99]
buffer_store_dwordx4 v[156:159], v9, s[12:15], s40 offen offset:3072 sc1
v_mfma_f32_16x16x32_bf16 v[100:103], v[200:203], a[140:143], v[100:103]
ds_read_b64_tr_b16 v[222:223], v12 offset:47104
v_cvt_pk_bf16_f32 v160, v160, v161
v_mfma_f32_16x16x32_bf16 v[100:103], v[204:207], a[156:159], v[100:103]
s_waitcnt lgkmcnt(4)
v_mfma_f32_16x16x32_bf16 v[104:107], v[208:211], a[128:131], v[104:107]
ds_read_b64_tr_b16 v[200:201], v13 offset:40960
v_mfma_f32_16x16x32_bf16 v[104:107], v[212:215], a[144:147], v[104:107]
buffer_load_dwordx4 v3, s[28:31], s6 offen offset:128 lds
v_mfma_f32_16x16x32_bf16 v[108:111], v[208:211], a[132:135], v[108:111]
ds_read_b64_tr_b16 v[202:203], v13 offset:43008
v_cvt_pk_bf16_f32 v161, v162, v163
v_mfma_f32_16x16x32_bf16 v[108:111], v[212:215], a[148:151], v[108:111]
s_add_u32 m0, s17, 7936
v_mfma_f32_16x16x32_bf16 v[112:115], v[208:211], a[136:139], v[112:115]
ds_read_b64_tr_b16 v[204:205], v13 offset:45056
v_mfma_f32_16x16x32_bf16 v[112:115], v[212:215], a[152:155], v[112:115]
buffer_load_dwordx4 v3, s[28:31], s6 offen offset:256 lds
v_mfma_f32_16x16x32_bf16 v[116:119], v[208:211], a[140:143], v[116:119]
ds_read_b64_tr_b16 v[206:207], v13 offset:47104
v_cvt_pk_bf16_f32 v162, v176, v177
v_mfma_f32_16x16x32_bf16 v[116:119], v[212:215], a[156:159], v[116:119]
s_waitcnt lgkmcnt(4)
v_mfma_f32_16x16x32_bf16 v[56:59], v[216:219], a[160:163], v[56:59]
s_add_u32 m0, s17, 139264
ds_read_b64_tr_b16 v[208:209], v14 offset:40960
v_mfma_f32_16x16x32_bf16 v[56:59], v[220:223], a[176:179], v[56:59]
v_mfma_f32_16x16x32_bf16 v[60:63], v[216:219], a[164:167], v[60:63]
ds_read_b64_tr_b16 v[210:211], v14 offset:43008
v_cvt_pk_bf16_f32 v163, v178, v179
v_mfma_f32_16x16x32_bf16 v[60:63], v[220:223], a[180:183], v[60:63]
v_mfma_f32_16x16x32_bf16 v[64:67], v[216:219], a[168:171], v[64:67]
ds_read_b64_tr_b16 v[212:213], v14 offset:45056
v_mfma_f32_16x16x32_bf16 v[64:67], v[220:223], a[184:187], v[64:67]
s_add_u32 s21, s0, 256
v_mfma_f32_16x16x32_bf16 v[68:71], v[216:219], a[172:175], v[68:71]
ds_read_b64_tr_b16 v[214:215], v14 offset:47104
v_mfma_f32_16x16x32_bf16 v[68:71], v[220:223], a[188:191], v[68:71]
s_waitcnt lgkmcnt(4)
v_mfma_f32_16x16x32_bf16 v[72:75], v[200:203], a[160:163], v[72:75]
ds_read_b64_tr_b16 v[216:217], v15 offset:40960
v_mfma_f32_16x16x32_bf16 v[72:75], v[204:207], a[176:179], v[72:75]
buffer_store_dwordx4 v[160:163], v10, s[12:15], s40 offen offset:3072 sc1
v_mfma_f32_16x16x32_bf16 v[76:79], v[200:203], a[164:167], v[76:79]
ds_read_b64_tr_b16 v[218:219], v15 offset:43008
v_cvt_pk_bf16_f32 v164, v164, v165
v_mfma_f32_16x16x32_bf16 v[76:79], v[204:207], a[180:183], v[76:79]
buffer_load_dwordx4 v2, s[24:27], s21 offen lds
v_mfma_f32_16x16x32_bf16 v[80:83], v[200:203], a[168:171], v[80:83]
ds_read_b64_tr_b16 v[220:221], v15 offset:45056
v_mfma_f32_16x16x32_bf16 v[80:83], v[204:207], a[184:187], v[80:83]
v_mfma_f32_16x16x32_bf16 v[84:87], v[200:203], a[172:175], v[84:87]
ds_read_b64_tr_b16 v[222:223], v15 offset:47104
v_cvt_pk_bf16_f32 v165, v166, v167
v_mfma_f32_16x16x32_bf16 v[84:87], v[204:207], a[188:191], v[84:87]
s_waitcnt lgkmcnt(4)
s_add_u32 m0, s17, 143360
v_mfma_f32_16x16x32_bf16 v[88:91], v[208:211], a[160:163], v[88:91]
s_waitcnt vmcnt(29)
s_barrier
v_mfma_f32_16x16x32_bf16 v[88:91], v[212:215], a[176:179], v[88:91]
ds_read_b64_tr_b16 v[200:201], v16 offset:0
v_mfma_f32_16x16x32_bf16 v[92:95], v[208:211], a[164:167], v[92:95]
ds_read_b64_tr_b16 v[202:203], v16 offset:2048
v_cvt_pk_bf16_f32 v166, v180, v181
v_mfma_f32_16x16x32_bf16 v[92:95], v[212:215], a[180:183], v[92:95]
v_mfma_f32_16x16x32_bf16 v[96:99], v[208:211], a[168:171], v[96:99]
s_add_u32 s21, s0, 295168
ds_read_b64_tr_b16 v[204:205], v16 offset:4096
v_mfma_f32_16x16x32_bf16 v[96:99], v[212:215], a[184:187], v[96:99]
v_mfma_f32_16x16x32_bf16 v[100:103], v[208:211], a[172:175], v[100:103]
ds_read_b64_tr_b16 v[206:207], v16 offset:6144
v_cvt_pk_bf16_f32 v167, v182, v183
v_mfma_f32_16x16x32_bf16 v[100:103], v[212:215], a[188:191], v[100:103]
s_waitcnt lgkmcnt(4)
v_mfma_f32_16x16x32_bf16 v[104:107], v[216:219], a[160:163], v[104:107]
ds_read_b64_tr_b16 v[208:209], v16 offset:8192
v_mfma_f32_16x16x32_bf16 v[104:107], v[220:223], a[176:179], v[104:107]
buffer_load_dwordx4 v2, s[24:27], s21 offen lds
v_mfma_f32_16x16x32_bf16 v[108:111], v[216:219], a[164:167], v[108:111]
ds_read_b64_tr_b16 v[210:211], v16 offset:10240
v_mfma_f32_16x16x32_bf16 v[108:111], v[220:223], a[180:183], v[108:111]
buffer_store_dwordx4 v[164:167], v11, s[12:15], s40 offen offset:3072 sc1
v_mfma_f32_16x16x32_bf16 v[112:115], v[216:219], a[168:171], v[112:115]
ds_read_b64_tr_b16 v[212:213], v16 offset:12288
v_mfma_f32_16x16x32_bf16 v[112:115], v[220:223], a[184:187], v[112:115]
v_mfma_f32_16x16x32_bf16 v[116:119], v[216:219], a[172:175], v[116:119]
ds_read_b64_tr_b16 v[214:215], v16 offset:14336
v_mfma_f32_16x16x32_bf16 v[116:119], v[220:223], a[188:191], v[116:119]
s_waitcnt lgkmcnt(4)
v_mfma_f32_16x16x32_bf16 v[56:59], v[200:203], a[192:195], v[56:59]
s_add_u32 s6, s62, 36864
ds_read_b64_tr_b16 v[216:217], v16 offset:16384
v_mfma_f32_16x16x32_bf16 v[56:59], v[204:207], a[208:211], v[56:59]
v_mfma_f32_16x16x32_bf16 v[60:63], v[200:203], a[196:199], v[60:63]
ds_read_b64_tr_b16 v[218:219], v16 offset:18432
v_mfma_f32_16x16x32_bf16 v[60:63], v[204:207], a[212:215], v[60:63]
v_mfma_f32_16x16x32_bf16 v[64:67], v[200:203], a[200:203], v[64:67]
s_add_u32 m0, s17, 12288
ds_read_b64_tr_b16 v[220:221], v16 offset:20480
v_mfma_f32_16x16x32_bf16 v[64:67], v[204:207], a[216:219], v[64:67]
v_mfma_f32_16x16x32_bf16 v[68:71], v[200:203], a[204:207], v[68:71]
ds_read_b64_tr_b16 v[222:223], v16 offset:22528
v_mfma_f32_16x16x32_bf16 v[68:71], v[204:207], a[220:223], v[68:71]
s_waitcnt lgkmcnt(4)
v_mfma_f32_16x16x32_bf16 v[56:59], v[208:211], a[224:227], v[56:59]
ds_read_b64_tr_b16 v[200:201], v17 offset:0
v_mfma_f32_16x16x32_bf16 v[56:59], v[212:215], a[240:243], v[56:59]
buffer_load_dwordx4 v3, s[28:31], s6 offen offset:0 lds
v_mfma_f32_16x16x32_bf16 v[60:63], v[208:211], a[228:231], v[60:63]
ds_read_b64_tr_b16 v[202:203], v17 offset:2048
v_mfma_f32_16x16x32_bf16 v[60:63], v[212:215], a[244:247], v[60:63]
v_mfma_f32_16x16x32_bf16 v[64:67], v[208:211], a[232:235], v[64:67]
s_add_u32 m0, s17, 16256
ds_read_b64_tr_b16 v[204:205], v17 offset:4096
v_mfma_f32_16x16x32_bf16 v[64:67], v[212:215], a[248:251], v[64:67]
v_mfma_f32_16x16x32_bf16 v[68:71], v[208:211], a[236:239], v[68:71]
ds_read_b64_tr_b16 v[206:207], v17 offset:6144
v_mfma_f32_16x16x32_bf16 v[68:71], v[212:215], a[252:255], v[68:71]
s_waitcnt lgkmcnt(4)
v_mfma_f32_16x16x32_bf16 v[56:59], v[216:219], v[224:227], v[56:59]
ds_read_b64_tr_b16 v[208:209], v17 offset:8192
v_mfma_f32_16x16x32_bf16 v[56:59], v[220:223], v[240:243], v[56:59]
buffer_load_dwordx4 v3, s[28:31], s6 offen offset:128 lds
v_mfma_f32_16x16x32_bf16 v[60:63], v[216:219], v[228:231], v[60:63]
ds_read_b64_tr_b16 v[210:211], v17 offset:10240
v_mfma_f32_16x16x32_bf16 v[60:63], v[220:223], v[244:247], v[60:63]
v_mfma_f32_16x16x32_bf16 v[64:67], v[216:219], v[232:235], v[64:67]
ds_read_b64_tr_b16 v[212:213], v17 offset:12288
v_mfma_f32_16x16x32_bf16 v[64:67], v[220:223], v[248:251], v[64:67]
s_add_u32 m0, s17, 20224
v_mfma_f32_16x16x32_bf16 v[68:71], v[216:219], v[236:239], v[68:71]
ds_read_b64_tr_b16 v[214:215], v17 offset:14336
v_mfma_f32_16x16x32_bf16 v[68:71], v[220:223], v[252:255], v[68:71]
s_waitcnt lgkmcnt(4)
v_mfma_f32_16x16x32_bf16 v[72:75], v[200:203], a[192:195], v[72:75]
ds_read_b64_tr_b16 v[216:217], v17 offset:16384
v_mfma_f32_16x16x32_bf16 v[72:75], v[204:207], a[208:211], v[72:75]
buffer_load_dwordx4 v3, s[28:31], s6 offen offset:256 lds
v_mfma_f32_16x16x32_bf16 v[76:79], v[200:203], a[196:199], v[76:79]
ds_read_b64_tr_b16 v[218:219], v17 offset:18432
v_mfma_f32_16x16x32_bf16 v[76:79], v[204:207], a[212:215], v[76:79]
v_exp_f32 v32, -v56
v_mfma_f32_16x16x32_bf16 v[80:83], v[200:203], a[200:203], v[80:83]
ds_read_b64_tr_b16 v[220:221], v17 offset:20480
v_mfma_f32_16x16x32_bf16 v[80:83], v[204:207], a[216:219], v[80:83]
v_exp_f32 v33, -v57
v_mfma_f32_16x16x32_bf16 v[84:87], v[200:203], a[204:207], v[84:87]
ds_read_b64_tr_b16 v[222:223], v17 offset:22528
v_add_f32 v32, 1.0, v32
v_mfma_f32_16x16x32_bf16 v[84:87], v[204:207], a[220:223], v[84:87]
s_waitcnt lgkmcnt(4)
v_exp_f32 v34, -v58
v_mfma_f32_16x16x32_bf16 v[72:75], v[208:211], a[224:227], v[72:75]
ds_read_b64_tr_b16 v[200:201], v18 offset:0
v_add_f32 v33, 1.0, v33
v_mfma_f32_16x16x32_bf16 v[72:75], v[212:215], a[240:243], v[72:75]
s_add_u32 s6, s62, 221184
v_rcp_f32 v32, v32
v_mfma_f32_16x16x32_bf16 v[76:79], v[208:211], a[228:231], v[76:79]
ds_read_b64_tr_b16 v[202:203], v18 offset:2048
v_mfma_f32_16x16x32_bf16 v[76:79], v[212:215], a[244:247], v[76:79]
s_add_u32 m0, s17, 24576
v_exp_f32 v35, -v59
v_mfma_f32_16x16x32_bf16 v[80:83], v[208:211], a[232:235], v[80:83]
ds_read_b64_tr_b16 v[204:205], v18 offset:4096
v_add_f32 v34, 1.0, v34
v_mfma_f32_16x16x32_bf16 v[80:83], v[212:215], a[248:251], v[80:83]
v_rcp_f32 v33, v33
v_mfma_f32_16x16x32_bf16 v[84:87], v[208:211], a[236:239], v[84:87]
ds_read_b64_tr_b16 v[206:207], v18 offset:6144
v_mul_f32 v56, v56, v32
v_mfma_f32_16x16x32_bf16 v[84:87], v[212:215], a[252:255], v[84:87]
s_waitcnt lgkmcnt(4)
v_exp_f32 v36, -v60
v_mfma_f32_16x16x32_bf16 v[72:75], v[216:219], v[224:227], v[72:75]
ds_read_b64_tr_b16 v[208:209], v18 offset:8192
v_add_f32 v35, 1.0, v35
v_mfma_f32_16x16x32_bf16 v[72:75], v[220:223], v[240:243], v[72:75]
buffer_load_dwordx4 v3, s[28:31], s6 offen offset:0 lds
v_mfma_f32_16x16x32_bf16 v[76:79], v[216:219], v[228:231], v[76:79]
ds_read_b64_tr_b16 v[210:211], v18 offset:10240
v_mfma_f32_16x16x32_bf16 v[76:79], v[220:223], v[244:247], v[76:79]
s_add_u32 m0, s17, 28544
v_rcp_f32 v34, v34
v_mfma_f32_16x16x32_bf16 v[80:83], v[216:219], v[232:235], v[80:83]
ds_read_b64_tr_b16 v[212:213], v18 offset:12288
v_mul_f32 v57, v57, v33
v_mfma_f32_16x16x32_bf16 v[80:83], v[220:223], v[248:251], v[80:83]
v_exp_f32 v37, -v61
v_mfma_f32_16x16x32_bf16 v[84:87], v[216:219], v[236:239], v[84:87]
ds_read_b64_tr_b16 v[214:215], v18 offset:14336
v_add_f32 v36, 1.0, v36
v_mfma_f32_16x16x32_bf16 v[84:87], v[220:223], v[252:255], v[84:87]
s_waitcnt lgkmcnt(4)
v_rcp_f32 v35, v35
v_mfma_f32_16x16x32_bf16 v[88:91], v[200:203], a[192:195], v[88:91]
s_barrier
v_mul_f32 v58, v58, v34
v_mfma_f32_16x16x32_bf16 v[88:91], v[204:207], a[208:211], v[88:91]
ds_read_b64_tr_b16 v[216:217], v18 offset:16384
v_mfma_f32_16x16x32_bf16 v[92:95], v[200:203], a[196:199], v[92:95]
ds_read_b64_tr_b16 v[218:219], v18 offset:18432
v_mfma_f32_16x16x32_bf16 v[92:95], v[204:207], a[212:215], v[92:95]
buffer_load_dwordx4 v3, s[28:31], s6 offen offset:128 lds
v_mfma_f32_16x16x32_bf16 v[96:99], v[200:203], a[200:203], v[96:99]
s_add_u32 m0, s17, 32512
ds_read_b64_tr_b16 v[220:221], v18 offset:20480
v_mfma_f32_16x16x32_bf16 v[96:99], v[204:207], a[216:219], v[96:99]
v_exp_f32 v38, -v62
v_mfma_f32_16x16x32_bf16 v[100:103], v[200:203], a[204:207], v[100:103]
ds_read_b64_tr_b16 v[222:223], v18 offset:22528
v_add_f32 v37, 1.0, v37
v_mfma_f32_16x16x32_bf16 v[100:103], v[204:207], a[220:223], v[100:103]
s_waitcnt lgkmcnt(4)
v_rcp_f32 v36, v36
v_mfma_f32_16x16x32_bf16 v[88:91], v[208:211], a[224:227], v[88:91]
ds_read_b64_tr_b16 v[200:201], v19 offset:0
v_mul_f32 v59, v59, v35
v_mfma_f32_16x16x32_bf16 v[88:91], v[212:215], a[240:243], v[88:91]
buffer_load_dwordx4 v3, s[28:31], s6 offen offset:256 lds
v_mfma_f32_16x16x32_bf16 v[92:95], v[208:211], a[228:231], v[92:95]
ds_read_b64_tr_b16 v[202:203], v19 offset:2048
v_mfma_f32_16x16x32_bf16 v[92:95], v[212:215], a[244:247], v[92:95]
buffer_load_dword v55, v26, s[12:15], s5 offen offset:0 sc1
v_mfma_f32_16x16x32_bf16 v[96:99], v[208:211], a[232:235], v[96:99]
ds_read_b64_tr_b16 v[204:205], v19 offset:4096
v_mfma_f32_16x16x32_bf16 v[96:99], v[212:215], a[248:251], v[96:99]
v_exp_f32 v39, -v63
v_mfma_f32_16x16x32_bf16 v[100:103], v[208:211], a[236:239], v[100:103]
ds_read_b64_tr_b16 v[206:207], v19 offset:6144
v_add_f32 v38, 1.0, v38
v_mfma_f32_16x16x32_bf16 v[100:103], v[212:215], a[252:255], v[100:103]
s_waitcnt lgkmcnt(4)
v_rcp_f32 v37, v37
v_mfma_f32_16x16x32_bf16 v[88:91], v[216:219], v[224:227], v[88:91]
ds_read_b64_tr_b16 v[208:209], v19 offset:8192
v_mul_f32 v60, v60, v36
v_mfma_f32_16x16x32_bf16 v[88:91], v[220:223], v[240:243], v[88:91]
s_add_u32 s6, s62, 258048
v_exp_f32 v32, -v64
v_mfma_f32_16x16x32_bf16 v[92:95], v[216:219], v[228:231], v[92:95]
ds_read_b64_tr_b16 v[210:211], v19 offset:10240
v_add_f32 v39, 1.0, v39
v_mfma_f32_16x16x32_bf16 v[92:95], v[220:223], v[244:247], v[92:95]
v_rcp_f32 v38, v38
v_mfma_f32_16x16x32_bf16 v[96:99], v[216:219], v[232:235], v[96:99]
ds_read_b64_tr_b16 v[212:213], v19 offset:12288
v_mul_f32 v61, v61, v37
v_mfma_f32_16x16x32_bf16 v[96:99], v[220:223], v[248:251], v[96:99]
s_add_u32 m0, s17, 36864
v_exp_f32 v33, -v65
v_mfma_f32_16x16x32_bf16 v[100:103], v[216:219], v[236:239], v[100:103]
ds_read_b64_tr_b16 v[214:215], v19 offset:14336
v_add_f32 v32, 1.0, v32
v_mfma_f32_16x16x32_bf16 v[100:103], v[220:223], v[252:255], v[100:103]
s_waitcnt lgkmcnt(4)
v_rcp_f32 v39, v39
v_mfma_f32_16x16x32_bf16 v[104:107], v[200:203], a[192:195], v[104:107]
ds_read_b64_tr_b16 v[216:217], v19 offset:16384
v_mul_f32 v62, v62, v38
v_mfma_f32_16x16x32_bf16 v[104:107], v[204:207], a[208:211], v[104:107]
buffer_load_dwordx4 v3, s[28:31], s6 offen offset:0 lds
v_mfma_f32_16x16x32_bf16 v[108:111], v[200:203], a[196:199], v[108:111]
ds_read_b64_tr_b16 v[218:219], v19 offset:18432
v_mfma_f32_16x16x32_bf16 v[108:111], v[204:207], a[212:215], v[108:111]
v_exp_f32 v34, -v66
v_mfma_f32_16x16x32_bf16 v[112:115], v[200:203], a[200:203], v[112:115]
ds_read_b64_tr_b16 v[220:221], v19 offset:20480
v_add_f32 v33, 1.0, v33
v_mfma_f32_16x16x32_bf16 v[112:115], v[204:207], a[216:219], v[112:115]
s_add_u32 m0, s17, 40832
v_rcp_f32 v32, v32
v_mfma_f32_16x16x32_bf16 v[116:119], v[200:203], a[204:207], v[116:119]
ds_read_b64_tr_b16 v[222:223], v19 offset:22528
v_mul_f32 v63, v63, v39
v_mfma_f32_16x16x32_bf16 v[116:119], v[204:207], a[220:223], v[116:119]
s_waitcnt lgkmcnt(4)
v_exp_f32 v35, -v67
v_mfma_f32_16x16x32_bf16 v[104:107], v[208:211], a[224:227], v[104:107]
s_waitcnt vmcnt(36)
s_barrier
v_add_f32 v34, 1.0, v34
v_mfma_f32_16x16x32_bf16 v[104:107], v[212:215], a[240:243], v[104:107]
ds_read_b64_tr_b16 v[200:201], v16 offset:24576
v_mfma_f32_16x16x32_bf16 v[108:111], v[208:211], a[228:231], v[108:111]
ds_read_b64_tr_b16 v[202:203], v16 offset:26624
v_mfma_f32_16x16x32_bf16 v[108:111], v[212:215], a[244:247], v[108:111]
buffer_load_dwordx4 v3, s[28:31], s6 offen offset:128 lds
v_mfma_f32_16x16x32_bf16 v[112:115], v[208:211], a[232:235], v[112:115]
ds_read_b64_tr_b16 v[204:205], v16 offset:28672
v_mfma_f32_16x16x32_bf16 v[112:115], v[212:215], a[248:251], v[112:115]
s_add_u32 m0, s17, 44800
v_rcp_f32 v33, v33
v_mfma_f32_16x16x32_bf16 v[116:119], v[208:211], a[236:239], v[116:119]
ds_read_b64_tr_b16 v[206:207], v16 offset:30720
v_mul_f32 v64, v64, v32
v_mfma_f32_16x16x32_bf16 v[116:119], v[212:215], a[252:255], v[116:119]
s_waitcnt lgkmcnt(4)
v_exp_f32 v36, -v68
v_mfma_f32_16x16x32_bf16 v[104:107], v[216:219], v[224:227], v[104:107]
ds_read_b64_tr_b16 v[208:209], v17 offset:24576
v_add_f32 v35, 1.0, v35
v_mfma_f32_16x16x32_bf16 v[104:107], v[220:223], v[240:243], v[104:107]
buffer_load_dwordx4 v3, s[28:31], s6 offen offset:256 lds
v_mfma_f32_16x16x32_bf16 v[108:111], v[216:219], v[228:231], v[108:111]
ds_read_b64_tr_b16 v[210:211], v17 offset:26624
v_mfma_f32_16x16x32_bf16 v[108:111], v[220:223], v[244:247], v[108:111]
v_rcp_f32 v34, v34
v_mfma_f32_16x16x32_bf16 v[112:115], v[216:219], v[232:235], v[112:115]
ds_read_b64_tr_b16 v[212:213], v17 offset:28672
v_mul_f32 v65, v65, v33
v_mfma_f32_16x16x32_bf16 v[112:115], v[220:223], v[248:251], v[112:115]
v_exp_f32 v37, -v69
v_mfma_f32_16x16x32_bf16 v[116:119], v[216:219], v[236:239], v[116:119]
ds_read_b64_tr_b16 v[214:215], v17 offset:30720
v_add_f32 v36, 1.0, v36
v_mfma_f32_16x16x32_bf16 v[116:119], v[220:223], v[252:255], v[116:119]
s_waitcnt lgkmcnt(4)
v_rcp_f32 v35, v35
v_mfma_f32_16x16x32_bf16 v[120:123], v[200:203], a[0:3], 0
ds_read_b64_tr_b16 v[216:217], v18 offset:24576
v_mul_f32 v66, v66, v34
v_mfma_f32_16x16x32_bf16 v[120:123], v[204:207], a[16:19], v[120:123]
s_waitcnt vmcnt(10)
buffer_store_dword v31, v28, s[12:15], s37 offen offset:128 sc1
v_mfma_f32_16x16x32_bf16 v[124:127], v[200:203], a[4:7], 0
ds_read_b64_tr_b16 v[218:219], v18 offset:26624
v_mfma_f32_16x16x32_bf16 v[124:127], v[204:207], a[20:23], v[124:127]
v_exp_f32 v38, -v70
v_mfma_f32_16x16x32_bf16 v[128:131], v[200:203], a[8:11], 0
ds_read_b64_tr_b16 v[220:221], v18 offset:28672
v_add_f32 v37, 1.0, v37
v_mfma_f32_16x16x32_bf16 v[128:131], v[204:207], a[24:27], v[128:131]
v_rcp_f32 v36, v36
v_mfma_f32_16x16x32_bf16 v[132:135], v[200:203], a[12:15], 0
ds_read_b64_tr_b16 v[222:223], v18 offset:30720
v_mul_f32 v67, v67, v35
v_mfma_f32_16x16x32_bf16 v[132:135], v[204:207], a[28:31], v[132:135]
s_waitcnt lgkmcnt(4)
v_exp_f32 v39, -v71
v_mfma_f32_16x16x32_bf16 v[136:139], v[208:211], a[0:3], 0
ds_read_b64_tr_b16 v[200:201], v19 offset:24576
v_add_f32 v38, 1.0, v38
v_mfma_f32_16x16x32_bf16 v[136:139], v[212:215], a[16:19], v[136:139]
v_rcp_f32 v37, v37
v_mfma_f32_16x16x32_bf16 v[140:143], v[208:211], a[4:7], 0
ds_read_b64_tr_b16 v[202:203], v19 offset:26624
v_mul_f32 v68, v68, v36
v_mfma_f32_16x16x32_bf16 v[140:143], v[212:215], a[20:23], v[140:143]
v_exp_f32 v32, -v72
v_mfma_f32_16x16x32_bf16 v[144:147], v[208:211], a[8:11], 0
ds_read_b64_tr_b16 v[204:205], v19 offset:28672
v_add_f32 v39, 1.0, v39
v_mfma_f32_16x16x32_bf16 v[144:147], v[212:215], a[24:27], v[144:147]
v_rcp_f32 v38, v38
v_mfma_f32_16x16x32_bf16 v[148:151], v[208:211], a[12:15], 0
ds_read_b64_tr_b16 v[206:207], v19 offset:30720
v_mul_f32 v69, v69, v37
v_mfma_f32_16x16x32_bf16 v[148:151], v[212:215], a[28:31], v[148:151]
s_waitcnt lgkmcnt(4)
v_exp_f32 v33, -v73
v_mfma_f32_16x16x32_bf16 v[152:155], v[216:219], a[0:3], 0
s_barrier
v_add_f32 v32, 1.0, v32
v_mfma_f32_16x16x32_bf16 v[152:155], v[220:223], a[16:19], v[152:155]
ds_read_b64_tr_b16 v[208:209], v16 offset:32768
v_mfma_f32_16x16x32_bf16 v[156:159], v[216:219], a[4:7], 0
ds_read_b64_tr_b16 v[210:211], v16 offset:34816
v_mfma_f32_16x16x32_bf16 v[156:159], v[220:223], a[20:23], v[156:159]
v_rcp_f32 v39, v39
v_mfma_f32_16x16x32_bf16 v[160:163], v[216:219], a[8:11], 0
ds_read_b64_tr_b16 v[212:213], v16 offset:36864
v_mul_f32 v70, v70, v38
v_mfma_f32_16x16x32_bf16 v[160:163], v[220:223], a[24:27], v[160:163]
v_exp_f32 v34, -v74
v_mfma_f32_16x16x32_bf16 v[164:167], v[216:219], a[12:15], 0
ds_read_b64_tr_b16 v[214:215], v16 offset:38912
v_add_f32 v33, 1.0, v33
v_mfma_f32_16x16x32_bf16 v[164:167], v[220:223], a[28:31], v[164:167]
s_waitcnt lgkmcnt(4)
v_rcp_f32 v32, v32
v_mfma_f32_16x16x32_bf16 v[168:171], v[200:203], a[0:3], 0
ds_read_b64_tr_b16 v[216:217], v17 offset:32768
v_mul_f32 v71, v71, v39
v_mfma_f32_16x16x32_bf16 v[168:171], v[204:207], a[16:19], v[168:171]
v_exp_f32 v35, -v75
v_mfma_f32_16x16x32_bf16 v[172:175], v[200:203], a[4:7], 0
ds_read_b64_tr_b16 v[218:219], v17 offset:34816
v_add_f32 v34, 1.0, v34
v_mfma_f32_16x16x32_bf16 v[172:175], v[204:207], a[20:23], v[172:175]
v_rcp_f32 v33, v33
v_mfma_f32_16x16x32_bf16 v[176:179], v[200:203], a[8:11], 0
ds_read_b64_tr_b16 v[220:221], v17 offset:36864
v_mul_f32 v72, v72, v32
v_mfma_f32_16x16x32_bf16 v[176:179], v[204:207], a[24:27], v[176:179]
v_exp_f32 v36, -v76
v_mfma_f32_16x16x32_bf16 v[180:183], v[200:203], a[12:15], 0
ds_read_b64_tr_b16 v[222:223], v17 offset:38912
v_add_f32 v35, 1.0, v35
v_mfma_f32_16x16x32_bf16 v[180:183], v[204:207], a[28:31], v[180:183]
s_waitcnt lgkmcnt(4)
v_rcp_f32 v34, v34
v_mfma_f32_16x16x32_bf16 v[120:123], v[208:211], a[32:35], v[120:123]
ds_read_b64_tr_b16 v[200:201], v18 offset:32768
v_mul_f32 v73, v73, v33
v_mfma_f32_16x16x32_bf16 v[120:123], v[212:215], a[48:51], v[120:123]
s_add_u32 s6, s62, 442368
v_exp_f32 v37, -v77
v_mfma_f32_16x16x32_bf16 v[124:127], v[208:211], a[36:39], v[124:127]
ds_read_b64_tr_b16 v[202:203], v18 offset:34816
v_add_f32 v36, 1.0, v36
v_mfma_f32_16x16x32_bf16 v[124:127], v[212:215], a[52:55], v[124:127]
s_add_u32 m0, s17, 49152
v_rcp_f32 v35, v35
v_mfma_f32_16x16x32_bf16 v[128:131], v[208:211], a[40:43], v[128:131]
ds_read_b64_tr_b16 v[204:205], v18 offset:36864
v_mul_f32 v74, v74, v34
v_mfma_f32_16x16x32_bf16 v[128:131], v[212:215], a[56:59], v[128:131]
v_exp_f32 v38, -v78
v_mfma_f32_16x16x32_bf16 v[132:135], v[208:211], a[44:47], v[132:135]
ds_read_b64_tr_b16 v[206:207], v18 offset:38912
v_add_f32 v37, 1.0, v37
v_mfma_f32_16x16x32_bf16 v[132:135], v[212:215], a[60:63], v[132:135]
s_waitcnt lgkmcnt(4)
v_rcp_f32 v36, v36
v_mfma_f32_16x16x32_bf16 v[136:139], v[216:219], a[32:35], v[136:139]
ds_read_b64_tr_b16 v[208:209], v19 offset:32768
v_mul_f32 v75, v75, v35
v_mfma_f32_16x16x32_bf16 v[136:139], v[220:223], a[48:51], v[136:139]
buffer_load_dwordx4 v3, s[28:31], s6 offen offset:0 lds
v_mfma_f32_16x16x32_bf16 v[140:143], v[216:219], a[36:39], v[140:143]
ds_read_b64_tr_b16 v[210:211], v19 offset:34816
v_mfma_f32_16x16x32_bf16 v[140:143], v[220:223], a[52:55], v[140:143]
s_add_u32 m0, s17, 53120
v_exp_f32 v39, -v79
v_mfma_f32_16x16x32_bf16 v[144:147], v[216:219], a[40:43], v[144:147]
ds_read_b64_tr_b16 v[212:213], v19 offset:36864
v_add_f32 v38, 1.0, v38
v_mfma_f32_16x16x32_bf16 v[144:147], v[220:223], a[56:59], v[144:147]
v_rcp_f32 v37, v37
v_mfma_f32_16x16x32_bf16 v[148:151], v[216:219], a[44:47], v[148:151]
ds_read_b64_tr_b16 v[214:215], v19 offset:38912
v_mul_f32 v76, v76, v36
v_mfma_f32_16x16x32_bf16 v[148:151], v[220:223], a[60:63], v[148:151]
s_waitcnt lgkmcnt(4)
v_exp_f32 v32, -v80
v_mfma_f32_16x16x32_bf16 v[152:155], v[200:203], a[32:35], v[152:155]
ds_read_b64_tr_b16 v[216:217], v16 offset:40960
v_add_f32 v39, 1.0, v39
v_mfma_f32_16x16x32_bf16 v[152:155], v[204:207], a[48:51], v[152:155]
buffer_load_dwordx4 v3, s[28:31], s6 offen offset:128 lds
v_mfma_f32_16x16x32_bf16 v[156:159], v[200:203], a[36:39], v[156:159]
s_add_u32 m0, s17, 57088
ds_read_b64_tr_b16 v[218:219], v16 offset:43008
v_mfma_f32_16x16x32_bf16 v[156:159], v[204:207], a[52:55], v[156:159]
v_rcp_f32 v38, v38
v_mfma_f32_16x16x32_bf16 v[160:163], v[200:203], a[40:43], v[160:163]
ds_read_b64_tr_b16 v[220:221], v16 offset:45056
v_mul_f32 v77, v77, v37
v_mfma_f32_16x16x32_bf16 v[160:163], v[204:207], a[56:59], v[160:163]
v_exp_f32 v33, -v81
v_mfma_f32_16x16x32_bf16 v[164:167], v[200:203], a[44:47], v[164:167]
ds_read_b64_tr_b16 v[222:223], v16 offset:47104
v_add_f32 v32, 1.0, v32
v_mfma_f32_16x16x32_bf16 v[164:167], v[204:207], a[60:63], v[164:167]
s_waitcnt lgkmcnt(4)
v_rcp_f32 v39, v39
v_mfma_f32_16x16x32_bf16 v[168:171], v[208:211], a[32:35], v[168:171]
ds_read_b64_tr_b16 v[200:201], v17 offset:40960
v_mul_f32 v78, v78, v38
v_mfma_f32_16x16x32_bf16 v[168:171], v[212:215], a[48:51], v[168:171]
buffer_load_dwordx4 v3, s[28:31], s6 offen offset:256 lds
v_mfma_f32_16x16x32_bf16 v[172:175], v[208:211], a[36:39], v[172:175]
ds_read_b64_tr_b16 v[202:203], v17 offset:43008
v_mfma_f32_16x16x32_bf16 v[172:175], v[212:215], a[52:55], v[172:175]
s_waitcnt vmcnt(7)
v_cmp_ne_u32 vcc, s76, v55
s_nop 1
s_cbranch_vccnz slow_f1
back_f1:
v_mfma_f32_16x16x32_bf16 v[176:179], v[208:211], a[40:43], v[176:179]
ds_read_b64_tr_b16 v[204:205], v17 offset:45056
v_mfma_f32_16x16x32_bf16 v[176:179], v[212:215], a[56:59], v[176:179]
v_exp_f32 v34, -v82
v_mfma_f32_16x16x32_bf16 v[180:183], v[208:211], a[44:47], v[180:183]
ds_read_b64_tr_b16 v[206:207], v17 offset:47104
v_add_f32 v33, 1.0, v33
v_mfma_f32_16x16x32_bf16 v[180:183], v[212:215], a[60:63], v[180:183]
s_waitcnt lgkmcnt(4)
v_rcp_f32 v32, v32
v_mfma_f32_16x16x32_bf16 v[120:123], v[216:219], a[64:67], v[120:123]
ds_read_b64_tr_b16 v[208:209], v18 offset:40960
v_mul_f32 v79, v79, v39
v_mfma_f32_16x16x32_bf16 v[120:123], v[220:223], a[80:83], v[120:123]
s_add_u32 s6, s62, 479232
v_exp_f32 v35, -v83
v_mfma_f32_16x16x32_bf16 v[124:127], v[216:219], a[68:71], v[124:127]
ds_read_b64_tr_b16 v[210:211], v18 offset:43008
v_add_f32 v34, 1.0, v34
v_mfma_f32_16x16x32_bf16 v[124:127], v[220:223], a[84:87], v[124:127]
s_add_u32 m0, s17, 61440
v_rcp_f32 v33, v33
v_mfma_f32_16x16x32_bf16 v[128:131], v[216:219], a[72:75], v[128:131]
ds_read_b64_tr_b16 v[212:213], v18 offset:45056
v_mul_f32 v80, v80, v32
v_mfma_f32_16x16x32_bf16 v[128:131], v[220:223], a[88:91], v[128:131]
buffer_load_dwordx4 v3, s[28:31], s6 offen offset:0 lds
v_mfma_f32_16x16x32_bf16 v[132:135], v[216:219], a[76:79], v[132:135]
ds_read_b64_tr_b16 v[214:215], v18 offset:47104
v_mfma_f32_16x16x32_bf16 v[132:135], v[220:223], a[92:95], v[132:135]
s_waitcnt lgkmcnt(4)
v_exp_f32 v36, -v84
v_mfma_f32_16x16x32_bf16 v[136:139], v[200:203], a[64:67], v[136:139]
ds_read_b64_tr_b16 v[216:217], v19 offset:40960
v_add_f32 v35, 1.0, v35
v_mfma_f32_16x16x32_bf16 v[136:139], v[204:207], a[80:83], v[136:139]
s_add_u32 m0, s17, 65408
v_rcp_f32 v34, v34
v_mfma_f32_16x16x32_bf16 v[140:143], v[200:203], a[68:71], v[140:143]
ds_read_b64_tr_b16 v[218:219], v19 offset:43008
v_mul_f32 v81, v81, v33
v_mfma_f32_16x16x32_bf16 v[140:143], v[204:207], a[84:87], v[140:143]
buffer_load_dwordx4 v3, s[28:31], s6 offen offset:128 lds
v_mfma_f32_16x16x32_bf16 v[144:147], v[200:203], a[72:75], v[144:147]
s_add_u32 m0, s17, 69376
ds_read_b64_tr_b16 v[220:221], v19 offset:45056
v_mfma_f32_16x16x32_bf16 v[144:147], v[204:207], a[88:91], v[144:147]
v_exp_f32 v37, -v85
v_mfma_f32_16x16x32_bf16 v[148:151], v[200:203], a[76:79], v[148:151]
ds_read_b64_tr_b16 v[222:223], v19 offset:47104
v_add_f32 v36, 1.0, v36
v_mfma_f32_16x16x32_bf16 v[148:151], v[204:207], a[92:95], v[148:151]
s_waitcnt lgkmcnt(4)
v_rcp_f32 v35, v35
v_mfma_f32_16x16x32_bf16 v[152:155], v[208:211], a[64:67], v[152:155]
s_barrier
v_mul_f32 v82, v82, v34
v_mfma_f32_16x16x32_bf16 v[152:155], v[212:215], a[80:83], v[152:155]
ds_read_b64_tr_b16 v[200:201], v20 offset:0
v_mfma_f32_16x16x32_bf16 v[156:159], v[208:211], a[68:71], v[156:159]
ds_read_b64_tr_b16 v[202:203], v20 offset:2048
v_mfma_f32_16x16x32_bf16 v[156:159], v[212:215], a[84:87], v[156:159]
buffer_load_dwordx4 v3, s[28:31], s6 offen offset:256 lds
v_mfma_f32_16x16x32_bf16 v[160:163], v[208:211], a[72:75], v[160:163]
s_add_u32 s3, s60, 0
ds_read_b64_tr_b16 v[204:205], v20 offset:4096
v_mfma_f32_16x16x32_bf16 v[160:163], v[212:215], a[88:91], v[160:163]
buffer_load_dwordx4 a[0:3], v45, s[12:15], s3 offen offset:0 sc1
v_mfma_f32_16x16x32_bf16 v[164:167], v[208:211], a[76:79], v[164:167]
ds_read_b64_tr_b16 v[206:207], v20 offset:6144
v_mfma_f32_16x16x32_bf16 v[164:167], v[212:215], a[92:95], v[164:167]
s_waitcnt lgkmcnt(4)
v_exp_f32 v38, -v86
v_mfma_f32_16x16x32_bf16 v[168:171], v[216:219], a[64:67], v[168:171]
ds_read_b64_tr_b16 v[208:209], v21 offset:0
v_add_f32 v37, 1.0, v37
v_mfma_f32_16x16x32_bf16 v[168:171], v[220:223], a[80:83], v[168:171]
buffer_load_dwordx4 a[4:7], v46, s[12:15], s3 offen offset:0 sc1
v_mfma_f32_16x16x32_bf16 v[172:175], v[216:219], a[68:71], v[172:175]
ds_read_b64_tr_b16 v[210:211], v21 offset:2048
v_mfma_f32_16x16x32_bf16 v[172:175], v[220:223], a[84:87], v[172:175]
buffer_load_dwordx4 a[8:11], v45, s[12:15], s3 offen offset:1024 sc1
v_mfma_f32_16x16x32_bf16 v[176:179], v[216:219], a[72:75], v[176:179]
ds_read_b64_tr_b16 v[212:213], v21 offset:4096
v_mfma_f32_16x16x32_bf16 v[176:179], v[220:223], a[88:91], v[176:179]
buffer_load_dwordx4 a[12:15], v46, s[12:15], s3 offen offset:1024 sc1
v_mfma_f32_16x16x32_bf16 v[180:183], v[216:219], a[76:79], v[180:183]
ds_read_b64_tr_b16 v[214:215], v21 offset:6144
v_mfma_f32_16x16x32_bf16 v[180:183], v[220:223], a[92:95], v[180:183]
s_waitcnt lgkmcnt(4)
v_rcp_f32 v36, v36
v_mfma_f32_16x16x32_bf16 v[120:123], v[200:203], a[96:99], v[120:123]
ds_read_b64_tr_b16 v[216:217], v22 offset:0
v_mul_f32 v83, v83, v35
v_mfma_f32_16x16x32_bf16 v[120:123], v[204:207], a[112:115], v[120:123]
s_add_u32 s6, s62, 663552
v_exp_f32 v39, -v87
v_mfma_f32_16x16x32_bf16 v[124:127], v[200:203], a[100:103], v[124:127]
ds_read_b64_tr_b16 v[218:219], v22 offset:2048
v_add_f32 v38, 1.0, v38
v_mfma_f32_16x16x32_bf16 v[124:127], v[204:207], a[116:119], v[124:127]
s_add_u32 m0, s17, 73728
v_rcp_f32 v37, v37
v_mfma_f32_16x16x32_bf16 v[128:131], v[200:203], a[104:107], v[128:131]
ds_read_b64_tr_b16 v[220:221], v22 offset:4096
v_mul_f32 v84, v84, v36
v_mfma_f32_16x16x32_bf16 v[128:131], v[204:207], a[120:123], v[128:131]
v_exp_f32 v32, -v88
v_mfma_f32_16x16x32_bf16 v[132:135], v[200:203], a[108:111], v[132:135]
ds_read_b64_tr_b16 v[222:223], v22 offset:6144
v_add_f32 v39, 1.0, v39
v_mfma_f32_16x16x32_bf16 v[132:135], v[204:207], a[124:127], v[132:135]
s_waitcnt lgkmcnt(4)
v_rcp_f32 v38, v38
v_mfma_f32_16x16x32_bf16 v[136:139], v[208:211], a[96:99], v[136:139]
ds_read_b64_tr_b16 v[200:201], v23 offset:0
v_mul_f32 v85, v85, v37
v_mfma_f32_16x16x32_bf16 v[136:139], v[212:215], a[112:115], v[136:139]
buffer_load_dwordx4 v3, s[28:31], s6 offen offset:0 lds
v_mfma_f32_16x16x32_bf16 v[140:143], v[208:211], a[100:103], v[140:143]
s_add_u32 m0, s17, 77696
ds_read_b64_tr_b16 v[202:203], v23 offset:2048
v_mfma_f32_16x16x32_bf16 v[140:143], v[212:215], a[116:119], v[140:143]
v_exp_f32 v33, -v89
v_mfma_f32_16x16x32_bf16 v[144:147], v[208:211], a[104:107], v[144:147]
ds_read_b64_tr_b16 v[204:205], v23 offset:4096
v_add_f32 v32, 1.0, v32
v_mfma_f32_16x16x32_bf16 v[144:147], v[212:215], a[120:123], v[144:147]
buffer_load_dwordx4 v3, s[28:31], s6 offen offset:128 lds
v_mfma_f32_16x16x32_bf16 v[148:151], v[208:211], a[108:111], v[148:151]
ds_read_b64_tr_b16 v[206:207], v23 offset:6144
v_mfma_f32_16x16x32_bf16 v[148:151], v[212:215], a[124:127], v[148:151]
s_waitcnt lgkmcnt(4)
v_rcp_f32 v39, v39
v_mfma_f32_16x16x32_bf16 v[152:155], v[216:219], a[96:99], v[152:155]
ds_read_b64_tr_b16 v[208:209], v20 offset:8192
v_mul_f32 v86, v86, v38
v_mfma_f32_16x16x32_bf16 v[152:155], v[220:223], a[112:115], v[152:155]
s_add_u32 m0, s17, 81664
v_exp_f32 v34, -v90
v_mfma_f32_16x16x32_bf16 v[156:159], v[216:219], a[100:103], v[156:159]
ds_read_b64_tr_b16 v[210:211], v20 offset:10240
v_add_f32 v33, 1.0, v33
v_mfma_f32_16x16x32_bf16 v[156:159], v[220:223], a[116:119], v[156:159]
buffer_load_dwordx4 v3, s[28:31], s6 offen offset:256 lds
v_mfma_f32_16x16x32_bf16 v[160:163], v[216:219], a[104:107], v[160:163]
ds_read_b64_tr_b16 v[212:213], v20 offset:12288
v_mfma_f32_16x16x32_bf16 v[160:163], v[220:223], a[120:123], v[160:163]
s_add_u32 s3, s60, 6144
v_rcp_f32 v32, v32
v_mfma_f32_16x16x32_bf16 v[164:167], v[216:219], a[108:111], v[164:167]
ds_read_b64_tr_b16 v[214:215], v20 offset:14336
v_mul_f32 v87, v87, v39
v_mfma_f32_16x16x32_bf16 v[164:167], v[220:223], a[124:127], v[164:167]
s_waitcnt lgkmcnt(4)
v_exp_f32 v35, -v91
v_mfma_f32_16x16x32_bf16 v[168:171], v[200:203], a[96:99], v[168:171]
ds_read_b64_tr_b16 v[216:217], v21 offset:8192
v_add_f32 v34, 1.0, v34
v_mfma_f32_16x16x32_bf16 v[168:171], v[204:207], a[112:115], v[168:171]
buffer_load_dwordx4 a[16:19], v45, s[12:15], s3 offen offset:0 sc1
v_mfma_f32_16x16x32_bf16 v[172:175], v[200:203], a[100:103], v[172:175]
ds_read_b64_tr_b16 v[218:219], v21 offset:10240
v_mfma_f32_16x16x32_bf16 v[172:175], v[204:207], a[116:119], v[172:175]
buffer_load_dwordx4 a[20:23], v46, s[12:15], s3 offen offset:0 sc1
v_mfma_f32_16x16x32_bf16 v[176:179], v[200:203], a[104:107], v[176:179]
ds_read_b64_tr_b16 v[220:221], v21 offset:12288
v_mfma_f32_16x16x32_bf16 v[176:179], v[204:207], a[120:123], v[176:179]
v_rcp_f32 v33, v33
v_mfma_f32_16x16x32_bf16 v[180:183], v[200:203], a[108:111], v[180:183]
ds_read_b64_tr_b16 v[222:223], v21 offset:14336
v_mul_f32 v88, v88, v32
v_mfma_f32_16x16x32_bf16 v[180:183], v[204:207], a[124:127], v[180:183]
s_waitcnt lgkmcnt(4)
v_exp_f32 v36, -v92
v_mfma_f32_16x16x32_bf16 v[120:123], v[208:211], a[128:131], v[120:123]
ds_read_b64_tr_b16 v[200:201], v22 offset:8192
v_add_f32 v35, 1.0, v35
v_mfma_f32_16x16x32_bf16 v[120:123], v[212:215], a[144:147], v[120:123]
buffer_load_dwordx4 a[24:27], v45, s[12:15], s3 offen offset:1024 sc1
v_mfma_f32_16x16x32_bf16 v[124:127], v[208:211], a[132:135], v[124:127]
ds_read_b64_tr_b16 v[202:203], v22 offset:10240
v_mfma_f32_16x16x32_bf16 v[124:127], v[212:215], a[148:151], v[124:127]
v_rcp_f32 v34, v34
v_mfma_f32_16x16x32_bf16 v[128:131], v[208:211], a[136:139], v[128:131]
ds_read_b64_tr_b16 v[204:205], v22 offset:12288
v_mul_f32 v89, v89, v33
v_mfma_f32_16x16x32_bf16 v[128:131], v[212:215], a[152:155], v[128:131]
v_exp_f32 v37, -v93
v_mfma_f32_16x16x32_bf16 v[132:135], v[208:211], a[140:143], v[132:135]
ds_read_b64_tr_b16 v[206:207], v22 offset:14336
v_add_f32 v36, 1.0, v36
v_mfma_f32_16x16x32_bf16 v[132:135], v[212:215], a[156:159], v[132:135]
s_waitcnt lgkmcnt(4)
v_rcp_f32 v35, v35
v_mfma_f32_16x16x32_bf16 v[136:139], v[216:219], a[128:131], v[136:139]
ds_read_b64_tr_b16 v[208:209], v23 offset:8192
v_mul_f32 v90, v90, v34
v_mfma_f32_16x16x32_bf16 v[136:139], v[220:223], a[144:147], v[136:139]
buffer_load_dwordx4 a[28:31], v46, s[12:15], s3 offen offset:1024 sc1
v_mfma_f32_16x16x32_bf16 v[140:143], v[216:219], a[132:135], v[140:143]
ds_read_b64_tr_b16 v[210:211], v23 offset:10240
v_mfma_f32_16x16x32_bf16 v[140:143], v[220:223], a[148:151], v[140:143]
v_exp_f32 v38, -v94
v_mfma_f32_16x16x32_bf16 v[144:147], v[216:219], a[136:139], v[144:147]
ds_read_b64_tr_b16 v[212:213], v23 offset:12288
v_add_f32 v37, 1.0, v37
v_mfma_f32_16x16x32_bf16 v[144:147], v[220:223], a[152:155], v[144:147]
s_add_u32 s3, s60, 12288
v_rcp_f32 v36, v36
v_mfma_f32_16x16x32_bf16 v[148:151], v[216:219], a[140:143], v[148:151]
ds_read_b64_tr_b16 v[214:215], v23 offset:14336
v_mul_f32 v91, v91, v35
v_mfma_f32_16x16x32_bf16 v[148:151], v[220:223], a[156:159], v[148:151]
s_waitcnt lgkmcnt(4)
v_exp_f32 v39, -v95
v_mfma_f32_16x16x32_bf16 v[152:155], v[200:203], a[128:131], v[152:155]
ds_read_b64_tr_b16 v[216:217], v20 offset:16384
v_add_f32 v38, 1.0, v38
v_mfma_f32_16x16x32_bf16 v[152:155], v[204:207], a[144:147], v[152:155]
v_rcp_f32 v37, v37
v_mfma_f32_16x16x32_bf16 v[156:159], v[200:203], a[132:135], v[156:159]
ds_read_b64_tr_b16 v[218:219], v20 offset:18432
v_mul_f32 v92, v92, v36
v_mfma_f32_16x16x32_bf16 v[156:159], v[204:207], a[148:151], v[156:159]
buffer_load_dwordx4 a[32:35], v45, s[12:15], s3 offen offset:0 sc1
v_mfma_f32_16x16x32_bf16 v[160:163], v[200:203], a[136:139], v[160:163]
ds_read_b64_tr_b16 v[220:221], v20 offset:20480
v_mfma_f32_16x16x32_bf16 v[160:163], v[204:207], a[152:155], v[160:163]
v_exp_f32 v32, -v96
v_mfma_f32_16x16x32_bf16 v[164:167], v[200:203], a[140:143], v[164:167]
ds_read_b64_tr_b16 v[222:223], v20 offset:22528
v_add_f32 v39, 1.0, v39
v_mfma_f32_16x16x32_bf16 v[164:167], v[204:207], a[156:159], v[164:167]
s_waitcnt lgkmcnt(4)
v_rcp_f32 v38, v38
v_mfma_f32_16x16x32_bf16 v[168:171], v[208:211], a[128:131], v[168:171]
ds_read_b64_tr_b16 v[200:201], v21 offset:16384
v_mul_f32 v93, v93, v37
v_mfma_f32_16x16x32_bf16 v[168:171], v[212:215], a[144:147], v[168:171]
buffer_load_dwordx4 a[36:39], v46, s[12:15], s3 offen offset:0 sc1
v_mfma_f32_16x16x32_bf16 v[172:175], v[208:211], a[132:135], v[172:175]
ds_read_b64_tr_b16 v[202:203], v21 offset:18432
v_mfma_f32_16x16x32_bf16 v[172:175], v[212:215], a[148:151], v[172:175]
v_exp_f32 v33, -v97
v_mfma_f32_16x16x32_bf16 v[176:179], v[208:211], a[136:139], v[176:179]
ds_read_b64_tr_b16 v[204:205], v21 offset:20480
v_add_f32 v32, 1.0, v32
v_mfma_f32_16x16x32_bf16 v[176:179], v[212:215], a[152:155], v[176:179]
v_rcp_f32 v39, v39
v_mfma_f32_16x16x32_bf16 v[180:183], v[208:211], a[140:143], v[180:183]
ds_read_b64_tr_b16 v[206:207], v21 offset:22528
v_mul_f32 v94, v94, v38
v_mfma_f32_16x16x32_bf16 v[180:183], v[212:215], a[156:159], v[180:183]
s_waitcnt lgkmcnt(4)
v_exp_f32 v34, -v98
v_mfma_f32_16x16x32_bf16 v[120:123], v[216:219], a[160:163], v[120:123]
ds_read_b64_tr_b16 v[208:209], v22 offset:16384
v_add_f32 v33, 1.0, v33
v_mfma_f32_16x16x32_bf16 v[120:123], v[220:223], a[176:179], v[120:123]
buffer_load_dwordx4 a[40:43], v45, s[12:15], s3 offen offset:1024 sc1
v_mfma_f32_16x16x32_bf16 v[124:127], v[216:219], a[164:167], v[124:127]
ds_read_b64_tr_b16 v[210:211], v22 offset:18432
v_mfma_f32_16x16x32_bf16 v[124:127], v[220:223], a[180:183], v[124:127]
v_rcp_f32 v32, v32
v_mfma_f32_16x16x32_bf16 v[128:131], v[216:219], a[168:171], v[128:131]
ds_read_b64_tr_b16 v[212:213], v22 offset:20480
v_mul_f32 v95, v95, v39
v_mfma_f32_16x16x32_bf16 v[128:131], v[220:223], a[184:187], v[128:131]
v_exp_f32 v35, -v99
v_mfma_f32_16x16x32_bf16 v[132:135], v[216:219], a[172:175], v[132:135]
ds_read_b64_tr_b16 v[214:215], v22 offset:22528
v_add_f32 v34, 1.0, v34
v_mfma_f32_16x16x32_bf16 v[132:135], v[220:223], a[188:191], v[132:135]
s_waitcnt lgkmcnt(4)
v_rcp_f32 v33, v33
v_mfma_f32_16x16x32_bf16 v[136:139], v[200:203], a[160:163], v[136:139]
ds_read_b64_tr_b16 v[216:217], v23 offset:16384
v_mul_f32 v96, v96, v32
v_mfma_f32_16x16x32_bf16 v[136:139], v[204:207], a[176:179], v[136:139]
buffer_load_dwordx4 a[44:47], v46, s[12:15], s3 offen offset:1024 sc1
v_mfma_f32_16x16x32_bf16 v[140:143], v[200:203], a[164:167], v[140:143]
ds_read_b64_tr_b16 v[218:219], v23 offset:18432
v_mfma_f32_16x16x32_bf16 v[140:143], v[204:207], a[180:183], v[140:143]
v_exp_f32 v36, -v100
v_mfma_f32_16x16x32_bf16 v[144:147], v[200:203], a[168:171], v[144:147]
ds_read_b64_tr_b16 v[220:221], v23 offset:20480
v_add_f32 v35, 1.0, v35
v_mfma_f32_16x16x32_bf16 v[144:147], v[204:207], a[184:187], v[144:147]
s_add_u32 s3, s60, 18432
v_rcp_f32 v34, v34
v_mfma_f32_16x16x32_bf16 v[148:151], v[200:203], a[172:175], v[148:151]
ds_read_b64_tr_b16 v[222:223], v23 offset:22528
v_mul_f32 v97, v97, v33
v_mfma_f32_16x16x32_bf16 v[148:151], v[204:207], a[188:191], v[148:151]
s_waitcnt lgkmcnt(4)
v_exp_f32 v37, -v101
v_mfma_f32_16x16x32_bf16 v[152:155], v[208:211], a[160:163], v[152:155]
s_barrier
v_add_f32 v36, 1.0, v36
v_mfma_f32_16x16x32_bf16 v[152:155], v[212:215], a[176:179], v[152:155]
ds_read_b64_tr_b16 v[200:201], v20 offset:24576
v_mfma_f32_16x16x32_bf16 v[156:159], v[208:211], a[164:167], v[156:159]
ds_read_b64_tr_b16 v[202:203], v20 offset:26624
v_mfma_f32_16x16x32_bf16 v[156:159], v[212:215], a[180:183], v[156:159]
buffer_load_dwordx4 a[48:51], v45, s[12:15], s3 offen offset:0 sc1
v_mfma_f32_16x16x32_bf16 v[160:163], v[208:211], a[168:171], v[160:163]
ds_read_b64_tr_b16 v[204:205], v20 offset:28672
v_mfma_f32_16x16x32_bf16 v[160:163], v[212:215], a[184:187], v[160:163]
v_rcp_f32 v35, v35
v_mfma_f32_16x16x32_bf16 v[164:167], v[208:211], a[172:175], v[164:167]
ds_read_b64_tr_b16 v[206:207], v20 offset:30720
v_mul_f32 v98, v98, v34
v_mfma_f32_16x16x32_bf16 v[164:167], v[212:215], a[188:191], v[164:167]
s_waitcnt lgkmcnt(4)
v_exp_f32 v38, -v102
v_mfma_f32_16x16x32_bf16 v[168:171], v[216:219], a[160:163], v[168:171]
ds_read_b64_tr_b16 v[208:209], v20 offset:32768
v_add_f32 v37, 1.0, v37
v_mfma_f32_16x16x32_bf16 v[168:171], v[220:223], a[176:179], v[168:171]
buffer_load_dwordx4 a[52:55], v46, s[12:15], s3 offen offset:0 sc1
v_mfma_f32_16x16x32_bf16 v[172:175], v[216:219], a[164:167], v[172:175]
ds_read_b64_tr_b16 v[210:211], v20 offset:34816
v_mfma_f32_16x16x32_bf16 v[172:175], v[220:223], a[180:183], v[172:175]
v_rcp_f32 v36, v36
v_mfma_f32_16x16x32_bf16 v[176:179], v[216:219], a[168:171], v[176:179]
ds_read_b64_tr_b16 v[212:213], v20 offset:36864
v_mul_f32 v99, v99, v35
v_mfma_f32_16x16x32_bf16 v[176:179], v[220:223], a[184:187], v[176:179]
v_exp_f32 v39, -v103
v_mfma_f32_16x16x32_bf16 v[180:183], v[216:219], a[172:175], v[180:183]
ds_read_b64_tr_b16 v[214:215], v20 offset:38912
v_add_f32 v38, 1.0, v38
v_mfma_f32_16x16x32_bf16 v[180:183], v[220:223], a[188:191], v[180:183]
s_waitcnt lgkmcnt(4)
v_rcp_f32 v37, v37
v_mfma_f32_16x16x32_bf16 v[120:123], v[200:203], a[192:195], v[120:123]
ds_read_b64_tr_b16 v[216:217], v20 offset:40960
v_mul_f32 v100, v100, v36
v_mfma_f32_16x16x32_bf16 v[120:123], v[204:207], a[208:211], v[120:123]
s_add_u32 s6, s62, 700416
v_exp_f32 v32, -v104
v_mfma_f32_16x16x32_bf16 v[124:127], v[200:203], a[196:199], v[124:127]
ds_read_b64_tr_b16 v[218:219], v20 offset:43008
v_add_f32 v39, 1.0, v39
v_mfma_f32_16x16x32_bf16 v[124:127], v[204:207], a[212:215], v[124:127]
s_add_u32 m0, s17, 86016
v_rcp_f32 v38, v38
v_mfma_f32_16x16x32_bf16 v[128:131], v[200:203], a[200:203], v[128:131]
ds_read_b64_tr_b16 v[220:221], v20 offset:45056
v_mul_f32 v101, v101, v37
v_mfma_f32_16x16x32_bf16 v[128:131], v[204:207], a[216:219], v[128:131]
v_exp_f32 v33, -v105
v_mfma_f32_16x16x32_bf16 v[132:135], v[200:203], a[204:207], v[132:135]
ds_read_b64_tr_b16 v[222:223], v20 offset:47104
v_add_f32 v32, 1.0, v32
v_mfma_f32_16x16x32_bf16 v[132:135], v[204:207], a[220:223], v[132:135]
s_waitcnt lgkmcnt(4)
v_rcp_f32 v39, v39
v_mfma_f32_16x16x32_bf16 v[120:123], v[208:211], a[224:227], v[120:123]
ds_read_b64_tr_b16 v[200:201], v21 offset:24576
v_mul_f32 v102, v102, v38
v_mfma_f32_16x16x32_bf16 v[120:123], v[212:215], a[240:243], v[120:123]
buffer_load_dwordx4 v3, s[28:31], s6 offen offset:0 lds
v_mfma_f32_16x16x32_bf16 v[124:127], v[208:211], a[228:231], v[124:127]
s_add_u32 m0, s17, 89984
ds_read_b64_tr_b16 v[202:203], v21 offset:26624
v_mfma_f32_16x16x32_bf16 v[124:127], v[212:215], a[244:247], v[124:127]
v_exp_f32 v34, -v106
v_mfma_f32_16x16x32_bf16 v[128:131], v[208:211], a[232:235], v[128:131]
ds_read_b64_tr_b16 v[204:205], v21 offset:28672
v_add_f32 v33, 1.0, v33
v_mfma_f32_16x16x32_bf16 v[128:131], v[212:215], a[248:251], v[128:131]
buffer_load_dwordx4 v3, s[28:31], s6 offen offset:128 lds
v_mfma_f32_16x16x32_bf16 v[132:135], v[208:211], a[236:239], v[132:135]
ds_read_b64_tr_b16 v[206:207], v21 offset:30720
v_mfma_f32_16x16x32_bf16 v[132:135], v[212:215], a[252:255], v[132:135]
s_waitcnt lgkmcnt(4)
v_rcp_f32 v32, v32
v_mfma_f32_16x16x32_bf16 v[120:123], v[216:219], v[224:227], v[120:123]
ds_read_b64_tr_b16 v[208:209], v21 offset:32768
v_mul_f32 v103, v103, v39
v_mfma_f32_16x16x32_bf16 v[120:123], v[220:223], v[240:243], v[120:123]
s_add_u32 m0, s17, 93952
v_exp_f32 v35, -v107
v_mfma_f32_16x16x32_bf16 v[124:127], v[216:219], v[228:231], v[124:127]
ds_read_b64_tr_b16 v[210:211], v21 offset:34816
v_add_f32 v34, 1.0, v34
v_mfma_f32_16x16x32_bf16 v[124:127], v[220:223], v[244:247], v[124:127]
v_rcp_f32 v33, v33
v_mfma_f32_16x16x32_bf16 v[128:131], v[216:219], v[232:235], v[128:131]
ds_read_b64_tr_b16 v[212:213], v21 offset:36864
v_mul_f32 v104, v104, v32
v_mfma_f32_16x16x32_bf16 v[128:131], v[220:223], v[248:251], v[128:131]
buffer_load_dwordx4 v3, s[28:31], s6 offen offset:256 lds
v_mfma_f32_16x16x32_bf16 v[132:135], v[216:219], v[236:239], v[132:135]
ds_read_b64_tr_b16 v[214:215], v21 offset:38912
v_mfma_f32_16x16x32_bf16 v[132:135], v[220:223], v[252:255], v[132:135]
s_waitcnt lgkmcnt(4)
v_exp_f32 v36, -v108
v_mfma_f32_16x16x32_bf16 v[136:139], v[200:203], a[192:195], v[136:139]
ds_read_b64_tr_b16 v[216:217], v21 offset:40960
v_add_f32 v35, 1.0, v35
v_mfma_f32_16x16x32_bf16 v[136:139], v[204:207], a[208:211], v[136:139]
buffer_load_dwordx4 a[56:59], v45, s[12:15], s3 offen offset:1024 sc1
v_mfma_f32_16x16x32_bf16 v[140:143], v[200:203], a[196:199], v[140:143]
ds_read_b64_tr_b16 v[218:219], v21 offset:43008
v_mfma_f32_16x16x32_bf16 v[140:143], v[204:207], a[212:215], v[140:143]
buffer_load_dwordx4 a[60:63], v46, s[12:15], s3 offen offset:1024 sc1
v_mfma_f32_16x16x32_bf16 v[144:147], v[200:203], a[200:203], v[144:147]
ds_read_b64_tr_b16 v[220:221], v21 offset:45056
v_mul_f32 v120, v56, v120
v_mfma_f32_16x16x32_bf16 v[144:147], v[204:207], a[216:219], v[144:147]
v_rcp_f32 v34, v34
v_mfma_f32_16x16x32_bf16 v[148:151], v[200:203], a[204:207], v[148:151]
ds_read_b64_tr_b16 v[222:223], v21 offset:47104
v_mul_f32 v105, v105, v33
v_mfma_f32_16x16x32_bf16 v[148:151], v[204:207], a[220:223], v[148:151]
s_waitcnt lgkmcnt(4)
v_exp_f32 v37, -v109
v_mfma_f32_16x16x32_bf16 v[136:139], v[208:211], a[224:227], v[136:139]
ds_read_b64_tr_b16 v[200:201], v22 offset:24576
v_add_f32 v36, 1.0, v36
v_mfma_f32_16x16x32_bf16 v[136:139], v[212:215], a[240:243], v[136:139]
s_add_u32 s6, s62, 884736
v_rcp_f32 v35, v35
v_mfma_f32_16x16x32_bf16 v[140:143], v[208:211], a[228:231], v[140:143]
ds_read_b64_tr_b16 v[202:203], v22 offset:26624
v_mul_f32 v106, v106, v34
v_mfma_f32_16x16x32_bf16 v[140:143], v[212:215], a[244:247], v[140:143]
s_add_u32 m0, s17, 98304
v_exp_f32 v38, -v110
v_mfma_f32_16x16x32_bf16 v[144:147], v[208:211], a[232:235], v[144:147]
ds_read_b64_tr_b16 v[204:205], v22 offset:28672
v_add_f32 v37, 1.0, v37
v_mfma_f32_16x16x32_bf16 v[144:147], v[212:215], a[248:251], v[144:147]
v_rcp_f32 v36, v36
v_mfma_f32_16x16x32_bf16 v[148:151], v[208:211], a[236:239], v[148:151]
ds_read_b64_tr_b16 v[206:207], v22 offset:30720
v_mul_f32 v107, v107, v35
v_mfma_f32_16x16x32_bf16 v[148:151], v[212:215], a[252:255], v[148:151]
s_waitcnt lgkmcnt(4)
v_exp_f32 v39, -v111
v_mfma_f32_16x16x32_bf16 v[136:139], v[216:219], v[224:227], v[136:139]
ds_read_b64_tr_b16 v[208:209], v22 offset:32768
v_add_f32 v38, 1.0, v38
v_mfma_f32_16x16x32_bf16 v[136:139], v[220:223], v[240:243], v[136:139]
buffer_load_dwordx4 v3, s[28:31], s6 offen offset:0 lds
v_mfma_f32_16x16x32_bf16 v[140:143], v[216:219], v[228:231], v[140:143]
ds_read_b64_tr_b16 v[210:211], v22 offset:34816
v_mul_f32 v121, v57, v121
v_mfma_f32_16x16x32_bf16 v[140:143], v[220:223], v[244:247], v[140:143]
s_add_u32 m0, s17, 102272
v_rcp_f32 v37, v37
v_mfma_f32_16x16x32_bf16 v[144:147], v[216:219], v[232:235], v[144:147]
ds_read_b64_tr_b16 v[212:213], v22 offset:36864
v_mul_f32 v108, v108, v36
v_mfma_f32_16x16x32_bf16 v[144:147], v[220:223], v[248:251], v[144:147]
buffer_load_dwordx4 v3, s[28:31], s6 offen offset:128 lds
v_mfma_f32_16x16x32_bf16 v[148:151], v[216:219], v[236:239], v[148:151]
ds_read_b64_tr_b16 v[214:215], v22 offset:38912
v_mul_f32 v122, v58, v122
v_mfma_f32_16x16x32_bf16 v[148:151], v[220:223], v[252:255], v[148:151]
s_waitcnt lgkmcnt(4)
v_exp_f32 v32, -v112
v_mfma_f32_16x16x32_bf16 v[152:155], v[200:203], a[192:195], v[152:155]
ds_read_b64_tr_b16 v[216:217], v22 offset:40960
v_add_f32 v39, 1.0, v39
v_mfma_f32_16x16x32_bf16 v[152:155], v[204:207], a[208:211], v[152:155]
s_add_u32 m0, s17, 106240
v_rcp_f32 v38, v38
v_mfma_f32_16x16x32_bf16 v[156:159], v[200:203], a[196:199], v[156:159]
ds_read_b64_tr_b16 v[218:219], v22 offset:43008
v_mul_f32 v109, v109, v37
v_mfma_f32_16x16x32_bf16 v[156:159], v[204:207], a[212:215], v[156:159]
buffer_load_dwordx4 v3, s[28:31], s6 offen offset:256 lds
v_mfma_f32_16x16x32_bf16 v[160:163], v[200:203], a[200:203], v[160:163]
ds_read_b64_tr_b16 v[220:221], v22 offset:45056
v_mul_f32 v123, v59, v123
v_mfma_f32_16x16x32_bf16 v[160:163], v[204:207], a[216:219], v[160:163]
s_add_u32 s3, s60, 24576
v_exp_f32 v33, -v113
v_mfma_f32_16x16x32_bf16 v[164:167], v[200:203], a[204:207], v[164:167]
ds_read_b64_tr_b16 v[222:223], v22 offset:47104
v_add_f32 v32, 1.0, v32
v_mfma_f32_16x16x32_bf16 v[164:167], v[204:207], a[220:223], v[164:167]
s_waitcnt lgkmcnt(4)
v_rcp_f32 v39, v39
v_mfma_f32_16x16x32_bf16 v[152:155], v[208:211], a[224:227], v[152:155]
ds_read_b64_tr_b16 v[200:201], v23 offset:24576
v_mul_f32 v110, v110, v38
v_mfma_f32_16x16x32_bf16 v[152:155], v[212:215], a[240:243], v[152:155]
buffer_load_dwordx4 a[64:67], v45, s[12:15], s3 offen offset:0 sc1
v_mfma_f32_16x16x32_bf16 v[156:159], v[208:211], a[228:231], v[156:159]
ds_read_b64_tr_b16 v[202:203], v23 offset:26624
v_mul_f32 v124, v60, v124
v_mfma_f32_16x16x32_bf16 v[156:159], v[212:215], a[244:247], v[156:159]
buffer_load_dwordx4 a[68:71], v46, s[12:15], s3 offen offset:0 sc1
v_mfma_f32_16x16x32_bf16 v[160:163], v[208:211], a[232:235], v[160:163]
ds_read_b64_tr_b16 v[204:205], v23 offset:28672
v_mul_f32 v125, v61, v125
v_mfma_f32_16x16x32_bf16 v[160:163], v[212:215], a[248:251], v[160:163]
v_exp_f32 v34, -v114
v_mfma_f32_16x16x32_bf16 v[164:167], v[208:211], a[236:239], v[164:167]
ds_read_b64_tr_b16 v[206:207], v23 offset:30720
v_add_f32 v33, 1.0, v33
v_mfma_f32_16x16x32_bf16 v[164:167], v[212:215], a[252:255], v[164:167]
s_waitcnt lgkmcnt(4)
v_rcp_f32 v32, v32
v_mfma_f32_16x16x32_bf16 v[152:155], v[216:219], v[224:227], v[152:155]
ds_read_b64_tr_b16 v[208:209], v23 offset:32768
v_mul_f32 v111, v111, v39
v_mfma_f32_16x16x32_bf16 v[152:155], v[220:223], v[240:243], v[152:155]
buffer_load_dwordx4 a[72:75], v45, s[12:15], s3 offen offset:1024 sc1
v_mfma_f32_16x16x32_bf16 v[156:159], v[216:219], v[228:231], v[156:159]
ds_read_b64_tr_b16 v[210:211], v23 offset:34816
v_mul_f32 v126, v62, v126
v_mfma_f32_16x16x32_bf16 v[156:159], v[220:223], v[244:247], v[156:159]
v_exp_f32 v35, -v115
v_mfma_f32_16x16x32_bf16 v[160:163], v[216:219], v[232:235], v[160:163]
ds_read_b64_tr_b16 v[212:213], v23 offset:36864
v_add_f32 v34, 1.0, v34
v_mfma_f32_16x16x32_bf16 v[160:163], v[220:223], v[248:251], v[160:163]
v_rcp_f32 v33, v33
v_mfma_f32_16x16x32_bf16 v[164:167], v[216:219], v[236:239], v[164:167]
ds_read_b64_tr_b16 v[214:215], v23 offset:38912
v_mul_f32 v112, v112, v32
v_mfma_f32_16x16x32_bf16 v[164:167], v[220:223], v[252:255], v[164:167]
s_waitcnt lgkmcnt(4)
v_exp_f32 v36, -v116
v_mfma_f32_16x16x32_bf16 v[168:171], v[200:203], a[192:195], v[168:171]
ds_read_b64_tr_b16 v[216:217], v23 offset:40960
v_add_f32 v35, 1.0, v35
v_mfma_f32_16x16x32_bf16 v[168:171], v[204:207], a[208:211], v[168:171]
v_rcp_f32 v34, v34
v_mfma_f32_16x16x32_bf16 v[172:175], v[200:203], a[196:199], v[172:175]
ds_read_b64_tr_b16 v[218:219], v23 offset:43008
v_mul_f32 v113, v113, v33
v_mfma_f32_16x16x32_bf16 v[172:175], v[204:207], a[212:215], v[172:175]
v_exp_f32 v37, -v117
v_mfma_f32_16x16x32_bf16 v[176:179], v[200:203], a[200:203], v[176:179]
ds_read_b64_tr_b16 v[220:221], v23 offset:45056
v_add_f32 v36, 1.0, v36
v_mfma_f32_16x16x32_bf16 v[176:179], v[204:207], a[216:219], v[176:179]
v_rcp_f32 v35, v35
v_mfma_f32_16x16x32_bf16 v[180:183], v[200:203], a[204:207], v[180:183]
ds_read_b64_tr_b16 v[222:223], v23 offset:47104
v_mul_f32 v114, v114, v34
v_mfma_f32_16x16x32_bf16 v[180:183], v[204:207], a[220:223], v[180:183]
s_waitcnt lgkmcnt(4)
v_exp_f32 v38, -v118
v_mfma_f32_16x16x32_bf16 v[168:171], v[208:211], a[224:227], v[168:171]
s_waitcnt vmcnt(24)
s_barrier
v_add_f32 v37, 1.0, v37
v_mfma_f32_16x16x32_bf16 v[168:171], v[212:215], a[240:243], v[168:171]
ds_read_b64_tr_b16 v[184:185], v12 offset:0
v_mul_f32 v127, v63, v127
v_mfma_f32_16x16x32_bf16 v[172:175], v[208:211], a[228:231], v[172:175]
ds_read_b64_tr_b16 v[186:187], v12 offset:2048
v_mul_f32 v128, v64, v128
v_mfma_f32_16x16x32_bf16 v[172:175], v[212:215], a[244:247], v[172:175]
ds_read_b64_tr_b16 v[188:189], v12 offset:12288
v_mul_f32 v129, v65, v129
v_mfma_f32_16x16x32_bf16 v[176:179], v[208:211], a[232:235], v[176:179]
ds_read_b64_tr_b16 v[190:191], v12 offset:14336
v_mul_f32 v130, v66, v130
v_mfma_f32_16x16x32_bf16 v[176:179], v[212:215], a[248:251], v[176:179]
ds_read_b64_tr_b16 v[192:193], v13 offset:0
v_mul_f32 v131, v67, v131
v_mfma_f32_16x16x32_bf16 v[180:183], v[208:211], a[236:239], v[180:183]
ds_read_b64_tr_b16 v[194:195], v13 offset:2048
v_mul_f32 v132, v68, v132
v_mfma_f32_16x16x32_bf16 v[180:183], v[212:215], a[252:255], v[180:183]
s_waitcnt lgkmcnt(6)
ds_read_b64_tr_b16 v[196:197], v13 offset:12288
v_mfma_f32_16x16x32_bf16 v[168:171], v[216:219], v[224:227], v[168:171]
ds_read_b64_tr_b16 v[198:199], v13 offset:14336
v_mul_f32 v133, v69, v133
v_mfma_f32_16x16x32_bf16 v[168:171], v[220:223], v[240:243], v[168:171]
buffer_load_dwordx4 a[76:79], v46, s[12:15], s3 offen offset:1024 sc1
v_mfma_f32_16x16x32_bf16 v[172:175], v[216:219], v[228:231], v[172:175]
ds_read_b64_tr_b16 v[200:201], v14 offset:0
v_mul_f32 v134, v70, v134
v_mfma_f32_16x16x32_bf16 v[172:175], v[220:223], v[244:247], v[172:175]
ds_read_b64_tr_b16 v[202:203], v14 offset:2048
v_mul_f32 v135, v71, v135
v_mfma_f32_16x16x32_bf16 v[176:179], v[216:219], v[232:235], v[176:179]
ds_read_b64_tr_b16 v[204:205], v14 offset:12288
v_mul_f32 v136, v72, v136
v_mfma_f32_16x16x32_bf16 v[176:179], v[220:223], v[248:251], v[176:179]
ds_read_b64_tr_b16 v[206:207], v14 offset:14336
v_mul_f32 v137, v73, v137
v_mfma_f32_16x16x32_bf16 v[180:183], v[216:219], v[236:239], v[180:183]
v_mul_f32 v138, v74, v138
v_mul_f32 v139, v75, v139
v_mul_f32 v140, v76, v140
v_mul_f32 v141, v77, v141
v_mul_f32 v142, v78, v142
v_mul_f32 v143, v79, v143
v_mul_f32 v144, v80, v144
v_mul_f32 v145, v81, v145
v_mul_f32 v146, v82, v146
v_mul_f32 v147, v83, v147
v_mul_f32 v148, v84, v148
v_mul_f32 v149, v85, v149
v_mul_f32 v150, v86, v150
v_mul_f32 v151, v87, v151
v_cvt_pk_bf16_f32 v120, v120, v121
v_cvt_pk_bf16_f32 v121, v122, v123
v_cvt_pk_bf16_f32 v122, v136, v137
v_cvt_pk_bf16_f32 v123, v138, v139
buffer_store_dwordx4 v[120:123], v8, s[12:15], s41 offen offset:0 sc1
v_cvt_pk_bf16_f32 v124, v124, v125
v_cvt_pk_bf16_f32 v125, v126, v127
v_cvt_pk_bf16_f32 v126, v140, v141
v_cvt_pk_bf16_f32 v127, v142, v143
buffer_store_dwordx4 v[124:127], v9, s[12:15], s41 offen offset:0 sc1
v_cvt_pk_bf16_f32 v128, v128, v129
v_cvt_pk_bf16_f32 v129, v130, v131
v_cvt_pk_bf16_f32 v130, v144, v145
v_cvt_pk_bf16_f32 v131, v146, v147
buffer_store_dwordx4 v[128:131], v10, s[12:15], s41 offen offset:0 sc1
v_cvt_pk_bf16_f32 v132, v132, v133
v_cvt_pk_bf16_f32 v133, v134, v135
v_cvt_pk_bf16_f32 v134, v148, v149
v_cvt_pk_bf16_f32 v135, v150, v151
buffer_store_dwordx4 v[132:135], v11, s[12:15], s41 offen offset:0 sc1
v_mfma_f32_16x16x32_bf16 v[180:183], v[220:223], v[252:255], v[180:183]
s_waitcnt lgkmcnt(8)
v_rcp_f32 v36, v36
v_mfma_f32_16x16x32_bf16 v[56:59], v[184:187], a[0:3], 0
ds_read_b64_tr_b16 v[208:209], v15 offset:0
v_mul_f32 v115, v115, v35
v_mfma_f32_16x16x32_bf16 v[56:59], v[188:191], a[8:11], v[56:59]
buffer_load_dword v55, v26, s[12:15], s5 offen offset:128 sc1
v_mfma_f32_16x16x32_bf16 v[60:63], v[184:187], a[4:7], 0
ds_read_b64_tr_b16 v[210:211], v15 offset:2048
ds_read_b64_tr_b16 v[212:213], v15 offset:12288
v_exp_f32 v39, -v119
v_add_f32 v38, 1.0, v38
v_rcp_f32 v37, v37
v_mul_f32 v116, v116, v36
v_add_f32 v39, 1.0, v39
v_rcp_f32 v38, v38
v_mul_f32 v117, v117, v37
v_rcp_f32 v39, v39
v_mul_f32 v118, v118, v38
v_mul_f32 v119, v119, v39
v_mfma_f32_16x16x32_bf16 v[60:63], v[188:191], a[12:15], v[60:63]
s_waitcnt lgkmcnt(7)
ds_read_b64_tr_b16 v[214:215], v15 offset:14336
v_mfma_f32_16x16x32_bf16 v[64:67], v[192:195], a[0:3], 0
s_add_u32 s6, s62, 921600
s_add_u32 m0, s17, 110592
ds_read_b64_tr_b16 v[216:217], v12 offset:4096
v_mfma_f32_16x16x32_bf16 v[64:67], v[196:199], a[8:11], v[64:67]
buffer_load_dwordx4 v3, s[28:31], s6 offen offset:0 lds
v_mfma_f32_16x16x32_bf16 v[68:71], v[192:195], a[4:7], 0
ds_read_b64_tr_b16 v[218:219], v12 offset:6144
ds_read_b64_tr_b16 v[220:221], v12 offset:16384
v_mfma_f32_16x16x32_bf16 v[68:71], v[196:199], a[12:15], v[68:71]
s_waitcnt lgkmcnt(7)
ds_read_b64_tr_b16 v[222:223], v12 offset:18432
v_mfma_f32_16x16x32_bf16 v[72:75], v[200:203], a[0:3], 0
s_add_u32 m0, s17, 114560
ds_read_b64_tr_b16 v[184:185], v13 offset:4096
v_mfma_f32_16x16x32_bf16 v[72:75], v[204:207], a[8:11], v[72:75]
buffer_load_dwordx4 v3, s[28:31], s6 offen offset:128 lds
v_mul_f32 v152, v88, v152
v_mul_f32 v153, v89, v153
v_mul_f32 v154, v90, v154
v_mul_f32 v155, v91, v155
v_mul_f32 v156, v92, v156
v_mul_f32 v157, v93, v157
v_mul_f32 v158, v94, v158
v_mul_f32 v159, v95, v159
v_mul_f32 v160, v96, v160
v_mul_f32 v161, v97, v161
v_mul_f32 v162, v98, v162
v_mul_f32 v163, v99, v163
v_mul_f32 v164, v100, v164
v_mul_f32 v165, v101, v165
v_mul_f32 v166, v102, v166
v_mul_f32 v167, v103, v167
v_mul_f32 v168, v104, v168
v_mfma_f32_16x16x32_bf16 v[76:79], v[200:203], a[4:7], 0
ds_read_b64_tr_b16 v[186:187], v13 offset:6144
ds_read_b64_tr_b16 v[188:189], v13 offset:16384
v_mul_f32 v169, v105, v169
v_mfma_f32_16x16x32_bf16 v[76:79], v[204:207], a[12:15], v[76:79]
s_waitcnt lgkmcnt(7)
ds_read_b64_tr_b16 v[190:191], v13 offset:18432
v_mul_f32 v170, v106, v170
v_mfma_f32_16x16x32_bf16 v[80:83], v[208:211], a[0:3], 0
s_add_u32 m0, s17, 118528
ds_read_b64_tr_b16 v[192:193], v14 offset:4096
v_mul_f32 v171, v107, v171
v_mfma_f32_16x16x32_bf16 v[80:83], v[212:215], a[8:11], v[80:83]
buffer_load_dwordx4 v3, s[28:31], s6 offen offset:256 lds
v_mul_f32 v172, v108, v172
v_mfma_f32_16x16x32_bf16 v[84:87], v[208:211], a[4:7], 0
ds_read_b64_tr_b16 v[194:195], v14 offset:6144
ds_read_b64_tr_b16 v[196:197], v14 offset:16384
v_mul_f32 v173, v109, v173
v_mfma_f32_16x16x32_bf16 v[84:87], v[212:215], a[12:15], v[84:87]
s_waitcnt lgkmcnt(7)
ds_read_b64_tr_b16 v[198:199], v14 offset:18432
v_mul_f32 v174, v110, v174
v_mfma_f32_16x16x32_bf16 v[224:227], v[216:219], a[0:3], 0
ds_read_b64_tr_b16 v[200:201], v15 offset:4096
v_mul_f32 v175, v111, v175
v_mfma_f32_16x16x32_bf16 v[224:227], v[220:223], a[8:11], v[224:227]
ds_read_b64_tr_b16 v[202:203], v15 offset:6144
v_mul_f32 v176, v112, v176
v_mfma_f32_16x16x32_bf16 v[228:231], v[216:219], a[4:7], 0
ds_read_b64_tr_b16 v[204:205], v15 offset:16384
v_mul_f32 v177, v113, v177
v_mfma_f32_16x16x32_bf16 v[228:231], v[220:223], a[12:15], v[228:231]
s_waitcnt lgkmcnt(7)
ds_read_b64_tr_b16 v[206:207], v15 offset:18432
v_mul_f32 v178, v114, v178
v_mfma_f32_16x16x32_bf16 v[232:235], v[184:187], a[0:3], 0
ds_read_b64_tr_b16 v[208:209], v12 offset:8192
v_mul_f32 v179, v115, v179
v_mfma_f32_16x16x32_bf16 v[232:235], v[188:191], a[8:11], v[232:235]
ds_read_b64_tr_b16 v[210:211], v12 offset:10240
v_mul_f32 v180, v116, v180
v_mfma_f32_16x16x32_bf16 v[236:239], v[184:187], a[4:7], 0
ds_read_b64_tr_b16 v[212:213], v12 offset:20480
v_mul_f32 v181, v117, v181
v_mfma_f32_16x16x32_bf16 v[236:239], v[188:191], a[12:15], v[236:239]
s_waitcnt lgkmcnt(7)
ds_read_b64_tr_b16 v[214:215], v12 offset:22528
v_mul_f32 v182, v118, v182
v_mfma_f32_16x16x32_bf16 v[240:243], v[192:195], a[0:3], 0
ds_read_b64_tr_b16 v[216:217], v13 offset:8192
v_mul_f32 v183, v119, v183
v_cvt_pk_bf16_f32 v152, v152, v153
v_mfma_f32_16x16x32_bf16 v[240:243], v[196:199], a[8:11], v[240:243]
ds_read_b64_tr_b16 v[218:219], v13 offset:10240
v_cvt_pk_bf16_f32 v153, v154, v155
v_mfma_f32_16x16x32_bf16 v[244:247], v[192:195], a[4:7], 0
ds_read_b64_tr_b16 v[220:221], v13 offset:20480
v_cvt_pk_bf16_f32 v154, v168, v169
v_mfma_f32_16x16x32_bf16 v[244:247], v[196:199], a[12:15], v[244:247]
s_waitcnt lgkmcnt(7)
ds_read_b64_tr_b16 v[222:223], v13 offset:22528
v_cvt_pk_bf16_f32 v155, v170, v171
v_mfma_f32_16x16x32_bf16 v[248:251], v[200:203], a[0:3], 0
ds_read_b64_tr_b16 v[184:185], v14 offset:8192
v_cvt_pk_bf16_f32 v156, v156, v157
v_mfma_f32_16x16x32_bf16 v[248:251], v[204:207], a[8:11], v[248:251]
buffer_store_dwordx4 v[152:155], v8, s[12:15], s41 offen offset:1024 sc1
v_cvt_pk_bf16_f32 v157, v158, v159
v_mfma_f32_16x16x32_bf16 v[252:255], v[200:203], a[4:7], 0
ds_read_b64_tr_b16 v[186:187], v14 offset:10240
ds_read_b64_tr_b16 v[188:189], v14 offset:20480
v_cvt_pk_bf16_f32 v158, v172, v173
v_mfma_f32_16x16x32_bf16 v[252:255], v[204:207], a[12:15], v[252:255]
s_waitcnt lgkmcnt(7)
ds_read_b64_tr_b16 v[190:191], v14 offset:22528
v_cvt_pk_bf16_f32 v159, v174, v175
v_mfma_f32_16x16x32_bf16 v[88:91], v[208:211], a[0:3], 0
ds_read_b64_tr_b16 v[192:193], v15 offset:8192
v_mfma_f32_16x16x32_bf16 v[88:91], v[212:215], a[8:11], v[88:91]
buffer_store_dwordx4 v[156:159], v9, s[12:15], s41 offen offset:1024 sc1
v_mfma_f32_16x16x32_bf16 v[92:95], v[208:211], a[4:7], 0
ds_read_b64_tr_b16 v[194:195], v15 offset:10240
ds_read_b64_tr_b16 v[196:197], v15 offset:20480
v_mfma_f32_16x16x32_bf16 v[92:95], v[212:215], a[12:15], v[92:95]
s_waitcnt lgkmcnt(7)
ds_read_b64_tr_b16 v[198:199], v15 offset:22528
v_mfma_f32_16x16x32_bf16 v[96:99], v[216:219], a[0:3], 0
s_waitcnt vmcnt(28)
s_barrier
v_cvt_pk_bf16_f32 v160, v160, v161
v_mfma_f32_16x16x32_bf16 v[96:99], v[220:223], a[8:11], v[96:99]
ds_read_b64_tr_b16 v[200:201], v12 offset:24576
v_cvt_pk_bf16_f32 v161, v162, v163
v_mfma_f32_16x16x32_bf16 v[100:103], v[216:219], a[4:7], 0
ds_read_b64_tr_b16 v[202:203], v12 offset:26624
ds_read_b64_tr_b16 v[204:205], v12 offset:36864
v_cvt_pk_bf16_f32 v162, v176, v177
v_mfma_f32_16x16x32_bf16 v[100:103], v[220:223], a[12:15], v[100:103]
s_waitcnt lgkmcnt(7)
ds_read_b64_tr_b16 v[206:207], v12 offset:38912
v_cvt_pk_bf16_f32 v163, v178, v179
v_mfma_f32_16x16x32_bf16 v[104:107], v[184:187], a[0:3], 0
ds_read_b64_tr_b16 v[208:209], v13 offset:24576
v_cvt_pk_bf16_f32 v164, v164, v165
v_mfma_f32_16x16x32_bf16 v[104:107], v[188:191], a[8:11], v[104:107]
buffer_store_dwordx4 v[160:163], v10, s[12:15], s41 offen offset:1024 sc1
v_cvt_pk_bf16_f32 v165, v166, v167
v_mfma_f32_16x16x32_bf16 v[108:111], v[184:187], a[4:7], 0
ds_read_b64_tr_b16 v[210:211], v13 offset:26624
ds_read_b64_tr_b16 v[212:213], v13 offset:36864
v_cvt_pk_bf16_f32 v166, v180, v181
v_mfma_f32_16x16x32_bf16 v[108:111], v[188:191], a[12:15], v[108:111]
s_waitcnt lgkmcnt(7)
ds_read_b64_tr_b16 v[214:215], v13 offset:38912
v_cvt_pk_bf16_f32 v167, v182, v183
v_mfma_f32_16x16x32_bf16 v[112:115], v[192:195], a[0:3], 0
ds_read_b64_tr_b16 v[216:217], v14 offset:24576
v_mfma_f32_16x16x32_bf16 v[112:115], v[196:199], a[8:11], v[112:115]
buffer_store_dwordx4 v[164:167], v11, s[12:15], s41 offen offset:1024 sc1
v_mfma_f32_16x16x32_bf16 v[116:119], v[192:195], a[4:7], 0
ds_read_b64_tr_b16 v[218:219], v14 offset:26624
ds_read_b64_tr_b16 v[220:221], v14 offset:36864
v_mfma_f32_16x16x32_bf16 v[116:119], v[196:199], a[12:15], v[116:119]
s_waitcnt lgkmcnt(7)
ds_read_b64_tr_b16 v[222:223], v14 offset:38912
v_mfma_f32_16x16x32_bf16 v[56:59], v[200:203], a[16:19], v[56:59]
s_add_u32 s6, s62, 73728
s_add_u32 m0, s17, 122880
ds_read_b64_tr_b16 v[184:185], v15 offset:24576
v_mfma_f32_16x16x32_bf16 v[56:59], v[204:207], a[24:27], v[56:59]
buffer_load_dwordx4 v3, s[28:31], s6 offen offset:0 lds
v_mfma_f32_16x16x32_bf16 v[60:63], v[200:203], a[20:23], v[60:63]
ds_read_b64_tr_b16 v[186:187], v15 offset:26624
ds_read_b64_tr_b16 v[188:189], v15 offset:36864
v_mfma_f32_16x16x32_bf16 v[60:63], v[204:207], a[28:31], v[60:63]
s_waitcnt lgkmcnt(7)
ds_read_b64_tr_b16 v[190:191], v15 offset:38912
v_mfma_f32_16x16x32_bf16 v[64:67], v[208:211], a[16:19], v[64:67]
s_add_u32 m0, s17, 126848
ds_read_b64_tr_b16 v[192:193], v12 offset:28672
v_mfma_f32_16x16x32_bf16 v[64:67], v[212:215], a[24:27], v[64:67]
buffer_load_dwordx4 v3, s[28:31], s6 offen offset:128 lds
v_mfma_f32_16x16x32_bf16 v[68:71], v[208:211], a[20:23], v[68:71]
ds_read_b64_tr_b16 v[194:195], v12 offset:30720
ds_read_b64_tr_b16 v[196:197], v12 offset:40960
v_mfma_f32_16x16x32_bf16 v[68:71], v[212:215], a[28:31], v[68:71]
s_waitcnt lgkmcnt(7)
ds_read_b64_tr_b16 v[198:199], v12 offset:43008
v_mfma_f32_16x16x32_bf16 v[72:75], v[216:219], a[16:19], v[72:75]
s_add_u32 m0, s17, 130816
ds_read_b64_tr_b16 v[200:201], v13 offset:28672
v_mfma_f32_16x16x32_bf16 v[72:75], v[220:223], a[24:27], v[72:75]
buffer_load_dwordx4 v3, s[28:31], s6 offen offset:256 lds
v_mfma_f32_16x16x32_bf16 v[76:79], v[216:219], a[20:23], v[76:79]
ds_read_b64_tr_b16 v[202:203], v13 offset:30720
ds_read_b64_tr_b16 v[204:205], v13 offset:40960
v_mfma_f32_16x16x32_bf16 v[76:79], v[220:223], a[28:31], v[76:79]
s_waitcnt lgkmcnt(7)
ds_read_b64_tr_b16 v[206:207], v13 offset:43008
v_mfma_f32_16x16x32_bf16 v[80:83], v[184:187], a[16:19], v[80:83]
ds_read_b64_tr_b16 v[208:209], v14 offset:28672
v_mfma_f32_16x16x32_bf16 v[80:83], v[188:191], a[24:27], v[80:83]
s_waitcnt vmcnt(10)
v_cmp_ne_u32 vcc, s76, v55
s_nop 1
s_cbranch_vccnz slow_f2
back_f2:
v_mfma_f32_16x16x32_bf16 v[84:87], v[184:187], a[20:23], v[84:87]
ds_read_b64_tr_b16 v[210:211], v14 offset:30720
ds_read_b64_tr_b16 v[212:213], v14 offset:40960
v_mfma_f32_16x16x32_bf16 v[84:87], v[188:191], a[28:31], v[84:87]
s_waitcnt lgkmcnt(7)
ds_read_b64_tr_b16 v[214:215], v14 offset:43008
v_mfma_f32_16x16x32_bf16 v[224:227], v[192:195], a[16:19], v[224:227]
s_add_u32 s3, s60, 2048
ds_read_b64_tr_b16 v[216:217], v15 offset:28672
v_mfma_f32_16x16x32_bf16 v[224:227], v[196:199], a[24:27], v[224:227]
buffer_load_dwordx4 a[80:83], v45, s[12:15], s3 offen offset:0 sc1
v_mfma_f32_16x16x32_bf16 v[228:231], v[192:195], a[20:23], v[228:231]
ds_read_b64_tr_b16 v[218:219], v15 offset:30720
ds_read_b64_tr_b16 v[220:221], v15 offset:40960
v_mfma_f32_16x16x32_bf16 v[228:231], v[196:199], a[28:31], v[228:231]
s_waitcnt lgkmcnt(7)
ds_read_b64_tr_b16 v[222:223], v15 offset:43008
v_mfma_f32_16x16x32_bf16 v[232:235], v[200:203], a[16:19], v[232:235]
s_add_u32 s6, s62, 110592
ds_read_b64_tr_b16 v[184:185], v12 offset:32768
v_mfma_f32_16x16x32_bf16 v[232:235], v[204:207], a[24:27], v[232:235]
buffer_load_dwordx4 a[84:87], v46, s[12:15], s3 offen offset:0 sc1
v_mfma_f32_16x16x32_bf16 v[236:239], v[200:203], a[20:23], v[236:239]
ds_read_b64_tr_b16 v[186:187], v12 offset:34816
ds_read_b64_tr_b16 v[188:189], v12 offset:45056
v_mfma_f32_16x16x32_bf16 v[236:239], v[204:207], a[28:31], v[236:239]
s_waitcnt lgkmcnt(7)
ds_read_b64_tr_b16 v[190:191], v12 offset:47104
v_mfma_f32_16x16x32_bf16 v[240:243], v[208:211], a[16:19], v[240:243]
s_add_u32 m0, s17, 135168
ds_read_b64_tr_b16 v[192:193], v13 offset:32768
v_mfma_f32_16x16x32_bf16 v[240:243], v[212:215], a[24:27], v[240:243]
buffer_load_dwordx4 v3, s[28:31], s6 offen offset:0 lds
v_mfma_f32_16x16x32_bf16 v[244:247], v[208:211], a[20:23], v[244:247]
ds_read_b64_tr_b16 v[194:195], v13 offset:34816
ds_read_b64_tr_b16 v[196:197], v13 offset:45056
v_mfma_f32_16x16x32_bf16 v[244:247], v[212:215], a[28:31], v[244:247]
s_waitcnt lgkmcnt(7)
ds_read_b64_tr_b16 v[198:199], v13 offset:47104
v_mfma_f32_16x16x32_bf16 v[248:251], v[216:219], a[16:19], v[248:251]
s_add_u32 m0, s17, 139136
ds_read_b64_tr_b16 v[200:201], v14 offset:32768
v_mfma_f32_16x16x32_bf16 v[248:251], v[220:223], a[24:27], v[248:251]
buffer_load_dwordx4 v3, s[28:31], s6 offen offset:128 lds
v_mfma_f32_16x16x32_bf16 v[252:255], v[216:219], a[20:23], v[252:255]
ds_read_b64_tr_b16 v[202:203], v14 offset:34816
ds_read_b64_tr_b16 v[204:205], v14 offset:45056
v_mfma_f32_16x16x32_bf16 v[252:255], v[220:223], a[28:31], v[252:255]
s_waitcnt lgkmcnt(7)
ds_read_b64_tr_b16 v[206:207], v14 offset:47104
v_mfma_f32_16x16x32_bf16 v[88:91], v[184:187], a[16:19], v[88:91]
s_add_u32 m0, s17, 143104
ds_read_b64_tr_b16 v[208:209], v15 offset:32768
v_mfma_f32_16x16x32_bf16 v[88:91], v[188:191], a[24:27], v[88:91]
buffer_load_dwordx4 v3, s[28:31], s6 offen offset:256 lds
v_mfma_f32_16x16x32_bf16 v[92:95], v[184:187], a[20:23], v[92:95]
ds_read_b64_tr_b16 v[210:211], v15 offset:34816
ds_read_b64_tr_b16 v[212:213], v15 offset:45056
v_mfma_f32_16x16x32_bf16 v[92:95], v[188:191], a[28:31], v[92:95]
s_waitcnt lgkmcnt(7)
ds_read_b64_tr_b16 v[214:215], v15 offset:47104
v_mfma_f32_16x16x32_bf16 v[96:99], v[192:195], a[16:19], v[96:99]
s_barrier
v_mfma_f32_16x16x32_bf16 v[96:99], v[196:199], a[24:27], v[96:99]
ds_read_b64_tr_b16 v[216:217], v16 offset:0
v_mfma_f32_16x16x32_bf16 v[100:103], v[192:195], a[20:23], v[100:103]
ds_read_b64_tr_b16 v[218:219], v16 offset:2048
ds_read_b64_tr_b16 v[220:221], v16 offset:12288
v_mfma_f32_16x16x32_bf16 v[100:103], v[196:199], a[28:31], v[100:103]
s_waitcnt lgkmcnt(7)
ds_read_b64_tr_b16 v[222:223], v16 offset:14336
v_mfma_f32_16x16x32_bf16 v[104:107], v[200:203], a[16:19], v[104:107]
ds_read_b64_tr_b16 v[184:185], v17 offset:0
v_mfma_f32_16x16x32_bf16 v[104:107], v[204:207], a[24:27], v[104:107]
buffer_load_dwordx4 a[88:91], v45, s[12:15], s3 offen offset:1024 sc1
v_mfma_f32_16x16x32_bf16 v[108:111], v[200:203], a[20:23], v[108:111]
ds_read_b64_tr_b16 v[186:187], v17 offset:2048
ds_read_b64_tr_b16 v[188:189], v17 offset:12288
v_mfma_f32_16x16x32_bf16 v[108:111], v[204:207], a[28:31], v[108:111]
s_waitcnt lgkmcnt(7)
ds_read_b64_tr_b16 v[190:191], v17 offset:14336
v_mfma_f32_16x16x32_bf16 v[112:115], v[208:211], a[16:19], v[112:115]
s_add_u32 s6, s62, 294912
ds_read_b64_tr_b16 v[192:193], v18 offset:0
v_mfma_f32_16x16x32_bf16 v[112:115], v[212:215], a[24:27], v[112:115]
buffer_load_dwordx4 a[92:95], v46, s[12:15], s3 offen offset:1024 sc1
v_mfma_f32_16x16x32_bf16 v[116:119], v[208:211], a[20:23], v[116:119]
ds_read_b64_tr_b16 v[194:195], v18 offset:2048
ds_read_b64_tr_b16 v[196:197], v18 offset:12288
v_mfma_f32_16x16x32_bf16 v[116:119], v[212:215], a[28:31], v[116:119]
s_waitcnt lgkmcnt(7)
ds_read_b64_tr_b16 v[198:199], v18 offset:14336
v_mfma_f32_16x16x32_bf16 v[56:59], v[216:219], a[32:35], v[56:59]
s_add_u32 m0, s17, 0
ds_read_b64_tr_b16 v[200:201], v19 offset:0
v_mfma_f32_16x16x32_bf16 v[56:59], v[220:223], a[40:43], v[56:59]
buffer_load_dwordx4 v3, s[28:31], s6 offen offset:0 lds
v_mfma_f32_16x16x32_bf16 v[60:63], v[216:219], a[36:39], v[60:63]
ds_read_b64_tr_b16 v[202:203], v19 offset:2048
ds_read_b64_tr_b16 v[204:205], v19 offset:12288
v_mfma_f32_16x16x32_bf16 v[60:63], v[220:223], a[44:47], v[60:63]
s_waitcnt lgkmcnt(7)
ds_read_b64_tr_b16 v[206:207], v19 offset:14336
v_mfma_f32_16x16x32_bf16 v[64:67], v[184:187], a[32:35], v[64:67]
s_add_u32 m0, s17, 3968
ds_read_b64_tr_b16 v[208:209], v16 offset:4096
v_mfma_f32_16x16x32_bf16 v[64:67], v[188:191], a[40:43], v[64:67]
buffer_load_dwordx4 v3, s[28:31], s6 offen offset:128 lds
v_mfma_f32_16x16x32_bf16 v[68:71], v[184:187], a[36:39], v[68:71]
ds_read_b64_tr_b16 v[210:211], v16 offset:6144
ds_read_b64_tr_b16 v[212:213], v16 offset:16384
v_mfma_f32_16x16x32_bf16 v[68:71], v[188:191], a[44:47], v[68:71]
s_waitcnt lgkmcnt(7)
ds_read_b64_tr_b16 v[214:215], v16 offset:18432
v_mfma_f32_16x16x32_bf16 v[72:75], v[192:195], a[32:35], v[72:75]
s_add_u32 m0, s17, 7936
ds_read_b64_tr_b16 v[216:217], v17 offset:4096
v_mfma_f32_16x16x32_bf16 v[72:75], v[196:199], a[40:43], v[72:75]
buffer_load_dwordx4 v3, s[28:31], s6 offen offset:256 lds
v_mfma_f32_16x16x32_bf16 v[76:79], v[192:195], a[36:39], v[76:79]
ds_read_b64_tr_b16 v[218:219], v17 offset:6144
ds_read_b64_tr_b16 v[220:221], v17 offset:16384
v_mfma_f32_16x16x32_bf16 v[76:79], v[196:199], a[44:47], v[76:79]
s_waitcnt lgkmcnt(7)
ds_read_b64_tr_b16 v[222:223], v17 offset:18432
v_mfma_f32_16x16x32_bf16 v[80:83], v[200:203], a[32:35], v[80:83]
s_add_u32 s3, s60, 8192
ds_read_b64_tr_b16 v[184:185], v18 offset:4096
v_mfma_f32_16x16x32_bf16 v[80:83], v[204:207], a[40:43], v[80:83]
buffer_load_dwordx4 a[96:99], v45, s[12:15], s3 offen offset:0 sc1
v_mfma_f32_16x16x32_bf16 v[84:87], v[200:203], a[36:39], v[84:87]
ds_read_b64_tr_b16 v[186:187], v18 offset:6144
ds_read_b64_tr_b16 v[188:189], v18 offset:16384
v_mfma_f32_16x16x32_bf16 v[84:87], v[204:207], a[44:47], v[84:87]
s_waitcnt lgkmcnt(7)
ds_read_b64_tr_b16 v[190:191], v18 offset:18432
v_mfma_f32_16x16x32_bf16 v[224:227], v[208:211], a[32:35], v[224:227]
s_add_u32 s6, s62, 331776
ds_read_b64_tr_b16 v[192:193], v19 offset:4096
v_mfma_f32_16x16x32_bf16 v[224:227], v[212:215], a[40:43], v[224:227]
buffer_load_dwordx4 a[100:103], v46, s[12:15], s3 offen offset:0 sc1
v_mfma_f32_16x16x32_bf16 v[228:231], v[208:211], a[36:39], v[228:231]
ds_read_b64_tr_b16 v[194:195], v19 offset:6144
ds_read_b64_tr_b16 v[196:197], v19 offset:16384
v_mfma_f32_16x16x32_bf16 v[228:231], v[212:215], a[44:47], v[228:231]
s_waitcnt lgkmcnt(7)
ds_read_b64_tr_b16 v[198:199], v19 offset:18432
v_mfma_f32_16x16x32_bf16 v[232:235], v[216:219], a[32:35], v[232:235]
s_add_u32 m0, s17, 12288
ds_read_b64_tr_b16 v[200:201], v16 offset:8192
v_mfma_f32_16x16x32_bf16 v[232:235], v[220:223], a[40:43], v[232:235]
buffer_load_dwordx4 v3, s[28:31], s6 offen offset:0 lds
v_mfma_f32_16x16x32_bf16 v[236:239], v[216:219], a[36:39], v[236:239]
ds_read_b64_tr_b16 v[202:203], v16 offset:10240
ds_read_b64_tr_b16 v[204:205], v16 offset:20480
v_mfma_f32_16x16x32_bf16 v[236:239], v[220:223], a[44:47], v[236:239]
s_waitcnt lgkmcnt(7)
ds_read_b64_tr_b16 v[206:207], v16 offset:22528
v_mfma_f32_16x16x32_bf16 v[240:243], v[184:187], a[32:35], v[240:243]
s_add_u32 m0, s17, 16256
ds_read_b64_tr_b16 v[208:209], v17 offset:8192
v_mfma_f32_16x16x32_bf16 v[240:243], v[188:191], a[40:43], v[240:243]
buffer_load_dwordx4 v3, s[28:31], s6 offen offset:128 lds
v_mfma_f32_16x16x32_bf16 v[244:247], v[184:187], a[36:39], v[244:247]
ds_read_b64_tr_b16 v[210:211], v17 offset:10240
ds_read_b64_tr_b16 v[212:213], v17 offset:20480
v_mfma_f32_16x16x32_bf16 v[244:247], v[188:191], a[44:47], v[244:247]
s_waitcnt lgkmcnt(7)
ds_read_b64_tr_b16 v[214:215], v17 offset:22528
v_mfma_f32_16x16x32_bf16 v[248:251], v[192:195], a[32:35], v[248:251]
s_add_u32 m0, s17, 20224
ds_read_b64_tr_b16 v[216:217], v18 offset:8192
v_mfma_f32_16x16x32_bf16 v[248:251], v[196:199], a[40:43], v[248:251]
buffer_load_dwordx4 v3, s[28:31], s6 offen offset:256 lds
v_mfma_f32_16x16x32_bf16 v[252:255], v[192:195], a[36:39], v[252:255]
ds_read_b64_tr_b16 v[218:219], v18 offset:10240
ds_read_b64_tr_b16 v[220:221], v18 offset:20480
v_mfma_f32_16x16x32_bf16 v[252:255], v[196:199], a[44:47], v[252:255]
s_waitcnt lgkmcnt(7)
ds_read_b64_tr_b16 v[222:223], v18 offset:22528
v_mfma_f32_16x16x32_bf16 v[88:91], v[200:203], a[32:35], v[88:91]
ds_read_b64_tr_b16 v[184:185], v19 offset:8192
v_mfma_f32_16x16x32_bf16 v[88:91], v[204:207], a[40:43], v[88:91]
buffer_load_dwordx4 a[104:107], v45, s[12:15], s3 offen offset:1024 sc1
v_mfma_f32_16x16x32_bf16 v[92:95], v[200:203], a[36:39], v[92:95]
ds_read_b64_tr_b16 v[186:187], v19 offset:10240
ds_read_b64_tr_b16 v[188:189], v19 offset:20480
v_mfma_f32_16x16x32_bf16 v[92:95], v[204:207], a[44:47], v[92:95]
s_waitcnt lgkmcnt(7)
ds_read_b64_tr_b16 v[190:191], v19 offset:22528
v_mfma_f32_16x16x32_bf16 v[96:99], v[208:211], a[32:35], v[96:99]
s_barrier
v_mfma_f32_16x16x32_bf16 v[96:99], v[212:215], a[40:43], v[96:99]
ds_read_b64_tr_b16 v[192:193], v16 offset:24576
v_mfma_f32_16x16x32_bf16 v[100:103], v[208:211], a[36:39], v[100:103]
ds_read_b64_tr_b16 v[194:195], v16 offset:26624
ds_read_b64_tr_b16 v[196:197], v16 offset:36864
v_mfma_f32_16x16x32_bf16 v[100:103], v[212:215], a[44:47], v[100:103]
s_waitcnt lgkmcnt(7)
ds_read_b64_tr_b16 v[198:199], v16 offset:38912
v_mfma_f32_16x16x32_bf16 v[104:107], v[216:219], a[32:35], v[104:107]
s_add_u32 s6, s62, 516096
ds_read_b64_tr_b16 v[200:201], v17 offset:24576
v_mfma_f32_16x16x32_bf16 v[104:107], v[220:223], a[40:43], v[104:107]
buffer_load_dwordx4 a[108:111], v46, s[12:15], s3 offen offset:1024 sc1
v_mfma_f32_16x16x32_bf16 v[108:111], v[216:219], a[36:39], v[108:111]
ds_read_b64_tr_b16 v[202:203], v17 offset:26624
ds_read_b64_tr_b16 v[204:205], v17 offset:36864
v_mfma_f32_16x16x32_bf16 v[108:111], v[220:223], a[44:47], v[108:111]
s_waitcnt lgkmcnt(7)
ds_read_b64_tr_b16 v[206:207], v17 offset:38912
v_mfma_f32_16x16x32_bf16 v[112:115], v[184:187], a[32:35], v[112:115]
s_add_u32 m0, s17, 24576
ds_read_b64_tr_b16 v[208:209], v18 offset:24576
v_mfma_f32_16x16x32_bf16 v[112:115], v[188:191], a[40:43], v[112:115]
buffer_load_dwordx4 v3, s[28:31], s6 offen offset:0 lds
v_mfma_f32_16x16x32_bf16 v[116:119], v[184:187], a[36:39], v[116:119]
ds_read_b64_tr_b16 v[210:211], v18 offset:26624
ds_read_b64_tr_b16 v[212:213], v18 offset:36864
v_mfma_f32_16x16x32_bf16 v[116:119], v[188:191], a[44:47], v[116:119]
s_waitcnt lgkmcnt(7)
ds_read_b64_tr_b16 v[214:215], v18 offset:38912
v_mfma_f32_16x16x32_bf16 v[56:59], v[192:195], a[48:51], v[56:59]
s_add_u32 m0, s17, 28544
ds_read_b64_tr_b16 v[216:217], v19 offset:24576
v_mfma_f32_16x16x32_bf16 v[56:59], v[196:199], a[56:59], v[56:59]
buffer_load_dwordx4 v3, s[28:31], s6 offen offset:128 lds
v_mfma_f32_16x16x32_bf16 v[60:63], v[192:195], a[52:55], v[60:63]
ds_read_b64_tr_b16 v[218:219], v19 offset:26624
ds_read_b64_tr_b16 v[220:221], v19 offset:36864
v_mfma_f32_16x16x32_bf16 v[60:63], v[196:199], a[60:63], v[60:63]
s_waitcnt lgkmcnt(7)
ds_read_b64_tr_b16 v[222:223], v19 offset:38912
v_mfma_f32_16x16x32_bf16 v[64:67], v[200:203], a[48:51], v[64:67]
s_add_u32 m0, s17, 32512
ds_read_b64_tr_b16 v[184:185], v16 offset:28672
v_mfma_f32_16x16x32_bf16 v[64:67], v[204:207], a[56:59], v[64:67]
buffer_load_dwordx4 v3, s[28:31], s6 offen offset:256 lds
v_mfma_f32_16x16x32_bf16 v[68:71], v[200:203], a[52:55], v[68:71]
ds_read_b64_tr_b16 v[186:187], v16 offset:30720
ds_read_b64_tr_b16 v[188:189], v16 offset:40960
v_mfma_f32_16x16x32_bf16 v[68:71], v[204:207], a[60:63], v[68:71]
s_waitcnt lgkmcnt(7)
ds_read_b64_tr_b16 v[190:191], v16 offset:43008
v_mfma_f32_16x16x32_bf16 v[72:75], v[208:211], a[48:51], v[72:75]
s_add_u32 s3, s60, 14336
ds_read_b64_tr_b16 v[192:193], v17 offset:28672
v_mfma_f32_16x16x32_bf16 v[72:75], v[212:215], a[56:59], v[72:75]
buffer_load_dwordx4 a[112:115], v45, s[12:15], s3 offen offset:0 sc1
v_mfma_f32_16x16x32_bf16 v[76:79], v[208:211], a[52:55], v[76:79]
ds_read_b64_tr_b16 v[194:195], v17 offset:30720
ds_read_b64_tr_b16 v[196:197], v17 offset:40960
v_mfma_f32_16x16x32_bf16 v[76:79], v[212:215], a[60:63], v[76:79]
s_waitcnt lgkmcnt(7)
ds_read_b64_tr_b16 v[198:199], v17 offset:43008
v_mfma_f32_16x16x32_bf16 v[80:83], v[216:219], a[48:51], v[80:83]
s_add_u32 s6, s62, 552960
ds_read_b64_tr_b16 v[200:201], v18 offset:28672
v_mfma_f32_16x16x32_bf16 v[80:83], v[220:223], a[56:59], v[80:83]
buffer_load_dwordx4 a[116:119], v46, s[12:15], s3 offen offset:0 sc1
v_mfma_f32_16x16x32_bf16 v[84:87], v[216:219], a[52:55], v[84:87]
ds_read_b64_tr_b16 v[202:203], v18 offset:30720
ds_read_b64_tr_b16 v[204:205], v18 offset:40960
v_mfma_f32_16x16x32_bf16 v[84:87], v[220:223], a[60:63], v[84:87]
s_waitcnt lgkmcnt(7)
ds_read_b64_tr_b16 v[206:207], v18 offset:43008
v_mfma_f32_16x16x32_bf16 v[224:227], v[184:187], a[48:51], v[224:227]
ds_read_b64_tr_b16 v[208:209], v19 offset:28672
v_mfma_f32_16x16x32_bf16 v[224:227], v[188:191], a[56:59], v[224:227]
s_waitcnt vmcnt(25)
buffer_store_dword v31, v28, s[12:15], s37 offen offset:256 sc1
v_mfma_f32_16x16x32_bf16 v[228:231], v[184:187], a[52:55], v[228:231]
ds_read_b64_tr_b16 v[210:211], v19 offset:30720
ds_read_b64_tr_b16 v[212:213], v19 offset:40960
v_mfma_f32_16x16x32_bf16 v[228:231], v[188:191], a[60:63], v[228:231]
s_waitcnt lgkmcnt(7)
ds_read_b64_tr_b16 v[214:215], v19 offset:43008
v_mfma_f32_16x16x32_bf16 v[232:235], v[192:195], a[48:51], v[232:235]
s_add_u32 m0, s17, 36864
ds_read_b64_tr_b16 v[216:217], v16 offset:32768
v_mfma_f32_16x16x32_bf16 v[232:235], v[196:199], a[56:59], v[232:235]
buffer_load_dwordx4 v3, s[28:31], s6 offen offset:0 lds
v_mfma_f32_16x16x32_bf16 v[236:239], v[192:195], a[52:55], v[236:239]
ds_read_b64_tr_b16 v[218:219], v16 offset:34816
ds_read_b64_tr_b16 v[220:221], v16 offset:45056
v_mfma_f32_16x16x32_bf16 v[236:239], v[196:199], a[60:63], v[236:239]
s_waitcnt lgkmcnt(7)
ds_read_b64_tr_b16 v[222:223], v16 offset:47104
v_mfma_f32_16x16x32_bf16 v[240:243], v[200:203], a[48:51], v[240:243]
s_add_u32 m0, s17, 40832
ds_read_b64_tr_b16 v[184:185], v17 offset:32768
v_mfma_f32_16x16x32_bf16 v[240:243], v[204:207], a[56:59], v[240:243]
buffer_load_dwordx4 v3, s[28:31], s6 offen offset:128 lds
v_mfma_f32_16x16x32_bf16 v[244:247], v[200:203], a[52:55], v[244:247]
ds_read_b64_tr_b16 v[186:187], v17 offset:34816
ds_read_b64_tr_b16 v[188:189], v17 offset:45056
v_mfma_f32_16x16x32_bf16 v[244:247], v[204:207], a[60:63], v[244:247]
s_waitcnt lgkmcnt(7)
ds_read_b64_tr_b16 v[190:191], v17 offset:47104
v_mfma_f32_16x16x32_bf16 v[248:251], v[208:211], a[48:51], v[248:251]
s_add_u32 m0, s17, 44800
ds_read_b64_tr_b16 v[192:193], v18 offset:32768
v_mfma_f32_16x16x32_bf16 v[248:251], v[212:215], a[56:59], v[248:251]
buffer_load_dwordx4 v3, s[28:31], s6 offen offset:256 lds
v_mfma_f32_16x16x32_bf16 v[252:255], v[208:211], a[52:55], v[252:255]
ds_read_b64_tr_b16 v[194:195], v18 offset:34816
ds_read_b64_tr_b16 v[196:197], v18 offset:45056
v_mfma_f32_16x16x32_bf16 v[252:255], v[212:215], a[60:63], v[252:255]
s_waitcnt lgkmcnt(7)
ds_read_b64_tr_b16 v[198:199], v18 offset:47104
v_mfma_f32_16x16x32_bf16 v[88:91], v[216:219], a[48:51], v[88:91]
ds_read_b64_tr_b16 v[200:201], v19 offset:32768
v_mfma_f32_16x16x32_bf16 v[88:91], v[220:223], a[56:59], v[88:91]
buffer_load_dwordx4 a[120:123], v45, s[12:15], s3 offen offset:1024 sc1
v_mfma_f32_16x16x32_bf16 v[92:95], v[216:219], a[52:55], v[92:95]
ds_read_b64_tr_b16 v[202:203], v19 offset:34816
ds_read_b64_tr_b16 v[204:205], v19 offset:45056
v_mfma_f32_16x16x32_bf16 v[92:95], v[220:223], a[60:63], v[92:95]
s_waitcnt lgkmcnt(7)
ds_read_b64_tr_b16 v[206:207], v19 offset:47104
v_mfma_f32_16x16x32_bf16 v[96:99], v[184:187], a[48:51], v[96:99]
s_barrier
v_mfma_f32_16x16x32_bf16 v[96:99], v[188:191], a[56:59], v[96:99]
ds_read_b64_tr_b16 v[208:209], v20 offset:0
v_mfma_f32_16x16x32_bf16 v[100:103], v[184:187], a[52:55], v[100:103]
ds_read_b64_tr_b16 v[210:211], v20 offset:2048
ds_read_b64_tr_b16 v[212:213], v20 offset:12288
v_mfma_f32_16x16x32_bf16 v[100:103], v[188:191], a[60:63], v[100:103]
s_waitcnt lgkmcnt(7)
ds_read_b64_tr_b16 v[214:215], v20 offset:14336
v_mfma_f32_16x16x32_bf16 v[104:107], v[192:195], a[48:51], v[104:107]
s_add_u32 s6, s62, 737280
ds_read_b64_tr_b16 v[216:217], v21 offset:0
v_mfma_f32_16x16x32_bf16 v[104:107], v[196:199], a[56:59], v[104:107]
buffer_load_dwordx4 a[124:127], v46, s[12:15], s3 offen offset:1024 sc1
v_mfma_f32_16x16x32_bf16 v[108:111], v[192:195], a[52:55], v[108:111]
ds_read_b64_tr_b16 v[218:219], v21 offset:2048
ds_read_b64_tr_b16 v[220:221], v21 offset:12288
v_mfma_f32_16x16x32_bf16 v[108:111], v[196:199], a[60:63], v[108:111]
s_waitcnt lgkmcnt(7)
ds_read_b64_tr_b16 v[222:223], v21 offset:14336
v_mfma_f32_16x16x32_bf16 v[112:115], v[200:203], a[48:51], v[112:115]
s_add_u32 m0, s17, 49152
ds_read_b64_tr_b16 v[184:185], v22 offset:0
v_mfma_f32_16x16x32_bf16 v[112:115], v[204:207], a[56:59], v[112:115]
buffer_load_dwordx4 v3, s[28:31], s6 offen offset:0 lds
v_mfma_f32_16x16x32_bf16 v[116:119], v[200:203], a[52:55], v[116:119]
ds_read_b64_tr_b16 v[186:187], v22 offset:2048
ds_read_b64_tr_b16 v[188:189], v22 offset:12288
v_mfma_f32_16x16x32_bf16 v[116:119], v[204:207], a[60:63], v[116:119]
s_waitcnt lgkmcnt(7)
ds_read_b64_tr_b16 v[190:191], v22 offset:14336
v_mfma_f32_16x16x32_bf16 v[56:59], v[208:211], a[64:67], v[56:59]
s_add_u32 m0, s17, 53120
ds_read_b64_tr_b16 v[192:193], v23 offset:0
v_mfma_f32_16x16x32_bf16 v[56:59], v[212:215], a[72:75], v[56:59]
buffer_load_dwordx4 v3, s[28:31], s6 offen offset:128 lds
v_mfma_f32_16x16x32_bf16 v[60:63], v[208:211], a[68:71], v[60:63]
ds_read_b64_tr_b16 v[194:195], v23 offset:2048
ds_read_b64_tr_b16 v[196:197], v23 offset:12288
v_mfma_f32_16x16x32_bf16 v[60:63], v[212:215], a[76:79], v[60:63]
s_waitcnt lgkmcnt(7)
ds_read_b64_tr_b16 v[198:199], v23 offset:14336
v_mfma_f32_16x16x32_bf16 v[64:67], v[216:219], a[64:67], v[64:67]
s_add_u32 m0, s17, 57088
ds_read_b64_tr_b16 v[200:201], v20 offset:4096
v_mfma_f32_16x16x32_bf16 v[64:67], v[220:223], a[72:75], v[64:67]
buffer_load_dwordx4 v3, s[28:31], s6 offen offset:256 lds
v_mfma_f32_16x16x32_bf16 v[68:71], v[216:219], a[68:71], v[68:71]
ds_read_b64_tr_b16 v[202:203], v20 offset:6144
ds_read_b64_tr_b16 v[204:205], v20 offset:16384
v_mfma_f32_16x16x32_bf16 v[68:71], v[220:223], a[76:79], v[68:71]
s_waitcnt lgkmcnt(7)
ds_read_b64_tr_b16 v[206:207], v20 offset:18432
v_mfma_f32_16x16x32_bf16 v[72:75], v[184:187], a[64:67], v[72:75]
s_add_u32 s3, s60, 20480
ds_read_b64_tr_b16 v[208:209], v21 offset:4096
v_mfma_f32_16x16x32_bf16 v[72:75], v[188:191], a[72:75], v[72:75]
buffer_load_dwordx4 a[128:131], v45, s[12:15], s3 offen offset:0 sc1
v_mfma_f32_16x16x32_bf16 v[76:79], v[184:187], a[68:71], v[76:79]
ds_read_b64_tr_b16 v[210:211], v21 offset:6144
ds_read_b64_tr_b16 v[212:213], v21 offset:16384
v_mfma_f32_16x16x32_bf16 v[76:79], v[188:191], a[76:79], v[76:79]
s_waitcnt lgkmcnt(7)
ds_read_b64_tr_b16 v[214:215], v21 offset:18432
v_mfma_f32_16x16x32_bf16 v[80:83], v[192:195], a[64:67], v[80:83]
s_add_u32 s6, s62, 774144
ds_read_b64_tr_b16 v[216:217], v22 offset:4096
v_mfma_f32_16x16x32_bf16 v[80:83], v[196:199], a[72:75], v[80:83]
buffer_load_dwordx4 a[132:135], v46, s[12:15], s3 offen offset:0 sc1
v_mfma_f32_16x16x32_bf16 v[84:87], v[192:195], a[68:71], v[84:87]
ds_read_b64_tr_b16 v[218:219], v22 offset:6144
ds_read_b64_tr_b16 v[220:221], v22 offset:16384
v_mfma_f32_16x16x32_bf16 v[84:87], v[196:199], a[76:79], v[84:87]
s_waitcnt lgkmcnt(7)
ds_read_b64_tr_b16 v[222:223], v22 offset:18432
v_mfma_f32_16x16x32_bf16 v[224:227], v[200:203], a[64:67], v[224:227]
s_add_u32 m0, s17, 61440
ds_read_b64_tr_b16 v[184:185], v23 offset:4096
v_mfma_f32_16x16x32_bf16 v[224:227], v[204:207], a[72:75], v[224:227]
buffer_load_dwordx4 v3, s[28:31], s6 offen offset:0 lds
v_mfma_f32_16x16x32_bf16 v[228:231], v[200:203], a[68:71], v[228:231]
ds_read_b64_tr_b16 v[186:187], v23 offset:6144
ds_read_b64_tr_b16 v[188:189], v23 offset:16384
v_mfma_f32_16x16x32_bf16 v[228:231], v[204:207], a[76:79], v[228:231]
s_waitcnt lgkmcnt(7)
ds_read_b64_tr_b16 v[190:191], v23 offset:18432
v_mfma_f32_16x16x32_bf16 v[232:235], v[208:211], a[64:67], v[232:235]
s_add_u32 m0, s17, 65408
ds_read_b64_tr_b16 v[192:193], v20 offset:8192
v_mfma_f32_16x16x32_bf16 v[232:235], v[212:215], a[72:75], v[232:235]
buffer_load_dwordx4 v3, s[28:31], s6 offen offset:128 lds
v_mfma_f32_16x16x32_bf16 v[236:239], v[208:211], a[68:71], v[236:239]
ds_read_b64_tr_b16 v[194:195], v20 offset:10240
ds_read_b64_tr_b16 v[196:197], v20 offset:20480
v_mfma_f32_16x16x32_bf16 v[236:239], v[212:215], a[76:79], v[236:239]
s_waitcnt lgkmcnt(7)
ds_read_b64_tr_b16 v[198:199], v20 offset:22528
v_mfma_f32_16x16x32_bf16 v[240:243], v[216:219], a[64:67], v[240:243]
ds_read_b64_tr_b16 v[200:201], v21 offset:8192
v_mfma_f32_16x16x32_bf16 v[240:243], v[220:223], a[72:75], v[240:243]
buffer_load_dword v55, v26, s[12:15], s5 offen offset:256 sc1
v_mfma_f32_16x16x32_bf16 v[244:247], v[216:219], a[68:71], v[244:247]
ds_read_b64_tr_b16 v[202:203], v21 offset:10240
ds_read_b64_tr_b16 v[204:205], v21 offset:20480
v_mfma_f32_16x16x32_bf16 v[244:247], v[220:223], a[76:79], v[244:247]
s_waitcnt lgkmcnt(7)
ds_read_b64_tr_b16 v[206:207], v21 offset:22528
v_mfma_f32_16x16x32_bf16 v[248:251], v[184:187], a[64:67], v[248:251]
s_add_u32 m0, s17, 69376
ds_read_b64_tr_b16 v[208:209], v22 offset:8192
v_mfma_f32_16x16x32_bf16 v[248:251], v[188:191], a[72:75], v[248:251]
buffer_load_dwordx4 v3, s[28:31], s6 offen offset:256 lds
v_mfma_f32_16x16x32_bf16 v[252:255], v[184:187], a[68:71], v[252:255]
ds_read_b64_tr_b16 v[210:211], v22 offset:10240
ds_read_b64_tr_b16 v[212:213], v22 offset:20480
v_mfma_f32_16x16x32_bf16 v[252:255], v[188:191], a[76:79], v[252:255]
s_waitcnt lgkmcnt(7)
ds_read_b64_tr_b16 v[214:215], v22 offset:22528
v_mfma_f32_16x16x32_bf16 v[88:91], v[192:195], a[64:67], v[88:91]
ds_read_b64_tr_b16 v[216:217], v23 offset:8192
v_mfma_f32_16x16x32_bf16 v[88:91], v[196:199], a[72:75], v[88:91]
buffer_load_dwordx4 a[136:139], v45, s[12:15], s3 offen offset:1024 sc1
v_mfma_f32_16x16x32_bf16 v[92:95], v[192:195], a[68:71], v[92:95]
ds_read_b64_tr_b16 v[218:219], v23 offset:10240
ds_read_b64_tr_b16 v[220:221], v23 offset:20480
v_mfma_f32_16x16x32_bf16 v[92:95], v[196:199], a[76:79], v[92:95]
s_waitcnt lgkmcnt(7)
ds_read_b64_tr_b16 v[222:223], v23 offset:22528
v_mfma_f32_16x16x32_bf16 v[96:99], v[200:203], a[64:67], v[96:99]
s_waitcnt vmcnt(31)
s_barrier
v_mfma_f32_16x16x32_bf16 v[96:99], v[204:207], a[72:75], v[96:99]
ds_read_b64_tr_b16 v[184:185], v20 offset:24576
v_mfma_f32_16x16x32_bf16 v[100:103], v[200:203], a[68:71], v[100:103]
ds_read_b64_tr_b16 v[186:187], v20 offset:26624
ds_read_b64_tr_b16 v[188:189], v20 offset:36864
v_mfma_f32_16x16x32_bf16 v[100:103], v[204:207], a[76:79], v[100:103]
s_waitcnt lgkmcnt(7)
ds_read_b64_tr_b16 v[190:191], v20 offset:38912
v_mfma_f32_16x16x32_bf16 v[104:107], v[208:211], a[64:67], v[104:107]
s_add_u32 s6, s62, 958464
ds_read_b64_tr_b16 v[192:193], v21 offset:24576
v_mfma_f32_16x16x32_bf16 v[104:107], v[212:215], a[72:75], v[104:107]
buffer_load_dwordx4 a[140:143], v46, s[12:15], s3 offen offset:1024 sc1
v_mfma_f32_16x16x32_bf16 v[108:111], v[208:211], a[68:71], v[108:111]
ds_read_b64_tr_b16 v[194:195], v21 offset:26624
ds_read_b64_tr_b16 v[196:197], v21 offset:36864
v_mfma_f32_16x16x32_bf16 v[108:111], v[212:215], a[76:79], v[108:111]
s_waitcnt lgkmcnt(7)
ds_read_b64_tr_b16 v[198:199], v21 offset:38912
v_mfma_f32_16x16x32_bf16 v[112:115], v[216:219], a[64:67], v[112:115]
s_add_u32 m0, s17, 73728
ds_read_b64_tr_b16 v[200:201], v22 offset:24576
v_mfma_f32_16x16x32_bf16 v[112:115], v[220:223], a[72:75], v[112:115]
buffer_load_dwordx4 v3, s[28:31], s6 offen offset:0 lds
v_mfma_f32_16x16x32_bf16 v[116:119], v[216:219], a[68:71], v[116:119]
ds_read_b64_tr_b16 v[202:203], v22 offset:26624
ds_read_b64_tr_b16 v[204:205], v22 offset:36864
v_mfma_f32_16x16x32_bf16 v[116:119], v[220:223], a[76:79], v[116:119]
s_waitcnt lgkmcnt(7)
ds_read_b64_tr_b16 v[206:207], v22 offset:38912
v_mfma_f32_16x16x32_bf16 v[56:59], v[184:187], a[80:83], v[56:59]
s_add_u32 m0, s17, 77696
ds_read_b64_tr_b16 v[208:209], v23 offset:24576
v_mfma_f32_16x16x32_bf16 v[56:59], v[188:191], a[88:91], v[56:59]
buffer_load_dwordx4 v3, s[28:31], s6 offen offset:128 lds
v_mfma_f32_16x16x32_bf16 v[60:63], v[184:187], a[84:87], v[60:63]
ds_read_b64_tr_b16 v[210:211], v23 offset:26624
ds_read_b64_tr_b16 v[212:213], v23 offset:36864
v_mfma_f32_16x16x32_bf16 v[60:63], v[188:191], a[92:95], v[60:63]
s_waitcnt lgkmcnt(7)
ds_read_b64_tr_b16 v[214:215], v23 offset:38912
v_mfma_f32_16x16x32_bf16 v[64:67], v[192:195], a[80:83], v[64:67]
s_add_u32 m0, s17, 81664
ds_read_b64_tr_b16 v[216:217], v20 offset:28672
v_mfma_f32_16x16x32_bf16 v[64:67], v[196:199], a[88:91], v[64:67]
buffer_load_dwordx4 v3, s[28:31], s6 offen offset:256 lds
v_mfma_f32_16x16x32_bf16 v[68:71], v[192:195], a[84:87], v[68:71]
ds_read_b64_tr_b16 v[218:219], v20 offset:30720
ds_read_b64_tr_b16 v[220:221], v20 offset:40960
v_mfma_f32_16x16x32_bf16 v[68:71], v[196:199], a[92:95], v[68:71]
s_waitcnt lgkmcnt(7)
ds_read_b64_tr_b16 v[222:223], v20 offset:43008
v_mfma_f32_16x16x32_bf16 v[72:75], v[200:203], a[80:83], v[72:75]
s_add_u32 s3, s60, 26624
ds_read_b64_tr_b16 v[184:185], v21 offset:28672
v_mfma_f32_16x16x32_bf16 v[72:75], v[204:207], a[88:91], v[72:75]
buffer_load_dwordx4 a[144:147], v45, s[12:15], s3 offen offset:0 sc1
v_mfma_f32_16x16x32_bf16 v[76:79], v[200:203], a[84:87], v[76:79]
ds_read_b64_tr_b16 v[186:187], v21 offset:30720
ds_read_b64_tr_b16 v[188:189], v21 offset:40960
v_mfma_f32_16x16x32_bf16 v[76:79], v[204:207], a[92:95], v[76:79]
s_waitcnt lgkmcnt(7)
ds_read_b64_tr_b16 v[190:191], v21 offset:43008
v_mfma_f32_16x16x32_bf16 v[80:83], v[208:211], a[80:83], v[80:83]
s_add_u32 s6, s62, 995328
ds_read_b64_tr_b16 v[192:193], v22 offset:28672
v_mfma_f32_16x16x32_bf16 v[80:83], v[212:215], a[88:91], v[80:83]
buffer_load_dwordx4 a[148:151], v46, s[12:15], s3 offen offset:0 sc1
v_mfma_f32_16x16x32_bf16 v[84:87], v[208:211], a[84:87], v[84:87]
ds_read_b64_tr_b16 v[194:195], v22 offset:30720
ds_read_b64_tr_b16 v[196:197], v22 offset:40960
v_mfma_f32_16x16x32_bf16 v[84:87], v[212:215], a[92:95], v[84:87]
s_waitcnt lgkmcnt(7)
ds_read_b64_tr_b16 v[198:199], v22 offset:43008
v_mfma_f32_16x16x32_bf16 v[224:227], v[216:219], a[80:83], v[224:227]
s_add_u32 m0, s17, 86016
ds_read_b64_tr_b16 v[200:201], v23 offset:28672
v_mfma_f32_16x16x32_bf16 v[224:227], v[220:223], a[88:91], v[224:227]
buffer_load_dwordx4 v3, s[28:31], s6 offen offset:0 lds
v_mfma_f32_16x16x32_bf16 v[228:231], v[216:219], a[84:87], v[228:231]
ds_read_b64_tr_b16 v[202:203], v23 offset:30720
ds_read_b64_tr_b16 v[204:205], v23 offset:40960
v_mfma_f32_16x16x32_bf16 v[228:231], v[220:223], a[92:95], v[228:231]
s_waitcnt lgkmcnt(7)
ds_read_b64_tr_b16 v[206:207], v23 offset:43008
v_mfma_f32_16x16x32_bf16 v[232:235], v[184:187], a[80:83], v[232:235]
s_add_u32 m0, s17, 89984
ds_read_b64_tr_b16 v[208:209], v20 offset:32768
v_mfma_f32_16x16x32_bf16 v[232:235], v[188:191], a[88:91], v[232:235]
buffer_load_dwordx4 v3, s[28:31], s6 offen offset:128 lds
v_mfma_f32_16x16x32_bf16 v[236:239], v[184:187], a[84:87], v[236:239]
ds_read_b64_tr_b16 v[210:211], v20 offset:34816
ds_read_b64_tr_b16 v[212:213], v20 offset:45056
v_mfma_f32_16x16x32_bf16 v[236:239], v[188:191], a[92:95], v[236:239]
s_waitcnt lgkmcnt(7)
ds_read_b64_tr_b16 v[214:215], v20 offset:47104
v_mfma_f32_16x16x32_bf16 v[240:243], v[192:195], a[80:83], v[240:243]
s_add_u32 m0, s17, 93952
ds_read_b64_tr_b16 v[216:217], v21 offset:32768
v_mfma_f32_16x16x32_bf16 v[240:243], v[196:199], a[88:91], v[240:243]
buffer_load_dwordx4 v3, s[28:31], s6 offen offset:256 lds
v_mfma_f32_16x16x32_bf16 v[244:247], v[192:195], a[84:87], v[244:247]
ds_read_b64_tr_b16 v[218:219], v21 offset:34816
ds_read_b64_tr_b16 v[220:221], v21 offset:45056
v_mfma_f32_16x16x32_bf16 v[244:247], v[196:199], a[92:95], v[244:247]
s_waitcnt lgkmcnt(7)
ds_read_b64_tr_b16 v[222:223], v21 offset:47104
v_mfma_f32_16x16x32_bf16 v[248:251], v[200:203], a[80:83], v[248:251]
ds_read_b64_tr_b16 v[184:185], v22 offset:32768
v_mfma_f32_16x16x32_bf16 v[248:251], v[204:207], a[88:91], v[248:251]
buffer_load_dwordx4 a[152:155], v45, s[12:15], s3 offen offset:1024 sc1
v_mfma_f32_16x16x32_bf16 v[252:255], v[200:203], a[84:87], v[252:255]
ds_read_b64_tr_b16 v[186:187], v22 offset:34816
ds_read_b64_tr_b16 v[188:189], v22 offset:45056
v_mfma_f32_16x16x32_bf16 v[252:255], v[204:207], a[92:95], v[252:255]
s_waitcnt lgkmcnt(7)
ds_read_b64_tr_b16 v[190:191], v22 offset:47104
v_mfma_f32_16x16x32_bf16 v[88:91], v[208:211], a[80:83], v[88:91]
s_add_u32 s6, s62, 147456
ds_read_b64_tr_b16 v[192:193], v23 offset:32768
v_mfma_f32_16x16x32_bf16 v[88:91], v[212:215], a[88:91], v[88:91]
buffer_load_dwordx4 a[156:159], v46, s[12:15], s3 offen offset:1024 sc1
v_mfma_f32_16x16x32_bf16 v[92:95], v[208:211], a[84:87], v[92:95]
ds_read_b64_tr_b16 v[194:195], v23 offset:34816
ds_read_b64_tr_b16 v[196:197], v23 offset:45056
v_mfma_f32_16x16x32_bf16 v[92:95], v[212:215], a[92:95], v[92:95]
s_waitcnt lgkmcnt(7)
ds_read_b64_tr_b16 v[198:199], v23 offset:47104
v_mfma_f32_16x16x32_bf16 v[96:99], v[216:219], a[80:83], v[96:99]
s_waitcnt vmcnt(32)
s_barrier
v_mfma_f32_16x16x32_bf16 v[96:99], v[220:223], a[88:91], v[96:99]
ds_read_b64_tr_b16 v[200:201], v12 offset:0
v_mfma_f32_16x16x32_bf16 v[100:103], v[216:219], a[84:87], v[100:103]
ds_read_b64_tr_b16 v[202:203], v12 offset:2048
ds_read_b64_tr_b16 v[204:205], v12 offset:12288
v_mfma_f32_16x16x32_bf16 v[100:103], v[220:223], a[92:95], v[100:103]
s_waitcnt lgkmcnt(7)
ds_read_b64_tr_b16 v[206:207], v12 offset:14336
v_mfma_f32_16x16x32_bf16 v[104:107], v[184:187], a[80:83], v[104:107]
s_add_u32 m0, s17, 98304
ds_read_b64_tr_b16 v[208:209], v13 offset:0
v_mfma_f32_16x16x32_bf16 v[104:107], v[188:191], a[88:91], v[104:107]
buffer_load_dwordx4 v3, s[28:31], s6 offen offset:0 lds
v_mfma_f32_16x16x32_bf16 v[108:111], v[184:187], a[84:87], v[108:111]
ds_read_b64_tr_b16 v[210:211], v13 offset:2048
ds_read_b64_tr_b16 v[212:213], v13 offset:12288
v_mfma_f32_16x16x32_bf16 v[108:111], v[188:191], a[92:95], v[108:111]
s_waitcnt lgkmcnt(7)
ds_read_b64_tr_b16 v[214:215], v13 offset:14336
v_mfma_f32_16x16x32_bf16 v[112:115], v[192:195], a[80:83], v[112:115]
s_add_u32 m0, s17, 102272
ds_read_b64_tr_b16 v[216:217], v14 offset:0
v_mfma_f32_16x16x32_bf16 v[112:115], v[196:199], a[88:91], v[112:115]
buffer_load_dwordx4 v3, s[28:31], s6 offen offset:128 lds
v_mfma_f32_16x16x32_bf16 v[116:119], v[192:195], a[84:87], v[116:119]
ds_read_b64_tr_b16 v[218:219], v14 offset:2048
ds_read_b64_tr_b16 v[220:221], v14 offset:12288
v_mfma_f32_16x16x32_bf16 v[116:119], v[196:199], a[92:95], v[116:119]
s_waitcnt lgkmcnt(7)
ds_read_b64_tr_b16 v[222:223], v14 offset:14336
v_mfma_f32_16x16x32_bf16 v[56:59], v[200:203], a[96:99], v[56:59]
s_add_u32 m0, s17, 106240
ds_read_b64_tr_b16 v[184:185], v15 offset:0
v_mfma_f32_16x16x32_bf16 v[56:59], v[204:207], a[104:107], v[56:59]
buffer_load_dwordx4 v3, s[28:31], s6 offen offset:256 lds
v_mfma_f32_16x16x32_bf16 v[60:63], v[200:203], a[100:103], v[60:63]
ds_read_b64_tr_b16 v[186:187], v15 offset:2048
ds_read_b64_tr_b16 v[188:189], v15 offset:12288
v_mfma_f32_16x16x32_bf16 v[60:63], v[204:207], a[108:111], v[60:63]
s_waitcnt lgkmcnt(7)
ds_read_b64_tr_b16 v[190:191], v15 offset:14336
v_mfma_f32_16x16x32_bf16 v[64:67], v[208:211], a[96:99], v[64:67]
ds_read_b64_tr_b16 v[192:193], v12 offset:4096
v_mfma_f32_16x16x32_bf16 v[64:67], v[212:215], a[104:107], v[64:67]
s_waitcnt vmcnt(16)
v_cmp_ne_u32 vcc, s76, v55
s_nop 1
s_cbranch_vccnz slow_f3
back_f3:
v_mfma_f32_16x16x32_bf16 v[68:71], v[208:211], a[100:103], v[68:71]
ds_read_b64_tr_b16 v[194:195], v12 offset:6144
ds_read_b64_tr_b16 v[196:197], v12 offset:16384
v_mfma_f32_16x16x32_bf16 v[68:71], v[212:215], a[108:111], v[68:71]
s_waitcnt lgkmcnt(7)
ds_read_b64_tr_b16 v[198:199], v12 offset:18432
v_mfma_f32_16x16x32_bf16 v[72:75], v[216:219], a[96:99], v[72:75]
s_add_u32 s3, s60, 4096
ds_read_b64_tr_b16 v[200:201], v13 offset:4096
v_mfma_f32_16x16x32_bf16 v[72:75], v[220:223], a[104:107], v[72:75]
buffer_load_dwordx4 a[160:163], v45, s[12:15], s3 offen offset:0 sc1
v_mfma_f32_16x16x32_bf16 v[76:79], v[216:219], a[100:103], v[76:79]
ds_read_b64_tr_b16 v[202:203], v13 offset:6144
ds_read_b64_tr_b16 v[204:205], v13 offset:16384
v_mfma_f32_16x16x32_bf16 v[76:79], v[220:223], a[108:111], v[76:79]
s_waitcnt lgkmcnt(7)
ds_read_b64_tr_b16 v[206:207], v13 offset:18432
v_mfma_f32_16x16x32_bf16 v[80:83], v[184:187], a[96:99], v[80:83]
s_add_u32 s6, s62, 184320
ds_read_b64_tr_b16 v[208:209], v14 offset:4096
v_mfma_f32_16x16x32_bf16 v[80:83], v[188:191], a[104:107], v[80:83]
buffer_load_dwordx4 a[164:167], v46, s[12:15], s3 offen offset:0 sc1
v_mfma_f32_16x16x32_bf16 v[84:87], v[184:187], a[100:103], v[84:87]
ds_read_b64_tr_b16 v[210:211], v14 offset:6144
ds_read_b64_tr_b16 v[212:213], v14 offset:16384
v_mfma_f32_16x16x32_bf16 v[84:87], v[188:191], a[108:111], v[84:87]
s_waitcnt lgkmcnt(7)
ds_read_b64_tr_b16 v[214:215], v14 offset:18432
v_mfma_f32_16x16x32_bf16 v[224:227], v[192:195], a[96:99], v[224:227]
s_add_u32 m0, s17, 110592
ds_read_b64_tr_b16 v[216:217], v15 offset:4096
v_mfma_f32_16x16x32_bf16 v[224:227], v[196:199], a[104:107], v[224:227]
buffer_load_dwordx4 v3, s[28:31], s6 offen offset:0 lds
v_mfma_f32_16x16x32_bf16 v[228:231], v[192:195], a[100:103], v[228:231]
ds_read_b64_tr_b16 v[218:219], v15 offset:6144
ds_read_b64_tr_b16 v[220:221], v15 offset:16384
v_mfma_f32_16x16x32_bf16 v[228:231], v[196:199], a[108:111], v[228:231]
s_waitcnt lgkmcnt(7)
ds_read_b64_tr_b16 v[222:223], v15 offset:18432
v_mfma_f32_16x16x32_bf16 v[232:235], v[200:203], a[96:99], v[232:235]
s_add_u32 m0, s17, 114560
ds_read_b64_tr_b16 v[184:185], v12 offset:8192
v_mfma_f32_16x16x32_bf16 v[232:235], v[204:207], a[104:107], v[232:235]
buffer_load_dwordx4 v3, s[28:31], s6 offen offset:128 lds
v_mfma_f32_16x16x32_bf16 v[236:239], v[200:203], a[100:103], v[236:239]
ds_read_b64_tr_b16 v[186:187], v12 offset:10240
ds_read_b64_tr_b16 v[188:189], v12 offset:20480
v_mfma_f32_16x16x32_bf16 v[236:239], v[204:207], a[108:111], v[236:239]
s_waitcnt lgkmcnt(7)
ds_read_b64_tr_b16 v[190:191], v12 offset:22528
v_mfma_f32_16x16x32_bf16 v[240:243], v[208:211], a[96:99], v[240:243]
s_add_u32 m0, s17, 118528
ds_read_b64_tr_b16 v[192:193], v13 offset:8192
v_mfma_f32_16x16x32_bf16 v[240:243], v[212:215], a[104:107], v[240:243]
buffer_load_dwordx4 v3, s[28:31], s6 offen offset:256 lds
v_mfma_f32_16x16x32_bf16 v[244:247], v[208:211], a[100:103], v[244:247]
ds_read_b64_tr_b16 v[194:195], v13 offset:10240
ds_read_b64_tr_b16 v[196:197], v13 offset:20480
v_mfma_f32_16x16x32_bf16 v[244:247], v[212:215], a[108:111], v[244:247]
s_waitcnt lgkmcnt(7)
ds_read_b64_tr_b16 v[198:199], v13 offset:22528
v_mfma_f32_16x16x32_bf16 v[248:251], v[216:219], a[96:99], v[248:251]
ds_read_b64_tr_b16 v[200:201], v14 offset:8192
v_mfma_f32_16x16x32_bf16 v[248:251], v[220:223], a[104:107], v[248:251]
buffer_load_dwordx4 a[168:171], v45, s[12:15], s3 offen offset:1024 sc1
v_mfma_f32_16x16x32_bf16 v[252:255], v[216:219], a[100:103], v[252:255]
ds_read_b64_tr_b16 v[202:203], v14 offset:10240
ds_read_b64_tr_b16 v[204:205], v14 offset:20480
v_mfma_f32_16x16x32_bf16 v[252:255], v[220:223], a[108:111], v[252:255]
s_waitcnt lgkmcnt(7)
ds_read_b64_tr_b16 v[206:207], v14 offset:22528
v_mfma_f32_16x16x32_bf16 v[88:91], v[184:187], a[96:99], v[88:91]
s_add_u32 s6, s62, 368640
ds_read_b64_tr_b16 v[208:209], v15 offset:8192
v_mfma_f32_16x16x32_bf16 v[88:91], v[188:191], a[104:107], v[88:91]
buffer_load_dwordx4 a[172:175], v46, s[12:15], s3 offen offset:1024 sc1
v_mfma_f32_16x16x32_bf16 v[92:95], v[184:187], a[100:103], v[92:95]
ds_read_b64_tr_b16 v[210:211], v15 offset:10240
ds_read_b64_tr_b16 v[212:213], v15 offset:20480
v_mfma_f32_16x16x32_bf16 v[92:95], v[188:191], a[108:111], v[92:95]
s_waitcnt lgkmcnt(7)
ds_read_b64_tr_b16 v[214:215], v15 offset:22528
v_mfma_f32_16x16x32_bf16 v[96:99], v[192:195], a[96:99], v[96:99]
s_barrier
v_mfma_f32_16x16x32_bf16 v[96:99], v[196:199], a[104:107], v[96:99]
ds_read_b64_tr_b16 v[216:217], v12 offset:24576
v_mfma_f32_16x16x32_bf16 v[100:103], v[192:195], a[100:103], v[100:103]
ds_read_b64_tr_b16 v[218:219], v12 offset:26624
ds_read_b64_tr_b16 v[220:221], v12 offset:36864
v_mfma_f32_16x16x32_bf16 v[100:103], v[196:199], a[108:111], v[100:103]
s_waitcnt lgkmcnt(7)
ds_read_b64_tr_b16 v[222:223], v12 offset:38912
v_mfma_f32_16x16x32_bf16 v[104:107], v[200:203], a[96:99], v[104:107]
s_add_u32 m0, s17, 122880
ds_read_b64_tr_b16 v[184:185], v13 offset:24576
v_mfma_f32_16x16x32_bf16 v[104:107], v[204:207], a[104:107], v[104:107]
buffer_load_dwordx4 v3, s[28:31], s6 offen offset:0 lds
v_mfma_f32_16x16x32_bf16 v[108:111], v[200:203], a[100:103], v[108:111]
ds_read_b64_tr_b16 v[186:187], v13 offset:26624
ds_read_b64_tr_b16 v[188:189], v13 offset:36864
v_mfma_f32_16x16x32_bf16 v[108:111], v[204:207], a[108:111], v[108:111]
s_waitcnt lgkmcnt(7)
ds_read_b64_tr_b16 v[190:191], v13 offset:38912
v_mfma_f32_16x16x32_bf16 v[112:115], v[208:211], a[96:99], v[112:115]
s_add_u32 m0, s17, 126848
ds_read_b64_tr_b16 v[192:193], v14 offset:24576
v_mfma_f32_16x16x32_bf16 v[112:115], v[212:215], a[104:107], v[112:115]
buffer_load_dwordx4 v3, s[28:31], s6 offen offset:128 lds
v_mfma_f32_16x16x32_bf16 v[116:119], v[208:211], a[100:103], v[116:119]
ds_read_b64_tr_b16 v[194:195], v14 offset:26624
ds_read_b64_tr_b16 v[196:197], v14 offset:36864
v_mfma_f32_16x16x32_bf16 v[116:119], v[212:215], a[108:111], v[116:119]
s_waitcnt lgkmcnt(7)
ds_read_b64_tr_b16 v[198:199], v14 offset:38912
v_mfma_f32_16x16x32_bf16 v[56:59], v[216:219], a[112:115], v[56:59]
s_add_u32 m0, s17, 130816
ds_read_b64_tr_b16 v[200:201], v15 offset:24576
v_mfma_f32_16x16x32_bf16 v[56:59], v[220:223], a[120:123], v[56:59]
buffer_load_dwordx4 v3, s[28:31], s6 offen offset:256 lds
v_mfma_f32_16x16x32_bf16 v[60:63], v[216:219], a[116:119], v[60:63]
ds_read_b64_tr_b16 v[202:203], v15 offset:26624
ds_read_b64_tr_b16 v[204:205], v15 offset:36864
v_mfma_f32_16x16x32_bf16 v[60:63], v[220:223], a[124:127], v[60:63]
s_waitcnt lgkmcnt(7)
ds_read_b64_tr_b16 v[206:207], v15 offset:38912
v_mfma_f32_16x16x32_bf16 v[64:67], v[184:187], a[112:115], v[64:67]
s_add_u32 s3, s60, 10240
ds_read_b64_tr_b16 v[208:209], v12 offset:28672
v_mfma_f32_16x16x32_bf16 v[64:67], v[188:191], a[120:123], v[64:67]
buffer_load_dwordx4 a[176:179], v45, s[12:15], s3 offen offset:0 sc1
v_mfma_f32_16x16x32_bf16 v[68:71], v[184:187], a[116:119], v[68:71]
ds_read_b64_tr_b16 v[210:211], v12 offset:30720
ds_read_b64_tr_b16 v[212:213], v12 offset:40960
v_mfma_f32_16x16x32_bf16 v[68:71], v[188:191], a[124:127], v[68:71]
s_waitcnt lgkmcnt(7)
ds_read_b64_tr_b16 v[214:215], v12 offset:43008
v_mfma_f32_16x16x32_bf16 v[72:75], v[192:195], a[112:115], v[72:75]
s_add_u32 s6, s62, 405504
ds_read_b64_tr_b16 v[216:217], v13 offset:28672
v_mfma_f32_16x16x32_bf16 v[72:75], v[196:199], a[120:123], v[72:75]
buffer_load_dwordx4 a[180:183], v46, s[12:15], s3 offen offset:0 sc1
v_mfma_f32_16x16x32_bf16 v[76:79], v[192:195], a[116:119], v[76:79]
ds_read_b64_tr_b16 v[218:219], v13 offset:30720
ds_read_b64_tr_b16 v[220:221], v13 offset:40960
v_mfma_f32_16x16x32_bf16 v[76:79], v[196:199], a[124:127], v[76:79]
s_waitcnt lgkmcnt(7)
ds_read_b64_tr_b16 v[222:223], v13 offset:43008
v_mfma_f32_16x16x32_bf16 v[80:83], v[200:203], a[112:115], v[80:83]
s_add_u32 m0, s17, 135168
ds_read_b64_tr_b16 v[184:185], v14 offset:28672
v_mfma_f32_16x16x32_bf16 v[80:83], v[204:207], a[120:123], v[80:83]
buffer_load_dwordx4 v3, s[28:31], s6 offen offset:0 lds
v_mfma_f32_16x16x32_bf16 v[84:87], v[200:203], a[116:119], v[84:87]
ds_read_b64_tr_b16 v[186:187], v14 offset:30720
ds_read_b64_tr_b16 v[188:189], v14 offset:40960
v_mfma_f32_16x16x32_bf16 v[84:87], v[204:207], a[124:127], v[84:87]
s_waitcnt lgkmcnt(7)
ds_read_b64_tr_b16 v[190:191], v14 offset:43008
v_mfma_f32_16x16x32_bf16 v[224:227], v[208:211], a[112:115], v[224:227]
s_add_u32 m0, s17, 139136
ds_read_b64_tr_b16 v[192:193], v15 offset:28672
v_mfma_f32_16x16x32_bf16 v[224:227], v[212:215], a[120:123], v[224:227]
buffer_load_dwordx4 v3, s[28:31], s6 offen offset:128 lds
v_mfma_f32_16x16x32_bf16 v[228:231], v[208:211], a[116:119], v[228:231]
ds_read_b64_tr_b16 v[194:195], v15 offset:30720
ds_read_b64_tr_b16 v[196:197], v15 offset:40960
v_mfma_f32_16x16x32_bf16 v[228:231], v[212:215], a[124:127], v[228:231]
s_waitcnt lgkmcnt(7)
ds_read_b64_tr_b16 v[198:199], v15 offset:43008
v_mfma_f32_16x16x32_bf16 v[232:235], v[216:219], a[112:115], v[232:235]
s_add_u32 m0, s17, 143104
ds_read_b64_tr_b16 v[200:201], v12 offset:32768
v_mfma_f32_16x16x32_bf16 v[232:235], v[220:223], a[120:123], v[232:235]
buffer_load_dwordx4 v3, s[28:31], s6 offen offset:256 lds
v_mfma_f32_16x16x32_bf16 v[236:239], v[216:219], a[116:119], v[236:239]
ds_read_b64_tr_b16 v[202:203], v12 offset:34816
ds_read_b64_tr_b16 v[204:205], v12 offset:45056
v_mfma_f32_16x16x32_bf16 v[236:239], v[220:223], a[124:127], v[236:239]
s_waitcnt lgkmcnt(7)
ds_read_b64_tr_b16 v[206:207], v12 offset:47104
v_mfma_f32_16x16x32_bf16 v[240:243], v[184:187], a[112:115], v[240:243]
ds_read_b64_tr_b16 v[208:209], v13 offset:32768
v_mfma_f32_16x16x32_bf16 v[240:243], v[188:191], a[120:123], v[240:243]
buffer_load_dwordx4 a[184:187], v45, s[12:15], s3 offen offset:1024 sc1
v_mfma_f32_16x16x32_bf16 v[244:247], v[184:187], a[116:119], v[244:247]
ds_read_b64_tr_b16 v[210:211], v13 offset:34816
ds_read_b64_tr_b16 v[212:213], v13 offset:45056
v_mfma_f32_16x16x32_bf16 v[244:247], v[188:191], a[124:127], v[244:247]
s_waitcnt lgkmcnt(7)
ds_read_b64_tr_b16 v[214:215], v13 offset:47104
v_mfma_f32_16x16x32_bf16 v[248:251], v[192:195], a[112:115], v[248:251]
s_add_u32 s6, s62, 589824
ds_read_b64_tr_b16 v[216:217], v14 offset:32768
v_mfma_f32_16x16x32_bf16 v[248:251], v[196:199], a[120:123], v[248:251]
buffer_load_dwordx4 a[188:191], v46, s[12:15], s3 offen offset:1024 sc1
v_mfma_f32_16x16x32_bf16 v[252:255], v[192:195], a[116:119], v[252:255]
ds_read_b64_tr_b16 v[218:219], v14 offset:34816
ds_read_b64_tr_b16 v[220:221], v14 offset:45056
v_mfma_f32_16x16x32_bf16 v[252:255], v[196:199], a[124:127], v[252:255]
s_waitcnt lgkmcnt(7)
ds_read_b64_tr_b16 v[222:223], v14 offset:47104
v_mfma_f32_16x16x32_bf16 v[88:91], v[200:203], a[112:115], v[88:91]
ds_read_b64_tr_b16 v[184:185], v15 offset:32768
v_mfma_f32_16x16x32_bf16 v[88:91], v[204:207], a[120:123], v[88:91]
ds_read_b64_tr_b16 v[186:187], v15 offset:34816
v_mfma_f32_16x16x32_bf16 v[92:95], v[200:203], a[116:119], v[92:95]
ds_read_b64_tr_b16 v[188:189], v15 offset:45056
v_mfma_f32_16x16x32_bf16 v[92:95], v[204:207], a[124:127], v[92:95]
s_waitcnt lgkmcnt(7)
ds_read_b64_tr_b16 v[190:191], v15 offset:47104
v_mfma_f32_16x16x32_bf16 v[96:99], v[208:211], a[112:115], v[96:99]
s_waitcnt vmcnt(30)
s_barrier
v_mfma_f32_16x16x32_bf16 v[96:99], v[212:215], a[120:123], v[96:99]
ds_read_b64_tr_b16 v[192:193], v16 offset:0
v_mfma_f32_16x16x32_bf16 v[100:103], v[208:211], a[116:119], v[100:103]
ds_read_b64_tr_b16 v[194:195], v16 offset:2048
ds_read_b64_tr_b16 v[196:197], v16 offset:12288
v_mfma_f32_16x16x32_bf16 v[100:103], v[212:215], a[124:127], v[100:103]
s_waitcnt lgkmcnt(7)
ds_read_b64_tr_b16 v[198:199], v16 offset:14336
v_mfma_f32_16x16x32_bf16 v[104:107], v[216:219], a[112:115], v[104:107]
s_add_u32 m0, s17, 0
ds_read_b64_tr_b16 v[200:201], v17 offset:0
v_mfma_f32_16x16x32_bf16 v[104:107], v[220:223], a[120:123], v[104:107]
buffer_load_dwordx4 v3, s[28:31], s6 offen offset:0 lds
v_mfma_f32_16x16x32_bf16 v[108:111], v[216:219], a[116:119], v[108:111]
ds_read_b64_tr_b16 v[202:203], v17 offset:2048
ds_read_b64_tr_b16 v[204:205], v17 offset:12288
v_mfma_f32_16x16x32_bf16 v[108:111], v[220:223], a[124:127], v[108:111]
s_waitcnt lgkmcnt(7)
ds_read_b64_tr_b16 v[206:207], v17 offset:14336
v_mfma_f32_16x16x32_bf16 v[112:115], v[184:187], a[112:115], v[112:115]
s_add_u32 m0, s17, 3968
ds_read_b64_tr_b16 v[208:209], v18 offset:0
v_mfma_f32_16x16x32_bf16 v[112:115], v[188:191], a[120:123], v[112:115]
buffer_load_dwordx4 v3, s[28:31], s6 offen offset:128 lds
v_mfma_f32_16x16x32_bf16 v[116:119], v[184:187], a[116:119], v[116:119]
ds_read_b64_tr_b16 v[210:211], v18 offset:2048
ds_read_b64_tr_b16 v[212:213], v18 offset:12288
v_mfma_f32_16x16x32_bf16 v[116:119], v[188:191], a[124:127], v[116:119]
s_waitcnt lgkmcnt(7)
ds_read_b64_tr_b16 v[214:215], v18 offset:14336
v_mfma_f32_16x16x32_bf16 v[56:59], v[192:195], a[128:131], v[56:59]
s_add_u32 m0, s17, 7936
ds_read_b64_tr_b16 v[216:217], v19 offset:0
v_mfma_f32_16x16x32_bf16 v[56:59], v[196:199], a[136:139], v[56:59]
buffer_load_dwordx4 v3, s[28:31], s6 offen offset:256 lds
v_mfma_f32_16x16x32_bf16 v[60:63], v[192:195], a[132:135], v[60:63]
ds_read_b64_tr_b16 v[218:219], v19 offset:2048
ds_read_b64_tr_b16 v[220:221], v19 offset:12288
v_mfma_f32_16x16x32_bf16 v[60:63], v[196:199], a[140:143], v[60:63]
s_waitcnt lgkmcnt(7)
ds_read_b64_tr_b16 v[222:223], v19 offset:14336
v_mfma_f32_16x16x32_bf16 v[64:67], v[200:203], a[128:131], v[64:67]
s_add_u32 s3, s60, 16384
ds_read_b64_tr_b16 v[184:185], v16 offset:4096
v_mfma_f32_16x16x32_bf16 v[64:67], v[204:207], a[136:139], v[64:67]
buffer_load_dwordx4 a[192:195], v45, s[12:15], s3 offen offset:0 sc1
v_mfma_f32_16x16x32_bf16 v[68:71], v[200:203], a[132:135], v[68:71]
ds_read_b64_tr_b16 v[186:187], v16 offset:6144
ds_read_b64_tr_b16 v[188:189], v16 offset:16384
v_mfma_f32_16x16x32_bf16 v[68:71], v[204:207], a[140:143], v[68:71]
s_waitcnt lgkmcnt(7)
ds_read_b64_tr_b16 v[190:191], v16 offset:18432
v_mfma_f32_16x16x32_bf16 v[72:75], v[208:211], a[128:131], v[72:75]
s_add_u32 s6, s62, 626688
ds_read_b64_tr_b16 v[192:193], v17 offset:4096
v_mfma_f32_16x16x32_bf16 v[72:75], v[212:215], a[136:139], v[72:75]
buffer_load_dwordx4 a[196:199], v46, s[12:15], s3 offen offset:0 sc1
v_mfma_f32_16x16x32_bf16 v[76:79], v[208:211], a[132:135], v[76:79]
ds_read_b64_tr_b16 v[194:195], v17 offset:6144
ds_read_b64_tr_b16 v[196:197], v17 offset:16384
v_mfma_f32_16x16x32_bf16 v[76:79], v[212:215], a[140:143], v[76:79]
s_waitcnt lgkmcnt(7)
ds_read_b64_tr_b16 v[198:199], v17 offset:18432
v_mfma_f32_16x16x32_bf16 v[80:83], v[216:219], a[128:131], v[80:83]
s_add_u32 m0, s17, 12288
ds_read_b64_tr_b16 v[200:201], v18 offset:4096
v_mfma_f32_16x16x32_bf16 v[80:83], v[220:223], a[136:139], v[80:83]
buffer_load_dwordx4 v3, s[28:31], s6 offen offset:0 lds
v_mfma_f32_16x16x32_bf16 v[84:87], v[216:219], a[132:135], v[84:87]
ds_read_b64_tr_b16 v[202:203], v18 offset:6144
ds_read_b64_tr_b16 v[204:205], v18 offset:16384
v_mfma_f32_16x16x32_bf16 v[84:87], v[220:223], a[140:143], v[84:87]
s_waitcnt lgkmcnt(7)
ds_read_b64_tr_b16 v[206:207], v18 offset:18432
v_mfma_f32_16x16x32_bf16 v[224:227], v[184:187], a[128:131], v[224:227]
s_add_u32 m0, s17, 16256
ds_read_b64_tr_b16 v[208:209], v19 offset:4096
v_mfma_f32_16x16x32_bf16 v[224:227], v[188:191], a[136:139], v[224:227]
buffer_load_dwordx4 v3, s[28:31], s6 offen offset:128 lds
v_mfma_f32_16x16x32_bf16 v[228:231], v[184:187], a[132:135], v[228:231]
ds_read_b64_tr_b16 v[210:211], v19 offset:6144
ds_read_b64_tr_b16 v[212:213], v19 offset:16384
v_mfma_f32_16x16x32_bf16 v[228:231], v[188:191], a[140:143], v[228:231]
s_waitcnt lgkmcnt(7)
ds_read_b64_tr_b16 v[214:215], v19 offset:18432
v_mfma_f32_16x16x32_bf16 v[232:235], v[192:195], a[128:131], v[232:235]
s_add_u32 m0, s17, 20224
ds_read_b64_tr_b16 v[216:217], v16 offset:8192
v_mfma_f32_16x16x32_bf16 v[232:235], v[196:199], a[136:139], v[232:235]
buffer_load_dwordx4 v3, s[28:31], s6 offen offset:256 lds
v_mfma_f32_16x16x32_bf16 v[236:239], v[192:195], a[132:135], v[236:239]
ds_read_b64_tr_b16 v[218:219], v16 offset:10240
ds_read_b64_tr_b16 v[220:221], v16 offset:20480
v_mfma_f32_16x16x32_bf16 v[236:239], v[196:199], a[140:143], v[236:239]
s_waitcnt lgkmcnt(7)
ds_read_b64_tr_b16 v[222:223], v16 offset:22528
v_mfma_f32_16x16x32_bf16 v[240:243], v[200:203], a[128:131], v[240:243]
ds_read_b64_tr_b16 v[184:185], v17 offset:8192
v_mfma_f32_16x16x32_bf16 v[240:243], v[204:207], a[136:139], v[240:243]
buffer_load_dwordx4 a[200:203], v45, s[12:15], s3 offen offset:1024 sc1
v_mfma_f32_16x16x32_bf16 v[244:247], v[200:203], a[132:135], v[244:247]
ds_read_b64_tr_b16 v[186:187], v17 offset:10240
ds_read_b64_tr_b16 v[188:189], v17 offset:20480
v_mfma_f32_16x16x32_bf16 v[244:247], v[204:207], a[140:143], v[244:247]
s_waitcnt lgkmcnt(7)
ds_read_b64_tr_b16 v[190:191], v17 offset:22528
v_mfma_f32_16x16x32_bf16 v[248:251], v[208:211], a[128:131], v[248:251]
s_add_u32 s6, s62, 811008
ds_read_b64_tr_b16 v[192:193], v18 offset:8192
v_mfma_f32_16x16x32_bf16 v[248:251], v[212:215], a[136:139], v[248:251]
buffer_load_dwordx4 a[204:207], v46, s[12:15], s3 offen offset:1024 sc1
v_mfma_f32_16x16x32_bf16 v[252:255], v[208:211], a[132:135], v[252:255]
ds_read_b64_tr_b16 v[194:195], v18 offset:10240
ds_read_b64_tr_b16 v[196:197], v18 offset:20480
v_mfma_f32_16x16x32_bf16 v[252:255], v[212:215], a[140:143], v[252:255]
s_waitcnt lgkmcnt(7)
ds_read_b64_tr_b16 v[198:199], v18 offset:22528
v_mfma_f32_16x16x32_bf16 v[88:91], v[216:219], a[128:131], v[88:91]
ds_read_b64_tr_b16 v[200:201], v19 offset:8192
v_mfma_f32_16x16x32_bf16 v[88:91], v[220:223], a[136:139], v[88:91]
ds_read_b64_tr_b16 v[202:203], v19 offset:10240
v_mfma_f32_16x16x32_bf16 v[92:95], v[216:219], a[132:135], v[92:95]
ds_read_b64_tr_b16 v[204:205], v19 offset:20480
v_mfma_f32_16x16x32_bf16 v[92:95], v[220:223], a[140:143], v[92:95]
s_waitcnt lgkmcnt(7)
ds_read_b64_tr_b16 v[206:207], v19 offset:22528
v_mfma_f32_16x16x32_bf16 v[96:99], v[184:187], a[128:131], v[96:99]
s_waitcnt vmcnt(30)
s_barrier
v_mfma_f32_16x16x32_bf16 v[96:99], v[188:191], a[136:139], v[96:99]
ds_read_b64_tr_b16 v[208:209], v16 offset:24576
v_mfma_f32_16x16x32_bf16 v[100:103], v[184:187], a[132:135], v[100:103]
ds_read_b64_tr_b16 v[210:211], v16 offset:26624
ds_read_b64_tr_b16 v[212:213], v16 offset:36864
v_mfma_f32_16x16x32_bf16 v[100:103], v[188:191], a[140:143], v[100:103]
s_waitcnt lgkmcnt(7)
ds_read_b64_tr_b16 v[214:215], v16 offset:38912
v_mfma_f32_16x16x32_bf16 v[104:107], v[192:195], a[128:131], v[104:107]
s_add_u32 m0, s17, 24576
ds_read_b64_tr_b16 v[216:217], v17 offset:24576
v_mfma_f32_16x16x32_bf16 v[104:107], v[196:199], a[136:139], v[104:107]
buffer_load_dwordx4 v3, s[28:31], s6 offen offset:0 lds
v_mfma_f32_16x16x32_bf16 v[108:111], v[192:195], a[132:135], v[108:111]
ds_read_b64_tr_b16 v[218:219], v17 offset:26624
ds_read_b64_tr_b16 v[220:221], v17 offset:36864
v_mfma_f32_16x16x32_bf16 v[108:111], v[196:199], a[140:143], v[108:111]
s_waitcnt lgkmcnt(7)
ds_read_b64_tr_b16 v[222:223], v17 offset:38912
v_mfma_f32_16x16x32_bf16 v[112:115], v[200:203], a[128:131], v[112:115]
s_add_u32 m0, s17, 28544
ds_read_b64_tr_b16 v[184:185], v18 offset:24576
v_mfma_f32_16x16x32_bf16 v[112:115], v[204:207], a[136:139], v[112:115]
buffer_load_dwordx4 v3, s[28:31], s6 offen offset:128 lds
v_mfma_f32_16x16x32_bf16 v[116:119], v[200:203], a[132:135], v[116:119]
ds_read_b64_tr_b16 v[186:187], v18 offset:26624
ds_read_b64_tr_b16 v[188:189], v18 offset:36864
v_mfma_f32_16x16x32_bf16 v[116:119], v[204:207], a[140:143], v[116:119]
s_waitcnt lgkmcnt(7)
ds_read_b64_tr_b16 v[190:191], v18 offset:38912
v_mfma_f32_16x16x32_bf16 v[56:59], v[208:211], a[144:147], v[56:59]
s_add_u32 m0, s17, 32512
ds_read_b64_tr_b16 v[192:193], v19 offset:24576
v_mfma_f32_16x16x32_bf16 v[56:59], v[212:215], a[152:155], v[56:59]
buffer_load_dwordx4 v3, s[28:31], s6 offen offset:256 lds
v_mfma_f32_16x16x32_bf16 v[60:63], v[208:211], a[148:151], v[60:63]
ds_read_b64_tr_b16 v[194:195], v19 offset:26624
ds_read_b64_tr_b16 v[196:197], v19 offset:36864
v_mfma_f32_16x16x32_bf16 v[60:63], v[212:215], a[156:159], v[60:63]
s_waitcnt lgkmcnt(7)
ds_read_b64_tr_b16 v[198:199], v19 offset:38912
v_mfma_f32_16x16x32_bf16 v[64:67], v[216:219], a[144:147], v[64:67]
s_add_u32 s3, s60, 22528
ds_read_b64_tr_b16 v[200:201], v16 offset:28672
v_mfma_f32_16x16x32_bf16 v[64:67], v[220:223], a[152:155], v[64:67]
buffer_load_dwordx4 a[208:211], v45, s[12:15], s3 offen offset:0 sc1
v_mfma_f32_16x16x32_bf16 v[68:71], v[216:219], a[148:151], v[68:71]
ds_read_b64_tr_b16 v[202:203], v16 offset:30720
ds_read_b64_tr_b16 v[204:205], v16 offset:40960
v_mfma_f32_16x16x32_bf16 v[68:71], v[220:223], a[156:159], v[68:71]
s_waitcnt lgkmcnt(7)
ds_read_b64_tr_b16 v[206:207], v16 offset:43008
v_mfma_f32_16x16x32_bf16 v[72:75], v[184:187], a[144:147], v[72:75]
s_add_u32 s6, s62, 847872
ds_read_b64_tr_b16 v[208:209], v17 offset:28672
v_mfma_f32_16x16x32_bf16 v[72:75], v[188:191], a[152:155], v[72:75]
buffer_load_dwordx4 a[212:215], v46, s[12:15], s3 offen offset:0 sc1
v_mfma_f32_16x16x32_bf16 v[76:79], v[184:187], a[148:151], v[76:79]
ds_read_b64_tr_b16 v[210:211], v17 offset:30720
ds_read_b64_tr_b16 v[212:213], v17 offset:40960
v_mfma_f32_16x16x32_bf16 v[76:79], v[188:191], a[156:159], v[76:79]
s_waitcnt lgkmcnt(7)
ds_read_b64_tr_b16 v[214:215], v17 offset:43008
v_mfma_f32_16x16x32_bf16 v[80:83], v[192:195], a[144:147], v[80:83]
s_add_u32 m0, s17, 36864
ds_read_b64_tr_b16 v[216:217], v18 offset:28672
v_mfma_f32_16x16x32_bf16 v[80:83], v[196:199], a[152:155], v[80:83]
buffer_load_dwordx4 v3, s[28:31], s6 offen offset:0 lds
v_mfma_f32_16x16x32_bf16 v[84:87], v[192:195], a[148:151], v[84:87]
ds_read_b64_tr_b16 v[218:219], v18 offset:30720
ds_read_b64_tr_b16 v[220:221], v18 offset:40960
v_mfma_f32_16x16x32_bf16 v[84:87], v[196:199], a[156:159], v[84:87]
s_waitcnt lgkmcnt(7)
ds_read_b64_tr_b16 v[222:223], v18 offset:43008
v_mfma_f32_16x16x32_bf16 v[224:227], v[200:203], a[144:147], v[224:227]
s_add_u32 m0, s17, 40832
ds_read_b64_tr_b16 v[184:185], v19 offset:28672
v_mfma_f32_16x16x32_bf16 v[224:227], v[204:207], a[152:155], v[224:227]
buffer_load_dwordx4 v3, s[28:31], s6 offen offset:128 lds
v_mfma_f32_16x16x32_bf16 v[228:231], v[200:203], a[148:151], v[228:231]
ds_read_b64_tr_b16 v[186:187], v19 offset:30720
ds_read_b64_tr_b16 v[188:189], v19 offset:40960
v_mfma_f32_16x16x32_bf16 v[228:231], v[204:207], a[156:159], v[228:231]
s_waitcnt lgkmcnt(7)
ds_read_b64_tr_b16 v[190:191], v19 offset:43008
v_mfma_f32_16x16x32_bf16 v[232:235], v[208:211], a[144:147], v[232:235]
s_add_u32 m0, s17, 44800
ds_read_b64_tr_b16 v[192:193], v16 offset:32768
v_mfma_f32_16x16x32_bf16 v[232:235], v[212:215], a[152:155], v[232:235]
buffer_load_dwordx4 v3, s[28:31], s6 offen offset:256 lds
v_mfma_f32_16x16x32_bf16 v[236:239], v[208:211], a[148:151], v[236:239]
ds_read_b64_tr_b16 v[194:195], v16 offset:34816
ds_read_b64_tr_b16 v[196:197], v16 offset:45056
v_mfma_f32_16x16x32_bf16 v[236:239], v[212:215], a[156:159], v[236:239]
s_waitcnt lgkmcnt(7)
ds_read_b64_tr_b16 v[198:199], v16 offset:47104
v_mfma_f32_16x16x32_bf16 v[240:243], v[216:219], a[144:147], v[240:243]
ds_read_b64_tr_b16 v[200:201], v17 offset:32768
v_mfma_f32_16x16x32_bf16 v[240:243], v[220:223], a[152:155], v[240:243]
buffer_load_dwordx4 a[216:219], v45, s[12:15], s3 offen offset:1024 sc1
v_mfma_f32_16x16x32_bf16 v[244:247], v[216:219], a[148:151], v[244:247]
ds_read_b64_tr_b16 v[202:203], v17 offset:34816
ds_read_b64_tr_b16 v[204:205], v17 offset:45056
v_mfma_f32_16x16x32_bf16 v[244:247], v[220:223], a[156:159], v[244:247]
s_waitcnt lgkmcnt(7)
ds_read_b64_tr_b16 v[206:207], v17 offset:47104
v_mfma_f32_16x16x32_bf16 v[248:251], v[184:187], a[144:147], v[248:251]
s_add_u32 s6, s62, 1032192
ds_read_b64_tr_b16 v[208:209], v18 offset:32768
v_mfma_f32_16x16x32_bf16 v[248:251], v[188:191], a[152:155], v[248:251]
buffer_load_dwordx4 a[220:223], v46, s[12:15], s3 offen offset:1024 sc1
v_mfma_f32_16x16x32_bf16 v[252:255], v[184:187], a[148:151], v[252:255]
ds_read_b64_tr_b16 v[210:211], v18 offset:34816
ds_read_b64_tr_b16 v[212:213], v18 offset:45056
v_mfma_f32_16x16x32_bf16 v[252:255], v[188:191], a[156:159], v[252:255]
s_waitcnt lgkmcnt(7)
ds_read_b64_tr_b16 v[214:215], v18 offset:47104
v_mfma_f32_16x16x32_bf16 v[88:91], v[192:195], a[144:147], v[88:91]
ds_read_b64_tr_b16 v[216:217], v19 offset:32768
v_mfma_f32_16x16x32_bf16 v[88:91], v[196:199], a[152:155], v[88:91]
ds_read_b64_tr_b16 v[218:219], v19 offset:34816
v_mfma_f32_16x16x32_bf16 v[92:95], v[192:195], a[148:151], v[92:95]
ds_read_b64_tr_b16 v[220:221], v19 offset:45056
v_mfma_f32_16x16x32_bf16 v[92:95], v[196:199], a[156:159], v[92:95]
s_waitcnt lgkmcnt(7)
ds_read_b64_tr_b16 v[222:223], v19 offset:47104
v_mfma_f32_16x16x32_bf16 v[96:99], v[200:203], a[144:147], v[96:99]
s_waitcnt vmcnt(30)
s_barrier
v_mfma_f32_16x16x32_bf16 v[96:99], v[204:207], a[152:155], v[96:99]
ds_read_b64_tr_b16 v[184:185], v20 offset:0
v_mfma_f32_16x16x32_bf16 v[100:103], v[200:203], a[148:151], v[100:103]
ds_read_b64_tr_b16 v[186:187], v20 offset:2048
ds_read_b64_tr_b16 v[188:189], v20 offset:12288
v_mfma_f32_16x16x32_bf16 v[100:103], v[204:207], a[156:159], v[100:103]
s_waitcnt lgkmcnt(7)
ds_read_b64_tr_b16 v[190:191], v20 offset:14336
v_mfma_f32_16x16x32_bf16 v[104:107], v[208:211], a[144:147], v[104:107]
s_add_u32 m0, s17, 49152
ds_read_b64_tr_b16 v[192:193], v21 offset:0
v_mfma_f32_16x16x32_bf16 v[104:107], v[212:215], a[152:155], v[104:107]
buffer_load_dwordx4 v3, s[28:31], s6 offen offset:0 lds
v_mfma_f32_16x16x32_bf16 v[108:111], v[208:211], a[148:151], v[108:111]
ds_read_b64_tr_b16 v[194:195], v21 offset:2048
ds_read_b64_tr_b16 v[196:197], v21 offset:12288
v_mfma_f32_16x16x32_bf16 v[108:111], v[212:215], a[156:159], v[108:111]
s_waitcnt lgkmcnt(7)
ds_read_b64_tr_b16 v[198:199], v21 offset:14336
v_mfma_f32_16x16x32_bf16 v[112:115], v[216:219], a[144:147], v[112:115]
s_add_u32 m0, s17, 53120
ds_read_b64_tr_b16 v[200:201], v22 offset:0
v_mfma_f32_16x16x32_bf16 v[112:115], v[220:223], a[152:155], v[112:115]
buffer_load_dwordx4 v3, s[28:31], s6 offen offset:128 lds
v_mfma_f32_16x16x32_bf16 v[116:119], v[216:219], a[148:151], v[116:119]
ds_read_b64_tr_b16 v[202:203], v22 offset:2048
ds_read_b64_tr_b16 v[204:205], v22 offset:12288
v_mfma_f32_16x16x32_bf16 v[116:119], v[220:223], a[156:159], v[116:119]
s_waitcnt lgkmcnt(7)
ds_read_b64_tr_b16 v[206:207], v22 offset:14336
v_mfma_f32_16x16x32_bf16 v[56:59], v[184:187], a[160:163], v[56:59]
s_add_u32 m0, s17, 57088
ds_read_b64_tr_b16 v[208:209], v23 offset:0
v_mfma_f32_16x16x32_bf16 v[56:59], v[188:191], a[168:171], v[56:59]
buffer_load_dwordx4 v3, s[28:31], s6 offen offset:256 lds
v_mfma_f32_16x16x32_bf16 v[60:63], v[184:187], a[164:167], v[60:63]
ds_read_b64_tr_b16 v[210:211], v23 offset:2048
ds_read_b64_tr_b16 v[212:213], v23 offset:12288
v_mfma_f32_16x16x32_bf16 v[60:63], v[188:191], a[172:175], v[60:63]
s_waitcnt lgkmcnt(7)
ds_read_b64_tr_b16 v[214:215], v23 offset:14336
v_mfma_f32_16x16x32_bf16 v[64:67], v[192:195], a[160:163], v[64:67]
s_add_u32 s3, s60, 28672
ds_read_b64_tr_b16 v[216:217], v20 offset:4096
v_mfma_f32_16x16x32_bf16 v[64:67], v[196:199], a[168:171], v[64:67]
buffer_load_dwordx4 a[224:227], v45, s[12:15], s3 offen offset:0 sc1
v_mfma_f32_16x16x32_bf16 v[68:71], v[192:195], a[164:167], v[68:71]
ds_read_b64_tr_b16 v[218:219], v20 offset:6144
ds_read_b64_tr_b16 v[220:221], v20 offset:16384
v_mfma_f32_16x16x32_bf16 v[68:71], v[196:199], a[172:175], v[68:71]
s_waitcnt lgkmcnt(7)
ds_read_b64_tr_b16 v[222:223], v20 offset:18432
v_mfma_f32_16x16x32_bf16 v[72:75], v[200:203], a[160:163], v[72:75]
s_add_u32 s6, s62, 1069056
ds_read_b64_tr_b16 v[184:185], v21 offset:4096
v_mfma_f32_16x16x32_bf16 v[72:75], v[204:207], a[168:171], v[72:75]
buffer_load_dwordx4 a[228:231], v46, s[12:15], s3 offen offset:0 sc1
v_mfma_f32_16x16x32_bf16 v[76:79], v[200:203], a[164:167], v[76:79]
ds_read_b64_tr_b16 v[186:187], v21 offset:6144
ds_read_b64_tr_b16 v[188:189], v21 offset:16384
v_mfma_f32_16x16x32_bf16 v[76:79], v[204:207], a[172:175], v[76:79]
s_waitcnt lgkmcnt(7)
ds_read_b64_tr_b16 v[190:191], v21 offset:18432
v_mfma_f32_16x16x32_bf16 v[80:83], v[208:211], a[160:163], v[80:83]
s_add_u32 m0, s17, 61440
ds_read_b64_tr_b16 v[192:193], v22 offset:4096
v_mfma_f32_16x16x32_bf16 v[80:83], v[212:215], a[168:171], v[80:83]
buffer_load_dwordx4 v3, s[28:31], s6 offen offset:0 lds
v_mfma_f32_16x16x32_bf16 v[84:87], v[208:211], a[164:167], v[84:87]
ds_read_b64_tr_b16 v[194:195], v22 offset:6144
ds_read_b64_tr_b16 v[196:197], v22 offset:16384
v_mfma_f32_16x16x32_bf16 v[84:87], v[212:215], a[172:175], v[84:87]
s_waitcnt lgkmcnt(7)
ds_read_b64_tr_b16 v[198:199], v22 offset:18432
v_mfma_f32_16x16x32_bf16 v[224:227], v[216:219], a[160:163], v[224:227]
s_add_u32 m0, s17, 65408
ds_read_b64_tr_b16 v[200:201], v23 offset:4096
v_mfma_f32_16x16x32_bf16 v[224:227], v[220:223], a[168:171], v[224:227]
buffer_load_dwordx4 v3, s[28:31], s6 offen offset:128 lds
v_mfma_f32_16x16x32_bf16 v[228:231], v[216:219], a[164:167], v[228:231]
ds_read_b64_tr_b16 v[202:203], v23 offset:6144
ds_read_b64_tr_b16 v[204:205], v23 offset:16384
v_mfma_f32_16x16x32_bf16 v[228:231], v[220:223], a[172:175], v[228:231]
s_waitcnt lgkmcnt(7)
ds_read_b64_tr_b16 v[206:207], v23 offset:18432
v_mfma_f32_16x16x32_bf16 v[232:235], v[184:187], a[160:163], v[232:235]
s_add_u32 m0, s17, 69376
ds_read_b64_tr_b16 v[208:209], v20 offset:8192
v_mfma_f32_16x16x32_bf16 v[232:235], v[188:191], a[168:171], v[232:235]
buffer_load_dwordx4 v3, s[28:31], s6 offen offset:256 lds
v_mfma_f32_16x16x32_bf16 v[236:239], v[184:187], a[164:167], v[236:239]
ds_read_b64_tr_b16 v[210:211], v20 offset:10240
ds_read_b64_tr_b16 v[212:213], v20 offset:20480
v_mfma_f32_16x16x32_bf16 v[236:239], v[188:191], a[172:175], v[236:239]
s_waitcnt lgkmcnt(7)
ds_read_b64_tr_b16 v[214:215], v20 offset:22528
v_mfma_f32_16x16x32_bf16 v[240:243], v[192:195], a[160:163], v[240:243]
ds_read_b64_tr_b16 v[216:217], v21 offset:8192
v_mfma_f32_16x16x32_bf16 v[240:243], v[196:199], a[168:171], v[240:243]
buffer_load_dwordx4 a[232:235], v45, s[12:15], s3 offen offset:1024 sc1
v_mfma_f32_16x16x32_bf16 v[244:247], v[192:195], a[164:167], v[244:247]
ds_read_b64_tr_b16 v[218:219], v21 offset:10240
ds_read_b64_tr_b16 v[220:221], v21 offset:20480
v_mfma_f32_16x16x32_bf16 v[244:247], v[196:199], a[172:175], v[244:247]
s_waitcnt lgkmcnt(7)
ds_read_b64_tr_b16 v[222:223], v21 offset:22528
v_mfma_f32_16x16x32_bf16 v[248:251], v[200:203], a[160:163], v[248:251]
s_add_u32 s6, s63, 4571136
ds_read_b64_tr_b16 v[184:185], v22 offset:8192
v_mfma_f32_16x16x32_bf16 v[248:251], v[204:207], a[168:171], v[248:251]
buffer_load_dwordx4 a[236:239], v46, s[12:15], s3 offen offset:1024 sc1
v_mfma_f32_16x16x32_bf16 v[252:255], v[200:203], a[164:167], v[252:255]
ds_read_b64_tr_b16 v[186:187], v22 offset:10240
ds_read_b64_tr_b16 v[188:189], v22 offset:20480
v_mfma_f32_16x16x32_bf16 v[252:255], v[204:207], a[172:175], v[252:255]
s_waitcnt lgkmcnt(7)
ds_read_b64_tr_b16 v[190:191], v22 offset:22528
v_mfma_f32_16x16x32_bf16 v[88:91], v[208:211], a[160:163], v[88:91]
ds_read_b64_tr_b16 v[192:193], v23 offset:8192
v_mfma_f32_16x16x32_bf16 v[88:91], v[212:215], a[168:171], v[88:91]
ds_read_b64_tr_b16 v[194:195], v23 offset:10240
v_mfma_f32_16x16x32_bf16 v[92:95], v[208:211], a[164:167], v[92:95]
ds_read_b64_tr_b16 v[196:197], v23 offset:20480
v_mfma_f32_16x16x32_bf16 v[92:95], v[212:215], a[172:175], v[92:95]
s_waitcnt lgkmcnt(7)
ds_read_b64_tr_b16 v[198:199], v23 offset:22528
v_mfma_f32_16x16x32_bf16 v[96:99], v[216:219], a[160:163], v[96:99]
s_waitcnt vmcnt(30)
s_barrier
v_mfma_f32_16x16x32_bf16 v[96:99], v[220:223], a[168:171], v[96:99]
ds_read_b64_tr_b16 v[200:201], v20 offset:24576
v_mfma_f32_16x16x32_bf16 v[100:103], v[216:219], a[164:167], v[100:103]
ds_read_b64_tr_b16 v[202:203], v20 offset:26624
ds_read_b64_tr_b16 v[204:205], v20 offset:36864
v_mfma_f32_16x16x32_bf16 v[100:103], v[220:223], a[172:175], v[100:103]
s_waitcnt lgkmcnt(7)
ds_read_b64_tr_b16 v[206:207], v20 offset:38912
v_mfma_f32_16x16x32_bf16 v[104:107], v[184:187], a[160:163], v[104:107]
s_add_u32 m0, s17, 73728
ds_read_b64_tr_b16 v[208:209], v21 offset:24576
v_mfma_f32_16x16x32_bf16 v[104:107], v[188:191], a[168:171], v[104:107]
buffer_load_dwordx4 v3, s[28:31], s6 offen offset:0 lds
v_mfma_f32_16x16x32_bf16 v[108:111], v[184:187], a[164:167], v[108:111]
ds_read_b64_tr_b16 v[210:211], v21 offset:26624
ds_read_b64_tr_b16 v[212:213], v21 offset:36864
v_mfma_f32_16x16x32_bf16 v[108:111], v[188:191], a[172:175], v[108:111]
s_waitcnt lgkmcnt(7)
ds_read_b64_tr_b16 v[214:215], v21 offset:38912
v_mfma_f32_16x16x32_bf16 v[112:115], v[192:195], a[160:163], v[112:115]
s_add_u32 m0, s17, 77696
ds_read_b64_tr_b16 v[216:217], v22 offset:24576
v_mfma_f32_16x16x32_bf16 v[112:115], v[196:199], a[168:171], v[112:115]
buffer_load_dwordx4 v3, s[28:31], s6 offen offset:128 lds
v_mfma_f32_16x16x32_bf16 v[116:119], v[192:195], a[164:167], v[116:119]
ds_read_b64_tr_b16 v[218:219], v22 offset:26624
ds_read_b64_tr_b16 v[220:221], v22 offset:36864
v_mfma_f32_16x16x32_bf16 v[116:119], v[196:199], a[172:175], v[116:119]
s_waitcnt lgkmcnt(7)
ds_read_b64_tr_b16 v[222:223], v22 offset:38912
v_mfma_f32_16x16x32_bf16 v[56:59], v[200:203], a[176:179], v[56:59]
s_add_u32 m0, s17, 81664
ds_read_b64_tr_b16 v[184:185], v23 offset:24576
v_mfma_f32_16x16x32_bf16 v[56:59], v[204:207], a[184:187], v[56:59]
buffer_load_dwordx4 v3, s[28:31], s6 offen offset:256 lds
v_mfma_f32_16x16x32_bf16 v[60:63], v[200:203], a[180:183], v[60:63]
ds_read_b64_tr_b16 v[186:187], v23 offset:26624
ds_read_b64_tr_b16 v[188:189], v23 offset:36864
v_mfma_f32_16x16x32_bf16 v[60:63], v[204:207], a[188:191], v[60:63]
s_waitcnt lgkmcnt(7)
ds_read_b64_tr_b16 v[190:191], v23 offset:38912
v_mfma_f32_16x16x32_bf16 v[64:67], v[208:211], a[176:179], v[64:67]
s_add_u32 s3, s61, 126976
ds_read_b64_tr_b16 v[192:193], v20 offset:28672
v_mfma_f32_16x16x32_bf16 v[64:67], v[212:215], a[184:187], v[64:67]
buffer_load_dwordx4 a[240:243], v45, s[12:15], s3 offen offset:0 sc1
v_mfma_f32_16x16x32_bf16 v[68:71], v[208:211], a[180:183], v[68:71]
ds_read_b64_tr_b16 v[194:195], v20 offset:30720
ds_read_b64_tr_b16 v[196:197], v20 offset:40960
v_mfma_f32_16x16x32_bf16 v[68:71], v[212:215], a[188:191], v[68:71]
s_waitcnt lgkmcnt(7)
ds_read_b64_tr_b16 v[198:199], v20 offset:43008
v_mfma_f32_16x16x32_bf16 v[72:75], v[216:219], a[176:179], v[72:75]
s_add_u32 s6, s63, 4608000
ds_read_b64_tr_b16 v[200:201], v21 offset:28672
v_mfma_f32_16x16x32_bf16 v[72:75], v[220:223], a[184:187], v[72:75]
buffer_load_dwordx4 a[244:247], v46, s[12:15], s3 offen offset:0 sc1
v_mfma_f32_16x16x32_bf16 v[76:79], v[216:219], a[180:183], v[76:79]
ds_read_b64_tr_b16 v[202:203], v21 offset:30720
ds_read_b64_tr_b16 v[204:205], v21 offset:40960
v_mfma_f32_16x16x32_bf16 v[76:79], v[220:223], a[188:191], v[76:79]
s_waitcnt lgkmcnt(7)
ds_read_b64_tr_b16 v[206:207], v21 offset:43008
v_mfma_f32_16x16x32_bf16 v[80:83], v[184:187], a[176:179], v[80:83]
s_add_u32 m0, s17, 86016
ds_read_b64_tr_b16 v[208:209], v22 offset:28672
v_mfma_f32_16x16x32_bf16 v[80:83], v[188:191], a[184:187], v[80:83]
buffer_load_dwordx4 v3, s[28:31], s6 offen offset:0 lds
v_mfma_f32_16x16x32_bf16 v[84:87], v[184:187], a[180:183], v[84:87]
ds_read_b64_tr_b16 v[210:211], v22 offset:30720
ds_read_b64_tr_b16 v[212:213], v22 offset:40960
v_mfma_f32_16x16x32_bf16 v[84:87], v[188:191], a[188:191], v[84:87]
s_waitcnt lgkmcnt(7)
ds_read_b64_tr_b16 v[214:215], v22 offset:43008
v_mfma_f32_16x16x32_bf16 v[224:227], v[192:195], a[176:179], v[224:227]
s_add_u32 m0, s17, 89984
ds_read_b64_tr_b16 v[216:217], v23 offset:28672
v_mfma_f32_16x16x32_bf16 v[224:227], v[196:199], a[184:187], v[224:227]
buffer_load_dwordx4 v3, s[28:31], s6 offen offset:128 lds
v_mfma_f32_16x16x32_bf16 v[228:231], v[192:195], a[180:183], v[228:231]
ds_read_b64_tr_b16 v[218:219], v23 offset:30720
ds_read_b64_tr_b16 v[220:221], v23 offset:40960
v_mfma_f32_16x16x32_bf16 v[228:231], v[196:199], a[188:191], v[228:231]
s_waitcnt lgkmcnt(7)
ds_read_b64_tr_b16 v[222:223], v23 offset:43008
v_mfma_f32_16x16x32_bf16 v[232:235], v[200:203], a[176:179], v[232:235]
s_add_u32 m0, s17, 93952
ds_read_b64_tr_b16 v[184:185], v20 offset:32768
v_mfma_f32_16x16x32_bf16 v[232:235], v[204:207], a[184:187], v[232:235]
buffer_load_dwordx4 v3, s[28:31], s6 offen offset:256 lds
v_mfma_f32_16x16x32_bf16 v[236:239], v[200:203], a[180:183], v[236:239]
ds_read_b64_tr_b16 v[186:187], v20 offset:34816
ds_read_b64_tr_b16 v[188:189], v20 offset:45056
v_mfma_f32_16x16x32_bf16 v[236:239], v[204:207], a[188:191], v[236:239]
s_waitcnt lgkmcnt(7)
ds_read_b64_tr_b16 v[190:191], v20 offset:47104
v_mfma_f32_16x16x32_bf16 v[240:243], v[208:211], a[176:179], v[240:243]
ds_read_b64_tr_b16 v[192:193], v21 offset:32768
v_mfma_f32_16x16x32_bf16 v[240:243], v[212:215], a[184:187], v[240:243]
buffer_load_dwordx4 a[248:251], v45, s[12:15], s3 offen offset:1024 sc1
v_mfma_f32_16x16x32_bf16 v[244:247], v[208:211], a[180:183], v[244:247]
ds_read_b64_tr_b16 v[194:195], v21 offset:34816
ds_read_b64_tr_b16 v[196:197], v21 offset:45056
v_mfma_f32_16x16x32_bf16 v[244:247], v[212:215], a[188:191], v[244:247]
s_waitcnt lgkmcnt(7)
ds_read_b64_tr_b16 v[198:199], v21 offset:47104
v_mfma_f32_16x16x32_bf16 v[248:251], v[216:219], a[176:179], v[248:251]
ds_read_b64_tr_b16 v[200:201], v22 offset:32768
v_mfma_f32_16x16x32_bf16 v[248:251], v[220:223], a[184:187], v[248:251]
buffer_load_dwordx4 a[252:255], v46, s[12:15], s3 offen offset:1024 sc1
v_mfma_f32_16x16x32_bf16 v[252:255], v[216:219], a[180:183], v[252:255]
ds_read_b64_tr_b16 v[202:203], v22 offset:34816
ds_read_b64_tr_b16 v[204:205], v22 offset:45056
v_mfma_f32_16x16x32_bf16 v[252:255], v[220:223], a[188:191], v[252:255]
s_waitcnt lgkmcnt(7)
ds_read_b64_tr_b16 v[206:207], v22 offset:47104
v_mfma_f32_16x16x32_bf16 v[88:91], v[184:187], a[176:179], v[88:91]
ds_read_b64_tr_b16 v[208:209], v23 offset:32768
v_mfma_f32_16x16x32_bf16 v[88:91], v[188:191], a[184:187], v[88:91]
ds_read_b64_tr_b16 v[210:211], v23 offset:34816
v_mfma_f32_16x16x32_bf16 v[92:95], v[184:187], a[180:183], v[92:95]
ds_read_b64_tr_b16 v[212:213], v23 offset:45056
v_mfma_f32_16x16x32_bf16 v[92:95], v[188:191], a[188:191], v[92:95]
s_waitcnt lgkmcnt(7)
ds_read_b64_tr_b16 v[214:215], v23 offset:47104
v_mfma_f32_16x16x32_bf16 v[96:99], v[192:195], a[176:179], v[96:99]
s_waitcnt vmcnt(30)
s_barrier
v_mfma_f32_16x16x32_bf16 v[96:99], v[196:199], a[184:187], v[96:99]
ds_read_b64_tr_b16 v[216:217], v12 offset:0
v_mfma_f32_16x16x32_bf16 v[100:103], v[192:195], a[180:183], v[100:103]
ds_read_b64_tr_b16 v[218:219], v12 offset:2048
ds_read_b64_tr_b16 v[220:221], v12 offset:12288
v_mfma_f32_16x16x32_bf16 v[100:103], v[196:199], a[188:191], v[100:103]
s_waitcnt lgkmcnt(7)
ds_read_b64_tr_b16 v[222:223], v12 offset:14336
v_mfma_f32_16x16x32_bf16 v[104:107], v[200:203], a[176:179], v[104:107]
ds_read_b64_tr_b16 v[184:185], v13 offset:0
v_mfma_f32_16x16x32_bf16 v[104:107], v[204:207], a[184:187], v[104:107]
ds_read_b64_tr_b16 v[186:187], v13 offset:2048
v_mfma_f32_16x16x32_bf16 v[108:111], v[200:203], a[180:183], v[108:111]
ds_read_b64_tr_b16 v[188:189], v13 offset:12288
v_mfma_f32_16x16x32_bf16 v[108:111], v[204:207], a[188:191], v[108:111]
s_waitcnt lgkmcnt(7)
ds_read_b64_tr_b16 v[190:191], v13 offset:14336
v_mfma_f32_16x16x32_bf16 v[112:115], v[208:211], a[176:179], v[112:115]
ds_read_b64_tr_b16 v[192:193], v14 offset:0
v_mfma_f32_16x16x32_bf16 v[112:115], v[212:215], a[184:187], v[112:115]
ds_read_b64_tr_b16 v[194:195], v14 offset:2048
v_mfma_f32_16x16x32_bf16 v[116:119], v[208:211], a[180:183], v[116:119]
ds_read_b64_tr_b16 v[196:197], v14 offset:12288
v_mfma_f32_16x16x32_bf16 v[116:119], v[212:215], a[188:191], v[116:119]
s_waitcnt lgkmcnt(7)
ds_read_b64_tr_b16 v[198:199], v14 offset:14336
v_mfma_f32_16x16x32_bf16 v[56:59], v[216:219], a[192:195], v[56:59]
ds_read_b64_tr_b16 v[200:201], v15 offset:0
v_mfma_f32_16x16x32_bf16 v[56:59], v[220:223], a[200:203], v[56:59]
ds_read_b64_tr_b16 v[202:203], v15 offset:2048
v_mfma_f32_16x16x32_bf16 v[60:63], v[216:219], a[196:199], v[60:63]
ds_read_b64_tr_b16 v[204:205], v15 offset:12288
v_mfma_f32_16x16x32_bf16 v[60:63], v[220:223], a[204:207], v[60:63]
s_waitcnt lgkmcnt(7)
ds_read_b64_tr_b16 v[206:207], v15 offset:14336
v_mfma_f32_16x16x32_bf16 v[64:67], v[184:187], a[192:195], v[64:67]
ds_read_b64_tr_b16 v[208:209], v12 offset:4096
v_mfma_f32_16x16x32_bf16 v[64:67], v[188:191], a[200:203], v[64:67]
ds_read_b64_tr_b16 v[210:211], v12 offset:6144
v_mfma_f32_16x16x32_bf16 v[68:71], v[184:187], a[196:199], v[68:71]
ds_read_b64_tr_b16 v[212:213], v12 offset:16384
v_mfma_f32_16x16x32_bf16 v[68:71], v[188:191], a[204:207], v[68:71]
s_waitcnt lgkmcnt(7)
ds_read_b64_tr_b16 v[214:215], v12 offset:18432
v_mfma_f32_16x16x32_bf16 v[72:75], v[192:195], a[192:195], v[72:75]
ds_read_b64_tr_b16 v[216:217], v13 offset:4096
v_mfma_f32_16x16x32_bf16 v[72:75], v[196:199], a[200:203], v[72:75]
ds_read_b64_tr_b16 v[218:219], v13 offset:6144
v_mfma_f32_16x16x32_bf16 v[76:79], v[192:195], a[196:199], v[76:79]
ds_read_b64_tr_b16 v[220:221], v13 offset:16384
v_mfma_f32_16x16x32_bf16 v[76:79], v[196:199], a[204:207], v[76:79]
s_waitcnt lgkmcnt(7)
ds_read_b64_tr_b16 v[222:223], v13 offset:18432
v_mfma_f32_16x16x32_bf16 v[80:83], v[200:203], a[192:195], v[80:83]
ds_read_b64_tr_b16 v[184:185], v14 offset:4096
v_mfma_f32_16x16x32_bf16 v[80:83], v[204:207], a[200:203], v[80:83]
ds_read_b64_tr_b16 v[186:187], v14 offset:6144
v_mfma_f32_16x16x32_bf16 v[84:87], v[200:203], a[196:199], v[84:87]
ds_read_b64_tr_b16 v[188:189], v14 offset:16384
v_mfma_f32_16x16x32_bf16 v[84:87], v[204:207], a[204:207], v[84:87]
s_waitcnt lgkmcnt(7)
ds_read_b64_tr_b16 v[190:191], v14 offset:18432
v_mfma_f32_16x16x32_bf16 v[224:227], v[208:211], a[192:195], v[224:227]
ds_read_b64_tr_b16 v[192:193], v15 offset:4096
v_mfma_f32_16x16x32_bf16 v[224:227], v[212:215], a[200:203], v[224:227]
ds_read_b64_tr_b16 v[194:195], v15 offset:6144
v_mfma_f32_16x16x32_bf16 v[228:231], v[208:211], a[196:199], v[228:231]
ds_read_b64_tr_b16 v[196:197], v15 offset:16384
v_mfma_f32_16x16x32_bf16 v[228:231], v[212:215], a[204:207], v[228:231]
s_waitcnt lgkmcnt(7)
ds_read_b64_tr_b16 v[198:199], v15 offset:18432
v_mfma_f32_16x16x32_bf16 v[232:235], v[216:219], a[192:195], v[232:235]
ds_read_b64_tr_b16 v[200:201], v12 offset:8192
v_mfma_f32_16x16x32_bf16 v[232:235], v[220:223], a[200:203], v[232:235]
ds_read_b64_tr_b16 v[202:203], v12 offset:10240
v_mfma_f32_16x16x32_bf16 v[236:239], v[216:219], a[196:199], v[236:239]
ds_read_b64_tr_b16 v[204:205], v12 offset:20480
v_mfma_f32_16x16x32_bf16 v[236:239], v[220:223], a[204:207], v[236:239]
s_waitcnt lgkmcnt(7)
ds_read_b64_tr_b16 v[206:207], v12 offset:22528
v_mfma_f32_16x16x32_bf16 v[240:243], v[184:187], a[192:195], v[240:243]
ds_read_b64_tr_b16 v[208:209], v13 offset:8192
v_mfma_f32_16x16x32_bf16 v[240:243], v[188:191], a[200:203], v[240:243]
ds_read_b64_tr_b16 v[210:211], v13 offset:10240
v_mfma_f32_16x16x32_bf16 v[244:247], v[184:187], a[196:199], v[244:247]
ds_read_b64_tr_b16 v[212:213], v13 offset:20480
v_mfma_f32_16x16x32_bf16 v[244:247], v[188:191], a[204:207], v[244:247]
s_waitcnt lgkmcnt(7)
ds_read_b64_tr_b16 v[214:215], v13 offset:22528
v_mfma_f32_16x16x32_bf16 v[248:251], v[192:195], a[192:195], v[248:251]
ds_read_b64_tr_b16 v[216:217], v14 offset:8192
v_mfma_f32_16x16x32_bf16 v[248:251], v[196:199], a[200:203], v[248:251]
ds_read_b64_tr_b16 v[218:219], v14 offset:10240
v_mfma_f32_16x16x32_bf16 v[252:255], v[192:195], a[196:199], v[252:255]
ds_read_b64_tr_b16 v[220:221], v14 offset:20480
v_mfma_f32_16x16x32_bf16 v[252:255], v[196:199], a[204:207], v[252:255]
s_waitcnt lgkmcnt(7)
ds_read_b64_tr_b16 v[222:223], v14 offset:22528
v_mfma_f32_16x16x32_bf16 v[88:91], v[200:203], a[192:195], v[88:91]
ds_read_b64_tr_b16 v[184:185], v15 offset:8192
v_mfma_f32_16x16x32_bf16 v[88:91], v[204:207], a[200:203], v[88:91]
ds_read_b64_tr_b16 v[186:187], v15 offset:10240
v_mfma_f32_16x16x32_bf16 v[92:95], v[200:203], a[196:199], v[92:95]
ds_read_b64_tr_b16 v[188:189], v15 offset:20480
v_mfma_f32_16x16x32_bf16 v[92:95], v[204:207], a[204:207], v[92:95]
s_waitcnt lgkmcnt(7)
ds_read_b64_tr_b16 v[190:191], v15 offset:22528
v_mfma_f32_16x16x32_bf16 v[96:99], v[208:211], a[192:195], v[96:99]
s_waitcnt vmcnt(0)
s_barrier
v_mfma_f32_16x16x32_bf16 v[96:99], v[212:215], a[200:203], v[96:99]
ds_read_b64_tr_b16 v[192:193], v12 offset:24576
v_mfma_f32_16x16x32_bf16 v[100:103], v[208:211], a[196:199], v[100:103]
ds_read_b64_tr_b16 v[194:195], v12 offset:26624
ds_read_b64_tr_b16 v[196:197], v12 offset:36864
v_mfma_f32_16x16x32_bf16 v[100:103], v[212:215], a[204:207], v[100:103]
s_waitcnt lgkmcnt(7)
ds_read_b64_tr_b16 v[198:199], v12 offset:38912
v_mfma_f32_16x16x32_bf16 v[104:107], v[216:219], a[192:195], v[104:107]
ds_read_b64_tr_b16 v[200:201], v16 offset:0
v_mfma_f32_16x16x32_bf16 v[104:107], v[220:223], a[200:203], v[104:107]
ds_read_b64_tr_b16 v[202:203], v16 offset:2048
v_mfma_f32_16x16x32_bf16 v[108:111], v[216:219], a[196:199], v[108:111]
ds_read_b64_tr_b16 v[204:205], v16 offset:12288
v_mfma_f32_16x16x32_bf16 v[108:111], v[220:223], a[204:207], v[108:111]
s_waitcnt lgkmcnt(7)
ds_read_b64_tr_b16 v[206:207], v16 offset:14336
v_mfma_f32_16x16x32_bf16 v[112:115], v[184:187], a[192:195], v[112:115]
ds_read_b64_tr_b16 v[208:209], v16 offset:24576
v_mfma_f32_16x16x32_bf16 v[112:115], v[188:191], a[200:203], v[112:115]
ds_read_b64_tr_b16 v[210:211], v16 offset:26624
v_mfma_f32_16x16x32_bf16 v[116:119], v[184:187], a[196:199], v[116:119]
ds_read_b64_tr_b16 v[212:213], v16 offset:36864
v_mfma_f32_16x16x32_bf16 v[116:119], v[188:191], a[204:207], v[116:119]
s_waitcnt lgkmcnt(7)
ds_read_b64_tr_b16 v[214:215], v16 offset:38912
v_mfma_f32_16x16x32_bf16 v[56:59], v[192:195], a[208:211], v[56:59]
ds_read_b64_tr_b16 v[216:217], v13 offset:24576
v_and_b32 v24, 15, v1
v_mfma_f32_16x16x32_bf16 v[56:59], v[196:199], a[216:219], v[56:59]
ds_read_b64_tr_b16 v[218:219], v13 offset:26624
v_mul_u32_u24 v24, 1152, v24
v_mfma_f32_16x16x32_bf16 v[60:63], v[192:195], a[212:215], v[60:63]
ds_read_b64_tr_b16 v[220:221], v13 offset:36864
v_bfe_u32 v32, v1, 4, 1
v_mfma_f32_16x16x32_bf16 v[60:63], v[196:199], a[220:223], v[60:63]
s_waitcnt lgkmcnt(7)
ds_read_b64_tr_b16 v[222:223], v13 offset:38912
v_mfma_f32_16x16x32_bf16 v[56:59], v[200:203], a[224:227], v[56:59]
ds_read_b64_tr_b16 v[184:185], v17 offset:0
v_lshl_add_u32 v24, v32, 5, v24
v_mfma_f32_16x16x32_bf16 v[56:59], v[204:207], a[232:235], v[56:59]
ds_read_b64_tr_b16 v[186:187], v17 offset:2048
v_lshrrev_b32 v32, 5, v1
v_mfma_f32_16x16x32_bf16 v[60:63], v[200:203], a[228:231], v[60:63]
ds_read_b64_tr_b16 v[188:189], v17 offset:12288
v_lshl_add_u32 v24, v32, 4, v24
v_mfma_f32_16x16x32_bf16 v[60:63], v[204:207], a[236:239], v[60:63]
s_waitcnt lgkmcnt(7)
ds_read_b64_tr_b16 v[190:191], v17 offset:14336
v_mfma_f32_16x16x32_bf16 v[56:59], v[208:211], a[240:243], v[56:59]
ds_read_b64_tr_b16 v[192:193], v17 offset:24576
v_mfma_f32_16x16x32_bf16 v[56:59], v[212:215], a[248:251], v[56:59]
ds_read_b64_tr_b16 v[194:195], v17 offset:26624
v_mfma_f32_16x16x32_bf16 v[60:63], v[208:211], a[244:247], v[60:63]
ds_read_b64_tr_b16 v[196:197], v17 offset:36864
v_mfma_f32_16x16x32_bf16 v[60:63], v[212:215], a[252:255], v[60:63]
s_waitcnt lgkmcnt(7)
ds_read_b64_tr_b16 v[198:199], v17 offset:38912
v_mfma_f32_16x16x32_bf16 v[64:67], v[216:219], a[208:211], v[64:67]
s_add_u32 s22, s78, 1
ds_read_b64_tr_b16 v[200:201], v12 offset:28672
v_mfma_f32_16x16x32_bf16 v[64:67], v[220:223], a[216:219], v[64:67]
ds_read_b64_tr_b16 v[202:203], v12 offset:30720
v_mfma_f32_16x16x32_bf16 v[68:71], v[216:219], a[212:215], v[68:71]
ds_read_b64_tr_b16 v[204:205], v12 offset:40960
v_and_b32 v26, 3, v1
v_mfma_f32_16x16x32_bf16 v[68:71], v[220:223], a[220:223], v[68:71]
s_waitcnt lgkmcnt(7)
ds_read_b64_tr_b16 v[206:207], v12 offset:43008
v_mfma_f32_16x16x32_bf16 v[64:67], v[184:187], a[224:227], v[64:67]
ds_read_b64_tr_b16 v[208:209], v16 offset:4096
v_cvt_pk_bf16_f32 v120, v56, v57
v_mfma_f32_16x16x32_bf16 v[64:67], v[188:191], a[232:235], v[64:67]
buffer_load_dwordx4 v[168:171], v24, s[64:67], s55 offen offset:0
v_cvt_pk_bf16_f32 v121, v58, v59
v_mfma_f32_16x16x32_bf16 v[68:71], v[184:187], a[228:231], v[68:71]
ds_read_b64_tr_b16 v[210:211], v16 offset:6144
ds_read_b64_tr_b16 v[212:213], v16 offset:16384
v_cvt_pk_bf16_f32 v136, v60, v61
v_mfma_f32_16x16x32_bf16 v[68:71], v[188:191], a[236:239], v[68:71]
s_waitcnt lgkmcnt(7)
ds_read_b64_tr_b16 v[214:215], v16 offset:18432
v_cvt_pk_bf16_f32 v137, v62, v63
v_mfma_f32_16x16x32_bf16 v[64:67], v[192:195], a[240:243], v[64:67]
ds_read_b64_tr_b16 v[216:217], v16 offset:28672
v_add_u32 v26, s22, v26
v_mfma_f32_16x16x32_bf16 v[64:67], v[196:199], a[248:251], v[64:67]
buffer_load_dwordx4 v[172:175], v24, s[64:67], s55 offen offset:128
v_mfma_f32_16x16x32_bf16 v[68:71], v[192:195], a[244:247], v[68:71]
ds_read_b64_tr_b16 v[218:219], v16 offset:30720
ds_read_b64_tr_b16 v[220:221], v16 offset:40960
v_mfma_f32_16x16x32_bf16 v[68:71], v[196:199], a[252:255], v[68:71]
s_waitcnt lgkmcnt(7)
ds_read_b64_tr_b16 v[222:223], v16 offset:43008
v_mfma_f32_16x16x32_bf16 v[224:227], v[200:203], a[208:211], v[224:227]
ds_read_b64_tr_b16 v[184:185], v13 offset:28672
v_subrev_u32 v32, 5, v26
v_mfma_f32_16x16x32_bf16 v[224:227], v[204:207], a[216:219], v[224:227]
buffer_load_dwordx4 v[176:179], v24, s[64:67], s55 offen offset:256
v_mfma_f32_16x16x32_bf16 v[228:231], v[200:203], a[212:215], v[228:231]
ds_read_b64_tr_b16 v[186:187], v13 offset:30720
ds_read_b64_tr_b16 v[188:189], v13 offset:40960
v_mfma_f32_16x16x32_bf16 v[228:231], v[204:207], a[220:223], v[228:231]
s_waitcnt lgkmcnt(7)
ds_read_b64_tr_b16 v[190:191], v13 offset:43008
v_mfma_f32_16x16x32_bf16 v[224:227], v[208:211], a[224:227], v[224:227]
ds_read_b64_tr_b16 v[192:193], v17 offset:4096
v_cvt_pk_bf16_f32 v122, v64, v65
v_mfma_f32_16x16x32_bf16 v[224:227], v[212:215], a[232:235], v[224:227]
ds_read_b64_tr_b16 v[194:195], v17 offset:6144
v_cvt_pk_bf16_f32 v123, v66, v67
v_mfma_f32_16x16x32_bf16 v[228:231], v[208:211], a[228:231], v[228:231]
ds_read_b64_tr_b16 v[196:197], v17 offset:16384
v_cvt_pk_bf16_f32 v138, v68, v69
v_mfma_f32_16x16x32_bf16 v[228:231], v[212:215], a[236:239], v[228:231]
s_waitcnt lgkmcnt(7)
ds_read_b64_tr_b16 v[198:199], v17 offset:18432
v_cvt_pk_bf16_f32 v139, v70, v71
v_mfma_f32_16x16x32_bf16 v[224:227], v[216:219], a[240:243], v[224:227]
ds_read_b64_tr_b16 v[200:201], v17 offset:28672
v_min_u32 v26, v26, v32
v_mfma_f32_16x16x32_bf16 v[224:227], v[220:223], a[248:251], v[224:227]
buffer_store_dwordx4 v[120:123], v4, s[12:15], s7 offen offset:0 sc1
v_mfma_f32_16x16x32_bf16 v[228:231], v[216:219], a[244:247], v[228:231]
ds_read_b64_tr_b16 v[202:203], v17 offset:30720
ds_read_b64_tr_b16 v[204:205], v17 offset:40960
v_mfma_f32_16x16x32_bf16 v[228:231], v[220:223], a[252:255], v[228:231]
s_waitcnt lgkmcnt(7)
ds_read_b64_tr_b16 v[206:207], v17 offset:43008
v_mfma_f32_16x16x32_bf16 v[232:235], v[184:187], a[208:211], v[232:235]
s_mov_b32 s22, 3145728
ds_read_b64_tr_b16 v[208:209], v12 offset:32768
v_mfma_f32_16x16x32_bf16 v[232:235], v[188:191], a[216:219], v[232:235]
buffer_store_dwordx4 v[136:139], v4, s[12:15], s52 offen offset:0 sc1
v_mfma_f32_16x16x32_bf16 v[236:239], v[184:187], a[212:215], v[236:239]
ds_read_b64_tr_b16 v[210:211], v12 offset:34816
ds_read_b64_tr_b16 v[212:213], v12 offset:45056
v_mfma_f32_16x16x32_bf16 v[236:239], v[188:191], a[220:223], v[236:239]
s_waitcnt lgkmcnt(7)
ds_read_b64_tr_b16 v[214:215], v12 offset:47104
v_mfma_f32_16x16x32_bf16 v[232:235], v[192:195], a[224:227], v[232:235]
ds_read_b64_tr_b16 v[216:217], v16 offset:8192
v_cvt_pk_bf16_f32 v124, v224, v225
v_mfma_f32_16x16x32_bf16 v[232:235], v[196:199], a[232:235], v[232:235]
ds_read_b64_tr_b16 v[218:219], v16 offset:10240
v_cvt_pk_bf16_f32 v125, v226, v227
v_mfma_f32_16x16x32_bf16 v[236:239], v[192:195], a[228:231], v[236:239]
ds_read_b64_tr_b16 v[220:221], v16 offset:20480
v_cvt_pk_bf16_f32 v140, v228, v229
v_mfma_f32_16x16x32_bf16 v[236:239], v[196:199], a[236:239], v[236:239]
s_waitcnt lgkmcnt(7)
ds_read_b64_tr_b16 v[222:223], v16 offset:22528
v_cvt_pk_bf16_f32 v141, v230, v231
v_mfma_f32_16x16x32_bf16 v[232:235], v[200:203], a[240:243], v[232:235]
ds_read_b64_tr_b16 v[184:185], v16 offset:32768
v_mul_lo_u32 v26, v26, s22
v_mfma_f32_16x16x32_bf16 v[232:235], v[204:207], a[248:251], v[232:235]
s_mov_b32 s23, 0x3ef5fdf0
ds_read_b64_tr_b16 v[186:187], v16 offset:34816
v_mfma_f32_16x16x32_bf16 v[236:239], v[200:203], a[244:247], v[236:239]
s_mov_b32 s38, 0x3f80
ds_read_b64_tr_b16 v[188:189], v16 offset:45056
v_mfma_f32_16x16x32_bf16 v[236:239], v[204:207], a[252:255], v[236:239]
s_waitcnt lgkmcnt(7)
ds_read_b64_tr_b16 v[190:191], v16 offset:47104
v_mfma_f32_16x16x32_bf16 v[88:91], v[208:211], a[208:211], v[88:91]
s_mov_b32 s39, 0x3f800000
ds_read_b64_tr_b16 v[192:193], v13 offset:32768
v_mfma_f32_16x16x32_bf16 v[88:91], v[212:215], a[216:219], v[88:91]
s_add_u32 s22, s78, 1
ds_read_b64_tr_b16 v[194:195], v13 offset:34816
v_mfma_f32_16x16x32_bf16 v[92:95], v[208:211], a[212:215], v[92:95]
s_sub_u32 s42, s22, 5
ds_read_b64_tr_b16 v[196:197], v13 offset:45056
v_mfma_f32_16x16x32_bf16 v[92:95], v[212:215], a[220:223], v[92:95]
s_waitcnt lgkmcnt(7)
ds_read_b64_tr_b16 v[198:199], v13 offset:47104
v_mfma_f32_16x16x32_bf16 v[88:91], v[216:219], a[224:227], v[88:91]
ds_read_b64_tr_b16 v[200:201], v17 offset:8192
v_cvt_pk_bf16_f32 v126, v232, v233
v_mfma_f32_16x16x32_bf16 v[88:91], v[220:223], a[232:235], v[88:91]
ds_read_b64_tr_b16 v[202:203], v17 offset:10240
v_cvt_pk_bf16_f32 v127, v234, v235
v_mfma_f32_16x16x32_bf16 v[92:95], v[216:219], a[228:231], v[92:95]
ds_read_b64_tr_b16 v[204:205], v17 offset:20480
v_cvt_pk_bf16_f32 v142, v236, v237
v_mfma_f32_16x16x32_bf16 v[92:95], v[220:223], a[236:239], v[92:95]
s_waitcnt lgkmcnt(7)
ds_read_b64_tr_b16 v[206:207], v17 offset:22528
v_cvt_pk_bf16_f32 v143, v238, v239
v_mfma_f32_16x16x32_bf16 v[88:91], v[184:187], a[240:243], v[88:91]
s_min_u32 s22, s22, s42
ds_read_b64_tr_b16 v[208:209], v17 offset:32768
v_mfma_f32_16x16x32_bf16 v[88:91], v[188:191], a[248:251], v[88:91]
buffer_store_dwordx4 v[124:127], v4, s[12:15], s7 offen offset:1024 sc1
v_mfma_f32_16x16x32_bf16 v[92:95], v[184:187], a[244:247], v[92:95]
ds_read_b64_tr_b16 v[210:211], v17 offset:34816
ds_read_b64_tr_b16 v[212:213], v17 offset:45056
v_mfma_f32_16x16x32_bf16 v[92:95], v[188:191], a[252:255], v[92:95]
s_waitcnt lgkmcnt(7)
ds_read_b64_tr_b16 v[214:215], v17 offset:47104
v_mfma_f32_16x16x32_bf16 v[96:99], v[192:195], a[208:211], v[96:99]
s_mul_i32 s22, s22, 3145728
ds_read_b64_tr_b16 v[216:217], v14 offset:24576
v_mfma_f32_16x16x32_bf16 v[96:99], v[196:199], a[216:219], v[96:99]
buffer_store_dwordx4 v[140:143], v4, s[12:15], s52 offen offset:1024 sc1
v_mfma_f32_16x16x32_bf16 v[100:103], v[192:195], a[212:215], v[100:103]
ds_read_b64_tr_b16 v[218:219], v14 offset:26624
ds_read_b64_tr_b16 v[220:221], v14 offset:36864
v_mfma_f32_16x16x32_bf16 v[100:103], v[196:199], a[220:223], v[100:103]
s_waitcnt lgkmcnt(7)
ds_read_b64_tr_b16 v[222:223], v14 offset:38912
v_mfma_f32_16x16x32_bf16 v[96:99], v[200:203], a[224:227], v[96:99]
ds_read_b64_tr_b16 v[184:185], v18 offset:0
v_cvt_pk_bf16_f32 v128, v88, v89
v_mfma_f32_16x16x32_bf16 v[96:99], v[204:207], a[232:235], v[96:99]
ds_read_b64_tr_b16 v[186:187], v18 offset:2048
v_cvt_pk_bf16_f32 v129, v90, v91
v_mfma_f32_16x16x32_bf16 v[100:103], v[200:203], a[228:231], v[100:103]
ds_read_b64_tr_b16 v[188:189], v18 offset:12288
v_cvt_pk_bf16_f32 v144, v92, v93
v_mfma_f32_16x16x32_bf16 v[100:103], v[204:207], a[236:239], v[100:103]
s_waitcnt lgkmcnt(7)
ds_read_b64_tr_b16 v[190:191], v18 offset:14336
v_cvt_pk_bf16_f32 v145, v94, v95
v_mfma_f32_16x16x32_bf16 v[96:99], v[208:211], a[240:243], v[96:99]
s_add_u32 s33, s22, s54
ds_read_b64_tr_b16 v[192:193], v18 offset:24576
v_mfma_f32_16x16x32_bf16 v[96:99], v[212:215], a[248:251], v[96:99]
s_add_u32 s22, s78, 2
ds_read_b64_tr_b16 v[194:195], v18 offset:26624
v_mfma_f32_16x16x32_bf16 v[100:103], v[208:211], a[244:247], v[100:103]
s_sub_u32 s42, s22, 5
ds_read_b64_tr_b16 v[196:197], v18 offset:36864
v_mfma_f32_16x16x32_bf16 v[100:103], v[212:215], a[252:255], v[100:103]
s_waitcnt lgkmcnt(7)
ds_read_b64_tr_b16 v[198:199], v18 offset:38912
v_mfma_f32_16x16x32_bf16 v[72:75], v[216:219], a[208:211], v[72:75]
s_min_u32 s22, s22, s42
ds_read_b64_tr_b16 v[200:201], v15 offset:24576
v_mfma_f32_16x16x32_bf16 v[72:75], v[220:223], a[216:219], v[72:75]
s_mul_i32 s22, s22, 3145728
ds_read_b64_tr_b16 v[202:203], v15 offset:26624
v_mfma_f32_16x16x32_bf16 v[76:79], v[216:219], a[212:215], v[76:79]
s_add_u32 s34, s22, s54
ds_read_b64_tr_b16 v[204:205], v15 offset:36864
v_mfma_f32_16x16x32_bf16 v[76:79], v[220:223], a[220:223], v[76:79]
s_waitcnt lgkmcnt(7)
ds_read_b64_tr_b16 v[206:207], v15 offset:38912
v_mfma_f32_16x16x32_bf16 v[72:75], v[184:187], a[224:227], v[72:75]
ds_read_b64_tr_b16 v[208:209], v19 offset:0
v_cvt_pk_bf16_f32 v130, v96, v97
v_mfma_f32_16x16x32_bf16 v[72:75], v[188:191], a[232:235], v[72:75]
ds_read_b64_tr_b16 v[210:211], v19 offset:2048
v_cvt_pk_bf16_f32 v131, v98, v99
v_mfma_f32_16x16x32_bf16 v[76:79], v[184:187], a[228:231], v[76:79]
ds_read_b64_tr_b16 v[212:213], v19 offset:12288
v_cvt_pk_bf16_f32 v146, v100, v101
v_mfma_f32_16x16x32_bf16 v[76:79], v[188:191], a[236:239], v[76:79]
s_waitcnt lgkmcnt(7)
ds_read_b64_tr_b16 v[214:215], v19 offset:14336
v_cvt_pk_bf16_f32 v147, v102, v103
v_mfma_f32_16x16x32_bf16 v[72:75], v[192:195], a[240:243], v[72:75]
s_add_u32 s22, s78, 3
ds_read_b64_tr_b16 v[216:217], v19 offset:24576
v_mfma_f32_16x16x32_bf16 v[72:75], v[196:199], a[248:251], v[72:75]
buffer_store_dwordx4 v[128:131], v4, s[12:15], s7 offen offset:2048 sc1
v_mfma_f32_16x16x32_bf16 v[76:79], v[192:195], a[244:247], v[76:79]
ds_read_b64_tr_b16 v[218:219], v19 offset:26624
ds_read_b64_tr_b16 v[220:221], v19 offset:36864
v_mfma_f32_16x16x32_bf16 v[76:79], v[196:199], a[252:255], v[76:79]
s_waitcnt lgkmcnt(7)
ds_read_b64_tr_b16 v[222:223], v19 offset:38912
v_mfma_f32_16x16x32_bf16 v[80:83], v[200:203], a[208:211], v[80:83]
s_sub_u32 s42, s22, 5
ds_read_b64_tr_b16 v[184:185], v14 offset:28672
v_mfma_f32_16x16x32_bf16 v[80:83], v[204:207], a[216:219], v[80:83]
buffer_store_dwordx4 v[144:147], v4, s[12:15], s52 offen offset:2048 sc1
v_mfma_f32_16x16x32_bf16 v[84:87], v[200:203], a[212:215], v[84:87]
ds_read_b64_tr_b16 v[186:187], v14 offset:30720
ds_read_b64_tr_b16 v[188:189], v14 offset:40960
v_mfma_f32_16x16x32_bf16 v[84:87], v[204:207], a[220:223], v[84:87]
s_waitcnt lgkmcnt(7)
ds_read_b64_tr_b16 v[190:191], v14 offset:43008
v_mfma_f32_16x16x32_bf16 v[80:83], v[208:211], a[224:227], v[80:83]
ds_read_b64_tr_b16 v[192:193], v18 offset:4096
v_cvt_pk_bf16_f32 v152, v72, v73
v_mfma_f32_16x16x32_bf16 v[80:83], v[212:215], a[232:235], v[80:83]
ds_read_b64_tr_b16 v[194:195], v18 offset:6144
v_cvt_pk_bf16_f32 v153, v74, v75
v_mfma_f32_16x16x32_bf16 v[84:87], v[208:211], a[228:231], v[84:87]
s_min_u32 s22, s22, s42
ds_read_b64_tr_b16 v[196:197], v18 offset:16384
v_mfma_f32_16x16x32_bf16 v[84:87], v[212:215], a[236:239], v[84:87]
s_waitcnt lgkmcnt(7)
ds_read_b64_tr_b16 v[198:199], v18 offset:18432
v_mfma_f32_16x16x32_bf16 v[80:83], v[216:219], a[240:243], v[80:83]
s_mul_i32 s22, s22, 3145728
ds_read_b64_tr_b16 v[200:201], v18 offset:28672
v_mfma_f32_16x16x32_bf16 v[80:83], v[220:223], a[248:251], v[80:83]
s_add_u32 s35, s22, s54
ds_read_b64_tr_b16 v[202:203], v18 offset:30720
v_mfma_f32_16x16x32_bf16 v[84:87], v[216:219], a[244:247], v[84:87]
s_add_u32 s22, s78, 4
ds_read_b64_tr_b16 v[204:205], v18 offset:40960
v_mfma_f32_16x16x32_bf16 v[84:87], v[220:223], a[252:255], v[84:87]
s_waitcnt lgkmcnt(7)
ds_read_b64_tr_b16 v[206:207], v18 offset:43008
v_mfma_f32_16x16x32_bf16 v[240:243], v[184:187], a[208:211], v[240:243]
s_sub_u32 s42, s22, 5
ds_read_b64_tr_b16 v[208:209], v15 offset:28672
v_mfma_f32_16x16x32_bf16 v[240:243], v[188:191], a[216:219], v[240:243]
s_min_u32 s22, s22, s42
ds_read_b64_tr_b16 v[210:211], v15 offset:30720
v_mfma_f32_16x16x32_bf16 v[244:247], v[184:187], a[212:215], v[244:247]
s_mul_i32 s22, s22, 3145728
ds_read_b64_tr_b16 v[212:213], v15 offset:40960
v_mfma_f32_16x16x32_bf16 v[244:247], v[188:191], a[220:223], v[244:247]
s_waitcnt lgkmcnt(7)
ds_read_b64_tr_b16 v[214:215], v15 offset:43008
v_mfma_f32_16x16x32_bf16 v[240:243], v[192:195], a[224:227], v[240:243]
ds_read_b64_tr_b16 v[216:217], v19 offset:4096
v_cvt_pk_bf16_f32 v154, v80, v81
v_mfma_f32_16x16x32_bf16 v[240:243], v[196:199], a[232:235], v[240:243]
ds_read_b64_tr_b16 v[218:219], v19 offset:6144
v_cvt_pk_bf16_f32 v155, v82, v83
v_mfma_f32_16x16x32_bf16 v[244:247], v[192:195], a[228:231], v[244:247]
s_add_u32 s36, s22, s54
ds_read_b64_tr_b16 v[220:221], v19 offset:16384
v_mfma_f32_16x16x32_bf16 v[244:247], v[196:199], a[236:239], v[244:247]
s_waitcnt lgkmcnt(7)
ds_read_b64_tr_b16 v[222:223], v19 offset:18432
v_mfma_f32_16x16x32_bf16 v[240:243], v[200:203], a[240:243], v[240:243]
ds_read_b64_tr_b16 v[184:185], v19 offset:28672
v_mfma_f32_16x16x32_bf16 v[240:243], v[204:207], a[248:251], v[240:243]
buffer_store_dwordx4 v[152:155], v4, s[12:15], s53 offen offset:0 sc1
v_mfma_f32_16x16x32_bf16 v[244:247], v[200:203], a[244:247], v[244:247]
ds_read_b64_tr_b16 v[186:187], v19 offset:30720
ds_read_b64_tr_b16 v[188:189], v19 offset:40960
v_mfma_f32_16x16x32_bf16 v[244:247], v[204:207], a[252:255], v[244:247]
s_waitcnt lgkmcnt(7)
ds_read_b64_tr_b16 v[190:191], v19 offset:43008
v_mfma_f32_16x16x32_bf16 v[248:251], v[208:211], a[208:211], v[248:251]
ds_read_b64_tr_b16 v[192:193], v14 offset:32768
v_mfma_f32_16x16x32_bf16 v[248:251], v[212:215], a[216:219], v[248:251]
ds_read_b64_tr_b16 v[194:195], v14 offset:34816
v_mfma_f32_16x16x32_bf16 v[252:255], v[208:211], a[212:215], v[252:255]
ds_read_b64_tr_b16 v[196:197], v14 offset:45056
v_mfma_f32_16x16x32_bf16 v[252:255], v[212:215], a[220:223], v[252:255]
s_waitcnt lgkmcnt(7)
ds_read_b64_tr_b16 v[198:199], v14 offset:47104
v_mfma_f32_16x16x32_bf16 v[248:251], v[216:219], a[224:227], v[248:251]
ds_read_b64_tr_b16 v[200:201], v18 offset:8192
v_cvt_pk_bf16_f32 v156, v240, v241
v_mfma_f32_16x16x32_bf16 v[248:251], v[220:223], a[232:235], v[248:251]
ds_read_b64_tr_b16 v[202:203], v18 offset:10240
v_cvt_pk_bf16_f32 v157, v242, v243
v_mfma_f32_16x16x32_bf16 v[252:255], v[216:219], a[228:231], v[252:255]
ds_read_b64_tr_b16 v[204:205], v18 offset:20480
v_mfma_f32_16x16x32_bf16 v[252:255], v[220:223], a[236:239], v[252:255]
s_waitcnt lgkmcnt(7)
ds_read_b64_tr_b16 v[206:207], v18 offset:22528
v_mfma_f32_16x16x32_bf16 v[248:251], v[184:187], a[240:243], v[248:251]
ds_read_b64_tr_b16 v[208:209], v18 offset:32768
v_mfma_f32_16x16x32_bf16 v[248:251], v[188:191], a[248:251], v[248:251]
ds_read_b64_tr_b16 v[210:211], v18 offset:34816
v_mfma_f32_16x16x32_bf16 v[252:255], v[184:187], a[244:247], v[252:255]
ds_read_b64_tr_b16 v[212:213], v18 offset:45056
v_mfma_f32_16x16x32_bf16 v[252:255], v[188:191], a[252:255], v[252:255]
s_waitcnt lgkmcnt(7)
ds_read_b64_tr_b16 v[214:215], v18 offset:47104
v_mfma_f32_16x16x32_bf16 v[104:107], v[192:195], a[208:211], v[104:107]
ds_read_b64_tr_b16 v[216:217], v15 offset:32768
v_mfma_f32_16x16x32_bf16 v[104:107], v[196:199], a[216:219], v[104:107]
ds_read_b64_tr_b16 v[218:219], v15 offset:34816
v_mfma_f32_16x16x32_bf16 v[108:111], v[192:195], a[212:215], v[108:111]
ds_read_b64_tr_b16 v[220:221], v15 offset:45056
v_mfma_f32_16x16x32_bf16 v[108:111], v[196:199], a[220:223], v[108:111]
s_waitcnt lgkmcnt(7)
ds_read_b64_tr_b16 v[222:223], v15 offset:47104
v_mfma_f32_16x16x32_bf16 v[104:107], v[200:203], a[224:227], v[104:107]
ds_read_b64_tr_b16 v[184:185], v19 offset:8192
v_cvt_pk_bf16_f32 v158, v248, v249
v_mfma_f32_16x16x32_bf16 v[104:107], v[204:207], a[232:235], v[104:107]
s_waitcnt vmcnt(2)
buffer_store_dword v31, v28, s[12:15], s7 offen offset:4092 sc1
v_cvt_pk_bf16_f32 v159, v250, v251
v_mfma_f32_16x16x32_bf16 v[108:111], v[200:203], a[228:231], v[108:111]
ds_read_b64_tr_b16 v[186:187], v19 offset:10240
ds_read_b64_tr_b16 v[188:189], v19 offset:20480
v_mfma_f32_16x16x32_bf16 v[108:111], v[204:207], a[236:239], v[108:111]
s_waitcnt lgkmcnt(7)
ds_read_b64_tr_b16 v[190:191], v19 offset:22528
v_mfma_f32_16x16x32_bf16 v[104:107], v[208:211], a[240:243], v[104:107]
ds_read_b64_tr_b16 v[192:193], v19 offset:32768
v_mfma_f32_16x16x32_bf16 v[104:107], v[212:215], a[248:251], v[104:107]
buffer_store_dwordx4 v[156:159], v4, s[12:15], s53 offen offset:1024 sc1
v_mfma_f32_16x16x32_bf16 v[108:111], v[208:211], a[244:247], v[108:111]
ds_read_b64_tr_b16 v[194:195], v19 offset:34816
ds_read_b64_tr_b16 v[196:197], v19 offset:45056
v_mfma_f32_16x16x32_bf16 v[108:111], v[212:215], a[252:255], v[108:111]
s_waitcnt lgkmcnt(7)
ds_read_b64_tr_b16 v[198:199], v19 offset:47104
v_mfma_f32_16x16x32_bf16 v[112:115], v[216:219], a[208:211], v[112:115]
v_mfma_f32_16x16x32_bf16 v[112:115], v[220:223], a[216:219], v[112:115]
s_waitcnt vmcnt(3)
buffer_store_dword v31, v28, s[12:15], s52 offen offset:4092 sc1
v_mfma_f32_16x16x32_bf16 v[116:119], v[216:219], a[212:215], v[116:119]
v_mfma_f32_16x16x32_bf16 v[116:119], v[220:223], a[220:223], v[116:119]
s_waitcnt lgkmcnt(4)
v_mfma_f32_16x16x32_bf16 v[112:115], v[184:187], a[224:227], v[112:115]
v_cvt_pk_bf16_f32 v160, v104, v105
v_mfma_f32_16x16x32_bf16 v[112:115], v[188:191], a[232:235], v[112:115]
v_cvt_pk_bf16_f32 v161, v106, v107
v_mfma_f32_16x16x32_bf16 v[116:119], v[184:187], a[228:231], v[116:119]
v_mfma_f32_16x16x32_bf16 v[116:119], v[188:191], a[236:239], v[116:119]
s_waitcnt lgkmcnt(0)
v_mfma_f32_16x16x32_bf16 v[112:115], v[192:195], a[240:243], v[112:115]
v_mfma_f32_16x16x32_bf16 v[112:115], v[196:199], a[248:251], v[112:115]
v_mfma_f32_16x16x32_bf16 v[116:119], v[192:195], a[244:247], v[116:119]
v_mfma_f32_16x16x32_bf16 v[116:119], v[196:199], a[252:255], v[116:119]
s_nop 5
v_cvt_pk_bf16_f32 v162, v112, v113
v_cvt_pk_bf16_f32 v163, v114, v115
buffer_store_dwordx4 v[160:163], v4, s[12:15], s53 offen offset:2048 sc1
s_waitcnt vmcnt(0)
buffer_store_dword v31, v28, s[12:15], s53 offen offset:4092 sc1
buffer_load_dword v55, v26, s[12:15], s54 offen offset:4092 sc1
v_lshlrev_b32 v184, 16, v168
v_and_b32 v185, 0xffff0000, v168
v_lshlrev_b32 v186, 16, v169
v_and_b32 v187, 0xffff0000, v169
v_lshlrev_b32 v188, 16, v170
v_and_b32 v189, 0xffff0000, v170
v_lshlrev_b32 v190, 16, v171
v_and_b32 v191, 0xffff0000, v171
v_lshlrev_b32 v192, 16, v172
v_and_b32 v193, 0xffff0000, v172
v_lshlrev_b32 v194, 16, v173
v_and_b32 v195, 0xffff0000, v173
v_lshlrev_b32 v196, 16, v174
v_and_b32 v197, 0xffff0000, v174
v_lshlrev_b32 v198, 16, v175
v_and_b32 v199, 0xffff0000, v175
v_lshlrev_b32 v200, 16, v176
v_and_b32 v201, 0xffff0000, v176
v_lshlrev_b32 v202, 16, v177
v_and_b32 v203, 0xffff0000, v177
v_lshlrev_b32 v204, 16, v178
v_and_b32 v205, 0xffff0000, v178
v_lshlrev_b32 v206, 16, v179
v_and_b32 v207, 0xffff0000, v179
s_waitcnt vmcnt(0)
v_cmp_ne_u32 vcc, s76, v55
s_nop 1
s_cbranch_vccnz slow_f4
back_f4:
buffer_load_dwordx4 v[120:123], v4, s[12:15], s33 offen offset:0 sc1
buffer_load_dwordx4 v[124:127], v4, s[12:15], s33 offen offset:1024 sc1
buffer_load_dwordx4 v[128:131], v4, s[12:15], s33 offen offset:2048 sc1
buffer_load_dwordx4 v[136:139], v4, s[12:15], s34 offen offset:0 sc1
buffer_load_dwordx4 v[140:143], v4, s[12:15], s34 offen offset:1024 sc1
buffer_load_dwordx4 v[144:147], v4, s[12:15], s34 offen offset:2048 sc1
buffer_load_dwordx4 v[152:155], v4, s[12:15], s35 offen offset:0 sc1
buffer_load_dwordx4 v[156:159], v4, s[12:15], s35 offen offset:1024 sc1
buffer_load_dwordx4 v[160:163], v4, s[12:15], s35 offen offset:2048 sc1
buffer_load_dwordx4 v[168:171], v4, s[12:15], s36 offen offset:0 sc1
buffer_load_dwordx4 v[172:175], v4, s[12:15], s36 offen offset:1024 sc1
buffer_load_dwordx4 v[176:179], v4, s[12:15], s36 offen offset:2048 sc1
s_waitcnt vmcnt(11)
v_dot2_f32_bf16 v76, v120, s38, v76
v_dot2_f32_bf16 v77, v120, s39, v77
v_dot2_f32_bf16 v78, v121, s38, v78
v_dot2_f32_bf16 v79, v121, s39, v79
v_dot2_f32_bf16 v84, v122, s38, v84
v_dot2_f32_bf16 v85, v122, s39, v85
v_dot2_f32_bf16 v86, v123, s38, v86
v_dot2_f32_bf16 v87, v123, s39, v87
s_waitcnt vmcnt(10)
v_dot2_f32_bf16 v244, v124, s38, v244
v_dot2_f32_bf16 v245, v124, s39, v245
v_dot2_f32_bf16 v246, v125, s38, v246
v_dot2_f32_bf16 v247, v125, s39, v247
v_dot2_f32_bf16 v252, v126, s38, v252
v_dot2_f32_bf16 v253, v126, s39, v253
v_dot2_f32_bf16 v254, v127, s38, v254
v_dot2_f32_bf16 v255, v127, s39, v255
s_waitcnt vmcnt(9)
v_dot2_f32_bf16 v108, v128, s38, v108
v_dot2_f32_bf16 v109, v128, s39, v109
v_dot2_f32_bf16 v110, v129, s38, v110
v_dot2_f32_bf16 v111, v129, s39, v111
v_dot2_f32_bf16 v116, v130, s38, v116
v_dot2_f32_bf16 v117, v130, s39, v117
v_dot2_f32_bf16 v118, v131, s38, v118
v_dot2_f32_bf16 v119, v131, s39, v119
s_waitcnt vmcnt(8)
v_dot2_f32_bf16 v76, v136, s38, v76
v_dot2_f32_bf16 v77, v136, s39, v77
v_dot2_f32_bf16 v78, v137, s38, v78
v_dot2_f32_bf16 v79, v137, s39, v79
v_dot2_f32_bf16 v84, v138, s38, v84
v_dot2_f32_bf16 v85, v138, s39, v85
v_dot2_f32_bf16 v86, v139, s38, v86
v_dot2_f32_bf16 v87, v139, s39, v87
s_waitcnt vmcnt(7)
v_dot2_f32_bf16 v244, v140, s38, v244
v_dot2_f32_bf16 v245, v140, s39, v245
v_dot2_f32_bf16 v246, v141, s38, v246
v_dot2_f32_bf16 v247, v141, s39, v247
v_dot2_f32_bf16 v252, v142, s38, v252
v_dot2_f32_bf16 v253, v142, s39, v253
v_dot2_f32_bf16 v254, v143, s38, v254
v_dot2_f32_bf16 v255, v143, s39, v255
s_waitcnt vmcnt(6)
v_dot2_f32_bf16 v108, v144, s38, v108
v_dot2_f32_bf16 v109, v144, s39, v109
v_dot2_f32_bf16 v110, v145, s38, v110
v_dot2_f32_bf16 v111, v145, s39, v111
v_dot2_f32_bf16 v116, v146, s38, v116
v_dot2_f32_bf16 v117, v146, s39, v117
v_dot2_f32_bf16 v118, v147, s38, v118
v_dot2_f32_bf16 v119, v147, s39, v119
s_waitcnt vmcnt(5)
v_dot2_f32_bf16 v76, v152, s38, v76
v_dot2_f32_bf16 v77, v152, s39, v77
v_dot2_f32_bf16 v78, v153, s38, v78
v_dot2_f32_bf16 v79, v153, s39, v79
v_dot2_f32_bf16 v84, v154, s38, v84
v_dot2_f32_bf16 v85, v154, s39, v85
v_dot2_f32_bf16 v86, v155, s38, v86
v_dot2_f32_bf16 v87, v155, s39, v87
s_waitcnt vmcnt(4)
v_dot2_f32_bf16 v244, v156, s38, v244
v_dot2_f32_bf16 v245, v156, s39, v245
v_dot2_f32_bf16 v246, v157, s38, v246
v_dot2_f32_bf16 v247, v157, s39, v247
v_dot2_f32_bf16 v252, v158, s38, v252
v_dot2_f32_bf16 v253, v158, s39, v253
v_dot2_f32_bf16 v254, v159, s38, v254
v_dot2_f32_bf16 v255, v159, s39, v255
s_waitcnt vmcnt(3)
v_dot2_f32_bf16 v108, v160, s38, v108
v_dot2_f32_bf16 v109, v160, s39, v109
v_dot2_f32_bf16 v110, v161, s38, v110
v_dot2_f32_bf16 v111, v161, s39, v111
v_dot2_f32_bf16 v116, v162, s38, v116
v_dot2_f32_bf16 v117, v162, s39, v117
v_dot2_f32_bf16 v118, v163, s38, v118
v_dot2_f32_bf16 v119, v163, s39, v119
s_waitcnt vmcnt(2)
v_dot2_f32_bf16 v76, v168, s38, v76
v_dot2_f32_bf16 v77, v168, s39, v77
v_dot2_f32_bf16 v78, v169, s38, v78
v_dot2_f32_bf16 v79, v169, s39, v79
v_dot2_f32_bf16 v84, v170, s38, v84
v_dot2_f32_bf16 v85, v170, s39, v85
v_dot2_f32_bf16 v86, v171, s38, v86
v_dot2_f32_bf16 v87, v171, s39, v87
s_waitcnt vmcnt(1)
v_dot2_f32_bf16 v244, v172, s38, v244
v_dot2_f32_bf16 v245, v172, s39, v245
v_dot2_f32_bf16 v246, v173, s38, v246
v_dot2_f32_bf16 v247, v173, s39, v247
v_dot2_f32_bf16 v252, v174, s38, v252
v_dot2_f32_bf16 v253, v174, s39, v253
v_dot2_f32_bf16 v254, v175, s38, v254
v_dot2_f32_bf16 v255, v175, s39, v255
s_waitcnt vmcnt(0)
v_dot2_f32_bf16 v108, v176, s38, v108
v_dot2_f32_bf16 v109, v176, s39, v109
v_dot2_f32_bf16 v110, v177, s38, v110
v_dot2_f32_bf16 v111, v177, s39, v111
v_dot2_f32_bf16 v116, v178, s38, v116
v_dot2_f32_bf16 v117, v178, s39, v117
v_dot2_f32_bf16 v118, v179, s38, v118
v_dot2_f32_bf16 v119, v179, s39, v119
v_permlane16_swap_b32 v76, v84
v_permlane16_swap_b32 v77, v85
v_permlane16_swap_b32 v78, v86
v_permlane16_swap_b32 v79, v87
v_fmac_f32 v184, s23, v76
v_fmac_f32 v185, s23, v77
v_fmac_f32 v186, s23, v78
v_fmac_f32 v187, s23, v79
v_fmac_f32 v188, s23, v84
v_fmac_f32 v189, s23, v85
v_fmac_f32 v190, s23, v86
v_fmac_f32 v191, s23, v87
v_cvt_pk_bf16_f32 v208, v184, v185
v_cvt_pk_bf16_f32 v209, v186, v187
v_cvt_pk_bf16_f32 v210, v188, v189
v_cvt_pk_bf16_f32 v211, v190, v191
buffer_store_dwordx4 v[208:211], v24, s[68:71], s55 offen offset:0 sc1
v_permlane16_swap_b32 v244, v252
v_permlane16_swap_b32 v245, v253
v_permlane16_swap_b32 v246, v254
v_permlane16_swap_b32 v247, v255
v_fmac_f32 v192, s23, v244
v_fmac_f32 v193, s23, v245
v_fmac_f32 v194, s23, v246
v_fmac_f32 v195, s23, v247
v_fmac_f32 v196, s23, v252
v_fmac_f32 v197, s23, v253
v_fmac_f32 v198, s23, v254
v_fmac_f32 v199, s23, v255
v_cvt_pk_bf16_f32 v212, v192, v193
v_cvt_pk_bf16_f32 v213, v194, v195
v_cvt_pk_bf16_f32 v214, v196, v197
v_cvt_pk_bf16_f32 v215, v198, v199
buffer_store_dwordx4 v[212:215], v24, s[68:71], s55 offen offset:128 sc1
v_permlane16_swap_b32 v108, v116
v_permlane16_swap_b32 v109, v117
v_permlane16_swap_b32 v110, v118
v_permlane16_swap_b32 v111, v119
v_fmac_f32 v200, s23, v108
v_fmac_f32 v201, s23, v109
v_fmac_f32 v202, s23, v110
v_fmac_f32 v203, s23, v111
v_fmac_f32 v204, s23, v116
v_fmac_f32 v205, s23, v117
v_fmac_f32 v206, s23, v118
v_fmac_f32 v207, s23, v119
v_cvt_pk_bf16_f32 v216, v200, v201
v_cvt_pk_bf16_f32 v217, v202, v203
v_cvt_pk_bf16_f32 v218, v204, v205
v_cvt_pk_bf16_f32 v219, v206, v207
buffer_store_dwordx4 v[216:219], v24, s[68:71], s55 offen offset:256 sc1
k1_end:
s_endpgm
slow_tagl:
s_mov_b32 s4, 0
spin_tagl:
buffer_load_dword v55, v31, s[72:75], 0 offen sc1
s_waitcnt vmcnt(0)
v_readfirstlane_b32 s76, v55
s_add_u32 s4, s4, 1
s_nop 0
s_cmp_lg_u32 s76, 0
s_cbranch_scc1 back_tagl
s_cmp_lt_u32 s4, 0x4000
s_cbranch_scc1 spin_tagl
s_branch back_tagl
slow_f0:
s_mov_b32 s4, 0
spin_f0:
buffer_load_dword v55, v39, s[12:15], s6 offen offset:0 sc1
s_waitcnt vmcnt(0)
v_cmp_ne_u32 vcc, s76, v55
s_nop 1
s_cbranch_vccz back_f0
s_add_u32 s4, s4, 1
s_cmp_lt_u32 s4, 0x4000
s_cbranch_scc1 spin_f0
s_branch back_f0
slow_tagf:
s_mov_b32 s4, 0
spin_tagf:
buffer_load_dword v38, v31, s[72:75], 0 offen sc1
s_waitcnt vmcnt(0)
v_readfirstlane_b32 s76, v38
s_add_u32 s4, s4, 1
s_nop 0
s_cmp_lg_u32 s76, 0
s_cbranch_scc1 back_tagf
s_cmp_lt_u32 s4, 0x4000
s_cbranch_scc1 spin_tagf
s_branch back_tagf
slow_f1:
s_mov_b32 s4, 0
spin_f1:
buffer_load_dword v55, v26, s[12:15], s5 offen offset:0 sc1
s_waitcnt vmcnt(0)
v_cmp_ne_u32 vcc, s76, v55
s_nop 1
s_cbranch_vccz back_f1
s_add_u32 s4, s4, 1
s_cmp_lt_u32 s4, 0x4000
s_cbranch_scc1 spin_f1
s_branch back_f1
slow_f2:
s_mov_b32 s4, 0
spin_f2:
buffer_load_dword v55, v26, s[12:15], s5 offen offset:128 sc1
s_waitcnt vmcnt(0)
v_cmp_ne_u32 vcc, s76, v55
s_nop 1
s_cbranch_vccz back_f2
s_add_u32 s4, s4, 1
s_cmp_lt_u32 s4, 0x4000
s_cbranch_scc1 spin_f2
s_branch back_f2
slow_f3:
s_mov_b32 s4, 0
spin_f3:
buffer_load_dword v55, v26, s[12:15], s5 offen offset:256 sc1
s_waitcnt vmcnt(0)
v_cmp_ne_u32 vcc, s76, v55
s_nop 1
s_cbranch_vccz back_f3
s_add_u32 s4, s4, 1
s_cmp_lt_u32 s4, 0x4000
s_cbranch_scc1 spin_f3
s_branch back_f3
slow_f4:
s_mov_b32 s4, 0
spin_f4:
buffer_load_dword v55, v26, s[12:15], s54 offen offset:4092 sc1
s_waitcnt vmcnt(0)
v_cmp_ne_u32 vcc, s76, v55
s_nop 1
s_cbranch_vccz back_f4
s_add_u32 s4, s4, 1
s_cmp_lt_u32 s4, 0x4000
s_cbranch_scc1 spin_f4
s_branch back_f4
k1_att:
v_lshrrev_b32 v32, 1, v1
v_and_b32 v33, 31, v1
v_bfe_u32 v34, v32, 2, 2
v_and_b32 v24, 3, v32
v_lshl_add_u32 v24, v34, 3, v24
v_lshrrev_b32 v34, 4, v32
v_lshl_add_u32 v24, v34, 2, v24
v_bfe_u32 v34, v33, 2, 2
v_and_b32 v25, 3, v33
v_lshl_add_u32 v25, v34, 3, v25
v_lshrrev_b32 v34, 4, v33
v_lshl_add_u32 v25, v34, 2, v25
v_mul_u32_u24 v24, 3456, v24
v_and_b32 v32, 1, v1
v_mul_u32_u24 v32, 1152, v32
v_add_u32 v24, v24, v32
v_add_u32 v24, 128, v24
v_lshlrev_b32 v26, 3, v1
v_add_u32 v26, 94208, v26
s_add_u32 m0, s17, 49152
s_add_u32 s21, s42, 0
buffer_load_dwordx4 v2, s[8:11], s21 offen lds
s_add_u32 m0, s17, 53248
s_add_u32 s21, s42, 110592
buffer_load_dwordx4 v2, s[8:11], s21 offen lds
s_add_u32 m0, s17, 57344
s_add_u32 s21, s43, 0
buffer_load_dwordx4 v2, s[8:11], s21 offen lds
s_add_u32 m0, s17, 61440
s_add_u32 s21, s43, 110592
buffer_load_dwordx4 v2, s[8:11], s21 offen lds
s_add_u32 m0, s17, 65536
s_add_u32 s21, s0, 0
buffer_load_dwordx4 v2, s[8:11], s21 offen lds
s_add_u32 m0, s17, 69632
s_add_u32 s21, s0, 110592
buffer_load_dwordx4 v2, s[8:11], s21 offen lds
v_mov_b32 v31, 0
buffer_load_dword v38, v31, s[72:75], 0 offen sc1
buffer_load_dword v55, v39, s[12:15], s6 offen offset:0 sc1
s_waitcnt vmcnt(1)
v_readfirstlane_b32 s76, v38
s_nop 1
s_cmp_eq_u32 s76, 0
s_cbranch_scc1 slow_taga
back_taga:
v_mov_b32 v31, s76
s_waitcnt vmcnt(0)
v_cmp_ne_u32 vcc, s76, v55
s_nop 1
s_cbranch_vccnz slow_a0
back_a0:
buffer_load_dwordx4 a[0:3], v4, s[12:15], s44 offen offset:0 sc1
buffer_load_dwordx4 a[4:7], v5, s[12:15], s44 offen offset:0 sc1
buffer_load_dwordx4 a[8:11], v6, s[12:15], s44 offen offset:0 sc1
buffer_load_dwordx4 a[12:15], v7, s[12:15], s44 offen offset:0 sc1
buffer_load_dwordx4 a[16:19], v4, s[12:15], s44 offen offset:1024 sc1
buffer_load_dwordx4 a[20:23], v5, s[12:15], s44 offen offset:1024 sc1
buffer_load_dwordx4 a[24:27], v6, s[12:15], s44 offen offset:1024 sc1
buffer_load_dwordx4 a[28:31], v7, s[12:15], s44 offen offset:1024 sc1
buffer_load_dwordx4 a[32:35], v4, s[12:15], s45 offen offset:0 sc1
buffer_load_dwordx4 a[36:39], v5, s[12:15], s45 offen offset:0 sc1
buffer_load_dwordx4 a[40:43], v6, s[12:15], s45 offen offset:0 sc1
buffer_load_dwordx4 a[44:47], v7, s[12:15], s45 offen offset:0 sc1
buffer_load_dwordx4 a[48:51], v4, s[12:15], s45 offen offset:1024 sc1
buffer_load_dwordx4 a[52:55], v5, s[12:15], s45 offen offset:1024 sc1
buffer_load_dwordx4 a[56:59], v6, s[12:15], s45 offen offset:1024 sc1
buffer_load_dwordx4 a[60:63], v7, s[12:15], s45 offen offset:1024 sc1
buffer_load_dwordx4 a[64:67], v4, s[12:15], s46 offen offset:0 sc1
buffer_load_dwordx4 a[68:71], v5, s[12:15], s46 offen offset:0 sc1
buffer_load_dwordx4 a[72:75], v6, s[12:15], s46 offen offset:0 sc1
buffer_load_dwordx4 a[76:79], v7, s[12:15], s46 offen offset:0 sc1
buffer_load_dwordx4 a[80:83], v4, s[12:15], s46 offen offset:1024 sc1
buffer_load_dwordx4 a[84:87], v5, s[12:15], s46 offen offset:1024 sc1
buffer_load_dwordx4 a[88:91], v6, s[12:15], s46 offen offset:1024 sc1
buffer_load_dwordx4 a[92:95], v7, s[12:15], s46 offen offset:1024 sc1
s_barrier
ds_read_b64_tr_b16 v[200:201], v12 offset:0
ds_read_b64_tr_b16 v[202:203], v12 offset:2048
ds_read_b64_tr_b16 v[204:205], v12 offset:4096
ds_read_b64_tr_b16 v[206:207], v12 offset:6144
ds_read_b64_tr_b16 v[208:209], v13 offset:0
ds_read_b64_tr_b16 v[210:211], v13 offset:2048
ds_read_b64_tr_b16 v[212:213], v13 offset:4096
ds_read_b64_tr_b16 v[214:215], v13 offset:6144
s_waitcnt lgkmcnt(4) vmcnt(23)
v_mfma_f32_16x16x32_bf16 v[56:59], a[0:3], v[200:203], 0
s_waitcnt vmcnt(19)
ds_read_b64_tr_b16 v[216:217], v14 offset:0
v_mfma_f32_16x16x32_bf16 v[56:59], a[16:19], v[204:207], v[56:59]
v_mfma_f32_16x16x32_bf16 v[60:63], a[4:7], v[200:203], 0
s_waitcnt vmcnt(18)
ds_read_b64_tr_b16 v[218:219], v14 offset:2048
v_mfma_f32_16x16x32_bf16 v[60:63], a[20:23], v[204:207], v[60:63]
v_mfma_f32_16x16x32_bf16 v[64:67], a[8:11], v[200:203], 0
s_waitcnt vmcnt(17)
ds_read_b64_tr_b16 v[220:221], v14 offset:4096
v_mfma_f32_16x16x32_bf16 v[64:67], a[24:27], v[204:207], v[64:67]
v_mfma_f32_16x16x32_bf16 v[68:71], a[12:15], v[200:203], 0
s_waitcnt vmcnt(16)
ds_read_b64_tr_b16 v[222:223], v14 offset:6144
v_mfma_f32_16x16x32_bf16 v[68:71], a[28:31], v[204:207], v[68:71]
s_waitcnt lgkmcnt(4)
v_mfma_f32_16x16x32_bf16 v[72:75], a[0:3], v[208:211], 0
ds_read_b64_tr_b16 v[200:201], v15 offset:0
v_mfma_f32_16x16x32_bf16 v[72:75], a[16:19], v[212:215], v[72:75]
buffer_load_dwordx4 a[96:99], v4, s[12:15], s47 offen offset:0 sc1
v_mfma_f32_16x16x32_bf16 v[76:79], a[4:7], v[208:211], 0
ds_read_b64_tr_b16 v[202:203], v15 offset:2048
v_mfma_f32_16x16x32_bf16 v[76:79], a[20:23], v[212:215], v[76:79]
buffer_load_dwordx4 a[100:103], v5, s[12:15], s47 offen offset:0 sc1
v_mfma_f32_16x16x32_bf16 v[80:83], a[8:11], v[208:211], 0
ds_read_b64_tr_b16 v[204:205], v15 offset:4096
v_mfma_f32_16x16x32_bf16 v[80:83], a[24:27], v[212:215], v[80:83]
buffer_load_dwordx4 a[104:107], v6, s[12:15], s47 offen offset:0 sc1
v_mfma_f32_16x16x32_bf16 v[84:87], a[12:15], v[208:211], 0
ds_read_b64_tr_b16 v[206:207], v15 offset:6144
v_mfma_f32_16x16x32_bf16 v[84:87], a[28:31], v[212:215], v[84:87]
s_waitcnt lgkmcnt(4)
v_mfma_f32_16x16x32_bf16 v[88:91], a[0:3], v[216:219], 0
s_barrier
v_mfma_f32_16x16x32_bf16 v[88:91], a[16:19], v[220:223], v[88:91]
ds_read_b64_tr_b16 v[208:209], v12 offset:8192
v_mfma_f32_16x16x32_bf16 v[92:95], a[4:7], v[216:219], 0
ds_read_b64_tr_b16 v[210:211], v12 offset:10240
v_mfma_f32_16x16x32_bf16 v[92:95], a[20:23], v[220:223], v[92:95]
buffer_load_dwordx4 a[108:111], v7, s[12:15], s47 offen offset:0 sc1
v_mfma_f32_16x16x32_bf16 v[96:99], a[8:11], v[216:219], 0
ds_read_b64_tr_b16 v[212:213], v12 offset:12288
v_mfma_f32_16x16x32_bf16 v[96:99], a[24:27], v[220:223], v[96:99]
buffer_load_dwordx4 a[112:115], v4, s[12:15], s47 offen offset:1024 sc1
v_mfma_f32_16x16x32_bf16 v[100:103], a[12:15], v[216:219], 0
ds_read_b64_tr_b16 v[214:215], v12 offset:14336
v_mfma_f32_16x16x32_bf16 v[100:103], a[28:31], v[220:223], v[100:103]
s_waitcnt lgkmcnt(4)
v_mfma_f32_16x16x32_bf16 v[104:107], a[0:3], v[200:203], 0
ds_read_b64_tr_b16 v[216:217], v13 offset:8192
v_mfma_f32_16x16x32_bf16 v[104:107], a[16:19], v[204:207], v[104:107]
buffer_load_dwordx4 a[116:119], v5, s[12:15], s47 offen offset:1024 sc1
v_mfma_f32_16x16x32_bf16 v[108:111], a[4:7], v[200:203], 0
ds_read_b64_tr_b16 v[218:219], v13 offset:10240
v_mfma_f32_16x16x32_bf16 v[108:111], a[20:23], v[204:207], v[108:111]
buffer_load_dwordx4 a[120:123], v6, s[12:15], s47 offen offset:1024 sc1
v_mfma_f32_16x16x32_bf16 v[112:115], a[8:11], v[200:203], 0
ds_read_b64_tr_b16 v[220:221], v13 offset:12288
v_mfma_f32_16x16x32_bf16 v[112:115], a[24:27], v[204:207], v[112:115]
buffer_load_dwordx4 a[124:127], v7, s[12:15], s47 offen offset:1024 sc1
v_mfma_f32_16x16x32_bf16 v[116:119], a[12:15], v[200:203], 0
ds_read_b64_tr_b16 v[222:223], v13 offset:14336
v_mfma_f32_16x16x32_bf16 v[116:119], a[28:31], v[204:207], v[116:119]
s_waitcnt lgkmcnt(4) vmcnt(23)
v_mfma_f32_16x16x32_bf16 v[56:59], a[32:35], v[208:211], v[56:59]
s_waitcnt vmcnt(19)
ds_read_b64_tr_b16 v[200:201], v14 offset:8192
v_mfma_f32_16x16x32_bf16 v[56:59], a[48:51], v[212:215], v[56:59]
v_mfma_f32_16x16x32_bf16 v[60:63], a[36:39], v[208:211], v[60:63]
s_waitcnt vmcnt(18)
ds_read_b64_tr_b16 v[202:203], v14 offset:10240
v_mfma_f32_16x16x32_bf16 v[60:63], a[52:55], v[212:215], v[60:63]
v_mfma_f32_16x16x32_bf16 v[64:67], a[40:43], v[208:211], v[64:67]
s_waitcnt vmcnt(17)
ds_read_b64_tr_b16 v[204:205], v14 offset:12288
v_mfma_f32_16x16x32_bf16 v[64:67], a[56:59], v[212:215], v[64:67]
v_mfma_f32_16x16x32_bf16 v[68:71], a[44:47], v[208:211], v[68:71]
s_waitcnt vmcnt(16)
ds_read_b64_tr_b16 v[206:207], v14 offset:14336
v_mfma_f32_16x16x32_bf16 v[68:71], a[60:63], v[212:215], v[68:71]
s_waitcnt lgkmcnt(4)
v_mfma_f32_16x16x32_bf16 v[72:75], a[32:35], v[216:219], v[72:75]
ds_read_b64_tr_b16 v[208:209], v15 offset:8192
v_mfma_f32_16x16x32_bf16 v[72:75], a[48:51], v[220:223], v[72:75]
buffer_load_dwordx4 a[128:131], v4, s[12:15], s48 offen offset:0 sc1
v_mfma_f32_16x16x32_bf16 v[76:79], a[36:39], v[216:219], v[76:79]
ds_read_b64_tr_b16 v[210:211], v15 offset:10240
v_mfma_f32_16x16x32_bf16 v[76:79], a[52:55], v[220:223], v[76:79]
buffer_load_dwordx4 a[132:135], v5, s[12:15], s48 offen offset:0 sc1
v_mfma_f32_16x16x32_bf16 v[80:83], a[40:43], v[216:219], v[80:83]
ds_read_b64_tr_b16 v[212:213], v15 offset:12288
v_mfma_f32_16x16x32_bf16 v[80:83], a[56:59], v[220:223], v[80:83]
buffer_load_dwordx4 a[136:139], v6, s[12:15], s48 offen offset:0 sc1
v_mfma_f32_16x16x32_bf16 v[84:87], a[44:47], v[216:219], v[84:87]
ds_read_b64_tr_b16 v[214:215], v15 offset:14336
v_mfma_f32_16x16x32_bf16 v[84:87], a[60:63], v[220:223], v[84:87]
s_waitcnt lgkmcnt(4)
v_mfma_f32_16x16x32_bf16 v[88:91], a[32:35], v[200:203], v[88:91]
s_barrier
v_mfma_f32_16x16x32_bf16 v[88:91], a[48:51], v[204:207], v[88:91]
ds_read_b64_tr_b16 v[216:217], v12 offset:16384
v_mfma_f32_16x16x32_bf16 v[92:95], a[36:39], v[200:203], v[92:95]
ds_read_b64_tr_b16 v[218:219], v12 offset:18432
v_mfma_f32_16x16x32_bf16 v[92:95], a[52:55], v[204:207], v[92:95]
buffer_load_dwordx4 a[140:143], v7, s[12:15], s48 offen offset:0 sc1
v_mfma_f32_16x16x32_bf16 v[96:99], a[40:43], v[200:203], v[96:99]
ds_read_b64_tr_b16 v[220:221], v12 offset:20480
v_mfma_f32_16x16x32_bf16 v[96:99], a[56:59], v[204:207], v[96:99]
buffer_load_dwordx4 a[144:147], v4, s[12:15], s48 offen offset:1024 sc1
v_mfma_f32_16x16x32_bf16 v[100:103], a[44:47], v[200:203], v[100:103]
ds_read_b64_tr_b16 v[222:223], v12 offset:22528
v_mfma_f32_16x16x32_bf16 v[100:103], a[60:63], v[204:207], v[100:103]
s_waitcnt lgkmcnt(4)
v_mfma_f32_16x16x32_bf16 v[104:107], a[32:35], v[208:211], v[104:107]
ds_read_b64_tr_b16 v[200:201], v13 offset:16384
v_mfma_f32_16x16x32_bf16 v[104:107], a[48:51], v[212:215], v[104:107]
buffer_load_dwordx4 a[148:151], v5, s[12:15], s48 offen offset:1024 sc1
v_mfma_f32_16x16x32_bf16 v[108:111], a[36:39], v[208:211], v[108:111]
ds_read_b64_tr_b16 v[202:203], v13 offset:18432
v_mfma_f32_16x16x32_bf16 v[108:111], a[52:55], v[212:215], v[108:111]
buffer_load_dwordx4 a[152:155], v6, s[12:15], s48 offen offset:1024 sc1
v_mfma_f32_16x16x32_bf16 v[112:115], a[40:43], v[208:211], v[112:115]
ds_read_b64_tr_b16 v[204:205], v13 offset:20480
v_mfma_f32_16x16x32_bf16 v[112:115], a[56:59], v[212:215], v[112:115]
buffer_load_dwordx4 a[156:159], v7, s[12:15], s48 offen offset:1024 sc1
v_mfma_f32_16x16x32_bf16 v[116:119], a[44:47], v[208:211], v[116:119]
ds_read_b64_tr_b16 v[206:207], v13 offset:22528
v_mfma_f32_16x16x32_bf16 v[116:119], a[60:63], v[212:215], v[116:119]
s_waitcnt lgkmcnt(4) vmcnt(23)
v_mfma_f32_16x16x32_bf16 v[56:59], a[64:67], v[216:219], v[56:59]
s_waitcnt vmcnt(19)
ds_read_b64_tr_b16 v[208:209], v14 offset:16384
v_mfma_f32_16x16x32_bf16 v[56:59], a[80:83], v[220:223], v[56:59]
v_mfma_f32_16x16x32_bf16 v[60:63], a[68:71], v[216:219], v[60:63]
s_waitcnt vmcnt(18)
ds_read_b64_tr_b16 v[210:211], v14 offset:18432
v_mfma_f32_16x16x32_bf16 v[60:63], a[84:87], v[220:223], v[60:63]
v_mfma_f32_16x16x32_bf16 v[64:67], a[72:75], v[216:219], v[64:67]
s_waitcnt vmcnt(17)
ds_read_b64_tr_b16 v[212:213], v14 offset:20480
v_mfma_f32_16x16x32_bf16 v[64:67], a[88:91], v[220:223], v[64:67]
v_mfma_f32_16x16x32_bf16 v[68:71], a[76:79], v[216:219], v[68:71]
s_waitcnt vmcnt(16)
ds_read_b64_tr_b16 v[214:215], v14 offset:22528
v_mfma_f32_16x16x32_bf16 v[68:71], a[92:95], v[220:223], v[68:71]
s_waitcnt lgkmcnt(4)
v_mfma_f32_16x16x32_bf16 v[72:75], a[64:67], v[200:203], v[72:75]
ds_read_b64_tr_b16 v[216:217], v15 offset:16384
v_mfma_f32_16x16x32_bf16 v[72:75], a[80:83], v[204:207], v[72:75]
buffer_load_dwordx4 a[160:163], v4, s[12:15], s49 offen offset:0 sc1
v_mfma_f32_16x16x32_bf16 v[76:79], a[68:71], v[200:203], v[76:79]
ds_read_b64_tr_b16 v[218:219], v15 offset:18432
v_mfma_f32_16x16x32_bf16 v[76:79], a[84:87], v[204:207], v[76:79]
buffer_load_dwordx4 a[164:167], v5, s[12:15], s49 offen offset:0 sc1
v_mfma_f32_16x16x32_bf16 v[80:83], a[72:75], v[200:203], v[80:83]
ds_read_b64_tr_b16 v[220:221], v15 offset:20480
v_mfma_f32_16x16x32_bf16 v[80:83], a[88:91], v[204:207], v[80:83]
buffer_load_dwordx4 a[168:171], v6, s[12:15], s49 offen offset:0 sc1
v_mfma_f32_16x16x32_bf16 v[84:87], a[76:79], v[200:203], v[84:87]
ds_read_b64_tr_b16 v[222:223], v15 offset:22528
v_mfma_f32_16x16x32_bf16 v[84:87], a[92:95], v[204:207], v[84:87]
s_waitcnt lgkmcnt(4)
v_mfma_f32_16x16x32_bf16 v[88:91], a[64:67], v[208:211], v[88:91]
s_barrier
v_mfma_f32_16x16x32_bf16 v[88:91], a[80:83], v[212:215], v[88:91]
ds_read_b64_tr_b16 v[200:201], v12 offset:24576
v_mfma_f32_16x16x32_bf16 v[92:95], a[68:71], v[208:211], v[92:95]
ds_read_b64_tr_b16 v[202:203], v12 offset:26624
v_mfma_f32_16x16x32_bf16 v[92:95], a[84:87], v[212:215], v[92:95]
buffer_load_dwordx4 a[172:175], v7, s[12:15], s49 offen offset:0 sc1
v_mfma_f32_16x16x32_bf16 v[96:99], a[72:75], v[208:211], v[96:99]
ds_read_b64_tr_b16 v[204:205], v12 offset:28672
v_mfma_f32_16x16x32_bf16 v[96:99], a[88:91], v[212:215], v[96:99]
buffer_load_dwordx4 a[176:179], v4, s[12:15], s49 offen offset:1024 sc1
v_mfma_f32_16x16x32_bf16 v[100:103], a[76:79], v[208:211], v[100:103]
ds_read_b64_tr_b16 v[206:207], v12 offset:30720
v_mfma_f32_16x16x32_bf16 v[100:103], a[92:95], v[212:215], v[100:103]
s_waitcnt lgkmcnt(4)
v_mfma_f32_16x16x32_bf16 v[104:107], a[64:67], v[216:219], v[104:107]
ds_read_b64_tr_b16 v[208:209], v13 offset:24576
v_mfma_f32_16x16x32_bf16 v[104:107], a[80:83], v[220:223], v[104:107]
buffer_load_dwordx4 a[180:183], v5, s[12:15], s49 offen offset:1024 sc1
v_mfma_f32_16x16x32_bf16 v[108:111], a[68:71], v[216:219], v[108:111]
ds_read_b64_tr_b16 v[210:211], v13 offset:26624
v_mfma_f32_16x16x32_bf16 v[108:111], a[84:87], v[220:223], v[108:111]
buffer_load_dwordx4 a[184:187], v6, s[12:15], s49 offen offset:1024 sc1
v_mfma_f32_16x16x32_bf16 v[112:115], a[72:75], v[216:219], v[112:115]
ds_read_b64_tr_b16 v[212:213], v13 offset:28672
v_mfma_f32_16x16x32_bf16 v[112:115], a[88:91], v[220:223], v[112:115]
buffer_load_dwordx4 a[188:191], v7, s[12:15], s49 offen offset:1024 sc1
v_mfma_f32_16x16x32_bf16 v[116:119], a[76:79], v[216:219], v[116:119]
ds_read_b64_tr_b16 v[214:215], v13 offset:30720
v_mfma_f32_16x16x32_bf16 v[116:119], a[92:95], v[220:223], v[116:119]
s_waitcnt lgkmcnt(4) vmcnt(23)
v_mfma_f32_16x16x32_bf16 v[56:59], a[96:99], v[200:203], v[56:59]
s_waitcnt vmcnt(19)
ds_read_b64_tr_b16 v[216:217], v14 offset:24576
v_mfma_f32_16x16x32_bf16 v[56:59], a[112:115], v[204:207], v[56:59]
v_mfma_f32_16x16x32_bf16 v[60:63], a[100:103], v[200:203], v[60:63]
s_waitcnt vmcnt(18)
ds_read_b64_tr_b16 v[218:219], v14 offset:26624
v_mfma_f32_16x16x32_bf16 v[60:63], a[116:119], v[204:207], v[60:63]
v_mfma_f32_16x16x32_bf16 v[64:67], a[104:107], v[200:203], v[64:67]
s_waitcnt vmcnt(17)
ds_read_b64_tr_b16 v[220:221], v14 offset:28672
v_mfma_f32_16x16x32_bf16 v[64:67], a[120:123], v[204:207], v[64:67]
v_mfma_f32_16x16x32_bf16 v[68:71], a[108:111], v[200:203], v[68:71]
s_waitcnt vmcnt(16)
ds_read_b64_tr_b16 v[222:223], v14 offset:30720
v_mfma_f32_16x16x32_bf16 v[68:71], a[124:127], v[204:207], v[68:71]
s_waitcnt lgkmcnt(4)
v_mfma_f32_16x16x32_bf16 v[72:75], a[96:99], v[208:211], v[72:75]
ds_read_b64_tr_b16 v[200:201], v15 offset:24576
v_mfma_f32_16x16x32_bf16 v[72:75], a[112:115], v[212:215], v[72:75]
buffer_load_dwordx4 a[192:195], v4, s[12:15], s50 offen offset:0 sc1
v_mfma_f32_16x16x32_bf16 v[76:79], a[100:103], v[208:211], v[76:79]
ds_read_b64_tr_b16 v[202:203], v15 offset:26624
v_mfma_f32_16x16x32_bf16 v[76:79], a[116:119], v[212:215], v[76:79]
buffer_load_dwordx4 a[196:199], v5, s[12:15], s50 offen offset:0 sc1
v_mfma_f32_16x16x32_bf16 v[80:83], a[104:107], v[208:211], v[80:83]
ds_read_b64_tr_b16 v[204:205], v15 offset:28672
v_mfma_f32_16x16x32_bf16 v[80:83], a[120:123], v[212:215], v[80:83]
buffer_load_dwordx4 a[200:203], v6, s[12:15], s50 offen offset:0 sc1
v_mfma_f32_16x16x32_bf16 v[84:87], a[108:111], v[208:211], v[84:87]
ds_read_b64_tr_b16 v[206:207], v15 offset:30720
v_mfma_f32_16x16x32_bf16 v[84:87], a[124:127], v[212:215], v[84:87]
s_waitcnt lgkmcnt(4)
v_mfma_f32_16x16x32_bf16 v[88:91], a[96:99], v[216:219], v[88:91]
s_barrier
v_mfma_f32_16x16x32_bf16 v[88:91], a[112:115], v[220:223], v[88:91]
ds_read_b64_tr_b16 v[208:209], v12 offset:32768
v_mfma_f32_16x16x32_bf16 v[92:95], a[100:103], v[216:219], v[92:95]
ds_read_b64_tr_b16 v[210:211], v12 offset:34816
v_mfma_f32_16x16x32_bf16 v[92:95], a[116:119], v[220:223], v[92:95]
buffer_load_dwordx4 a[204:207], v7, s[12:15], s50 offen offset:0 sc1
v_mfma_f32_16x16x32_bf16 v[96:99], a[104:107], v[216:219], v[96:99]
ds_read_b64_tr_b16 v[212:213], v12 offset:36864
v_mfma_f32_16x16x32_bf16 v[96:99], a[120:123], v[220:223], v[96:99]
buffer_load_dwordx4 a[208:211], v4, s[12:15], s50 offen offset:1024 sc1
v_mfma_f32_16x16x32_bf16 v[100:103], a[108:111], v[216:219], v[100:103]
ds_read_b64_tr_b16 v[214:215], v12 offset:38912
v_mfma_f32_16x16x32_bf16 v[100:103], a[124:127], v[220:223], v[100:103]
s_waitcnt lgkmcnt(4)
v_mfma_f32_16x16x32_bf16 v[104:107], a[96:99], v[200:203], v[104:107]
ds_read_b64_tr_b16 v[216:217], v13 offset:32768
v_mfma_f32_16x16x32_bf16 v[104:107], a[112:115], v[204:207], v[104:107]
buffer_load_dwordx4 a[212:215], v5, s[12:15], s50 offen offset:1024 sc1
v_mfma_f32_16x16x32_bf16 v[108:111], a[100:103], v[200:203], v[108:111]
ds_read_b64_tr_b16 v[218:219], v13 offset:34816
v_mfma_f32_16x16x32_bf16 v[108:111], a[116:119], v[204:207], v[108:111]
buffer_load_dwordx4 a[216:219], v6, s[12:15], s50 offen offset:1024 sc1
v_mfma_f32_16x16x32_bf16 v[112:115], a[104:107], v[200:203], v[112:115]
ds_read_b64_tr_b16 v[220:221], v13 offset:36864
v_mfma_f32_16x16x32_bf16 v[112:115], a[120:123], v[204:207], v[112:115]
buffer_load_dwordx4 a[220:223], v7, s[12:15], s50 offen offset:1024 sc1
v_mfma_f32_16x16x32_bf16 v[116:119], a[108:111], v[200:203], v[116:119]
ds_read_b64_tr_b16 v[222:223], v13 offset:38912
v_mfma_f32_16x16x32_bf16 v[116:119], a[124:127], v[204:207], v[116:119]
s_waitcnt lgkmcnt(4) vmcnt(23)
v_mfma_f32_16x16x32_bf16 v[56:59], a[128:131], v[208:211], v[56:59]
s_waitcnt vmcnt(19)
ds_read_b64_tr_b16 v[200:201], v14 offset:32768
v_mfma_f32_16x16x32_bf16 v[56:59], a[144:147], v[212:215], v[56:59]
v_mfma_f32_16x16x32_bf16 v[60:63], a[132:135], v[208:211], v[60:63]
s_waitcnt vmcnt(18)
ds_read_b64_tr_b16 v[202:203], v14 offset:34816
v_mfma_f32_16x16x32_bf16 v[60:63], a[148:151], v[212:215], v[60:63]
v_mfma_f32_16x16x32_bf16 v[64:67], a[136:139], v[208:211], v[64:67]
s_waitcnt vmcnt(17)
ds_read_b64_tr_b16 v[204:205], v14 offset:36864
v_mfma_f32_16x16x32_bf16 v[64:67], a[152:155], v[212:215], v[64:67]
v_mfma_f32_16x16x32_bf16 v[68:71], a[140:143], v[208:211], v[68:71]
s_waitcnt vmcnt(16)
ds_read_b64_tr_b16 v[206:207], v14 offset:38912
v_mfma_f32_16x16x32_bf16 v[68:71], a[156:159], v[212:215], v[68:71]
s_waitcnt lgkmcnt(4)
v_mfma_f32_16x16x32_bf16 v[72:75], a[128:131], v[216:219], v[72:75]
ds_read_b64_tr_b16 v[208:209], v15 offset:32768
v_mfma_f32_16x16x32_bf16 v[72:75], a[144:147], v[220:223], v[72:75]
buffer_load_dwordx4 a[224:227], v4, s[12:15], s51 offen offset:0 sc1
v_mfma_f32_16x16x32_bf16 v[76:79], a[132:135], v[216:219], v[76:79]
ds_read_b64_tr_b16 v[210:211], v15 offset:34816
v_mfma_f32_16x16x32_bf16 v[76:79], a[148:151], v[220:223], v[76:79]
buffer_load_dwordx4 a[228:231], v5, s[12:15], s51 offen offset:0 sc1
v_mfma_f32_16x16x32_bf16 v[80:83], a[136:139], v[216:219], v[80:83]
ds_read_b64_tr_b16 v[212:213], v15 offset:36864
v_mfma_f32_16x16x32_bf16 v[80:83], a[152:155], v[220:223], v[80:83]
buffer_load_dwordx4 a[232:235], v6, s[12:15], s51 offen offset:0 sc1
v_mfma_f32_16x16x32_bf16 v[84:87], a[140:143], v[216:219], v[84:87]
ds_read_b64_tr_b16 v[214:215], v15 offset:38912
v_mfma_f32_16x16x32_bf16 v[84:87], a[156:159], v[220:223], v[84:87]
s_waitcnt lgkmcnt(4)
v_mfma_f32_16x16x32_bf16 v[88:91], a[128:131], v[200:203], v[88:91]
s_barrier
v_mfma_f32_16x16x32_bf16 v[88:91], a[144:147], v[204:207], v[88:91]
ds_read_b64_tr_b16 v[216:217], v12 offset:40960
v_mfma_f32_16x16x32_bf16 v[92:95], a[132:135], v[200:203], v[92:95]
ds_read_b64_tr_b16 v[218:219], v12 offset:43008
v_mfma_f32_16x16x32_bf16 v[92:95], a[148:151], v[204:207], v[92:95]
buffer_load_dwordx4 a[236:239], v7, s[12:15], s51 offen offset:0 sc1
v_mfma_f32_16x16x32_bf16 v[96:99], a[136:139], v[200:203], v[96:99]
ds_read_b64_tr_b16 v[220:221], v12 offset:45056
v_mfma_f32_16x16x32_bf16 v[96:99], a[152:155], v[204:207], v[96:99]
buffer_load_dwordx4 a[240:243], v4, s[12:15], s51 offen offset:1024 sc1
v_mfma_f32_16x16x32_bf16 v[100:103], a[140:143], v[200:203], v[100:103]
ds_read_b64_tr_b16 v[222:223], v12 offset:47104
v_mfma_f32_16x16x32_bf16 v[100:103], a[156:159], v[204:207], v[100:103]
s_waitcnt lgkmcnt(4)
v_mfma_f32_16x16x32_bf16 v[104:107], a[128:131], v[208:211], v[104:107]
ds_read_b64_tr_b16 v[200:201], v13 offset:40960
v_mfma_f32_16x16x32_bf16 v[104:107], a[144:147], v[212:215], v[104:107]
buffer_load_dwordx4 a[244:247], v5, s[12:15], s51 offen offset:1024 sc1
v_mfma_f32_16x16x32_bf16 v[108:111], a[132:135], v[208:211], v[108:111]
ds_read_b64_tr_b16 v[202:203], v13 offset:43008
v_mfma_f32_16x16x32_bf16 v[108:111], a[148:151], v[212:215], v[108:111]
buffer_load_dwordx4 a[248:251], v6, s[12:15], s51 offen offset:1024 sc1
v_mfma_f32_16x16x32_bf16 v[112:115], a[136:139], v[208:211], v[112:115]
ds_read_b64_tr_b16 v[204:205], v13 offset:45056
v_mfma_f32_16x16x32_bf16 v[112:115], a[152:155], v[212:215], v[112:115]
buffer_load_dwordx4 a[252:255], v7, s[12:15], s51 offen offset:1024 sc1
v_mfma_f32_16x16x32_bf16 v[116:119], a[140:143], v[208:211], v[116:119]
ds_read_b64_tr_b16 v[206:207], v13 offset:47104
v_mfma_f32_16x16x32_bf16 v[116:119], a[156:159], v[212:215], v[116:119]
s_waitcnt lgkmcnt(4) vmcnt(23)
v_mfma_f32_16x16x32_bf16 v[56:59], a[160:163], v[216:219], v[56:59]
s_waitcnt vmcnt(19)
ds_read_b64_tr_b16 v[208:209], v14 offset:40960
v_mfma_f32_16x16x32_bf16 v[56:59], a[176:179], v[220:223], v[56:59]
v_mfma_f32_16x16x32_bf16 v[60:63], a[164:167], v[216:219], v[60:63]
s_waitcnt vmcnt(18)
ds_read_b64_tr_b16 v[210:211], v14 offset:43008
v_mfma_f32_16x16x32_bf16 v[60:63], a[180:183], v[220:223], v[60:63]
v_mfma_f32_16x16x32_bf16 v[64:67], a[168:171], v[216:219], v[64:67]
s_waitcnt vmcnt(17)
ds_read_b64_tr_b16 v[212:213], v14 offset:45056
v_mfma_f32_16x16x32_bf16 v[64:67], a[184:187], v[220:223], v[64:67]
v_mfma_f32_16x16x32_bf16 v[68:71], a[172:175], v[216:219], v[68:71]
s_waitcnt vmcnt(16)
ds_read_b64_tr_b16 v[214:215], v14 offset:47104
v_mfma_f32_16x16x32_bf16 v[68:71], a[188:191], v[220:223], v[68:71]
s_waitcnt lgkmcnt(4)
v_mfma_f32_16x16x32_bf16 v[72:75], a[160:163], v[200:203], v[72:75]
ds_read_b64_tr_b16 v[216:217], v15 offset:40960
v_mfma_f32_16x16x32_bf16 v[72:75], a[176:179], v[204:207], v[72:75]
buffer_load_dwordx4 v[224:227], v4, s[12:15], s32 offen offset:0 sc1
v_mfma_f32_16x16x32_bf16 v[76:79], a[164:167], v[200:203], v[76:79]
ds_read_b64_tr_b16 v[218:219], v15 offset:43008
v_mfma_f32_16x16x32_bf16 v[76:79], a[180:183], v[204:207], v[76:79]
buffer_load_dwordx4 v[228:231], v5, s[12:15], s32 offen offset:0 sc1
v_mfma_f32_16x16x32_bf16 v[80:83], a[168:171], v[200:203], v[80:83]
ds_read_b64_tr_b16 v[220:221], v15 offset:45056
v_mfma_f32_16x16x32_bf16 v[80:83], a[184:187], v[204:207], v[80:83]
buffer_load_dwordx4 v[232:235], v6, s[12:15], s32 offen offset:0 sc1
v_mfma_f32_16x16x32_bf16 v[84:87], a[172:175], v[200:203], v[84:87]
ds_read_b64_tr_b16 v[222:223], v15 offset:47104
v_mfma_f32_16x16x32_bf16 v[84:87], a[188:191], v[204:207], v[84:87]
s_waitcnt lgkmcnt(4)
v_mfma_f32_16x16x32_bf16 v[88:91], a[160:163], v[208:211], v[88:91]
s_barrier
v_mfma_f32_16x16x32_bf16 v[88:91], a[176:179], v[212:215], v[88:91]
ds_read_b64_tr_b16 v[200:201], v16 offset:0
v_mfma_f32_16x16x32_bf16 v[92:95], a[164:167], v[208:211], v[92:95]
ds_read_b64_tr_b16 v[202:203], v16 offset:2048
v_mfma_f32_16x16x32_bf16 v[92:95], a[180:183], v[212:215], v[92:95]
buffer_load_dwordx4 v[236:239], v7, s[12:15], s32 offen offset:0 sc1
v_mfma_f32_16x16x32_bf16 v[96:99], a[168:171], v[208:211], v[96:99]
ds_read_b64_tr_b16 v[204:205], v16 offset:4096
v_mfma_f32_16x16x32_bf16 v[96:99], a[184:187], v[212:215], v[96:99]
buffer_load_dwordx4 v[240:243], v4, s[12:15], s32 offen offset:1024 sc1
v_mfma_f32_16x16x32_bf16 v[100:103], a[172:175], v[208:211], v[100:103]
ds_read_b64_tr_b16 v[206:207], v16 offset:6144
v_mfma_f32_16x16x32_bf16 v[100:103], a[188:191], v[212:215], v[100:103]
s_waitcnt lgkmcnt(4)
v_mfma_f32_16x16x32_bf16 v[104:107], a[160:163], v[216:219], v[104:107]
ds_read_b64_tr_b16 v[208:209], v17 offset:0
v_mfma_f32_16x16x32_bf16 v[104:107], a[176:179], v[220:223], v[104:107]
buffer_load_dwordx4 v[244:247], v5, s[12:15], s32 offen offset:1024 sc1
v_mfma_f32_16x16x32_bf16 v[108:111], a[164:167], v[216:219], v[108:111]
ds_read_b64_tr_b16 v[210:211], v17 offset:2048
v_mfma_f32_16x16x32_bf16 v[108:111], a[180:183], v[220:223], v[108:111]
buffer_load_dwordx4 v[248:251], v6, s[12:15], s32 offen offset:1024 sc1
v_mfma_f32_16x16x32_bf16 v[112:115], a[168:171], v[216:219], v[112:115]
ds_read_b64_tr_b16 v[212:213], v17 offset:4096
v_mfma_f32_16x16x32_bf16 v[112:115], a[184:187], v[220:223], v[112:115]
buffer_load_dwordx4 v[252:255], v7, s[12:15], s32 offen offset:1024 sc1
v_mfma_f32_16x16x32_bf16 v[116:119], a[172:175], v[216:219], v[116:119]
ds_read_b64_tr_b16 v[214:215], v17 offset:6144
v_mfma_f32_16x16x32_bf16 v[116:119], a[188:191], v[220:223], v[116:119]
s_waitcnt lgkmcnt(4) vmcnt(23)
v_mfma_f32_16x16x32_bf16 v[56:59], a[192:195], v[200:203], v[56:59]
s_waitcnt vmcnt(19)
ds_read_b64_tr_b16 v[216:217], v18 offset:0
v_mfma_f32_16x16x32_bf16 v[56:59], a[208:211], v[204:207], v[56:59]
s_add_u32 m0, s17, 73728
s_add_u32 s21, s33, 1152
v_mfma_f32_16x16x32_bf16 v[60:63], a[196:199], v[200:203], v[60:63]
s_waitcnt vmcnt(18)
ds_read_b64_tr_b16 v[218:219], v18 offset:2048
v_mfma_f32_16x16x32_bf16 v[60:63], a[212:215], v[204:207], v[60:63]
v_mfma_f32_16x16x32_bf16 v[64:67], a[200:203], v[200:203], v[64:67]
s_waitcnt vmcnt(17)
ds_read_b64_tr_b16 v[220:221], v18 offset:4096
v_mfma_f32_16x16x32_bf16 v[64:67], a[216:219], v[204:207], v[64:67]
v_mfma_f32_16x16x32_bf16 v[68:71], a[204:207], v[200:203], v[68:71]
s_waitcnt vmcnt(16)
ds_read_b64_tr_b16 v[222:223], v18 offset:6144
v_mfma_f32_16x16x32_bf16 v[68:71], a[220:223], v[204:207], v[68:71]
s_waitcnt lgkmcnt(4)
v_mfma_f32_16x16x32_bf16 v[72:75], a[192:195], v[208:211], v[72:75]
ds_read_b64_tr_b16 v[200:201], v19 offset:0
v_mfma_f32_16x16x32_bf16 v[72:75], a[208:211], v[212:215], v[72:75]
buffer_load_dwordx4 v2, s[8:11], s21 offen lds
v_mfma_f32_16x16x32_bf16 v[76:79], a[196:199], v[208:211], v[76:79]
s_add_u32 m0, s17, 77824
ds_read_b64_tr_b16 v[202:203], v19 offset:2048
v_mfma_f32_16x16x32_bf16 v[76:79], a[212:215], v[212:215], v[76:79]
s_add_u32 s21, s33, 111744
v_mfma_f32_16x16x32_bf16 v[80:83], a[200:203], v[208:211], v[80:83]
ds_read_b64_tr_b16 v[204:205], v19 offset:4096
v_mfma_f32_16x16x32_bf16 v[80:83], a[216:219], v[212:215], v[80:83]
buffer_load_dwordx4 v2, s[8:11], s21 offen lds
v_mfma_f32_16x16x32_bf16 v[84:87], a[204:207], v[208:211], v[84:87]
s_add_u32 m0, s17, 0
ds_read_b64_tr_b16 v[206:207], v19 offset:6144
v_mfma_f32_16x16x32_bf16 v[84:87], a[220:223], v[212:215], v[84:87]
s_waitcnt lgkmcnt(4)
s_add_u32 s21, s34, 1152
v_mfma_f32_16x16x32_bf16 v[88:91], a[192:195], v[216:219], v[88:91]
s_barrier
v_mfma_f32_16x16x32_bf16 v[88:91], a[208:211], v[220:223], v[88:91]
ds_read_b64_tr_b16 v[208:209], v16 offset:8192
v_mfma_f32_16x16x32_bf16 v[92:95], a[196:199], v[216:219], v[92:95]
ds_read_b64_tr_b16 v[210:211], v16 offset:10240
v_mfma_f32_16x16x32_bf16 v[92:95], a[212:215], v[220:223], v[92:95]
buffer_load_dwordx4 v2, s[8:11], s21 offen lds
v_mfma_f32_16x16x32_bf16 v[96:99], a[200:203], v[216:219], v[96:99]
s_add_u32 m0, s17, 4096
ds_read_b64_tr_b16 v[212:213], v16 offset:12288
v_mfma_f32_16x16x32_bf16 v[96:99], a[216:219], v[220:223], v[96:99]
s_add_u32 s21, s34, 111744
v_mfma_f32_16x16x32_bf16 v[100:103], a[204:207], v[216:219], v[100:103]
ds_read_b64_tr_b16 v[214:215], v16 offset:14336
v_mfma_f32_16x16x32_bf16 v[100:103], a[220:223], v[220:223], v[100:103]
s_waitcnt lgkmcnt(4)
v_mfma_f32_16x16x32_bf16 v[104:107], a[192:195], v[200:203], v[104:107]
ds_read_b64_tr_b16 v[216:217], v17 offset:8192
v_mfma_f32_16x16x32_bf16 v[104:107], a[208:211], v[204:207], v[104:107]
buffer_load_dwordx4 v2, s[8:11], s21 offen lds
v_mfma_f32_16x16x32_bf16 v[108:111], a[196:199], v[200:203], v[108:111]
s_add_u32 m0, s17, 8192
ds_read_b64_tr_b16 v[218:219], v17 offset:10240
v_mfma_f32_16x16x32_bf16 v[108:111], a[212:215], v[204:207], v[108:111]
s_add_u32 s21, s35, 1152
v_mfma_f32_16x16x32_bf16 v[112:115], a[200:203], v[200:203], v[112:115]
ds_read_b64_tr_b16 v[220:221], v17 offset:12288
v_mfma_f32_16x16x32_bf16 v[112:115], a[216:219], v[204:207], v[112:115]
buffer_load_dwordx4 v2, s[8:11], s21 offen lds
v_mfma_f32_16x16x32_bf16 v[116:119], a[204:207], v[200:203], v[116:119]
s_add_u32 m0, s17, 12288
ds_read_b64_tr_b16 v[222:223], v17 offset:14336
v_mfma_f32_16x16x32_bf16 v[116:119], a[220:223], v[204:207], v[116:119]
s_waitcnt lgkmcnt(4) vmcnt(20)
s_add_u32 s21, s35, 111744
v_mfma_f32_16x16x32_bf16 v[56:59], a[224:227], v[208:211], v[56:59]
s_waitcnt vmcnt(16)
ds_read_b64_tr_b16 v[200:201], v18 offset:8192
v_mfma_f32_16x16x32_bf16 v[56:59], a[240:243], v[212:215], v[56:59]
v_mfma_f32_16x16x32_bf16 v[60:63], a[228:231], v[208:211], v[60:63]
s_waitcnt vmcnt(15)
ds_read_b64_tr_b16 v[202:203], v18 offset:10240
v_mfma_f32_16x16x32_bf16 v[60:63], a[244:247], v[212:215], v[60:63]
v_mfma_f32_16x16x32_bf16 v[64:67], a[232:235], v[208:211], v[64:67]
s_waitcnt vmcnt(14)
ds_read_b64_tr_b16 v[204:205], v18 offset:12288
v_mfma_f32_16x16x32_bf16 v[64:67], a[248:251], v[212:215], v[64:67]
v_mfma_f32_16x16x32_bf16 v[68:71], a[236:239], v[208:211], v[68:71]
s_waitcnt vmcnt(13)
ds_read_b64_tr_b16 v[206:207], v18 offset:14336
v_mfma_f32_16x16x32_bf16 v[68:71], a[252:255], v[212:215], v[68:71]
s_waitcnt lgkmcnt(4)
v_mfma_f32_16x16x32_bf16 v[72:75], a[224:227], v[216:219], v[72:75]
ds_read_b64_tr_b16 v[208:209], v19 offset:8192
v_mfma_f32_16x16x32_bf16 v[72:75], a[240:243], v[220:223], v[72:75]
buffer_load_dwordx4 v2, s[8:11], s21 offen lds
v_mfma_f32_16x16x32_bf16 v[76:79], a[228:231], v[216:219], v[76:79]
s_add_u32 s22, s16, 0
ds_read_b64_tr_b16 v[210:211], v19 offset:10240
v_mfma_f32_16x16x32_bf16 v[76:79], a[244:247], v[220:223], v[76:79]
s_lshl_b32 s23, s22, 10
s_add_u32 m0, s23, 94208
s_min_u32 s22, s22, 17
v_mfma_f32_16x16x32_bf16 v[80:83], a[232:235], v[216:219], v[80:83]
s_add_u32 s22, s22, s1
s_add_u32 s22, s22, s1
s_sub_u32 s23, s22, 18
s_min_u32 s22, s22, s23
s_mul_i32 s22, s22, 110592
s_add_u32 s22, s22, s20
buffer_load_dwordx4 v24, s[8:11], s22 offen lds
v_mfma_f32_16x16x32_bf16 v[80:83], a[248:251], v[220:223], v[80:83]
s_add_u32 m0, s17, 16384
ds_read_b64_tr_b16 v[212:213], v19 offset:12288
v_mfma_f32_16x16x32_bf16 v[84:87], a[236:239], v[216:219], v[84:87]
ds_read_b64_tr_b16 v[214:215], v19 offset:14336
v_lshrrev_b32 v40, 5, v1
v_mfma_f32_16x16x32_bf16 v[84:87], a[252:255], v[220:223], v[84:87]
s_waitcnt lgkmcnt(4)
v_lshl_add_u32 v25, v40, 5, v25
v_mul_u32_u24 v25, 3456, v25
v_mfma_f32_16x16x32_bf16 v[88:91], a[224:227], v[200:203], v[88:91]
s_barrier
v_add_u32 v25, 128, v25
v_mfma_f32_16x16x32_bf16 v[88:91], a[240:243], v[204:207], v[88:91]
ds_read_b64_tr_b16 v[216:217], v16 offset:16384
v_lshrrev_b32 v27, 2, v1
v_mfma_f32_16x16x32_bf16 v[92:95], a[228:231], v[200:203], v[92:95]
ds_read_b64_tr_b16 v[218:219], v16 offset:18432
v_lshlrev_b32 v27, 4, v27
v_mfma_f32_16x16x32_bf16 v[92:95], a[244:247], v[204:207], v[92:95]
s_add_u32 s21, s36, 1152
v_and_b32 v40, 1, v1
v_lshl_add_u32 v27, v40, 3, v27
v_mfma_f32_16x16x32_bf16 v[96:99], a[232:235], v[200:203], v[96:99]
ds_read_b64_tr_b16 v[220:221], v16 offset:20480
v_add_u32 v27, 81920, v27
v_mfma_f32_16x16x32_bf16 v[96:99], a[248:251], v[204:207], v[96:99]
buffer_load_dwordx4 v2, s[8:11], s21 offen lds
v_mfma_f32_16x16x32_bf16 v[100:103], a[236:239], v[200:203], v[100:103]
s_add_u32 m0, s17, 20480
ds_read_b64_tr_b16 v[222:223], v16 offset:22528
v_mfma_f32_16x16x32_bf16 v[100:103], a[252:255], v[204:207], v[100:103]
s_waitcnt lgkmcnt(4)
s_add_u32 s21, s36, 111744
s_lshl_b32 s50, s2, 2
v_mfma_f32_16x16x32_bf16 v[104:107], a[224:227], v[208:211], v[104:107]
s_add_u32 s50, s50, s16
ds_read_b64_tr_b16 v[200:201], v17 offset:16384
v_mfma_f32_16x16x32_bf16 v[104:107], a[240:243], v[212:215], v[104:107]
buffer_load_dwordx4 v2, s[8:11], s21 offen lds
v_mfma_f32_16x16x32_bf16 v[108:111], a[228:231], v[208:211], v[108:111]
s_add_u32 m0, s17, 24576
ds_read_b64_tr_b16 v[202:203], v17 offset:18432
v_mfma_f32_16x16x32_bf16 v[108:111], a[244:247], v[212:215], v[108:111]
s_add_u32 s21, s38, 1152
s_lshl_b32 s50, s50, 13
v_lshlrev_b32 v54, 7, v1
v_mfma_f32_16x16x32_bf16 v[112:115], a[232:235], v[208:211], v[112:115]
ds_read_b64_tr_b16 v[204:205], v17 offset:20480
v_add_u32 v54, s50, v54
v_mfma_f32_16x16x32_bf16 v[112:115], a[248:251], v[212:215], v[112:115]
buffer_load_dwordx4 v2, s[8:11], s21 offen lds
v_mfma_f32_16x16x32_bf16 v[116:119], a[236:239], v[208:211], v[116:119]
s_add_u32 m0, s17, 28672
ds_read_b64_tr_b16 v[206:207], v17 offset:22528
v_mfma_f32_16x16x32_bf16 v[116:119], a[252:255], v[212:215], v[116:119]
s_waitcnt lgkmcnt(4) vmcnt(17)
s_add_u32 s21, s38, 111744
s_lshr_b32 s50, s2, 3
v_mfma_f32_16x16x32_bf16 v[56:59], v[224:227], v[216:219], v[56:59]
s_waitcnt vmcnt(13)
ds_read_b64_tr_b16 v[208:209], v18 offset:16384
v_mfma_f32_16x16x32_bf16 v[56:59], v[240:243], v[220:223], v[56:59]
s_cmp_ge_u32 s50, 3
s_cselect_b32 s44, 1, 0
v_mfma_f32_16x16x32_bf16 v[60:63], v[228:231], v[216:219], v[60:63]
s_waitcnt vmcnt(12)
ds_read_b64_tr_b16 v[210:211], v18 offset:18432
v_mfma_f32_16x16x32_bf16 v[60:63], v[244:247], v[220:223], v[60:63]
s_mul_i32 s45, s44, 3
s_sub_u32 s45, s50, s45
v_mfma_f32_16x16x32_bf16 v[64:67], v[232:235], v[216:219], v[64:67]
s_waitcnt vmcnt(11)
ds_read_b64_tr_b16 v[212:213], v18 offset:20480
v_mfma_f32_16x16x32_bf16 v[64:67], v[248:251], v[220:223], v[64:67]
s_and_b32 s50, s2, 7
s_lshl_b32 s50, s50, 1
v_mfma_f32_16x16x32_bf16 v[68:71], v[236:239], v[216:219], v[68:71]
s_waitcnt vmcnt(10)
ds_read_b64_tr_b16 v[214:215], v18 offset:22528
v_mfma_f32_16x16x32_bf16 v[68:71], v[252:255], v[220:223], v[68:71]
s_waitcnt lgkmcnt(4)
s_add_u32 s44, s44, s50
s_mov_b32 s46, 4
v_mfma_f32_16x16x32_bf16 v[72:75], v[224:227], v[200:203], v[72:75]
ds_read_b64_tr_b16 v[216:217], v19 offset:16384
v_lshrrev_b32 v40, 3, v1
v_mfma_f32_16x16x32_bf16 v[72:75], v[240:243], v[204:207], v[72:75]
buffer_load_dwordx4 v2, s[8:11], s21 offen lds
v_mfma_f32_16x16x32_bf16 v[76:79], v[228:231], v[200:203], v[76:79]
ds_read_b64_tr_b16 v[218:219], v19 offset:18432
v_and_b32 v3, 6, v40
v_mfma_f32_16x16x32_bf16 v[76:79], v[244:247], v[204:207], v[76:79]
s_add_u32 m0, s17, 32768
v_and_b32 v41, 7, v1
v_xor_b32 v3, v3, v41
v_mfma_f32_16x16x32_bf16 v[80:83], v[232:235], v[200:203], v[80:83]
s_add_u32 s21, s39, 1152
buffer_load_dwordx4 v2, s[8:11], s21 offen lds
s_add_u32 m0, s17, 36864
s_add_u32 s21, s39, 111744
buffer_load_dwordx4 v2, s[8:11], s21 offen lds
s_add_u32 s22, s16, 4
s_lshl_b32 s23, s22, 10
s_add_u32 m0, s23, 94208
s_min_u32 s22, s22, 17
s_add_u32 s22, s22, s1
s_add_u32 s22, s22, s1
s_sub_u32 s23, s22, 18
s_min_u32 s22, s22, s23
s_mul_i32 s22, s22, 110592
s_add_u32 s22, s22, s20
buffer_load_dwordx4 v24, s[8:11], s22 offen lds
v_mfma_f32_16x16x32_bf16 v[80:83], v[248:251], v[204:207], v[80:83]
ds_read_b64_tr_b16 v[220:221], v19 offset:20480
v_lshlrev_b32 v3, 4, v3
v_mfma_f32_16x16x32_bf16 v[84:87], v[236:239], v[200:203], v[84:87]
s_add_u32 m0, s17, 40960
ds_read_b64_tr_b16 v[222:223], v19 offset:22528
v_mfma_f32_16x16x32_bf16 v[84:87], v[252:255], v[204:207], v[84:87]
s_waitcnt lgkmcnt(4)
s_add_u32 s21, s42, 1152
s_mov_b32 s78, s46
v_mfma_f32_16x16x32_bf16 v[88:91], v[224:227], v[208:211], v[88:91]
s_waitcnt vmcnt(7)
s_barrier
s_mov_b32 s49, 0
v_mfma_f32_16x16x32_bf16 v[88:91], v[240:243], v[212:215], v[88:91]
s_lshl_b32 s47, s49, 5
ds_read_b64_tr_b16 v[200:201], v26 offset:0
v_mfma_f32_16x16x32_bf16 v[92:95], v[228:231], v[208:211], v[92:95]
s_and_b32 s47, s47, 64
ds_read_b64_tr_b16 v[202:203], v26 offset:512
v_mfma_f32_16x16x32_bf16 v[92:95], v[244:247], v[212:215], v[92:95]
buffer_load_dwordx4 v2, s[8:11], s21 offen lds
v_mfma_f32_16x16x32_bf16 v[96:99], v[232:235], v[208:211], v[96:99]
ds_read_b64_tr_b16 v[204:205], v26 offset:1024
v_xor_b32 v3, s47, v3
v_mfma_f32_16x16x32_bf16 v[96:99], v[248:251], v[212:215], v[96:99]
s_add_u32 m0, s17, 45056
s_add_u32 s21, s42, 111744
s_lshl_b32 s47, s16, 3
v_mfma_f32_16x16x32_bf16 v[100:103], v[236:239], v[208:211], v[100:103]
ds_read_b64_tr_b16 v[206:207], v26 offset:1536
v_add_u32 v40, s47, v40
v_mfma_f32_16x16x32_bf16 v[100:103], v[252:255], v[212:215], v[100:103]
s_waitcnt lgkmcnt(4)
v_mul_u32_u24 v40, 1152, v40
v_add_u32 v3, v3, v40
v_mfma_f32_16x16x32_bf16 v[104:107], v[224:227], v[216:219], v[104:107]
ds_read_b64_tr_b16 v[208:209], v16 offset:24576
v_lshlrev_b32 v8, 4, v1
v_mfma_f32_16x16x32_bf16 v[104:107], v[240:243], v[220:223], v[104:107]
buffer_load_dwordx4 v2, s[8:11], s21 offen lds
v_mfma_f32_16x16x32_bf16 v[108:111], v[228:231], v[216:219], v[108:111]
ds_read_b64_tr_b16 v[210:211], v16 offset:26624
v_add_u32 v9, 165888, v8
v_mfma_f32_16x16x32_bf16 v[108:111], v[244:247], v[220:223], v[108:111]
s_add_u32 m0, s17, 49152
s_add_u32 s21, s43, 1152
s_mul_i32 s62, s45, 384
v_mfma_f32_16x16x32_bf16 v[112:115], v[232:235], v[216:219], v[112:115]
s_mul_i32 s54, s44, 3
ds_read_b64_tr_b16 v[212:213], v16 offset:28672
v_mfma_f32_16x16x32_bf16 v[112:115], v[248:251], v[220:223], v[112:115]
buffer_load_dwordx4 v2, s[8:11], s21 offen lds
v_mfma_f32_16x16x32_bf16 v[116:119], v[236:239], v[216:219], v[116:119]
s_add_u32 m0, s17, 53248
ds_read_b64_tr_b16 v[214:215], v16 offset:30720
v_mfma_f32_16x16x32_bf16 v[116:119], v[252:255], v[220:223], v[116:119]
s_waitcnt lgkmcnt(4)
s_add_u32 s21, s43, 111744
s_add_u32 s54, s54, s45
v_mfma_f32_16x16x32_bf16 v[120:123], a[0:3], v[200:203], 0
s_lshl_b32 s54, s54, 2
ds_read_b64_tr_b16 v[216:217], v17 offset:24576
v_mfma_f32_16x16x32_bf16 v[120:123], a[16:19], v[204:207], v[120:123]
buffer_load_dwordx4 v2, s[8:11], s21 offen lds
v_mfma_f32_16x16x32_bf16 v[124:127], a[4:7], v[200:203], 0
s_add_u32 s22, s16, 8
ds_read_b64_tr_b16 v[218:219], v17 offset:26624
v_mfma_f32_16x16x32_bf16 v[124:127], a[20:23], v[204:207], v[124:127]
s_lshl_b32 s23, s22, 10
v_mov_b32 v29, 0x3f317218
v_mov_b32 v30, 0x3f803f80
v_mfma_f32_16x16x32_bf16 v[128:131], a[8:11], v[200:203], 0
ds_read_b64_tr_b16 v[220:221], v17 offset:28672
v_and_b32 v32, 8, v1
v_mfma_f32_16x16x32_bf16 v[128:131], a[24:27], v[204:207], v[128:131]
s_add_u32 m0, s23, 94208
s_min_u32 s22, s22, 17
v_cmp_eq_u32 s[26:27], 0, v32
v_mfma_f32_16x16x32_bf16 v[132:135], a[12:15], v[200:203], 0
s_add_u32 s22, s22, s1
ds_read_b64_tr_b16 v[222:223], v17 offset:30720
v_mfma_f32_16x16x32_bf16 v[132:135], a[28:31], v[204:207], v[132:135]
s_waitcnt lgkmcnt(4)
v_exp_f32 v32, v56 clamp
v_mfma_f32_16x16x32_bf16 v[136:139], a[0:3], v[208:211], 0
ds_read_b64_tr_b16 v[200:201], v18 offset:24576
v_max_f32 v56, 0x35c1a2a0, v56
v_mfma_f32_16x16x32_bf16 v[136:139], a[16:19], v[212:215], v[136:139]
s_add_u32 s22, s22, s1
v_exp_f32 v33, v57 clamp
v_mfma_f32_16x16x32_bf16 v[140:143], a[4:7], v[208:211], 0
ds_read_b64_tr_b16 v[202:203], v18 offset:26624
v_fma_f32 v56, v56, v29, v32
v_mfma_f32_16x16x32_bf16 v[140:143], a[20:23], v[212:215], v[140:143]
s_sub_u32 s23, s22, 18
v_exp_f32 v34, v58 clamp
v_mfma_f32_16x16x32_bf16 v[144:147], a[8:11], v[208:211], 0
s_min_u32 s22, s22, s23
s_mul_i32 s22, s22, 110592
s_add_u32 s22, s22, s20
buffer_load_dwordx4 v24, s[8:11], s22 offen lds
v_mfma_f32_16x16x32_bf16 v[144:147], a[24:27], v[212:215], v[144:147]
ds_read_b64_tr_b16 v[204:205], v18 offset:28672
v_max_f32 v57, 0x35c1a2a0, v57
v_mfma_f32_16x16x32_bf16 v[148:151], a[12:15], v[208:211], 0
ds_read_b64_tr_b16 v[206:207], v18 offset:30720
v_fma_f32 v57, v57, v29, v33
v_mfma_f32_16x16x32_bf16 v[148:151], a[28:31], v[212:215], v[148:151]
s_waitcnt lgkmcnt(4)
v_exp_f32 v35, v59 clamp
v_mfma_f32_16x16x32_bf16 v[152:155], a[0:3], v[216:219], 0
ds_read_b64_tr_b16 v[208:209], v19 offset:24576
v_max_f32 v58, 0x35c1a2a0, v58
v_mfma_f32_16x16x32_bf16 v[152:155], a[16:19], v[220:223], v[152:155]
s_add_u32 m0, s17, 57344
v_exp_f32 v36, v60 clamp
v_mfma_f32_16x16x32_bf16 v[156:159], a[4:7], v[216:219], 0
ds_read_b64_tr_b16 v[210:211], v19 offset:26624
v_fma_f32 v58, v58, v29, v34
v_mfma_f32_16x16x32_bf16 v[156:159], a[20:23], v[220:223], v[156:159]
s_add_u32 s21, s0, 1152
v_exp_f32 v37, v61 clamp
v_mfma_f32_16x16x32_bf16 v[160:163], a[8:11], v[216:219], 0
ds_read_b64_tr_b16 v[212:213], v19 offset:28672
v_max_f32 v59, 0x35c1a2a0, v59
v_mfma_f32_16x16x32_bf16 v[160:163], a[24:27], v[220:223], v[160:163]
buffer_load_dwordx4 v2, s[8:11], s21 offen lds
v_mfma_f32_16x16x32_bf16 v[164:167], a[12:15], v[216:219], 0
ds_read_b64_tr_b16 v[214:215], v19 offset:30720
v_fma_f32 v59, v59, v29, v35
v_mfma_f32_16x16x32_bf16 v[164:167], a[28:31], v[220:223], v[164:167]
s_waitcnt lgkmcnt(4)
v_exp_f32 v38, v62 clamp
v_mfma_f32_16x16x32_bf16 v[168:171], a[0:3], v[200:203], 0
s_barrier
v_max_f32 v60, 0x35c1a2a0, v60
v_mfma_f32_16x16x32_bf16 v[168:171], a[16:19], v[204:207], v[168:171]
ds_read_b64_tr_b16 v[216:217], v26 offset:2048
v_fma_f32 v60, v60, v29, v36
v_mfma_f32_16x16x32_bf16 v[172:175], a[4:7], v[200:203], 0
ds_read_b64_tr_b16 v[218:219], v26 offset:2560
v_max_f32 v61, 0x35c1a2a0, v61
v_mfma_f32_16x16x32_bf16 v[172:175], a[20:23], v[204:207], v[172:175]
s_add_u32 m0, s17, 61440
v_exp_f32 v39, v63 clamp
v_mfma_f32_16x16x32_bf16 v[176:179], a[8:11], v[200:203], 0
ds_read_b64_tr_b16 v[220:221], v26 offset:3072
v_fma_f32 v61, v61, v29, v37
v_mfma_f32_16x16x32_bf16 v[176:179], a[24:27], v[204:207], v[176:179]
s_add_u32 s21, s0, 111744
v_exp_f32 v32, v64 clamp
v_mfma_f32_16x16x32_bf16 v[180:183], a[12:15], v[200:203], 0
ds_read_b64_tr_b16 v[222:223], v26 offset:3584
v_max_f32 v62, 0x35c1a2a0, v62
v_mfma_f32_16x16x32_bf16 v[180:183], a[28:31], v[204:207], v[180:183]
s_waitcnt lgkmcnt(4)
v_exp_f32 v33, v65 clamp
v_mfma_f32_16x16x32_bf16 v[184:187], a[0:3], v[208:211], 0
ds_read_b64_tr_b16 v[200:201], v12 offset:0
v_fma_f32 v62, v62, v29, v38
v_mfma_f32_16x16x32_bf16 v[184:187], a[16:19], v[212:215], v[184:187]
buffer_load_dwordx4 v2, s[8:11], s21 offen lds
v_mfma_f32_16x16x32_bf16 v[188:191], a[4:7], v[208:211], 0
ds_read_b64_tr_b16 v[202:203], v12 offset:2048
v_max_f32 v63, 0x35c1a2a0, v63
v_mfma_f32_16x16x32_bf16 v[188:191], a[20:23], v[212:215], v[188:191]
s_add_u32 s22, s16, 12
v_exp_f32 v34, v66 clamp
v_mfma_f32_16x16x32_bf16 v[192:195], a[8:11], v[208:211], 0
ds_read_b64_tr_b16 v[204:205], v12 offset:4096
v_fma_f32 v63, v63, v29, v39
v_mfma_f32_16x16x32_bf16 v[192:195], a[24:27], v[212:215], v[192:195]
s_lshl_b32 s23, s22, 10
v_exp_f32 v35, v67 clamp
v_mfma_f32_16x16x32_bf16 v[196:199], a[12:15], v[208:211], 0
ds_read_b64_tr_b16 v[206:207], v12 offset:6144
v_cvt_pk_bf16_f32 v56, v56, v57
v_mfma_f32_16x16x32_bf16 v[196:199], a[28:31], v[212:215], v[196:199]
s_waitcnt lgkmcnt(4)
v_exp_f32 v36, v68 clamp
v_mfma_f32_16x16x32_bf16 v[120:123], a[32:35], v[216:219], v[120:123]
ds_read_b64_tr_b16 v[208:209], v13 offset:0
v_cvt_pk_bf16_f32 v57, v58, v59
v_mfma_f32_16x16x32_bf16 v[120:123], a[48:51], v[220:223], v[120:123]
s_add_u32 m0, s23, 94208
v_exp_f32 v37, v69 clamp
v_mfma_f32_16x16x32_bf16 v[124:127], a[36:39], v[216:219], v[124:127]
ds_read_b64_tr_b16 v[210:211], v13 offset:2048
v_cvt_pk_bf16_f32 v58, v60, v61
v_mfma_f32_16x16x32_bf16 v[124:127], a[52:55], v[220:223], v[124:127]
s_min_u32 s22, s22, 17
v_exp_f32 v38, v70 clamp
v_mfma_f32_16x16x32_bf16 v[128:131], a[40:43], v[216:219], v[128:131]
ds_read_b64_tr_b16 v[212:213], v13 offset:4096
v_cvt_pk_bf16_f32 v59, v62, v63
v_mfma_f32_16x16x32_bf16 v[128:131], a[56:59], v[220:223], v[128:131]
s_add_u32 s22, s22, s1
v_exp_f32 v39, v71 clamp
v_mfma_f32_16x16x32_bf16 v[132:135], a[44:47], v[216:219], v[132:135]
ds_read_b64_tr_b16 v[214:215], v13 offset:6144
v_max_f32 v64, 0x35c1a2a0, v64
v_mfma_f32_16x16x32_bf16 v[132:135], a[60:63], v[220:223], v[132:135]
s_waitcnt lgkmcnt(4)
v_fma_f32 v64, v64, v29, v32
v_max_f32 v65, 0x35c1a2a0, v65
v_mfma_f32_16x16x32_bf16 v[136:139], a[32:35], v[200:203], v[136:139]
ds_read_b64_tr_b16 v[216:217], v14 offset:0
v_fma_f32 v65, v65, v29, v33
v_mfma_f32_16x16x32_bf16 v[136:139], a[48:51], v[204:207], v[136:139]
s_add_u32 s22, s22, s1
v_exp_f32 v32, v72 clamp
v_mfma_f32_16x16x32_bf16 v[140:143], a[36:39], v[200:203], v[140:143]
ds_read_b64_tr_b16 v[218:219], v14 offset:2048
v_max_f32 v66, 0x35c1a2a0, v66
v_mfma_f32_16x16x32_bf16 v[140:143], a[52:55], v[204:207], v[140:143]
s_sub_u32 s23, s22, 18
v_exp_f32 v33, v73 clamp
v_mfma_f32_16x16x32_bf16 v[144:147], a[40:43], v[200:203], v[144:147]
s_min_u32 s22, s22, s23
s_mul_i32 s22, s22, 110592
s_add_u32 s22, s22, s20
buffer_load_dwordx4 v24, s[8:11], s22 offen lds
v_mfma_f32_16x16x32_bf16 v[144:147], a[56:59], v[204:207], v[144:147]
ds_read_b64_tr_b16 v[220:221], v14 offset:4096
v_fma_f32 v66, v66, v29, v34
v_mfma_f32_16x16x32_bf16 v[148:151], a[44:47], v[200:203], v[148:151]
ds_read_b64_tr_b16 v[222:223], v14 offset:6144
v_max_f32 v67, 0x35c1a2a0, v67
v_mfma_f32_16x16x32_bf16 v[148:151], a[60:63], v[204:207], v[148:151]
s_waitcnt lgkmcnt(4)
v_exp_f32 v34, v74 clamp
v_mfma_f32_16x16x32_bf16 v[152:155], a[32:35], v[208:211], v[152:155]
ds_read_b64_tr_b16 v[200:201], v15 offset:0
v_fma_f32 v67, v67, v29, v35
v_mfma_f32_16x16x32_bf16 v[152:155], a[48:51], v[212:215], v[152:155]
s_add_u32 m0, s17, 65536
v_exp_f32 v35, v75 clamp
v_mfma_f32_16x16x32_bf16 v[156:159], a[36:39], v[208:211], v[156:159]
ds_read_b64_tr_b16 v[202:203], v15 offset:2048
v_max_f32 v68, 0x35c1a2a0, v68
v_mfma_f32_16x16x32_bf16 v[156:159], a[52:55], v[212:215], v[156:159]
s_add_u32 s21, s33, 4294966144
v_fma_f32 v68, v68, v29, v36
v_max_f32 v69, 0x35c1a2a0, v69
v_mfma_f32_16x16x32_bf16 v[160:163], a[40:43], v[208:211], v[160:163]
ds_read_b64_tr_b16 v[204:205], v15 offset:4096
v_fma_f32 v69, v69, v29, v37
v_mfma_f32_16x16x32_bf16 v[160:163], a[56:59], v[212:215], v[160:163]
buffer_load_dwordx4 v2, s[8:11], s21 offen lds
v_mfma_f32_16x16x32_bf16 v[164:167], a[44:47], v[208:211], v[164:167]
ds_read_b64_tr_b16 v[206:207], v15 offset:6144
v_max_f32 v70, 0x35c1a2a0, v70
v_mfma_f32_16x16x32_bf16 v[164:167], a[60:63], v[212:215], v[164:167]
s_waitcnt lgkmcnt(4)
v_exp_f32 v36, v76 clamp
v_mfma_f32_16x16x32_bf16 v[168:171], a[32:35], v[216:219], v[168:171]
s_waitcnt vmcnt(9)
s_barrier
v_fma_f32 v70, v70, v29, v38
v_mfma_f32_16x16x32_bf16 v[168:171], a[48:51], v[220:223], v[168:171]
ds_read_b64_tr_b16 v[208:209], v26 offset:4096
v_max_f32 v71, 0x35c1a2a0, v71
v_mfma_f32_16x16x32_bf16 v[172:175], a[36:39], v[216:219], v[172:175]
ds_read_b64_tr_b16 v[210:211], v26 offset:4608
v_fma_f32 v71, v71, v29, v39
v_mfma_f32_16x16x32_bf16 v[172:175], a[52:55], v[220:223], v[172:175]
s_add_u32 m0, s17, 69632
v_exp_f32 v37, v77 clamp
v_mfma_f32_16x16x32_bf16 v[176:179], a[40:43], v[216:219], v[176:179]
ds_read_b64_tr_b16 v[212:213], v26 offset:5120
v_cvt_pk_bf16_f32 v64, v64, v65
v_mfma_f32_16x16x32_bf16 v[176:179], a[56:59], v[220:223], v[176:179]
s_add_u32 s21, s33, 109440
v_exp_f32 v38, v78 clamp
v_mfma_f32_16x16x32_bf16 v[180:183], a[44:47], v[216:219], v[180:183]
ds_read_b64_tr_b16 v[214:215], v26 offset:5632
v_cvt_pk_bf16_f32 v65, v66, v67
v_mfma_f32_16x16x32_bf16 v[180:183], a[60:63], v[220:223], v[180:183]
s_waitcnt lgkmcnt(4)
v_exp_f32 v39, v79 clamp
v_mfma_f32_16x16x32_bf16 v[184:187], a[32:35], v[200:203], v[184:187]
ds_read_b64_tr_b16 v[216:217], v12 offset:8192
v_cvt_pk_bf16_f32 v66, v68, v69
v_mfma_f32_16x16x32_bf16 v[184:187], a[48:51], v[204:207], v[184:187]
buffer_load_dwordx4 v2, s[8:11], s21 offen lds
v_mfma_f32_16x16x32_bf16 v[188:191], a[36:39], v[200:203], v[188:191]
ds_read_b64_tr_b16 v[218:219], v12 offset:10240
v_cvt_pk_bf16_f32 v67, v70, v71
v_mfma_f32_16x16x32_bf16 v[188:191], a[52:55], v[204:207], v[188:191]
s_add_u32 s54, s54, s16
v_max_f32 v72, 0x35c1a2a0, v72
v_fma_f32 v72, v72, v29, v32
v_mfma_f32_16x16x32_bf16 v[192:195], a[40:43], v[200:203], v[192:195]
ds_read_b64_tr_b16 v[220:221], v12 offset:12288
v_max_f32 v73, 0x35c1a2a0, v73
v_mfma_f32_16x16x32_bf16 v[192:195], a[56:59], v[204:207], v[192:195]
s_lshl_b32 s54, s54, 14
v_exp_f32 v32, v80 clamp
v_mfma_f32_16x16x32_bf16 v[196:199], a[44:47], v[200:203], v[196:199]
ds_read_b64_tr_b16 v[222:223], v12 offset:14336
v_fma_f32 v73, v73, v29, v33
v_mfma_f32_16x16x32_bf16 v[196:199], a[60:63], v[204:207], v[196:199]
s_waitcnt lgkmcnt(4)
v_exp_f32 v33, v81 clamp
v_mfma_f32_16x16x32_bf16 v[120:123], a[64:67], v[208:211], v[120:123]
ds_read_b64_tr_b16 v[200:201], v13 offset:8192
v_max_f32 v74, 0x35c1a2a0, v74
v_mfma_f32_16x16x32_bf16 v[120:123], a[80:83], v[212:215], v[120:123]
s_add_u32 m0, s17, 73728
v_fma_f32 v74, v74, v29, v34
v_max_f32 v75, 0x35c1a2a0, v75
v_mfma_f32_16x16x32_bf16 v[124:127], a[68:71], v[208:211], v[124:127]
ds_read_b64_tr_b16 v[202:203], v13 offset:10240
v_fma_f32 v75, v75, v29, v35
v_mfma_f32_16x16x32_bf16 v[124:127], a[84:87], v[212:215], v[124:127]
s_add_u32 s21, s34, 4294966144
v_exp_f32 v34, v82 clamp
v_mfma_f32_16x16x32_bf16 v[128:131], a[72:75], v[208:211], v[128:131]
ds_read_b64_tr_b16 v[204:205], v13 offset:12288
v_max_f32 v76, 0x35c1a2a0, v76
v_mfma_f32_16x16x32_bf16 v[128:131], a[88:91], v[212:215], v[128:131]
buffer_load_dwordx4 v2, s[8:11], s21 offen lds
v_mfma_f32_16x16x32_bf16 v[132:135], a[76:79], v[208:211], v[132:135]
ds_read_b64_tr_b16 v[206:207], v13 offset:14336
v_fma_f32 v76, v76, v29, v36
v_mfma_f32_16x16x32_bf16 v[132:135], a[92:95], v[212:215], v[132:135]
s_waitcnt lgkmcnt(4)
v_exp_f32 v35, v83 clamp
v_mfma_f32_16x16x32_bf16 v[136:139], a[64:67], v[216:219], v[136:139]
ds_read_b64_tr_b16 v[208:209], v14 offset:8192
v_max_f32 v77, 0x35c1a2a0, v77
v_mfma_f32_16x16x32_bf16 v[136:139], a[80:83], v[220:223], v[136:139]
s_add_u32 m0, s17, 77824
v_exp_f32 v36, v84 clamp
v_mfma_f32_16x16x32_bf16 v[140:143], a[68:71], v[216:219], v[140:143]
ds_read_b64_tr_b16 v[210:211], v14 offset:10240
v_fma_f32 v77, v77, v29, v37
v_mfma_f32_16x16x32_bf16 v[140:143], a[84:87], v[220:223], v[140:143]
s_add_u32 s21, s34, 109440
v_exp_f32 v37, v85 clamp
v_mfma_f32_16x16x32_bf16 v[144:147], a[72:75], v[216:219], v[144:147]
ds_read_b64_tr_b16 v[212:213], v14 offset:12288
v_max_f32 v78, 0x35c1a2a0, v78
v_mfma_f32_16x16x32_bf16 v[144:147], a[88:91], v[220:223], v[144:147]
buffer_load_dwordx4 v2, s[8:11], s21 offen lds
v_mfma_f32_16x16x32_bf16 v[148:151], a[76:79], v[216:219], v[148:151]
ds_read_b64_tr_b16 v[214:215], v14 offset:14336
v_fma_f32 v78, v78, v29, v38
v_mfma_f32_16x16x32_bf16 v[148:151], a[92:95], v[220:223], v[148:151]
s_waitcnt lgkmcnt(4)
v_exp_f32 v38, v86 clamp
v_mfma_f32_16x16x32_bf16 v[152:155], a[64:67], v[200:203], v[152:155]
ds_read_b64_tr_b16 v[216:217], v15 offset:8192
v_max_f32 v79, 0x35c1a2a0, v79
v_mfma_f32_16x16x32_bf16 v[152:155], a[80:83], v[204:207], v[152:155]
s_add_u32 s22, s16, 16
v_fma_f32 v79, v79, v29, v39
v_cvt_pk_bf16_f32 v72, v72, v73
v_mfma_f32_16x16x32_bf16 v[156:159], a[68:71], v[200:203], v[156:159]
ds_read_b64_tr_b16 v[218:219], v15 offset:10240
v_cvt_pk_bf16_f32 v73, v74, v75
v_mfma_f32_16x16x32_bf16 v[156:159], a[84:87], v[204:207], v[156:159]
s_lshl_b32 s23, s22, 10
v_exp_f32 v39, v87 clamp
v_mfma_f32_16x16x32_bf16 v[160:163], a[72:75], v[200:203], v[160:163]
ds_read_b64_tr_b16 v[220:221], v15 offset:12288
v_cvt_pk_bf16_f32 v74, v76, v77
v_mfma_f32_16x16x32_bf16 v[160:163], a[88:91], v[204:207], v[160:163]
s_add_u32 m0, s23, 94208
v_cvt_pk_bf16_f32 v75, v78, v79
v_max_f32 v80, 0x35c1a2a0, v80
v_mfma_f32_16x16x32_bf16 v[164:167], a[76:79], v[200:203], v[164:167]
ds_read_b64_tr_b16 v[222:223], v15 offset:14336
v_fma_f32 v80, v80, v29, v32
v_mfma_f32_16x16x32_bf16 v[164:167], a[92:95], v[204:207], v[164:167]
s_waitcnt lgkmcnt(4)
v_exp_f32 v32, v88 clamp
v_mfma_f32_16x16x32_bf16 v[168:171], a[64:67], v[208:211], v[168:171]
s_barrier
v_max_f32 v81, 0x35c1a2a0, v81
v_mfma_f32_16x16x32_bf16 v[168:171], a[80:83], v[212:215], v[168:171]
ds_read_b64_tr_b16 v[200:201], v26 offset:6144
v_fma_f32 v81, v81, v29, v33
v_mfma_f32_16x16x32_bf16 v[172:175], a[68:71], v[208:211], v[172:175]
ds_read_b64_tr_b16 v[202:203], v26 offset:6656
v_max_f32 v82, 0x35c1a2a0, v82
v_mfma_f32_16x16x32_bf16 v[172:175], a[84:87], v[212:215], v[172:175]
s_min_u32 s22, s22, 17
v_exp_f32 v33, v89 clamp
v_mfma_f32_16x16x32_bf16 v[176:179], a[72:75], v[208:211], v[176:179]
ds_read_b64_tr_b16 v[204:205], v26 offset:7168
v_fma_f32 v82, v82, v29, v34
v_mfma_f32_16x16x32_bf16 v[176:179], a[88:91], v[212:215], v[176:179]
s_add_u32 s22, s22, s1
v_exp_f32 v34, v90 clamp
v_mfma_f32_16x16x32_bf16 v[180:183], a[76:79], v[208:211], v[180:183]
ds_read_b64_tr_b16 v[206:207], v26 offset:7680
v_max_f32 v83, 0x35c1a2a0, v83
v_mfma_f32_16x16x32_bf16 v[180:183], a[92:95], v[212:215], v[180:183]
s_waitcnt lgkmcnt(4)
v_fma_f32 v83, v83, v29, v35
v_max_f32 v84, 0x35c1a2a0, v84
v_mfma_f32_16x16x32_bf16 v[184:187], a[64:67], v[216:219], v[184:187]
ds_read_b64_tr_b16 v[208:209], v12 offset:16384
v_fma_f32 v84, v84, v29, v36
v_mfma_f32_16x16x32_bf16 v[184:187], a[80:83], v[220:223], v[184:187]
s_add_u32 s22, s22, s1
v_exp_f32 v35, v91 clamp
v_mfma_f32_16x16x32_bf16 v[188:191], a[68:71], v[216:219], v[188:191]
ds_read_b64_tr_b16 v[210:211], v12 offset:18432
v_max_f32 v85, 0x35c1a2a0, v85
v_mfma_f32_16x16x32_bf16 v[188:191], a[84:87], v[220:223], v[188:191]
s_sub_u32 s23, s22, 18
v_exp_f32 v36, v92 clamp
v_mfma_f32_16x16x32_bf16 v[192:195], a[72:75], v[216:219], v[192:195]
ds_read_b64_tr_b16 v[212:213], v12 offset:20480
v_fma_f32 v85, v85, v29, v37
v_mfma_f32_16x16x32_bf16 v[192:195], a[88:91], v[220:223], v[192:195]
s_min_u32 s22, s22, s23
v_exp_f32 v37, v93 clamp
v_mfma_f32_16x16x32_bf16 v[196:199], a[76:79], v[216:219], v[196:199]
ds_read_b64_tr_b16 v[214:215], v12 offset:22528
v_max_f32 v86, 0x35c1a2a0, v86
v_mfma_f32_16x16x32_bf16 v[196:199], a[92:95], v[220:223], v[196:199]
s_waitcnt lgkmcnt(4)
v_fma_f32 v86, v86, v29, v38
v_max_f32 v87, 0x35c1a2a0, v87
v_mfma_f32_16x16x32_bf16 v[120:123], a[96:99], v[200:203], v[120:123]
ds_read_b64_tr_b16 v[216:217], v13 offset:16384
v_fma_f32 v87, v87, v29, v39
v_mfma_f32_16x16x32_bf16 v[120:123], a[112:115], v[204:207], v[120:123]
s_mul_i32 s22, s22, 110592
v_exp_f32 v38, v94 clamp
v_mfma_f32_16x16x32_bf16 v[124:127], a[100:103], v[200:203], v[124:127]
ds_read_b64_tr_b16 v[218:219], v13 offset:18432
v_cvt_pk_bf16_f32 v80, v80, v81
v_mfma_f32_16x16x32_bf16 v[124:127], a[116:119], v[204:207], v[124:127]
s_add_u32 s22, s22, s20
v_exp_f32 v39, v95 clamp
v_mfma_f32_16x16x32_bf16 v[128:131], a[104:107], v[200:203], v[128:131]
ds_read_b64_tr_b16 v[220:221], v13 offset:20480
v_cvt_pk_bf16_f32 v81, v82, v83
v_mfma_f32_16x16x32_bf16 v[128:131], a[120:123], v[204:207], v[128:131]
buffer_load_dwordx4 v24, s[8:11], s22 offen lds
v_mfma_f32_16x16x32_bf16 v[132:135], a[108:111], v[200:203], v[132:135]
ds_read_b64_tr_b16 v[222:223], v13 offset:22528
v_cvt_pk_bf16_f32 v82, v84, v85
v_mfma_f32_16x16x32_bf16 v[132:135], a[124:127], v[204:207], v[132:135]
s_waitcnt lgkmcnt(4)
v_cvt_pk_bf16_f32 v83, v86, v87
v_max_f32 v88, 0x35c1a2a0, v88
v_mfma_f32_16x16x32_bf16 v[136:139], a[96:99], v[208:211], v[136:139]
ds_read_b64_tr_b16 v[200:201], v14 offset:16384
v_fma_f32 v88, v88, v29, v32
v_mfma_f32_16x16x32_bf16 v[136:139], a[112:115], v[212:215], v[136:139]
s_add_u32 m0, s17, 0
v_exp_f32 v32, v96 clamp
v_mfma_f32_16x16x32_bf16 v[140:143], a[100:103], v[208:211], v[140:143]
ds_read_b64_tr_b16 v[202:203], v14 offset:18432
v_max_f32 v89, 0x35c1a2a0, v89
v_mfma_f32_16x16x32_bf16 v[140:143], a[116:119], v[212:215], v[140:143]
s_add_u32 s21, s35, 4294966144
v_fma_f32 v89, v89, v29, v33
v_max_f32 v90, 0x35c1a2a0, v90
v_mfma_f32_16x16x32_bf16 v[144:147], a[104:107], v[208:211], v[144:147]
ds_read_b64_tr_b16 v[204:205], v14 offset:20480
v_fma_f32 v90, v90, v29, v34
v_mfma_f32_16x16x32_bf16 v[144:147], a[120:123], v[212:215], v[144:147]
buffer_load_dwordx4 v2, s[8:11], s21 offen lds
v_mfma_f32_16x16x32_bf16 v[148:151], a[108:111], v[208:211], v[148:151]
ds_read_b64_tr_b16 v[206:207], v14 offset:22528
v_max_f32 v91, 0x35c1a2a0, v91
v_mfma_f32_16x16x32_bf16 v[148:151], a[124:127], v[212:215], v[148:151]
s_waitcnt lgkmcnt(4)
v_exp_f32 v33, v97 clamp
v_mfma_f32_16x16x32_bf16 v[152:155], a[96:99], v[216:219], v[152:155]
ds_read_b64_tr_b16 v[208:209], v15 offset:16384
v_fma_f32 v91, v91, v29, v35
v_mfma_f32_16x16x32_bf16 v[152:155], a[112:115], v[220:223], v[152:155]
s_add_u32 s54, s54, 67108864
v_exp_f32 v34, v98 clamp
v_mfma_f32_16x16x32_bf16 v[156:159], a[100:103], v[216:219], v[156:159]
ds_read_b64_tr_b16 v[210:211], v15 offset:18432
v_max_f32 v92, 0x35c1a2a0, v92
v_mfma_f32_16x16x32_bf16 v[156:159], a[116:119], v[220:223], v[156:159]
s_add_u32 m0, s17, 4096
v_exp_f32 v35, v99 clamp
v_mfma_f32_16x16x32_bf16 v[160:163], a[104:107], v[216:219], v[160:163]
ds_read_b64_tr_b16 v[212:213], v15 offset:20480
v_fma_f32 v92, v92, v29, v36
v_mfma_f32_16x16x32_bf16 v[160:163], a[120:123], v[220:223], v[160:163]
s_mul_i32 s48, s46, 3145728
v_exp_f32 v36, v100 clamp
v_mfma_f32_16x16x32_bf16 v[164:167], a[108:111], v[216:219], v[164:167]
ds_read_b64_tr_b16 v[214:215], v15 offset:22528
v_max_f32 v93, 0x35c1a2a0, v93
v_mfma_f32_16x16x32_bf16 v[164:167], a[124:127], v[220:223], v[164:167]
s_waitcnt lgkmcnt(4)
v_fma_f32 v93, v93, v29, v37
v_max_f32 v94, 0x35c1a2a0, v94
v_mfma_f32_16x16x32_bf16 v[168:171], a[96:99], v[200:203], v[168:171]
s_waitcnt vmcnt(9)
s_barrier
v_fma_f32 v94, v94, v29, v38
v_mfma_f32_16x16x32_bf16 v[168:171], a[112:115], v[204:207], v[168:171]
ds_read_b64_tr_b16 v[216:217], v26 offset:8192
v_max_f32 v95, 0x35c1a2a0, v95
v_mfma_f32_16x16x32_bf16 v[172:175], a[100:103], v[200:203], v[172:175]
ds_read_b64_tr_b16 v[218:219], v26 offset:8704
v_fma_f32 v95, v95, v29, v39
v_mfma_f32_16x16x32_bf16 v[172:175], a[116:119], v[204:207], v[172:175]
s_add_u32 s21, s35, 109440
v_exp_f32 v37, v101 clamp
v_mfma_f32_16x16x32_bf16 v[176:179], a[104:107], v[200:203], v[176:179]
ds_read_b64_tr_b16 v[220:221], v26 offset:9216
v_cvt_pk_bf16_f32 v88, v88, v89
v_mfma_f32_16x16x32_bf16 v[176:179], a[120:123], v[204:207], v[176:179]
s_add_u32 s48, s48, s54
v_exp_f32 v38, v102 clamp
v_mfma_f32_16x16x32_bf16 v[180:183], a[108:111], v[200:203], v[180:183]
ds_read_b64_tr_b16 v[222:223], v26 offset:9728
v_cvt_pk_bf16_f32 v89, v90, v91
v_mfma_f32_16x16x32_bf16 v[180:183], a[124:127], v[204:207], v[180:183]
s_waitcnt lgkmcnt(4)
v_exp_f32 v39, v103 clamp
v_mfma_f32_16x16x32_bf16 v[184:187], a[96:99], v[208:211], v[184:187]
ds_read_b64_tr_b16 v[200:201], v12 offset:24576
v_cvt_pk_bf16_f32 v90, v92, v93
v_mfma_f32_16x16x32_bf16 v[184:187], a[112:115], v[212:215], v[184:187]
buffer_load_dwordx4 v2, s[8:11], s21 offen lds
v_mfma_f32_16x16x32_bf16 v[188:191], a[100:103], v[208:211], v[188:191]
ds_read_b64_tr_b16 v[202:203], v12 offset:26624
v_cvt_pk_bf16_f32 v91, v94, v95
v_mfma_f32_16x16x32_bf16 v[188:191], a[116:119], v[212:215], v[188:191]
s_xor_b32 s47, s49, 0
v_max_f32 v96, 0x35c1a2a0, v96
v_fma_f32 v96, v96, v29, v32
v_mfma_f32_16x16x32_bf16 v[192:195], a[104:107], v[208:211], v[192:195]
ds_read_b64_tr_b16 v[204:205], v12 offset:28672
v_max_f32 v97, 0x35c1a2a0, v97
v_mfma_f32_16x16x32_bf16 v[192:195], a[120:123], v[212:215], v[192:195]
s_lshl_b32 s47, s47, 12
v_exp_f32 v32, v104 clamp
v_mfma_f32_16x16x32_bf16 v[196:199], a[108:111], v[208:211], v[196:199]
s_add_u32 s7, s48, s47
s_xor_b32 s47, s49, 1
s_lshl_b32 s47, s47, 12
s_add_u32 s52, s48, s47
s_xor_b32 s47, s49, 2
s_lshl_b32 s47, s47, 12
s_add_u32 s53, s48, s47
s_xor_b32 s47, s49, 3
s_lshl_b32 s47, s47, 12
s_add_u32 s79, s48, s47
s_lshl_b32 s47, s46, 12
s_add_u32 s54, s54, s47
s_lshl_b32 s47, s44, 3
s_lshl_b32 s48, s16, 1
s_add_u32 s47, s47, s48
s_mul_i32 s60, s47, 165888
s_add_u32 s60, s60, 4194304
s_and_b32 s48, s46, 1
s_add_u32 s48, s48, s47
s_mul_i32 s55, s48, 18432
s_lshr_b32 s48, s46, 1
s_lshl_b32 s48, s48, 6
s_add_u32 s55, s55, s48
s_add_u32 s55, s55, s62
s_lshr_b32 s47, s47, 2
s_lshl_b32 s5, s47, 9
s_add_u32 s5, s5, 58720256
s_lshl_b32 s47, s18, 2
s_add_u32 s47, s47, s16
s_lshl_b32 s37, s47, 9
s_lshl_b32 s47, s19, 2
s_add_u32 s37, s37, s47
s_add_u32 s37, s37, 58720256
v_lshrrev_b32 v40, 3, v1
v_and_b32 v48, 6, v40
v_and_b32 v41, 7, v1
v_xor_b32 v48, v48, v41
v_lshlrev_b32 v48, 4, v48
s_and_b32 s50, s16, 1
s_mul_i32 s50, s50, 144
s_lshr_b32 s51, s16, 1
s_lshl_b32 s51, s51, 2
s_add_u32 s50, s50, s51
s_add_u32 s50, s50, 64
v_lshrrev_b32 v41, 2, v40
v_mul_u32_u24 v41, 72, v41
v_and_b32 v40, 3, v40
v_add3_u32 v40, v40, v41, s50
v_mul_u32_u24 v40, 1152, v40
v_add_u32 v48, v48, v40
v_and_b32 v10, 3, v1
v_lshl_add_u32 v10, v10, 2, 64
v_add_u32 v10, 16, v10
v_and_b32 v11, 7, v1
v_lshlrev_b32 v11, 2, v11
v_mfma_f32_16x16x32_bf16 v[196:199], a[124:127], v[212:215], v[196:199]
s_waitcnt lgkmcnt(3)
ds_read_b64_tr_b16 v[206:207], v12 offset:30720
v_mfma_f32_16x16x32_bf16 v[120:123], a[128:131], v[216:219], v[120:123]
ds_read_b64_tr_b16 v[208:209], v13 offset:24576
v_fma_f32 v97, v97, v29, v33
v_mfma_f32_16x16x32_bf16 v[120:123], a[144:147], v[220:223], v[120:123]
s_add_u32 m0, s17, 8192
v_exp_f32 v33, v105 clamp
v_mfma_f32_16x16x32_bf16 v[124:127], a[132:135], v[216:219], v[124:127]
ds_read_b64_tr_b16 v[210:211], v13 offset:26624
v_max_f32 v98, 0x35c1a2a0, v98
v_mfma_f32_16x16x32_bf16 v[124:127], a[148:151], v[220:223], v[124:127]
v_fma_f32 v98, v98, v29, v34
v_max_f32 v99, 0x35c1a2a0, v99
v_mfma_f32_16x16x32_bf16 v[128:131], a[136:139], v[216:219], v[128:131]
ds_read_b64_tr_b16 v[212:213], v13 offset:28672
v_fma_f32 v99, v99, v29, v35
v_mfma_f32_16x16x32_bf16 v[128:131], a[152:155], v[220:223], v[128:131]
s_add_u32 s21, s36, 4294966144
v_exp_f32 v34, v106 clamp
v_mfma_f32_16x16x32_bf16 v[132:135], a[140:143], v[216:219], v[132:135]
ds_read_b64_tr_b16 v[214:215], v13 offset:30720
v_max_f32 v100, 0x35c1a2a0, v100
v_mfma_f32_16x16x32_bf16 v[132:135], a[156:159], v[220:223], v[132:135]
s_waitcnt lgkmcnt(4)
v_exp_f32 v35, v107 clamp
v_mfma_f32_16x16x32_bf16 v[136:139], a[128:131], v[200:203], v[136:139]
ds_read_b64_tr_b16 v[216:217], v14 offset:24576
v_fma_f32 v100, v100, v29, v36
v_mfma_f32_16x16x32_bf16 v[136:139], a[144:147], v[204:207], v[136:139]
v_exp_f32 v36, v108 clamp
v_mfma_f32_16x16x32_bf16 v[140:143], a[132:135], v[200:203], v[140:143]
ds_read_b64_tr_b16 v[218:219], v14 offset:26624
v_max_f32 v101, 0x35c1a2a0, v101
v_mfma_f32_16x16x32_bf16 v[140:143], a[148:151], v[204:207], v[140:143]
buffer_load_dwordx4 v2, s[8:11], s21 offen lds
v_mfma_f32_16x16x32_bf16 v[144:147], a[136:139], v[200:203], v[144:147]
ds_read_b64_tr_b16 v[220:221], v14 offset:28672
v_fma_f32 v101, v101, v29, v37
v_mfma_f32_16x16x32_bf16 v[144:147], a[152:155], v[204:207], v[144:147]
v_exp_f32 v37, v109 clamp
v_mfma_f32_16x16x32_bf16 v[148:151], a[140:143], v[200:203], v[148:151]
ds_read_b64_tr_b16 v[222:223], v14 offset:30720
v_max_f32 v102, 0x35c1a2a0, v102
v_mfma_f32_16x16x32_bf16 v[148:151], a[156:159], v[204:207], v[148:151]
s_waitcnt lgkmcnt(4)
v_fma_f32 v102, v102, v29, v38
v_max_f32 v103, 0x35c1a2a0, v103
v_mfma_f32_16x16x32_bf16 v[152:155], a[128:131], v[208:211], v[152:155]
ds_read_b64_tr_b16 v[200:201], v15 offset:24576
v_fma_f32 v103, v103, v29, v39
v_mfma_f32_16x16x32_bf16 v[152:155], a[144:147], v[212:215], v[152:155]
s_add_u32 m0, s17, 12288
v_exp_f32 v38, v110 clamp
v_mfma_f32_16x16x32_bf16 v[156:159], a[132:135], v[208:211], v[156:159]
ds_read_b64_tr_b16 v[202:203], v15 offset:26624
v_cvt_pk_bf16_f32 v96, v96, v97
v_mfma_f32_16x16x32_bf16 v[156:159], a[148:151], v[212:215], v[156:159]
v_exp_f32 v39, v111 clamp
v_mfma_f32_16x16x32_bf16 v[160:163], a[136:139], v[208:211], v[160:163]
ds_read_b64_tr_b16 v[204:205], v15 offset:28672
v_cvt_pk_bf16_f32 v97, v98, v99
v_mfma_f32_16x16x32_bf16 v[160:163], a[152:155], v[212:215], v[160:163]
s_add_u32 s21, s36, 109440
v_cvt_pk_bf16_f32 v98, v100, v101
v_cvt_pk_bf16_f32 v99, v102, v103
v_mfma_f32_16x16x32_bf16 v[164:167], a[140:143], v[208:211], v[164:167]
ds_read_b64_tr_b16 v[206:207], v15 offset:30720
v_max_f32 v104, 0x35c1a2a0, v104
v_mfma_f32_16x16x32_bf16 v[164:167], a[156:159], v[212:215], v[164:167]
s_waitcnt lgkmcnt(4)
v_fma_f32 v104, v104, v29, v32
v_max_f32 v105, 0x35c1a2a0, v105
v_mfma_f32_16x16x32_bf16 v[168:171], a[128:131], v[216:219], v[168:171]
s_barrier
v_fma_f32 v105, v105, v29, v33
v_mfma_f32_16x16x32_bf16 v[168:171], a[144:147], v[220:223], v[168:171]
ds_read_b64_tr_b16 v[208:209], v26 offset:10240
v_max_f32 v106, 0x35c1a2a0, v106
v_mfma_f32_16x16x32_bf16 v[172:175], a[132:135], v[216:219], v[172:175]
ds_read_b64_tr_b16 v[210:211], v26 offset:10752
v_fma_f32 v106, v106, v29, v34
v_mfma_f32_16x16x32_bf16 v[172:175], a[148:151], v[220:223], v[172:175]
buffer_load_dwordx4 v2, s[8:11], s21 offen lds
v_mfma_f32_16x16x32_bf16 v[176:179], a[136:139], v[216:219], v[176:179]
ds_read_b64_tr_b16 v[212:213], v26 offset:11264
v_max_f32 v107, 0x35c1a2a0, v107
v_mfma_f32_16x16x32_bf16 v[176:179], a[152:155], v[220:223], v[176:179]
v_exp_f32 v32, v112 clamp
v_mfma_f32_16x16x32_bf16 v[180:183], a[140:143], v[216:219], v[180:183]
ds_read_b64_tr_b16 v[214:215], v26 offset:11776
v_fma_f32 v107, v107, v29, v35
v_mfma_f32_16x16x32_bf16 v[180:183], a[156:159], v[220:223], v[180:183]
s_waitcnt lgkmcnt(4)
v_exp_f32 v33, v113 clamp
v_mfma_f32_16x16x32_bf16 v[184:187], a[128:131], v[200:203], v[184:187]
ds_read_b64_tr_b16 v[216:217], v12 offset:32768
v_max_f32 v108, 0x35c1a2a0, v108
v_mfma_f32_16x16x32_bf16 v[184:187], a[144:147], v[204:207], v[184:187]
buffer_load_dword v55, v54, s[56:59], 0 offen
v_mfma_f32_16x16x32_bf16 v[188:191], a[132:135], v[200:203], v[188:191]
ds_read_b64_tr_b16 v[218:219], v12 offset:34816
v_fma_f32 v108, v108, v29, v36
v_mfma_f32_16x16x32_bf16 v[188:191], a[148:151], v[204:207], v[188:191]
v_exp_f32 v34, v114 clamp
v_mfma_f32_16x16x32_bf16 v[192:195], a[136:139], v[200:203], v[192:195]
ds_read_b64_tr_b16 v[220:221], v12 offset:36864
v_max_f32 v109, 0x35c1a2a0, v109
v_mfma_f32_16x16x32_bf16 v[192:195], a[152:155], v[204:207], v[192:195]
v_exp_f32 v35, v115 clamp
v_mfma_f32_16x16x32_bf16 v[196:199], a[140:143], v[200:203], v[196:199]
ds_read_b64_tr_b16 v[222:223], v12 offset:38912
v_fma_f32 v109, v109, v29, v37
v_mfma_f32_16x16x32_bf16 v[196:199], a[156:159], v[204:207], v[196:199]
s_waitcnt lgkmcnt(4)
v_exp_f32 v36, v116 clamp
v_mfma_f32_16x16x32_bf16 v[120:123], a[160:163], v[208:211], v[120:123]
ds_read_b64_tr_b16 v[200:201], v13 offset:32768
v_max_f32 v110, 0x35c1a2a0, v110
v_mfma_f32_16x16x32_bf16 v[120:123], a[176:179], v[212:215], v[120:123]
s_add_u32 m0, s17, 16384
v_exp_f32 v37, v117 clamp
v_mfma_f32_16x16x32_bf16 v[124:127], a[164:167], v[208:211], v[124:127]
ds_read_b64_tr_b16 v[202:203], v13 offset:34816
v_fma_f32 v110, v110, v29, v38
v_mfma_f32_16x16x32_bf16 v[124:127], a[180:183], v[212:215], v[124:127]
s_add_u32 s21, s38, 4294966144
v_exp_f32 v38, v118 clamp
v_mfma_f32_16x16x32_bf16 v[128:131], a[168:171], v[208:211], v[128:131]
ds_read_b64_tr_b16 v[204:205], v13 offset:36864
v_max_f32 v111, 0x35c1a2a0, v111
v_mfma_f32_16x16x32_bf16 v[128:131], a[184:187], v[212:215], v[128:131]
buffer_load_dwordx4 v2, s[8:11], s21 offen lds
v_mfma_f32_16x16x32_bf16 v[132:135], a[172:175], v[208:211], v[132:135]
ds_read_b64_tr_b16 v[206:207], v13 offset:38912
v_fma_f32 v111, v111, v29, v39
v_mfma_f32_16x16x32_bf16 v[132:135], a[188:191], v[212:215], v[132:135]
s_waitcnt lgkmcnt(4)
v_exp_f32 v39, v119 clamp
v_mfma_f32_16x16x32_bf16 v[136:139], a[160:163], v[216:219], v[136:139]
ds_read_b64_tr_b16 v[208:209], v14 offset:32768
v_cvt_pk_bf16_f32 v104, v104, v105
v_mfma_f32_16x16x32_bf16 v[136:139], a[176:179], v[220:223], v[136:139]
s_add_u32 m0, s17, 20480
v_cvt_pk_bf16_f32 v105, v106, v107
v_cvt_pk_bf16_f32 v106, v108, v109
v_mfma_f32_16x16x32_bf16 v[140:143], a[164:167], v[216:219], v[140:143]
ds_read_b64_tr_b16 v[210:211], v14 offset:34816
v_cvt_pk_bf16_f32 v107, v110, v111
v_mfma_f32_16x16x32_bf16 v[140:143], a[180:183], v[220:223], v[140:143]
s_add_u32 s21, s38, 109440
v_max_f32 v112, 0x35c1a2a0, v112
v_fma_f32 v112, v112, v29, v32
v_mfma_f32_16x16x32_bf16 v[144:147], a[168:171], v[216:219], v[144:147]
ds_read_b64_tr_b16 v[212:213], v14 offset:36864
v_max_f32 v113, 0x35c1a2a0, v113
v_mfma_f32_16x16x32_bf16 v[144:147], a[184:187], v[220:223], v[144:147]
buffer_load_dwordx4 v2, s[8:11], s21 offen lds
v_mfma_f32_16x16x32_bf16 v[148:151], a[172:175], v[216:219], v[148:151]
ds_read_b64_tr_b16 v[214:215], v14 offset:38912
v_fma_f32 v113, v113, v29, v33
v_mfma_f32_16x16x32_bf16 v[148:151], a[188:191], v[220:223], v[148:151]
s_waitcnt lgkmcnt(4)
v_max_f32 v114, 0x35c1a2a0, v114
v_fma_f32 v114, v114, v29, v34
v_mfma_f32_16x16x32_bf16 v[152:155], a[160:163], v[200:203], v[152:155]
ds_read_b64_tr_b16 v[216:217], v15 offset:32768
v_max_f32 v115, 0x35c1a2a0, v115
v_mfma_f32_16x16x32_bf16 v[152:155], a[176:179], v[204:207], v[152:155]
s_add_u32 s22, s16, 0
v_fma_f32 v115, v115, v29, v35
v_max_f32 v116, 0x35c1a2a0, v116
v_mfma_f32_16x16x32_bf16 v[156:159], a[164:167], v[200:203], v[156:159]
ds_read_b64_tr_b16 v[218:219], v15 offset:34816
v_fma_f32 v116, v116, v29, v36
v_mfma_f32_16x16x32_bf16 v[156:159], a[180:183], v[204:207], v[156:159]
s_lshl_b32 s23, s22, 10
v_max_f32 v117, 0x35c1a2a0, v117
v_fma_f32 v117, v117, v29, v37
v_mfma_f32_16x16x32_bf16 v[160:163], a[168:171], v[200:203], v[160:163]
ds_read_b64_tr_b16 v[220:221], v15 offset:36864
v_max_f32 v118, 0x35c1a2a0, v118
v_mfma_f32_16x16x32_bf16 v[160:163], a[184:187], v[204:207], v[160:163]
s_add_u32 m0, s23, 81920
v_fma_f32 v118, v118, v29, v38
v_max_f32 v119, 0x35c1a2a0, v119
v_mfma_f32_16x16x32_bf16 v[164:167], a[172:175], v[200:203], v[164:167]
ds_read_b64_tr_b16 v[222:223], v15 offset:38912
v_fma_f32 v119, v119, v29, v39
v_mfma_f32_16x16x32_bf16 v[164:167], a[188:191], v[204:207], v[164:167]
s_waitcnt lgkmcnt(4)
v_cvt_pk_bf16_f32 v112, v112, v113
v_cvt_pk_bf16_f32 v113, v114, v115
v_mfma_f32_16x16x32_bf16 v[168:171], a[160:163], v[208:211], v[168:171]
s_waitcnt vmcnt(7)
s_barrier
v_cvt_pk_bf16_f32 v114, v116, v117
v_mfma_f32_16x16x32_bf16 v[168:171], a[176:179], v[212:215], v[168:171]
ds_read_b64_tr_b16 v[200:201], v26 offset:12288
v_cvt_pk_bf16_f32 v115, v118, v119
v_mfma_f32_16x16x32_bf16 v[172:175], a[164:167], v[208:211], v[172:175]
s_min_u32 s22, s22, 8
ds_read_b64_tr_b16 v[202:203], v26 offset:12800
v_mfma_f32_16x16x32_bf16 v[172:175], a[180:183], v[212:215], v[172:175]
s_add_u32 s22, s22, s1
s_sub_u32 s23, s22, 9
s_min_u32 s22, s22, s23
v_mfma_f32_16x16x32_bf16 v[176:179], a[168:171], v[208:211], v[176:179]
ds_read_b64_tr_b16 v[204:205], v26 offset:13312
v_mfma_f32_16x16x32_bf16 v[176:179], a[184:187], v[212:215], v[176:179]
s_mul_i32 s22, s22, 221184
v_mfma_f32_16x16x32_bf16 v[180:183], a[172:175], v[208:211], v[180:183]
ds_read_b64_tr_b16 v[206:207], v26 offset:13824
v_mfma_f32_16x16x32_bf16 v[180:183], a[188:191], v[212:215], v[180:183]
s_waitcnt lgkmcnt(4)
s_add_u32 s22, s22, s20
v_mfma_f32_16x16x32_bf16 v[184:187], a[160:163], v[216:219], v[184:187]
ds_read_b64_tr_b16 v[208:209], v26 offset:14336
v_mfma_f32_16x16x32_bf16 v[184:187], a[176:179], v[220:223], v[184:187]
s_sub_u32 s22, s22, 1152
v_mfma_f32_16x16x32_bf16 v[188:191], a[164:167], v[216:219], v[188:191]
ds_read_b64_tr_b16 v[210:211], v26 offset:14848
v_mfma_f32_16x16x32_bf16 v[188:191], a[180:183], v[220:223], v[188:191]
buffer_load_dwordx4 v25, s[8:11], s22 offen lds
v_mfma_f32_16x16x32_bf16 v[192:195], a[168:171], v[216:219], v[192:195]
ds_read_b64_tr_b16 v[212:213], v26 offset:15360
v_mfma_f32_16x16x32_bf16 v[192:195], a[184:187], v[220:223], v[192:195]
v_mfma_f32_16x16x32_bf16 v[196:199], a[172:175], v[216:219], v[196:199]
ds_read_b64_tr_b16 v[214:215], v26 offset:15872
v_mfma_f32_16x16x32_bf16 v[196:199], a[188:191], v[220:223], v[196:199]
s_waitcnt lgkmcnt(4)
v_mfma_f32_16x16x32_bf16 v[120:123], a[192:195], v[200:203], v[120:123]
s_add_u32 m0, s17, 24576
ds_read_b64_tr_b16 v[216:217], v26 offset:16384
v_mfma_f32_16x16x32_bf16 v[120:123], a[208:211], v[204:207], v[120:123]
v_mfma_f32_16x16x32_bf16 v[124:127], a[196:199], v[200:203], v[124:127]
s_add_u32 s21, s39, 4294966144
ds_read_b64_tr_b16 v[218:219], v26 offset:16896
v_mfma_f32_16x16x32_bf16 v[124:127], a[212:215], v[204:207], v[124:127]
v_mfma_f32_16x16x32_bf16 v[128:131], a[200:203], v[200:203], v[128:131]
ds_read_b64_tr_b16 v[220:221], v26 offset:17408
v_mfma_f32_16x16x32_bf16 v[128:131], a[216:219], v[204:207], v[128:131]
buffer_load_dwordx4 v2, s[8:11], s21 offen lds
v_mfma_f32_16x16x32_bf16 v[132:135], a[204:207], v[200:203], v[132:135]
s_add_u32 m0, s17, 28672
ds_read_b64_tr_b16 v[222:223], v26 offset:17920
v_mfma_f32_16x16x32_bf16 v[132:135], a[220:223], v[204:207], v[132:135]
s_waitcnt lgkmcnt(4)
v_mfma_f32_16x16x32_bf16 v[120:123], a[224:227], v[208:211], v[120:123]
s_add_u32 s21, s39, 109440
ds_read_b64_tr_b16 v[200:201], v12 offset:40960
v_mfma_f32_16x16x32_bf16 v[120:123], a[240:243], v[212:215], v[120:123]
v_mfma_f32_16x16x32_bf16 v[124:127], a[228:231], v[208:211], v[124:127]
ds_read_b64_tr_b16 v[202:203], v12 offset:43008
v_mfma_f32_16x16x32_bf16 v[124:127], a[244:247], v[212:215], v[124:127]
buffer_load_dwordx4 v2, s[8:11], s21 offen lds
v_mfma_f32_16x16x32_bf16 v[128:131], a[232:235], v[208:211], v[128:131]
ds_read_b64_tr_b16 v[204:205], v12 offset:45056
v_mfma_f32_16x16x32_bf16 v[128:131], a[248:251], v[212:215], v[128:131]
s_add_u32 s22, s16, 4
v_mfma_f32_16x16x32_bf16 v[132:135], a[236:239], v[208:211], v[132:135]
ds_read_b64_tr_b16 v[206:207], v12 offset:47104
v_mfma_f32_16x16x32_bf16 v[132:135], a[252:255], v[212:215], v[132:135]
s_waitcnt lgkmcnt(4)
s_lshl_b32 s23, s22, 10
v_mfma_f32_16x16x32_bf16 v[120:123], v[224:227], v[216:219], v[120:123]
ds_read_b64_tr_b16 v[208:209], v16 offset:0
v_mfma_f32_16x16x32_bf16 v[120:123], v[240:243], v[220:223], v[120:123]
s_add_u32 m0, s23, 81920
v_mfma_f32_16x16x32_bf16 v[124:127], v[228:231], v[216:219], v[124:127]
ds_read_b64_tr_b16 v[210:211], v16 offset:2048
v_mfma_f32_16x16x32_bf16 v[124:127], v[244:247], v[220:223], v[124:127]
v_mfma_f32_16x16x32_bf16 v[128:131], v[232:235], v[216:219], v[128:131]
s_min_u32 s22, s22, 8
ds_read_b64_tr_b16 v[212:213], v16 offset:4096
v_mfma_f32_16x16x32_bf16 v[128:131], v[248:251], v[220:223], v[128:131]
v_mfma_f32_16x16x32_bf16 v[132:135], v[236:239], v[216:219], v[132:135]
s_add_u32 s22, s22, s1
ds_read_b64_tr_b16 v[214:215], v16 offset:6144
v_mfma_f32_16x16x32_bf16 v[132:135], v[252:255], v[220:223], v[132:135]
s_waitcnt lgkmcnt(4)
v_mfma_f32_16x16x32_bf16 v[136:139], a[192:195], v[200:203], v[136:139]
s_barrier
s_sub_u32 s23, s22, 9
v_mfma_f32_16x16x32_bf16 v[136:139], a[208:211], v[204:207], v[136:139]
ds_read_b64_tr_b16 v[216:217], v16 offset:8192
v_mfma_f32_16x16x32_bf16 v[140:143], a[196:199], v[200:203], v[140:143]
s_min_u32 s22, s22, s23
ds_read_b64_tr_b16 v[218:219], v16 offset:10240
v_mfma_f32_16x16x32_bf16 v[140:143], a[212:215], v[204:207], v[140:143]
v_mfma_f32_16x16x32_bf16 v[144:147], a[200:203], v[200:203], v[144:147]
ds_read_b64_tr_b16 v[220:221], v16 offset:12288
v_cvt_pk_bf16_f32 v40, v120, v121
v_mfma_f32_16x16x32_bf16 v[144:147], a[216:219], v[204:207], v[144:147]
s_mul_i32 s22, s22, 221184
v_exp_f32 v32, v120 clamp
v_mfma_f32_16x16x32_bf16 v[148:151], a[204:207], v[200:203], v[148:151]
ds_read_b64_tr_b16 v[222:223], v16 offset:14336
v_cvt_pk_bf16_f32 v41, v122, v123
v_mfma_f32_16x16x32_bf16 v[148:151], a[220:223], v[204:207], v[148:151]
s_waitcnt lgkmcnt(4)
v_exp_f32 v33, v121 clamp
v_mfma_f32_16x16x32_bf16 v[136:139], a[224:227], v[208:211], v[136:139]
ds_read_b64_tr_b16 v[200:201], v13 offset:40960
v_cvt_pk_bf16_f32 v42, v124, v125
v_mfma_f32_16x16x32_bf16 v[136:139], a[240:243], v[212:215], v[136:139]
s_add_u32 s22, s22, s20
v_exp_f32 v34, v122 clamp
v_mfma_f32_16x16x32_bf16 v[140:143], a[228:231], v[208:211], v[140:143]
ds_read_b64_tr_b16 v[202:203], v13 offset:43008
v_cvt_pk_bf16_f32 v43, v126, v127
v_mfma_f32_16x16x32_bf16 v[140:143], a[244:247], v[212:215], v[140:143]
s_sub_u32 s22, s22, 1152
v_exp_f32 v35, v123 clamp
v_mfma_f32_16x16x32_bf16 v[144:147], a[232:235], v[208:211], v[144:147]
ds_read_b64_tr_b16 v[204:205], v13 offset:45056
v_cvt_pk_bf16_f32 v44, v128, v129
v_mfma_f32_16x16x32_bf16 v[144:147], a[248:251], v[212:215], v[144:147]
buffer_load_dwordx4 v25, s[8:11], s22 offen lds
v_mfma_f32_16x16x32_bf16 v[148:151], a[236:239], v[208:211], v[148:151]
ds_read_b64_tr_b16 v[206:207], v13 offset:47104
v_cvt_pk_bf16_f32 v45, v130, v131
v_mfma_f32_16x16x32_bf16 v[148:151], a[252:255], v[212:215], v[148:151]
s_waitcnt lgkmcnt(4)
v_exp_f32 v36, v124 clamp
v_mfma_f32_16x16x32_bf16 v[136:139], v[224:227], v[216:219], v[136:139]
ds_read_b64_tr_b16 v[208:209], v17 offset:0
v_cvt_pk_bf16_f32 v46, v132, v133
v_mfma_f32_16x16x32_bf16 v[136:139], v[240:243], v[220:223], v[136:139]
s_add_u32 m0, s17, 32768
v_exp_f32 v37, v125 clamp
v_mfma_f32_16x16x32_bf16 v[140:143], v[228:231], v[216:219], v[140:143]
ds_read_b64_tr_b16 v[210:211], v17 offset:2048
v_cvt_pk_bf16_f32 v47, v134, v135
v_mfma_f32_16x16x32_bf16 v[140:143], v[244:247], v[220:223], v[140:143]
s_add_u32 s21, s42, 4294966144
v_exp_f32 v38, v126 clamp
v_mfma_f32_16x16x32_bf16 v[144:147], v[232:235], v[216:219], v[144:147]
ds_read_b64_tr_b16 v[212:213], v17 offset:4096
v_cndmask_b32 v40, v40, v30, s[26:27]
v_mfma_f32_16x16x32_bf16 v[144:147], v[248:251], v[220:223], v[144:147]
buffer_load_dwordx4 v2, s[8:11], s21 offen lds
v_mfma_f32_16x16x32_bf16 v[148:151], v[236:239], v[216:219], v[148:151]
ds_read_b64_tr_b16 v[214:215], v17 offset:6144
v_cndmask_b32 v41, v41, v30, s[26:27]
v_mfma_f32_16x16x32_bf16 v[148:151], v[252:255], v[220:223], v[148:151]
s_waitcnt lgkmcnt(4)
v_exp_f32 v39, v127 clamp
v_mfma_f32_16x16x32_bf16 v[152:155], a[192:195], v[200:203], v[152:155]
ds_read_b64_tr_b16 v[216:217], v17 offset:8192
v_cndmask_b32 v42, v42, v30, s[26:27]
v_mfma_f32_16x16x32_bf16 v[152:155], a[208:211], v[204:207], v[152:155]
s_add_u32 m0, s17, 36864
v_cndmask_b32 v43, v43, v30, s[26:27]
v_cndmask_b32 v44, v44, v30, s[26:27]
v_mfma_f32_16x16x32_bf16 v[156:159], a[196:199], v[200:203], v[156:159]
ds_read_b64_tr_b16 v[218:219], v17 offset:10240
v_cndmask_b32 v45, v45, v30, s[26:27]
v_mfma_f32_16x16x32_bf16 v[156:159], a[212:215], v[204:207], v[156:159]
s_add_u32 s21, s42, 109440
v_cndmask_b32 v46, v46, v30, s[26:27]
v_cndmask_b32 v47, v47, v30, s[26:27]
v_mfma_f32_16x16x32_bf16 v[160:163], a[200:203], v[200:203], v[160:163]
ds_read_b64_tr_b16 v[220:221], v17 offset:12288
v_max_f32 v120, 0x35c1a2a0, v120
v_mfma_f32_16x16x32_bf16 v[160:163], a[216:219], v[204:207], v[160:163]
buffer_load_dwordx4 v2, s[8:11], s21 offen lds
v_mfma_f32_16x16x32_bf16 v[164:167], a[204:207], v[200:203], v[164:167]
ds_read_b64_tr_b16 v[222:223], v17 offset:14336
v_fma_f32 v120, v120, v29, v32
v_mfma_f32_16x16x32_bf16 v[164:167], a[220:223], v[204:207], v[164:167]
s_waitcnt lgkmcnt(4)
v_exp_f32 v32, v128 clamp
v_mfma_f32_16x16x32_bf16 v[152:155], a[224:227], v[208:211], v[152:155]
ds_read_b64_tr_b16 v[200:201], v14 offset:40960
v_max_f32 v121, 0x35c1a2a0, v121
v_mfma_f32_16x16x32_bf16 v[152:155], a[240:243], v[212:215], v[152:155]
s_add_u32 s22, s16, 8
v_fma_f32 v121, v121, v29, v33
v_max_f32 v122, 0x35c1a2a0, v122
v_mfma_f32_16x16x32_bf16 v[156:159], a[228:231], v[208:211], v[156:159]
ds_read_b64_tr_b16 v[202:203], v14 offset:43008
v_fma_f32 v122, v122, v29, v34
v_mfma_f32_16x16x32_bf16 v[156:159], a[244:247], v[212:215], v[156:159]
s_lshl_b32 s23, s22, 10
v_exp_f32 v33, v129 clamp
v_mfma_f32_16x16x32_bf16 v[160:163], a[232:235], v[208:211], v[160:163]
ds_read_b64_tr_b16 v[204:205], v14 offset:45056
v_max_f32 v123, 0x35c1a2a0, v123
v_mfma_f32_16x16x32_bf16 v[160:163], a[248:251], v[212:215], v[160:163]
s_add_u32 m0, s23, 81920
v_exp_f32 v34, v130 clamp
v_mfma_f32_16x16x32_bf16 v[164:167], a[236:239], v[208:211], v[164:167]
ds_read_b64_tr_b16 v[206:207], v14 offset:47104
v_fma_f32 v123, v123, v29, v35
v_mfma_f32_16x16x32_bf16 v[164:167], a[252:255], v[212:215], v[164:167]
s_waitcnt lgkmcnt(4)
v_exp_f32 v35, v131 clamp
v_mfma_f32_16x16x32_bf16 v[152:155], v[224:227], v[216:219], v[152:155]
s_barrier
v_max_f32 v124, 0x35c1a2a0, v124
v_mfma_f32_16x16x32_bf16 v[152:155], v[240:243], v[220:223], v[152:155]
ds_read_b64_tr_b16 v[208:209], v18 offset:0
v_fma_f32 v124, v124, v29, v36
v_mfma_f32_16x16x32_bf16 v[156:159], v[228:231], v[216:219], v[156:159]
ds_read_b64_tr_b16 v[210:211], v18 offset:2048
v_max_f32 v125, 0x35c1a2a0, v125
v_mfma_f32_16x16x32_bf16 v[156:159], v[244:247], v[220:223], v[156:159]
s_min_u32 s22, s22, 8
v_exp_f32 v36, v132 clamp
v_mfma_f32_16x16x32_bf16 v[160:163], v[232:235], v[216:219], v[160:163]
ds_read_b64_tr_b16 v[212:213], v18 offset:4096
v_fma_f32 v125, v125, v29, v37
v_mfma_f32_16x16x32_bf16 v[160:163], v[248:251], v[220:223], v[160:163]
s_add_u32 s22, s22, s1
v_exp_f32 v37, v133 clamp
v_mfma_f32_16x16x32_bf16 v[164:167], v[236:239], v[216:219], v[164:167]
ds_read_b64_tr_b16 v[214:215], v18 offset:6144
v_max_f32 v126, 0x35c1a2a0, v126
v_mfma_f32_16x16x32_bf16 v[164:167], v[252:255], v[220:223], v[164:167]
s_waitcnt lgkmcnt(4)
v_fma_f32 v126, v126, v29, v38
v_max_f32 v127, 0x35c1a2a0, v127
v_mfma_f32_16x16x32_bf16 v[168:171], a[192:195], v[200:203], v[168:171]
ds_read_b64_tr_b16 v[216:217], v18 offset:8192
v_fma_f32 v127, v127, v29, v39
v_mfma_f32_16x16x32_bf16 v[168:171], a[208:211], v[204:207], v[168:171]
s_sub_u32 s23, s22, 9
v_exp_f32 v38, v134 clamp
v_mfma_f32_16x16x32_bf16 v[172:175], a[196:199], v[200:203], v[172:175]
ds_read_b64_tr_b16 v[218:219], v18 offset:10240
v_cvt_pk_bf16_f32 v120, v120, v121
v_mfma_f32_16x16x32_bf16 v[172:175], a[212:215], v[204:207], v[172:175]
s_min_u32 s22, s22, s23
v_exp_f32 v39, v135 clamp
v_mfma_f32_16x16x32_bf16 v[176:179], a[200:203], v[200:203], v[176:179]
ds_read_b64_tr_b16 v[220:221], v18 offset:12288
v_cvt_pk_bf16_f32 v121, v122, v123
v_mfma_f32_16x16x32_bf16 v[176:179], a[216:219], v[204:207], v[176:179]
s_mul_i32 s22, s22, 221184
v_cvt_pk_bf16_f32 v122, v124, v125
v_cvt_pk_bf16_f32 v123, v126, v127
v_mfma_f32_16x16x32_bf16 v[180:183], a[204:207], v[200:203], v[180:183]
ds_read_b64_tr_b16 v[222:223], v18 offset:14336
v_max_f32 v128, 0x35c1a2a0, v128
v_mfma_f32_16x16x32_bf16 v[180:183], a[220:223], v[204:207], v[180:183]
s_waitcnt lgkmcnt(4)
v_fma_f32 v128, v128, v29, v32
v_max_f32 v129, 0x35c1a2a0, v129
v_mfma_f32_16x16x32_bf16 v[168:171], a[224:227], v[208:211], v[168:171]
ds_read_b64_tr_b16 v[200:201], v15 offset:40960
v_fma_f32 v129, v129, v29, v33
v_mfma_f32_16x16x32_bf16 v[168:171], a[240:243], v[212:215], v[168:171]
s_add_u32 s22, s22, s20
v_max_f32 v130, 0x35c1a2a0, v130
v_fma_f32 v130, v130, v29, v34
v_mfma_f32_16x16x32_bf16 v[172:175], a[228:231], v[208:211], v[172:175]
ds_read_b64_tr_b16 v[202:203], v15 offset:43008
v_max_f32 v131, 0x35c1a2a0, v131
v_mfma_f32_16x16x32_bf16 v[172:175], a[244:247], v[212:215], v[172:175]
s_sub_u32 s22, s22, 1152
v_fma_f32 v131, v131, v29, v35
v_max_f32 v132, 0x35c1a2a0, v132
v_mfma_f32_16x16x32_bf16 v[176:179], a[232:235], v[208:211], v[176:179]
ds_read_b64_tr_b16 v[204:205], v15 offset:45056
v_fma_f32 v132, v132, v29, v36
v_mfma_f32_16x16x32_bf16 v[176:179], a[248:251], v[212:215], v[176:179]
buffer_load_dwordx4 v25, s[8:11], s22 offen lds
v_mfma_f32_16x16x32_bf16 v[180:183], a[236:239], v[208:211], v[180:183]
ds_read_b64_tr_b16 v[206:207], v15 offset:47104
v_max_f32 v133, 0x35c1a2a0, v133
v_mfma_f32_16x16x32_bf16 v[180:183], a[252:255], v[212:215], v[180:183]
s_waitcnt lgkmcnt(4)
v_fma_f32 v133, v133, v29, v37
v_max_f32 v134, 0x35c1a2a0, v134
v_mfma_f32_16x16x32_bf16 v[168:171], v[224:227], v[216:219], v[168:171]
ds_read_b64_tr_b16 v[208:209], v19 offset:0
v_fma_f32 v134, v134, v29, v38
v_mfma_f32_16x16x32_bf16 v[168:171], v[240:243], v[220:223], v[168:171]
v_max_f32 v135, 0x35c1a2a0, v135
v_fma_f32 v135, v135, v29, v39
v_mfma_f32_16x16x32_bf16 v[172:175], v[228:231], v[216:219], v[172:175]
ds_read_b64_tr_b16 v[210:211], v19 offset:2048
v_cvt_pk_bf16_f32 v128, v128, v129
v_mfma_f32_16x16x32_bf16 v[172:175], v[244:247], v[220:223], v[172:175]
v_cvt_pk_bf16_f32 v129, v130, v131
v_cvt_pk_bf16_f32 v130, v132, v133
v_mfma_f32_16x16x32_bf16 v[176:179], v[232:235], v[216:219], v[176:179]
ds_read_b64_tr_b16 v[212:213], v19 offset:4096
v_cvt_pk_bf16_f32 v131, v134, v135
v_mfma_f32_16x16x32_bf16 v[176:179], v[248:251], v[220:223], v[176:179]
v_cvt_pk_bf16_f32 v136, v136, v137
v_cvt_pk_bf16_f32 v137, v138, v139
v_mfma_f32_16x16x32_bf16 v[180:183], v[236:239], v[216:219], v[180:183]
ds_read_b64_tr_b16 v[214:215], v19 offset:6144
v_cvt_pk_bf16_f32 v138, v140, v141
v_mfma_f32_16x16x32_bf16 v[180:183], v[252:255], v[220:223], v[180:183]
s_waitcnt lgkmcnt(4)
v_cvt_pk_bf16_f32 v139, v142, v143
v_cvt_pk_bf16_f32 v144, v144, v145
v_mfma_f32_16x16x32_bf16 v[184:187], a[192:195], v[200:203], v[184:187]
ds_read_b64_tr_b16 v[216:217], v19 offset:8192
v_cvt_pk_bf16_f32 v145, v146, v147
v_mfma_f32_16x16x32_bf16 v[184:187], a[208:211], v[204:207], v[184:187]
v_cvt_pk_bf16_f32 v146, v148, v149
v_cvt_pk_bf16_f32 v147, v150, v151
v_mfma_f32_16x16x32_bf16 v[188:191], a[196:199], v[200:203], v[188:191]
ds_read_b64_tr_b16 v[218:219], v19 offset:10240
v_cvt_pk_bf16_f32 v152, v152, v153
v_mfma_f32_16x16x32_bf16 v[188:191], a[212:215], v[204:207], v[188:191]
v_cvt_pk_bf16_f32 v153, v154, v155
v_cvt_pk_bf16_f32 v154, v156, v157
v_mfma_f32_16x16x32_bf16 v[192:195], a[200:203], v[200:203], v[192:195]
ds_read_b64_tr_b16 v[220:221], v19 offset:12288
v_cvt_pk_bf16_f32 v155, v158, v159
v_mfma_f32_16x16x32_bf16 v[192:195], a[216:219], v[204:207], v[192:195]
v_cvt_pk_bf16_f32 v160, v160, v161
v_cvt_pk_bf16_f32 v161, v162, v163
v_mfma_f32_16x16x32_bf16 v[196:199], a[204:207], v[200:203], v[196:199]
ds_read_b64_tr_b16 v[222:223], v19 offset:14336
v_cvt_pk_bf16_f32 v162, v164, v165
v_mfma_f32_16x16x32_bf16 v[196:199], a[220:223], v[204:207], v[196:199]
s_waitcnt lgkmcnt(4)
v_cvt_pk_bf16_f32 v163, v166, v167
v_cvt_pk_bf16_f32 v168, v168, v169
v_mfma_f32_16x16x32_bf16 v[184:187], a[224:227], v[208:211], v[184:187]
v_cvt_pk_bf16_f32 v169, v170, v171
v_cvt_pk_bf16_f32 v170, v172, v173
v_mfma_f32_16x16x32_bf16 v[184:187], a[240:243], v[212:215], v[184:187]
v_cvt_pk_bf16_f32 v171, v174, v175
v_cvt_pk_bf16_f32 v176, v176, v177
v_mfma_f32_16x16x32_bf16 v[188:191], a[228:231], v[208:211], v[188:191]
v_cvt_pk_bf16_f32 v177, v178, v179
v_cvt_pk_bf16_f32 v178, v180, v181
v_mfma_f32_16x16x32_bf16 v[188:191], a[244:247], v[212:215], v[188:191]
v_cvt_pk_bf16_f32 v179, v182, v183
v_mfma_f32_16x16x32_bf16 v[192:195], a[232:235], v[208:211], v[192:195]
s_barrier
v_mfma_f32_16x16x32_bf16 v[192:195], a[248:251], v[212:215], v[192:195]
v_mfma_f32_16x16x32_bf16 v[196:199], a[236:239], v[208:211], v[196:199]
v_mfma_f32_16x16x32_bf16 v[196:199], a[252:255], v[212:215], v[196:199]
s_waitcnt lgkmcnt(0)
v_mfma_f32_16x16x32_bf16 v[184:187], v[224:227], v[216:219], v[184:187]
v_mfma_f32_16x16x32_bf16 v[184:187], v[240:243], v[220:223], v[184:187]
v_mfma_f32_16x16x32_bf16 v[188:191], v[228:231], v[216:219], v[188:191]
v_mfma_f32_16x16x32_bf16 v[188:191], v[244:247], v[220:223], v[188:191]
v_mfma_f32_16x16x32_bf16 v[192:195], v[232:235], v[216:219], v[192:195]
v_mfma_f32_16x16x32_bf16 v[192:195], v[248:251], v[220:223], v[192:195]
v_mfma_f32_16x16x32_bf16 v[196:199], v[236:239], v[216:219], v[196:199]
v_mfma_f32_16x16x32_bf16 v[196:199], v[252:255], v[220:223], v[196:199]
s_lshl_b32 s22, s16, 14
s_add_u32 s22, s22, 94208
v_lshl_add_u32 v24, v1, 4, s22
s_lshl_b32 s22, s16, 12
s_add_u32 s22, s22, 94208
v_lshl_add_u32 v26, v1, 4, s22
s_lshl_b32 s23, s19, 16
s_lshl_b32 s22, s16, 11
s_add_u32 s61, s23, s22
s_add_u32 s61, s61, 33554432
s_lshl_b32 s22, s18, 13
s_add_u32 s63, s61, s22
v_cvt_pk_bf16_f32 v184, v184, v185
v_cvt_pk_bf16_f32 v185, v186, v187
v_cvt_pk_bf16_f32 v186, v188, v189
v_cvt_pk_bf16_f32 v187, v190, v191
v_cvt_pk_bf16_f32 v192, v192, v193
v_cvt_pk_bf16_f32 v193, v194, v195
v_cvt_pk_bf16_f32 v194, v196, v197
v_cvt_pk_bf16_f32 v195, v198, v199
v_mfma_f32_16x16x32_bf16 v[60:63], v[56:59], v[136:139], 0
v_mfma_f32_16x16x32_bf16 v[60:63], v[64:67], v[144:147], v[60:63]
v_mfma_f32_16x16x32_bf16 v[68:71], v[72:75], v[136:139], 0
v_mfma_f32_16x16x32_bf16 v[68:71], v[80:83], v[144:147], v[68:71]
v_mfma_f32_16x16x32_bf16 v[76:79], v[56:59], v[152:155], 0
v_mfma_f32_16x16x32_bf16 v[76:79], v[64:67], v[160:163], v[76:79]
v_mfma_f32_16x16x32_bf16 v[84:87], v[72:75], v[152:155], 0
v_mfma_f32_16x16x32_bf16 v[84:87], v[80:83], v[160:163], v[84:87]
v_mfma_f32_16x16x32_bf16 v[92:95], v[88:91], v[152:155], 0
v_mfma_f32_16x16x32_bf16 v[92:95], v[96:99], v[160:163], v[92:95]
ds_write_b128 v24, v[60:63] offset:0
v_mfma_f32_16x16x32_bf16 v[100:103], v[72:75], v[168:171], 0
v_mfma_f32_16x16x32_bf16 v[100:103], v[80:83], v[176:179], v[100:103]
ds_write_b128 v24, v[68:71] offset:1024
v_mfma_f32_16x16x32_bf16 v[108:111], v[88:91], v[168:171], 0
v_mfma_f32_16x16x32_bf16 v[108:111], v[96:99], v[176:179], v[108:111]
ds_write_b128 v24, v[76:79] offset:2048
v_mfma_f32_16x16x32_bf16 v[116:119], v[104:107], v[168:171], 0
v_mfma_f32_16x16x32_bf16 v[116:119], v[112:115], v[176:179], v[116:119]
ds_write_b128 v24, v[84:87] offset:3072
v_mfma_f32_16x16x32_bf16 v[124:127], v[88:91], v[184:187], 0
v_mfma_f32_16x16x32_bf16 v[124:127], v[96:99], v[192:195], v[124:127]
ds_write_b128 v24, v[92:95] offset:4096
v_mfma_f32_16x16x32_bf16 v[132:135], v[104:107], v[184:187], 0
v_mfma_f32_16x16x32_bf16 v[132:135], v[112:115], v[192:195], v[132:135]
ds_write_b128 v24, v[100:103] offset:5120
v_mfma_f32_16x16x32_bf16 v[140:143], v[120:123], v[184:187], 0
v_mfma_f32_16x16x32_bf16 v[140:143], v[128:131], v[192:195], v[140:143]
ds_write_b128 v24, v[108:111] offset:6144
v_mfma_f32_16x16x32_bf16 v[148:151], v[104:107], v[40:43], 0
v_mfma_f32_16x16x32_bf16 v[148:151], v[112:115], v[44:47], v[148:151]
ds_write_b128 v24, v[116:119] offset:7168
v_mfma_f32_16x16x32_bf16 v[156:159], v[120:123], v[40:43], 0
v_mfma_f32_16x16x32_bf16 v[156:159], v[128:131], v[44:47], v[156:159]
ds_write_b128 v24, v[124:127] offset:8192
v_mfma_f32_16x16x32_bf16 v[164:167], v[56:59], v[40:43], 0
v_mfma_f32_16x16x32_bf16 v[164:167], v[64:67], v[44:47], v[164:167]
ds_write_b128 v24, v[132:135] offset:9216
v_mfma_f32_16x16x32_bf16 v[172:175], v[72:75], v[40:43], 0
v_mfma_f32_16x16x32_bf16 v[172:175], v[80:83], v[44:47], v[172:175]
ds_write_b128 v24, v[140:143] offset:10240
v_mfma_f32_16x16x32_bf16 v[180:183], v[88:91], v[40:43], 0
v_mfma_f32_16x16x32_bf16 v[180:183], v[96:99], v[44:47], v[180:183]
ds_write_b128 v24, v[148:151] offset:11264
ds_write_b128 v24, v[156:159] offset:12288
ds_write_b128 v24, v[164:167] offset:13312
s_nop 1
ds_write_b128 v24, v[172:175] offset:14336
s_nop 1
ds_write_b128 v24, v[180:183] offset:15360
s_waitcnt lgkmcnt(0)
s_waitcnt vmcnt(0)
s_barrier
ds_read_b64_tr_b16 v[200:201], v16 offset:16384
ds_read_b64_tr_b16 v[202:203], v16 offset:18432
ds_read_b64_tr_b16 v[204:205], v16 offset:20480
ds_read_b64_tr_b16 v[206:207], v16 offset:22528
ds_read_b64_tr_b16 v[208:209], v17 offset:16384
ds_read_b64_tr_b16 v[210:211], v17 offset:18432
ds_read_b64_tr_b16 v[212:213], v17 offset:20480
ds_read_b64_tr_b16 v[214:215], v17 offset:22528
s_waitcnt lgkmcnt(4)
v_mfma_f32_16x16x32_bf16 v[56:59], v[200:203], a[0:3], 0
s_add_u32 m0, s17, 40960
ds_read_b64_tr_b16 v[216:217], v18 offset:16384
v_mfma_f32_16x16x32_bf16 v[56:59], v[204:207], a[16:19], v[56:59]
ds_read_b128 v[136:139], v26 offset:0
v_mfma_f32_16x16x32_bf16 v[60:63], v[200:203], a[4:7], 0
ds_read_b64_tr_b16 v[218:219], v18 offset:18432
v_mfma_f32_16x16x32_bf16 v[60:63], v[204:207], a[20:23], v[60:63]
s_add_u32 s21, s43, 4294966144
ds_read_b128 v[140:143], v26 offset:16384
v_mfma_f32_16x16x32_bf16 v[64:67], v[200:203], a[8:11], 0
ds_read_b64_tr_b16 v[220:221], v18 offset:20480
v_mfma_f32_16x16x32_bf16 v[64:67], v[204:207], a[24:27], v[64:67]
ds_read_b128 v[144:147], v26 offset:32768
v_mfma_f32_16x16x32_bf16 v[68:71], v[200:203], a[12:15], 0
ds_read_b64_tr_b16 v[222:223], v18 offset:22528
v_mfma_f32_16x16x32_bf16 v[68:71], v[204:207], a[28:31], v[68:71]
s_waitcnt lgkmcnt(7)
ds_read_b128 v[148:151], v26 offset:49152
v_mfma_f32_16x16x32_bf16 v[72:75], v[208:211], a[0:3], 0
ds_read_b64_tr_b16 v[200:201], v19 offset:16384
v_mfma_f32_16x16x32_bf16 v[72:75], v[212:215], a[16:19], v[72:75]
buffer_load_dwordx4 v2, s[8:11], s21 offen lds
v_mfma_f32_16x16x32_bf16 v[76:79], v[208:211], a[4:7], 0
s_add_u32 m0, s17, 45056
ds_read_b64_tr_b16 v[202:203], v19 offset:18432
v_mfma_f32_16x16x32_bf16 v[76:79], v[212:215], a[20:23], v[76:79]
ds_read_b128 v[152:155], v26 offset:1024
v_mfma_f32_16x16x32_bf16 v[80:83], v[208:211], a[8:11], 0
s_add_u32 s21, s43, 109440
ds_read_b64_tr_b16 v[204:205], v19 offset:20480
v_mfma_f32_16x16x32_bf16 v[80:83], v[212:215], a[24:27], v[80:83]
ds_read_b128 v[156:159], v26 offset:17408
v_mfma_f32_16x16x32_bf16 v[84:87], v[208:211], a[12:15], 0
ds_read_b64_tr_b16 v[206:207], v19 offset:22528
v_mfma_f32_16x16x32_bf16 v[84:87], v[212:215], a[28:31], v[84:87]
s_waitcnt lgkmcnt(7)
ds_read_b128 v[160:163], v26 offset:33792
v_mfma_f32_16x16x32_bf16 v[88:91], v[216:219], a[0:3], 0
ds_read_b64_tr_b16 v[208:209], v27 offset:0
v_mfma_f32_16x16x32_bf16 v[88:91], v[220:223], a[16:19], v[88:91]
buffer_load_dwordx4 v2, s[8:11], s21 offen lds
v_mfma_f32_16x16x32_bf16 v[92:95], v[216:219], a[4:7], 0
ds_read_b64_tr_b16 v[210:211], v27 offset:256
v_mfma_f32_16x16x32_bf16 v[92:95], v[220:223], a[20:23], v[92:95]
s_add_u32 m0, s17, 49152
ds_read_b128 v[164:167], v26 offset:50176
v_mfma_f32_16x16x32_bf16 v[96:99], v[216:219], a[8:11], 0
ds_read_b64_tr_b16 v[212:213], v27 offset:512
v_mfma_f32_16x16x32_bf16 v[96:99], v[220:223], a[24:27], v[96:99]
ds_read_b128 v[168:171], v26 offset:2048
v_mfma_f32_16x16x32_bf16 v[100:103], v[216:219], a[12:15], 0
s_add_u32 s21, s0, 4294966144
ds_read_b64_tr_b16 v[214:215], v27 offset:768
v_mfma_f32_16x16x32_bf16 v[100:103], v[220:223], a[28:31], v[100:103]
s_waitcnt lgkmcnt(7)
ds_read_b128 v[172:175], v26 offset:18432
v_mfma_f32_16x16x32_bf16 v[104:107], v[200:203], a[0:3], 0
s_barrier
v_mfma_f32_16x16x32_bf16 v[104:107], v[204:207], a[16:19], v[104:107]
ds_read_b64_tr_b16 v[216:217], v16 offset:24576
v_mfma_f32_16x16x32_bf16 v[108:111], v[200:203], a[4:7], 0
ds_read_b64_tr_b16 v[218:219], v16 offset:26624
v_mfma_f32_16x16x32_bf16 v[108:111], v[204:207], a[20:23], v[108:111]
buffer_load_dwordx4 v2, s[8:11], s21 offen lds
v_mfma_f32_16x16x32_bf16 v[112:115], v[200:203], a[8:11], 0
s_add_u32 m0, s17, 53248
ds_read_b64_tr_b16 v[220:221], v16 offset:28672
v_mfma_f32_16x16x32_bf16 v[112:115], v[204:207], a[24:27], v[112:115]
ds_read_b128 v[176:179], v26 offset:34816
v_mfma_f32_16x16x32_bf16 v[116:119], v[200:203], a[12:15], 0
ds_read_b64_tr_b16 v[222:223], v16 offset:30720
v_mfma_f32_16x16x32_bf16 v[116:119], v[204:207], a[28:31], v[116:119]
s_waitcnt lgkmcnt(6)
ds_read_b128 v[180:183], v26 offset:51200
v_mfma_f32_16x16x32_bf16 v[120:123], v[208:211], a[0:3], 0
s_add_u32 s21, s0, 109440
ds_read_b64_tr_b16 v[200:201], v17 offset:24576
v_mfma_f32_16x16x32_bf16 v[120:123], v[212:215], a[16:19], v[120:123]
ds_read_b128 v[184:187], v26 offset:3072
v_mfma_f32_16x16x32_bf16 v[124:127], v[208:211], a[4:7], 0
ds_read_b64_tr_b16 v[202:203], v17 offset:26624
v_mfma_f32_16x16x32_bf16 v[124:127], v[212:215], a[20:23], v[124:127]
buffer_load_dwordx4 v2, s[8:11], s21 offen lds
v_mfma_f32_16x16x32_bf16 v[128:131], v[208:211], a[8:11], 0
ds_read_b64_tr_b16 v[204:205], v17 offset:28672
v_mfma_f32_16x16x32_bf16 v[128:131], v[212:215], a[24:27], v[128:131]
ds_read_b128 v[188:191], v26 offset:19456
v_mfma_f32_16x16x32_bf16 v[132:135], v[208:211], a[12:15], 0
ds_read_b64_tr_b16 v[206:207], v17 offset:30720
v_mfma_f32_16x16x32_bf16 v[132:135], v[212:215], a[28:31], v[132:135]
s_waitcnt lgkmcnt(7)
ds_read_b128 v[192:195], v26 offset:35840
v_mfma_f32_16x16x32_bf16 v[56:59], v[216:219], a[32:35], v[56:59]
ds_read_b128 v[196:199], v26 offset:52224
v_mfma_f32_16x16x32_bf16 v[56:59], v[220:223], a[48:51], v[56:59]
ds_read_b64_tr_b16 v[208:209], v18 offset:24576
v_mfma_f32_16x16x32_bf16 v[60:63], v[216:219], a[36:39], v[60:63]
ds_read_b64_tr_b16 v[210:211], v18 offset:26624
v_mfma_f32_16x16x32_bf16 v[60:63], v[220:223], a[52:55], v[60:63]
v_add_f32 v136, v136, v140
v_add_f32 v144, v144, v148
v_mfma_f32_16x16x32_bf16 v[64:67], v[216:219], a[40:43], v[64:67]
ds_read_b64_tr_b16 v[212:213], v18 offset:28672
v_add_f32 v137, v137, v141
v_mfma_f32_16x16x32_bf16 v[64:67], v[220:223], a[56:59], v[64:67]
v_add_f32 v145, v145, v149
v_add_f32 v138, v138, v142
v_mfma_f32_16x16x32_bf16 v[68:71], v[216:219], a[44:47], v[68:71]
ds_read_b64_tr_b16 v[214:215], v18 offset:30720
v_add_f32 v146, v146, v150
v_mfma_f32_16x16x32_bf16 v[68:71], v[220:223], a[60:63], v[68:71]
s_waitcnt lgkmcnt(6)
v_add_f32 v139, v139, v143
v_add_f32 v147, v147, v151
v_mfma_f32_16x16x32_bf16 v[72:75], v[200:203], a[32:35], v[72:75]
ds_read_b64_tr_b16 v[216:217], v19 offset:24576
v_add_f32 v136, v136, v144
v_mfma_f32_16x16x32_bf16 v[72:75], v[204:207], a[48:51], v[72:75]
v_add_f32 v137, v137, v145
v_add_f32 v138, v138, v146
v_mfma_f32_16x16x32_bf16 v[76:79], v[200:203], a[36:39], v[76:79]
ds_read_b64_tr_b16 v[218:219], v19 offset:26624
v_add_f32 v139, v139, v147
v_mfma_f32_16x16x32_bf16 v[76:79], v[204:207], a[52:55], v[76:79]
v_add_f32 v152, v152, v156
v_add_f32 v160, v160, v164
v_mfma_f32_16x16x32_bf16 v[80:83], v[200:203], a[40:43], v[80:83]
ds_read_b64_tr_b16 v[220:221], v19 offset:28672
v_add_f32 v153, v153, v157
v_mfma_f32_16x16x32_bf16 v[80:83], v[204:207], a[56:59], v[80:83]
v_add_f32 v161, v161, v165
v_add_f32 v154, v154, v158
v_mfma_f32_16x16x32_bf16 v[84:87], v[200:203], a[44:47], v[84:87]
ds_read_b64_tr_b16 v[222:223], v19 offset:30720
v_add_f32 v162, v162, v166
v_mfma_f32_16x16x32_bf16 v[84:87], v[204:207], a[60:63], v[84:87]
s_waitcnt lgkmcnt(4)
v_add_f32 v155, v155, v159
v_add_f32 v163, v163, v167
v_mfma_f32_16x16x32_bf16 v[88:91], v[208:211], a[32:35], v[88:91]
ds_read_b64_tr_b16 v[200:201], v27 offset:1024
v_add_f32 v152, v152, v160
v_mfma_f32_16x16x32_bf16 v[88:91], v[212:215], a[48:51], v[88:91]
v_add_f32 v153, v153, v161
v_add_f32 v154, v154, v162
v_mfma_f32_16x16x32_bf16 v[92:95], v[208:211], a[36:39], v[92:95]
ds_read_b64_tr_b16 v[202:203], v27 offset:1280
v_add_f32 v155, v155, v163
v_mfma_f32_16x16x32_bf16 v[92:95], v[212:215], a[52:55], v[92:95]
v_cvt_pk_bf16_f32 v136, v136, v137
v_cvt_pk_bf16_f32 v137, v138, v139
v_mfma_f32_16x16x32_bf16 v[96:99], v[208:211], a[40:43], v[96:99]
ds_read_b64_tr_b16 v[204:205], v27 offset:1536
v_cvt_pk_bf16_f32 v138, v152, v153
v_mfma_f32_16x16x32_bf16 v[96:99], v[212:215], a[56:59], v[96:99]
v_cvt_pk_bf16_f32 v139, v154, v155
v_mfma_f32_16x16x32_bf16 v[100:103], v[208:211], a[44:47], v[100:103]
ds_read_b64_tr_b16 v[206:207], v27 offset:1792
v_mfma_f32_16x16x32_bf16 v[100:103], v[212:215], a[60:63], v[100:103]
s_waitcnt lgkmcnt(4)
v_mfma_f32_16x16x32_bf16 v[104:107], v[216:219], a[32:35], v[104:107]
s_barrier
v_mfma_f32_16x16x32_bf16 v[104:107], v[220:223], a[48:51], v[104:107]
ds_read_b64_tr_b16 v[208:209], v12 offset:0
v_mfma_f32_16x16x32_bf16 v[108:111], v[216:219], a[36:39], v[108:111]
ds_read_b64_tr_b16 v[210:211], v12 offset:2048
v_mfma_f32_16x16x32_bf16 v[108:111], v[220:223], a[52:55], v[108:111]
buffer_store_dwordx4 v[136:139], v4, s[12:15], s63 offen offset:0 sc1
v_mfma_f32_16x16x32_bf16 v[112:115], v[216:219], a[40:43], v[112:115]
ds_read_b64_tr_b16 v[212:213], v12 offset:4096
v_mfma_f32_16x16x32_bf16 v[112:115], v[220:223], a[56:59], v[112:115]
v_add_f32 v168, v168, v172
v_add_f32 v176, v176, v180
v_mfma_f32_16x16x32_bf16 v[116:119], v[216:219], a[44:47], v[116:119]
ds_read_b64_tr_b16 v[214:215], v12 offset:6144
v_add_f32 v169, v169, v173
v_mfma_f32_16x16x32_bf16 v[116:119], v[220:223], a[60:63], v[116:119]
s_waitcnt lgkmcnt(4)
v_add_f32 v177, v177, v181
v_add_f32 v170, v170, v174
v_mfma_f32_16x16x32_bf16 v[120:123], v[200:203], a[32:35], v[120:123]
ds_read_b64_tr_b16 v[216:217], v12 offset:8192
v_add_f32 v178, v178, v182
v_mfma_f32_16x16x32_bf16 v[120:123], v[204:207], a[48:51], v[120:123]
v_add_f32 v171, v171, v175
v_add_f32 v179, v179, v183
v_mfma_f32_16x16x32_bf16 v[124:127], v[200:203], a[36:39], v[124:127]
ds_read_b64_tr_b16 v[218:219], v12 offset:10240
v_add_f32 v168, v168, v176
v_mfma_f32_16x16x32_bf16 v[124:127], v[204:207], a[52:55], v[124:127]
v_add_f32 v169, v169, v177
v_add_f32 v170, v170, v178
v_mfma_f32_16x16x32_bf16 v[128:131], v[200:203], a[40:43], v[128:131]
ds_read_b64_tr_b16 v[220:221], v12 offset:12288
v_add_f32 v171, v171, v179
v_mfma_f32_16x16x32_bf16 v[128:131], v[204:207], a[56:59], v[128:131]
v_add_f32 v184, v184, v188
v_add_f32 v192, v192, v196
v_mfma_f32_16x16x32_bf16 v[132:135], v[200:203], a[44:47], v[132:135]
ds_read_b64_tr_b16 v[222:223], v12 offset:14336
v_add_f32 v185, v185, v189
v_mfma_f32_16x16x32_bf16 v[132:135], v[204:207], a[60:63], v[132:135]
s_waitcnt lgkmcnt(4)
v_add_f32 v193, v193, v197
v_add_f32 v186, v186, v190
v_mfma_f32_16x16x32_bf16 v[56:59], v[208:211], a[64:67], v[56:59]
ds_read_b64_tr_b16 v[200:201], v12 offset:16384
v_add_f32 v194, v194, v198
v_mfma_f32_16x16x32_bf16 v[56:59], v[212:215], a[80:83], v[56:59]
v_add_f32 v187, v187, v191
v_add_f32 v195, v195, v199
v_mfma_f32_16x16x32_bf16 v[60:63], v[208:211], a[68:71], v[60:63]
ds_read_b64_tr_b16 v[202:203], v12 offset:18432
v_add_f32 v184, v184, v192
v_mfma_f32_16x16x32_bf16 v[60:63], v[212:215], a[84:87], v[60:63]
v_add_f32 v185, v185, v193
v_add_f32 v186, v186, v194
v_mfma_f32_16x16x32_bf16 v[64:67], v[208:211], a[72:75], v[64:67]
ds_read_b64_tr_b16 v[204:205], v12 offset:20480
v_add_f32 v187, v187, v195
v_mfma_f32_16x16x32_bf16 v[64:67], v[212:215], a[88:91], v[64:67]
v_cvt_pk_bf16_f32 v168, v168, v169
v_cvt_pk_bf16_f32 v169, v170, v171
v_mfma_f32_16x16x32_bf16 v[68:71], v[208:211], a[76:79], v[68:71]
ds_read_b64_tr_b16 v[206:207], v12 offset:22528
v_cvt_pk_bf16_f32 v170, v184, v185
v_mfma_f32_16x16x32_bf16 v[68:71], v[212:215], a[92:95], v[68:71]
s_waitcnt lgkmcnt(4)
v_cvt_pk_bf16_f32 v171, v186, v187
v_mfma_f32_16x16x32_bf16 v[56:59], v[216:219], a[96:99], v[56:59]
ds_read_b64_tr_b16 v[208:209], v12 offset:24576
v_mfma_f32_16x16x32_bf16 v[56:59], v[220:223], a[112:115], v[56:59]
buffer_store_dwordx4 v[168:171], v4, s[12:15], s63 offen offset:1024 sc1
v_mfma_f32_16x16x32_bf16 v[60:63], v[216:219], a[100:103], v[60:63]
s_lshl_b32 s22, s19, 7
ds_read_b64_tr_b16 v[210:211], v12 offset:26624
v_mfma_f32_16x16x32_bf16 v[60:63], v[220:223], a[116:119], v[60:63]
s_add_u32 s6, s22, 58736640
s_lshl_b32 s22, s18, 4
s_lshl_b32 s23, s16, 2
v_mfma_f32_16x16x32_bf16 v[64:67], v[216:219], a[104:107], v[64:67]
s_add_u32 s22, s22, s23
ds_read_b64_tr_b16 v[212:213], v12 offset:28672
v_mfma_f32_16x16x32_bf16 v[64:67], v[220:223], a[120:123], v[64:67]
s_add_u32 s3, s22, s6
v_and_b32 v54, 31, v1
v_lshlrev_b32 v54, 2, v54
v_mfma_f32_16x16x32_bf16 v[68:71], v[216:219], a[108:111], v[68:71]
ds_read_b64_tr_b16 v[214:215], v12 offset:30720
v_lshrrev_b32 v32, 4, v1
v_mfma_f32_16x16x32_bf16 v[68:71], v[220:223], a[124:127], v[68:71]
s_waitcnt lgkmcnt(4)
v_and_b32 v33, 15, v1
v_add_u32 v35, 0, v33
v_mfma_f32_16x16x32_bf16 v[56:59], v[200:203], a[128:131], v[56:59]
ds_read_b64_tr_b16 v[216:217], v12 offset:32768
v_mul_u32_u24 v35, 3641, v35
v_mfma_f32_16x16x32_bf16 v[56:59], v[204:207], a[144:147], v[56:59]
v_lshrrev_b32 v35, 16, v35
v_mul_u32_u24 v35, 18, v35
v_mfma_f32_16x16x32_bf16 v[60:63], v[200:203], a[132:135], v[60:63]
ds_read_b64_tr_b16 v[218:219], v12 offset:34816
v_lshlrev_b32 v36, 2, v32
v_mfma_f32_16x16x32_bf16 v[60:63], v[204:207], a[148:151], v[60:63]
v_sub_u32 v49, v35, v36
v_add_u32 v35, 16, v33
v_mfma_f32_16x16x32_bf16 v[64:67], v[200:203], a[136:139], v[64:67]
ds_read_b64_tr_b16 v[220:221], v12 offset:36864
v_mul_u32_u24 v35, 3641, v35
v_mfma_f32_16x16x32_bf16 v[64:67], v[204:207], a[152:155], v[64:67]
v_lshrrev_b32 v35, 16, v35
v_mul_u32_u24 v35, 18, v35
v_mfma_f32_16x16x32_bf16 v[68:71], v[200:203], a[140:143], v[68:71]
ds_read_b64_tr_b16 v[222:223], v12 offset:38912
v_lshlrev_b32 v36, 2, v32
v_mfma_f32_16x16x32_bf16 v[68:71], v[204:207], a[156:159], v[68:71]
s_waitcnt lgkmcnt(4)
v_sub_u32 v50, v35, v36
v_add_u32 v35, 32, v33
v_mfma_f32_16x16x32_bf16 v[56:59], v[208:211], a[160:163], v[56:59]
s_waitcnt vmcnt(2)
s_barrier
v_mul_u32_u24 v35, 3641, v35
v_mfma_f32_16x16x32_bf16 v[56:59], v[212:215], a[176:179], v[56:59]
ds_read_b64_tr_b16 v[200:201], v12 offset:40960
v_lshrrev_b32 v35, 16, v35
v_mfma_f32_16x16x32_bf16 v[60:63], v[208:211], a[164:167], v[60:63]
ds_read_b64_tr_b16 v[202:203], v12 offset:43008
v_mul_u32_u24 v35, 18, v35
v_mfma_f32_16x16x32_bf16 v[60:63], v[212:215], a[180:183], v[60:63]
v_lshlrev_b32 v36, 2, v32
v_sub_u32 v51, v35, v36
v_mfma_f32_16x16x32_bf16 v[64:67], v[208:211], a[168:171], v[64:67]
ds_read_b64_tr_b16 v[204:205], v12 offset:45056
v_add_u32 v35, 48, v33
v_mfma_f32_16x16x32_bf16 v[64:67], v[212:215], a[184:187], v[64:67]
v_mul_u32_u24 v35, 3641, v35
v_lshrrev_b32 v35, 16, v35
v_mfma_f32_16x16x32_bf16 v[68:71], v[208:211], a[172:175], v[68:71]
ds_read_b64_tr_b16 v[206:207], v12 offset:47104
v_mul_u32_u24 v35, 18, v35
v_mfma_f32_16x16x32_bf16 v[68:71], v[212:215], a[188:191], v[68:71]
s_waitcnt lgkmcnt(4)
v_lshlrev_b32 v36, 2, v32
v_sub_u32 v52, v35, v36
v_mfma_f32_16x16x32_bf16 v[56:59], v[216:219], a[192:195], v[56:59]
ds_read_b64_tr_b16 v[208:209], v16 offset:0
v_add_u32 v35, 56, v33
v_mfma_f32_16x16x32_bf16 v[56:59], v[220:223], a[208:211], v[56:59]
v_mul_u32_u24 v35, 3641, v35
v_lshrrev_b32 v35, 16, v35
v_mfma_f32_16x16x32_bf16 v[60:63], v[216:219], a[196:199], v[60:63]
ds_read_b64_tr_b16 v[210:211], v16 offset:2048
v_mul_u32_u24 v35, 18, v35
v_mfma_f32_16x16x32_bf16 v[60:63], v[220:223], a[212:215], v[60:63]
v_lshlrev_b32 v36, 2, v32
v_sub_u32 v53, v35, v36
v_mfma_f32_16x16x32_bf16 v[64:67], v[216:219], a[200:203], v[64:67]
s_lshr_b32 s22, s19, 2
ds_read_b64_tr_b16 v[212:213], v16 offset:4096
v_mfma_f32_16x16x32_bf16 v[64:67], v[220:223], a[216:219], v[64:67]
s_lshl_b32 s22, s22, 10
s_and_b32 s23, s19, 3
s_lshl_b32 s23, s23, 8
v_mfma_f32_16x16x32_bf16 v[68:71], v[216:219], a[204:207], v[68:71]
s_add_u32 s22, s22, s23
ds_read_b64_tr_b16 v[214:215], v16 offset:6144
v_mfma_f32_16x16x32_bf16 v[68:71], v[220:223], a[220:223], v[68:71]
s_waitcnt lgkmcnt(4)
s_lshl_b32 s23, s19, 11
s_sub_u32 s22, s22, s23
v_mfma_f32_16x16x32_bf16 v[56:59], v[200:203], a[224:227], v[56:59]
s_add_u32 s22, s22, 16368
ds_read_b64_tr_b16 v[216:217], v13 offset:0
v_mfma_f32_16x16x32_bf16 v[56:59], v[204:207], a[240:243], v[56:59]
v_lshlrev_b32 v44, 4, v33
v_lshl_add_u32 v44, v32, 3, v44
v_mfma_f32_16x16x32_bf16 v[60:63], v[200:203], a[228:231], v[60:63]
ds_read_b64_tr_b16 v[218:219], v13 offset:2048
v_add_u32 v44, s22, v44
v_mfma_f32_16x16x32_bf16 v[60:63], v[204:207], a[244:247], v[60:63]
v_cmp_gt_u32 vcc, 32, v1
v_mov_b32 v35, 1073741824
v_mfma_f32_16x16x32_bf16 v[64:67], v[200:203], a[232:235], v[64:67]
ds_read_b64_tr_b16 v[220:221], v13 offset:4096
v_cndmask_b32 v44, v44, v35, vcc
v_mfma_f32_16x16x32_bf16 v[64:67], v[204:207], a[248:251], v[64:67]
s_add_u32 s40, s40, s23
s_add_u32 s40, s40, 147456
s_add_u32 s41, s40, 165888
v_mfma_f32_16x16x32_bf16 v[68:71], v[200:203], a[236:239], v[68:71]
s_add_u32 s24, s40, 331776
ds_read_b64_tr_b16 v[222:223], v13 offset:6144
v_mfma_f32_16x16x32_bf16 v[68:71], v[204:207], a[252:255], v[68:71]
s_waitcnt lgkmcnt(4)
s_add_u32 s25, s40, 497664
v_mfma_f32_16x16x32_bf16 v[56:59], v[208:211], v[224:227], v[56:59]
ds_read_b64_tr_b16 v[200:201], v13 offset:8192
v_mfma_f32_16x16x32_bf16 v[56:59], v[212:215], v[240:243], v[56:59]
v_mfma_f32_16x16x32_bf16 v[60:63], v[208:211], v[228:231], v[60:63]
ds_read_b64_tr_b16 v[202:203], v13 offset:10240
v_mfma_f32_16x16x32_bf16 v[60:63], v[212:215], v[244:247], v[60:63]
s_waitcnt vmcnt(0)
buffer_store_dword v31, v28, s[12:15], s3 offen sc1
v_mfma_f32_16x16x32_bf16 v[64:67], v[208:211], v[232:235], v[64:67]
ds_read_b64_tr_b16 v[204:205], v13 offset:12288
v_mfma_f32_16x16x32_bf16 v[64:67], v[212:215], v[248:251], v[64:67]
v_mfma_f32_16x16x32_bf16 v[68:71], v[208:211], v[236:239], v[68:71]
ds_read_b64_tr_b16 v[206:207], v13 offset:14336
v_mfma_f32_16x16x32_bf16 v[68:71], v[212:215], v[252:255], v[68:71]
s_waitcnt lgkmcnt(4)
v_mfma_f32_16x16x32_bf16 v[72:75], v[216:219], a[64:67], v[72:75]
ds_read_b64_tr_b16 v[208:209], v13 offset:16384
v_mfma_f32_16x16x32_bf16 v[72:75], v[220:223], a[80:83], v[72:75]
v_mfma_f32_16x16x32_bf16 v[76:79], v[216:219], a[68:71], v[76:79]
ds_read_b64_tr_b16 v[210:211], v13 offset:18432
v_mfma_f32_16x16x32_bf16 v[76:79], v[220:223], a[84:87], v[76:79]
v_mfma_f32_16x16x32_bf16 v[80:83], v[216:219], a[72:75], v[80:83]
ds_read_b64_tr_b16 v[212:213], v13 offset:20480
v_mfma_f32_16x16x32_bf16 v[80:83], v[220:223], a[88:91], v[80:83]
v_exp_f32 v32, v56 clamp
v_mfma_f32_16x16x32_bf16 v[84:87], v[216:219], a[76:79], v[84:87]
ds_read_b64_tr_b16 v[214:215], v13 offset:22528
v_max_f32 v56, 0x35c1a2a0, v56
v_mfma_f32_16x16x32_bf16 v[84:87], v[220:223], a[92:95], v[84:87]
s_waitcnt lgkmcnt(4)
v_exp_f32 v33, v57 clamp
v_mfma_f32_16x16x32_bf16 v[72:75], v[200:203], a[96:99], v[72:75]
s_barrier
v_fma_f32 v56, v56, v29, v32
v_mfma_f32_16x16x32_bf16 v[72:75], v[204:207], a[112:115], v[72:75]
ds_read_b64_tr_b16 v[216:217], v13 offset:24576
v_max_f32 v57, 0x35c1a2a0, v57
v_mfma_f32_16x16x32_bf16 v[76:79], v[200:203], a[100:103], v[76:79]
ds_read_b64_tr_b16 v[218:219], v13 offset:26624
v_fma_f32 v57, v57, v29, v33
v_mfma_f32_16x16x32_bf16 v[76:79], v[204:207], a[116:119], v[76:79]
v_exp_f32 v34, v58 clamp
v_mfma_f32_16x16x32_bf16 v[80:83], v[200:203], a[104:107], v[80:83]
ds_read_b64_tr_b16 v[220:221], v13 offset:28672
v_max_f32 v58, 0x35c1a2a0, v58
v_mfma_f32_16x16x32_bf16 v[80:83], v[204:207], a[120:123], v[80:83]
v_exp_f32 v35, v59 clamp
v_mfma_f32_16x16x32_bf16 v[84:87], v[200:203], a[108:111], v[84:87]
ds_read_b64_tr_b16 v[222:223], v13 offset:30720
v_fma_f32 v58, v58, v29, v34
v_mfma_f32_16x16x32_bf16 v[84:87], v[204:207], a[124:127], v[84:87]
s_waitcnt lgkmcnt(4)
v_exp_f32 v36, v60 clamp
v_mfma_f32_16x16x32_bf16 v[72:75], v[208:211], a[128:131], v[72:75]
ds_read_b64_tr_b16 v[200:201], v13 offset:32768
v_max_f32 v59, 0x35c1a2a0, v59
v_mfma_f32_16x16x32_bf16 v[72:75], v[212:215], a[144:147], v[72:75]
v_exp_f32 v37, v61 clamp
v_mfma_f32_16x16x32_bf16 v[76:79], v[208:211], a[132:135], v[76:79]
ds_read_b64_tr_b16 v[202:203], v13 offset:34816
v_fma_f32 v59, v59, v29, v35
v_mfma_f32_16x16x32_bf16 v[76:79], v[212:215], a[148:151], v[76:79]
v_exp_f32 v38, v62 clamp
v_mfma_f32_16x16x32_bf16 v[80:83], v[208:211], a[136:139], v[80:83]
ds_read_b64_tr_b16 v[204:205], v13 offset:36864
v_max_f32 v60, 0x35c1a2a0, v60
v_mfma_f32_16x16x32_bf16 v[80:83], v[212:215], a[152:155], v[80:83]
v_exp_f32 v39, v63 clamp
v_mfma_f32_16x16x32_bf16 v[84:87], v[208:211], a[140:143], v[84:87]
ds_read_b64_tr_b16 v[206:207], v13 offset:38912
v_fma_f32 v60, v60, v29, v36
v_mfma_f32_16x16x32_bf16 v[84:87], v[212:215], a[156:159], v[84:87]
s_waitcnt lgkmcnt(4)
v_exp_f32 v32, v64 clamp
v_mfma_f32_16x16x32_bf16 v[72:75], v[216:219], a[160:163], v[72:75]
ds_read_b64_tr_b16 v[208:209], v13 offset:40960
v_max_f32 v61, 0x35c1a2a0, v61
v_mfma_f32_16x16x32_bf16 v[72:75], v[220:223], a[176:179], v[72:75]
v_exp_f32 v33, v65 clamp
v_mfma_f32_16x16x32_bf16 v[76:79], v[216:219], a[164:167], v[76:79]
ds_read_b64_tr_b16 v[210:211], v13 offset:43008
v_fma_f32 v61, v61, v29, v37
v_mfma_f32_16x16x32_bf16 v[76:79], v[220:223], a[180:183], v[76:79]
v_exp_f32 v34, v66 clamp
v_mfma_f32_16x16x32_bf16 v[80:83], v[216:219], a[168:171], v[80:83]
ds_read_b64_tr_b16 v[212:213], v13 offset:45056
v_max_f32 v62, 0x35c1a2a0, v62
v_mfma_f32_16x16x32_bf16 v[80:83], v[220:223], a[184:187], v[80:83]
v_exp_f32 v35, v67 clamp
v_mfma_f32_16x16x32_bf16 v[84:87], v[216:219], a[172:175], v[84:87]
ds_read_b64_tr_b16 v[214:215], v13 offset:47104
v_fma_f32 v62, v62, v29, v38
v_mfma_f32_16x16x32_bf16 v[84:87], v[220:223], a[188:191], v[84:87]
s_waitcnt lgkmcnt(4)
v_exp_f32 v36, v68 clamp
v_mfma_f32_16x16x32_bf16 v[72:75], v[200:203], a[192:195], v[72:75]
ds_read_b64_tr_b16 v[216:217], v17 offset:0
v_max_f32 v63, 0x35c1a2a0, v63
v_mfma_f32_16x16x32_bf16 v[72:75], v[204:207], a[208:211], v[72:75]
v_exp_f32 v37, v69 clamp
v_mfma_f32_16x16x32_bf16 v[76:79], v[200:203], a[196:199], v[76:79]
ds_read_b64_tr_b16 v[218:219], v17 offset:2048
v_fma_f32 v63, v63, v29, v39
v_mfma_f32_16x16x32_bf16 v[76:79], v[204:207], a[212:215], v[76:79]
v_exp_f32 v38, v70 clamp
v_mfma_f32_16x16x32_bf16 v[80:83], v[200:203], a[200:203], v[80:83]
ds_read_b64_tr_b16 v[220:221], v17 offset:4096
v_max_f32 v64, 0x35c1a2a0, v64
v_mfma_f32_16x16x32_bf16 v[80:83], v[204:207], a[216:219], v[80:83]
v_exp_f32 v39, v71 clamp
v_mfma_f32_16x16x32_bf16 v[84:87], v[200:203], a[204:207], v[84:87]
ds_read_b64_tr_b16 v[222:223], v17 offset:6144
v_fma_f32 v64, v64, v29, v32
v_mfma_f32_16x16x32_bf16 v[84:87], v[204:207], a[220:223], v[84:87]
s_waitcnt lgkmcnt(4)
v_max_f32 v65, 0x35c1a2a0, v65
v_fma_f32 v65, v65, v29, v33
v_mfma_f32_16x16x32_bf16 v[72:75], v[208:211], a[224:227], v[72:75]
ds_read_b64_tr_b16 v[200:201], v14 offset:0
v_max_f32 v66, 0x35c1a2a0, v66
v_mfma_f32_16x16x32_bf16 v[72:75], v[212:215], a[240:243], v[72:75]
v_fma_f32 v66, v66, v29, v34
v_max_f32 v67, 0x35c1a2a0, v67
v_mfma_f32_16x16x32_bf16 v[76:79], v[208:211], a[228:231], v[76:79]
ds_read_b64_tr_b16 v[202:203], v14 offset:2048
v_fma_f32 v67, v67, v29, v35
v_mfma_f32_16x16x32_bf16 v[76:79], v[212:215], a[244:247], v[76:79]
v_max_f32 v68, 0x35c1a2a0, v68
v_fma_f32 v68, v68, v29, v36
v_mfma_f32_16x16x32_bf16 v[80:83], v[208:211], a[232:235], v[80:83]
ds_read_b64_tr_b16 v[204:205], v14 offset:4096
v_max_f32 v69, 0x35c1a2a0, v69
v_mfma_f32_16x16x32_bf16 v[80:83], v[212:215], a[248:251], v[80:83]
buffer_load_dword v55, v54, s[12:15], s6 offen offset:0 sc1
v_mfma_f32_16x16x32_bf16 v[84:87], v[208:211], a[236:239], v[84:87]
ds_read_b64_tr_b16 v[206:207], v14 offset:6144
v_fma_f32 v69, v69, v29, v37
v_mfma_f32_16x16x32_bf16 v[84:87], v[212:215], a[252:255], v[84:87]
s_waitcnt lgkmcnt(4)
v_max_f32 v70, 0x35c1a2a0, v70
v_fma_f32 v70, v70, v29, v38
v_mfma_f32_16x16x32_bf16 v[72:75], v[216:219], v[224:227], v[72:75]
s_barrier
v_max_f32 v71, 0x35c1a2a0, v71
v_mfma_f32_16x16x32_bf16 v[72:75], v[220:223], v[240:243], v[72:75]
ds_read_b64_tr_b16 v[208:209], v14 offset:8192
v_fma_f32 v71, v71, v29, v39
v_mfma_f32_16x16x32_bf16 v[76:79], v[216:219], v[228:231], v[76:79]
ds_read_b64_tr_b16 v[210:211], v14 offset:10240
v_mfma_f32_16x16x32_bf16 v[76:79], v[220:223], v[244:247], v[76:79]
v_mfma_f32_16x16x32_bf16 v[80:83], v[216:219], v[232:235], v[80:83]
ds_read_b64_tr_b16 v[212:213], v14 offset:12288
v_mfma_f32_16x16x32_bf16 v[80:83], v[220:223], v[248:251], v[80:83]
v_mfma_f32_16x16x32_bf16 v[84:87], v[216:219], v[236:239], v[84:87]
ds_read_b64_tr_b16 v[214:215], v14 offset:14336
v_mfma_f32_16x16x32_bf16 v[84:87], v[220:223], v[252:255], v[84:87]
s_waitcnt lgkmcnt(4)
v_mfma_f32_16x16x32_bf16 v[88:91], v[200:203], a[64:67], v[88:91]
ds_read_b64_tr_b16 v[216:217], v14 offset:16384
v_mfma_f32_16x16x32_bf16 v[88:91], v[204:207], a[80:83], v[88:91]
v_mfma_f32_16x16x32_bf16 v[92:95], v[200:203], a[68:71], v[92:95]
ds_read_b64_tr_b16 v[218:219], v14 offset:18432
v_mfma_f32_16x16x32_bf16 v[92:95], v[204:207], a[84:87], v[92:95]
v_mfma_f32_16x16x32_bf16 v[96:99], v[200:203], a[72:75], v[96:99]
ds_read_b64_tr_b16 v[220:221], v14 offset:20480
v_mfma_f32_16x16x32_bf16 v[96:99], v[204:207], a[88:91], v[96:99]
v_exp_f32 v32, v72 clamp
v_mfma_f32_16x16x32_bf16 v[100:103], v[200:203], a[76:79], v[100:103]
ds_read_b64_tr_b16 v[222:223], v14 offset:22528
v_max_f32 v72, 0x35c1a2a0, v72
v_mfma_f32_16x16x32_bf16 v[100:103], v[204:207], a[92:95], v[100:103]
s_waitcnt lgkmcnt(4)
v_exp_f32 v33, v73 clamp
v_mfma_f32_16x16x32_bf16 v[88:91], v[208:211], a[96:99], v[88:91]
ds_read_b64_tr_b16 v[200:201], v14 offset:24576
v_fma_f32 v72, v72, v29, v32
v_mfma_f32_16x16x32_bf16 v[88:91], v[212:215], a[112:115], v[88:91]
v_exp_f32 v34, v74 clamp
v_mfma_f32_16x16x32_bf16 v[92:95], v[208:211], a[100:103], v[92:95]
ds_read_b64_tr_b16 v[202:203], v14 offset:26624
v_max_f32 v73, 0x35c1a2a0, v73
v_mfma_f32_16x16x32_bf16 v[92:95], v[212:215], a[116:119], v[92:95]
v_exp_f32 v35, v75 clamp
v_mfma_f32_16x16x32_bf16 v[96:99], v[208:211], a[104:107], v[96:99]
ds_read_b64_tr_b16 v[204:205], v14 offset:28672
v_fma_f32 v73, v73, v29, v33
v_mfma_f32_16x16x32_bf16 v[96:99], v[212:215], a[120:123], v[96:99]
v_exp_f32 v36, v76 clamp
v_mfma_f32_16x16x32_bf16 v[100:103], v[208:211], a[108:111], v[100:103]
ds_read_b64_tr_b16 v[206:207], v14 offset:30720
v_max_f32 v74, 0x35c1a2a0, v74
v_mfma_f32_16x16x32_bf16 v[100:103], v[212:215], a[124:127], v[100:103]
s_waitcnt lgkmcnt(4)
v_exp_f32 v37, v77 clamp
v_mfma_f32_16x16x32_bf16 v[88:91], v[216:219], a[128:131], v[88:91]
ds_read_b64_tr_b16 v[208:209], v14 offset:32768
v_fma_f32 v74, v74, v29, v34
v_mfma_f32_16x16x32_bf16 v[88:91], v[220:223], a[144:147], v[88:91]
v_exp_f32 v38, v78 clamp
v_mfma_f32_16x16x32_bf16 v[92:95], v[216:219], a[132:135], v[92:95]
ds_read_b64_tr_b16 v[210:211], v14 offset:34816
v_max_f32 v75, 0x35c1a2a0, v75
v_mfma_f32_16x16x32_bf16 v[92:95], v[220:223], a[148:151], v[92:95]
v_exp_f32 v39, v79 clamp
v_mfma_f32_16x16x32_bf16 v[96:99], v[216:219], a[136:139], v[96:99]
ds_read_b64_tr_b16 v[212:213], v14 offset:36864
v_fma_f32 v75, v75, v29, v35
v_mfma_f32_16x16x32_bf16 v[96:99], v[220:223], a[152:155], v[96:99]
v_exp_f32 v32, v80 clamp
v_mfma_f32_16x16x32_bf16 v[100:103], v[216:219], a[140:143], v[100:103]
ds_read_b64_tr_b16 v[214:215], v14 offset:38912
v_max_f32 v76, 0x35c1a2a0, v76
v_mfma_f32_16x16x32_bf16 v[100:103], v[220:223], a[156:159], v[100:103]
s_waitcnt lgkmcnt(4)
v_exp_f32 v33, v81 clamp
v_mfma_f32_16x16x32_bf16 v[88:91], v[200:203], a[160:163], v[88:91]
ds_read_b64_tr_b16 v[216:217], v14 offset:40960
v_fma_f32 v76, v76, v29, v36
v_mfma_f32_16x16x32_bf16 v[88:91], v[204:207], a[176:179], v[88:91]
s_waitcnt vmcnt(0)
v_cmp_ne_u32 vcc, s76, v55
s_nop 1
s_cbranch_vccnz slow_a1
back_a1:
v_mfma_f32_16x16x32_bf16 v[92:95], v[200:203], a[164:167], v[92:95]
ds_read_b64_tr_b16 v[218:219], v14 offset:43008
v_max_f32 v77, 0x35c1a2a0, v77
v_mfma_f32_16x16x32_bf16 v[92:95], v[204:207], a[180:183], v[92:95]
buffer_load_dwordx4 v[136:139], v4, s[12:15], s61 offen offset:0 sc1
v_mfma_f32_16x16x32_bf16 v[96:99], v[200:203], a[168:171], v[96:99]
ds_read_b64_tr_b16 v[220:221], v14 offset:45056
v_fma_f32 v77, v77, v29, v37
v_mfma_f32_16x16x32_bf16 v[96:99], v[204:207], a[184:187], v[96:99]
buffer_load_dwordx4 v[140:143], v4, s[12:15], s61 offen offset:1024 sc1
v_mfma_f32_16x16x32_bf16 v[100:103], v[200:203], a[172:175], v[100:103]
ds_read_b64_tr_b16 v[222:223], v14 offset:47104
v_max_f32 v78, 0x35c1a2a0, v78
v_mfma_f32_16x16x32_bf16 v[100:103], v[204:207], a[188:191], v[100:103]
s_waitcnt lgkmcnt(4)
v_exp_f32 v34, v82 clamp
v_mfma_f32_16x16x32_bf16 v[88:91], v[208:211], a[192:195], v[88:91]
s_barrier
v_fma_f32 v78, v78, v29, v38
v_mfma_f32_16x16x32_bf16 v[88:91], v[212:215], a[208:211], v[88:91]
ds_read_b64_tr_b16 v[200:201], v18 offset:0
v_max_f32 v79, 0x35c1a2a0, v79
v_mfma_f32_16x16x32_bf16 v[92:95], v[208:211], a[196:199], v[92:95]
ds_read_b64_tr_b16 v[202:203], v18 offset:2048
v_fma_f32 v79, v79, v29, v39
v_mfma_f32_16x16x32_bf16 v[92:95], v[212:215], a[212:215], v[92:95]
s_add_u32 s61, s61, 8192
v_exp_f32 v35, v83 clamp
v_mfma_f32_16x16x32_bf16 v[96:99], v[208:211], a[200:203], v[96:99]
ds_read_b64_tr_b16 v[204:205], v18 offset:4096
v_max_f32 v80, 0x35c1a2a0, v80
v_mfma_f32_16x16x32_bf16 v[96:99], v[212:215], a[216:219], v[96:99]
buffer_load_dwordx4 v[144:147], v4, s[12:15], s61 offen offset:0 sc1
v_mfma_f32_16x16x32_bf16 v[100:103], v[208:211], a[204:207], v[100:103]
ds_read_b64_tr_b16 v[206:207], v18 offset:6144
v_fma_f32 v80, v80, v29, v32
v_mfma_f32_16x16x32_bf16 v[100:103], v[212:215], a[220:223], v[100:103]
s_waitcnt lgkmcnt(4)
v_exp_f32 v36, v84 clamp
v_mfma_f32_16x16x32_bf16 v[88:91], v[216:219], a[224:227], v[88:91]
ds_read_b64_tr_b16 v[208:209], v15 offset:0
v_max_f32 v81, 0x35c1a2a0, v81
v_mfma_f32_16x16x32_bf16 v[88:91], v[220:223], a[240:243], v[88:91]
buffer_load_dwordx4 v[148:151], v4, s[12:15], s61 offen offset:1024 sc1
v_mfma_f32_16x16x32_bf16 v[92:95], v[216:219], a[228:231], v[92:95]
ds_read_b64_tr_b16 v[210:211], v15 offset:2048
v_fma_f32 v81, v81, v29, v33
v_mfma_f32_16x16x32_bf16 v[92:95], v[220:223], a[244:247], v[92:95]
s_add_u32 s61, s61, 8192
v_exp_f32 v37, v85 clamp
v_mfma_f32_16x16x32_bf16 v[96:99], v[216:219], a[232:235], v[96:99]
ds_read_b64_tr_b16 v[212:213], v15 offset:4096
v_max_f32 v82, 0x35c1a2a0, v82
v_mfma_f32_16x16x32_bf16 v[96:99], v[220:223], a[248:251], v[96:99]
buffer_load_dwordx4 v[152:155], v4, s[12:15], s61 offen offset:0 sc1
v_mfma_f32_16x16x32_bf16 v[100:103], v[216:219], a[236:239], v[100:103]
ds_read_b64_tr_b16 v[214:215], v15 offset:6144
v_fma_f32 v82, v82, v29, v34
v_mfma_f32_16x16x32_bf16 v[100:103], v[220:223], a[252:255], v[100:103]
s_waitcnt lgkmcnt(4)
v_exp_f32 v38, v86 clamp
v_mfma_f32_16x16x32_bf16 v[88:91], v[200:203], v[224:227], v[88:91]
ds_read_b64_tr_b16 v[216:217], v15 offset:8192
v_max_f32 v83, 0x35c1a2a0, v83
v_mfma_f32_16x16x32_bf16 v[88:91], v[204:207], v[240:243], v[88:91]
buffer_load_dwordx4 v[156:159], v4, s[12:15], s61 offen offset:1024 sc1
v_mfma_f32_16x16x32_bf16 v[92:95], v[200:203], v[228:231], v[92:95]
ds_read_b64_tr_b16 v[218:219], v15 offset:10240
v_fma_f32 v83, v83, v29, v35
v_mfma_f32_16x16x32_bf16 v[92:95], v[204:207], v[244:247], v[92:95]
s_add_u32 s61, s61, 8192
v_exp_f32 v39, v87 clamp
v_mfma_f32_16x16x32_bf16 v[96:99], v[200:203], v[232:235], v[96:99]
ds_read_b64_tr_b16 v[220:221], v15 offset:12288
v_max_f32 v84, 0x35c1a2a0, v84
v_mfma_f32_16x16x32_bf16 v[96:99], v[204:207], v[248:251], v[96:99]
buffer_load_dwordx4 v[160:163], v4, s[12:15], s61 offen offset:0 sc1
v_mfma_f32_16x16x32_bf16 v[100:103], v[200:203], v[236:239], v[100:103]
ds_read_b64_tr_b16 v[222:223], v15 offset:14336
v_fma_f32 v84, v84, v29, v36
v_mfma_f32_16x16x32_bf16 v[100:103], v[204:207], v[252:255], v[100:103]
s_waitcnt lgkmcnt(4)
v_max_f32 v85, 0x35c1a2a0, v85
v_fma_f32 v85, v85, v29, v37
v_mfma_f32_16x16x32_bf16 v[104:107], v[208:211], a[64:67], v[104:107]
ds_read_b64_tr_b16 v[200:201], v15 offset:16384
v_max_f32 v86, 0x35c1a2a0, v86
v_mfma_f32_16x16x32_bf16 v[104:107], v[212:215], a[80:83], v[104:107]
buffer_load_dwordx4 v[164:167], v4, s[12:15], s61 offen offset:1024 sc1
v_mfma_f32_16x16x32_bf16 v[108:111], v[208:211], a[68:71], v[108:111]
ds_read_b64_tr_b16 v[202:203], v15 offset:18432
v_fma_f32 v86, v86, v29, v38
v_mfma_f32_16x16x32_bf16 v[108:111], v[212:215], a[84:87], v[108:111]
s_add_u32 s61, s61, 8192
v_max_f32 v87, 0x35c1a2a0, v87
v_fma_f32 v87, v87, v29, v39
v_mfma_f32_16x16x32_bf16 v[112:115], v[208:211], a[72:75], v[112:115]
ds_read_b64_tr_b16 v[204:205], v15 offset:20480
v_cvt_pk_bf16_f32 v56, v56, v57
v_mfma_f32_16x16x32_bf16 v[112:115], v[212:215], a[88:91], v[112:115]
buffer_load_dwordx4 v[168:171], v4, s[12:15], s61 offen offset:0 sc1
v_mfma_f32_16x16x32_bf16 v[116:119], v[208:211], a[76:79], v[116:119]
ds_read_b64_tr_b16 v[206:207], v15 offset:22528
v_cvt_pk_bf16_f32 v57, v58, v59
v_mfma_f32_16x16x32_bf16 v[116:119], v[212:215], a[92:95], v[116:119]
s_waitcnt lgkmcnt(4)
v_cvt_pk_bf16_f32 v58, v72, v73
v_cvt_pk_bf16_f32 v59, v74, v75
v_mfma_f32_16x16x32_bf16 v[104:107], v[216:219], a[96:99], v[104:107]
ds_read_b64_tr_b16 v[208:209], v15 offset:24576
v_cvt_pk_bf16_f32 v60, v60, v61
v_mfma_f32_16x16x32_bf16 v[104:107], v[220:223], a[112:115], v[104:107]
buffer_load_dwordx4 v[172:175], v4, s[12:15], s61 offen offset:1024 sc1
v_mfma_f32_16x16x32_bf16 v[108:111], v[216:219], a[100:103], v[108:111]
ds_read_b64_tr_b16 v[210:211], v15 offset:26624
v_cvt_pk_bf16_f32 v61, v62, v63
v_mfma_f32_16x16x32_bf16 v[108:111], v[220:223], a[116:119], v[108:111]
s_add_u32 s61, s61, 8192
v_cvt_pk_bf16_f32 v62, v76, v77
v_cvt_pk_bf16_f32 v63, v78, v79
v_mfma_f32_16x16x32_bf16 v[112:115], v[216:219], a[104:107], v[112:115]
ds_read_b64_tr_b16 v[212:213], v15 offset:28672
v_cvt_pk_bf16_f32 v64, v64, v65
v_mfma_f32_16x16x32_bf16 v[112:115], v[220:223], a[120:123], v[112:115]
buffer_load_dwordx4 v[176:179], v4, s[12:15], s61 offen offset:0 sc1
v_mfma_f32_16x16x32_bf16 v[116:119], v[216:219], a[108:111], v[116:119]
ds_read_b64_tr_b16 v[214:215], v15 offset:30720
v_cvt_pk_bf16_f32 v65, v66, v67
v_mfma_f32_16x16x32_bf16 v[116:119], v[220:223], a[124:127], v[116:119]
s_waitcnt lgkmcnt(4)
v_cvt_pk_bf16_f32 v66, v80, v81
v_cvt_pk_bf16_f32 v67, v82, v83
v_mfma_f32_16x16x32_bf16 v[104:107], v[200:203], a[128:131], v[104:107]
s_barrier
v_cvt_pk_bf16_f32 v68, v68, v69
v_mfma_f32_16x16x32_bf16 v[104:107], v[204:207], a[144:147], v[104:107]
ds_read_b64_tr_b16 v[216:217], v15 offset:32768
v_cvt_pk_bf16_f32 v69, v70, v71
v_mfma_f32_16x16x32_bf16 v[108:111], v[200:203], a[132:135], v[108:111]
ds_read_b64_tr_b16 v[218:219], v15 offset:34816
v_cvt_pk_bf16_f32 v70, v84, v85
v_mfma_f32_16x16x32_bf16 v[108:111], v[204:207], a[148:151], v[108:111]
buffer_load_dwordx4 v[180:183], v4, s[12:15], s61 offen offset:1024 sc1
v_mfma_f32_16x16x32_bf16 v[112:115], v[200:203], a[136:139], v[112:115]
ds_read_b64_tr_b16 v[220:221], v15 offset:36864
v_cvt_pk_bf16_f32 v71, v86, v87
v_mfma_f32_16x16x32_bf16 v[112:115], v[204:207], a[152:155], v[112:115]
s_add_u32 s61, s61, 8192
v_exp_f32 v32, v88 clamp
v_mfma_f32_16x16x32_bf16 v[116:119], v[200:203], a[140:143], v[116:119]
ds_read_b64_tr_b16 v[222:223], v15 offset:38912
v_max_f32 v88, 0x35c1a2a0, v88
v_mfma_f32_16x16x32_bf16 v[116:119], v[204:207], a[156:159], v[116:119]
s_waitcnt lgkmcnt(4)
v_exp_f32 v33, v89 clamp
v_mfma_f32_16x16x32_bf16 v[104:107], v[208:211], a[160:163], v[104:107]
ds_read_b64_tr_b16 v[200:201], v15 offset:40960
v_fma_f32 v88, v88, v29, v32
v_mfma_f32_16x16x32_bf16 v[104:107], v[212:215], a[176:179], v[104:107]
buffer_load_dwordx4 v[184:187], v4, s[12:15], s61 offen offset:0 sc1
v_mfma_f32_16x16x32_bf16 v[108:111], v[208:211], a[164:167], v[108:111]
ds_read_b64_tr_b16 v[202:203], v15 offset:43008
v_max_f32 v89, 0x35c1a2a0, v89
v_mfma_f32_16x16x32_bf16 v[108:111], v[212:215], a[180:183], v[108:111]
buffer_load_dwordx4 v[188:191], v4, s[12:15], s61 offen offset:1024 sc1
v_mfma_f32_16x16x32_bf16 v[112:115], v[208:211], a[168:171], v[112:115]
ds_read_b64_tr_b16 v[204:205], v15 offset:45056
v_fma_f32 v89, v89, v29, v33
v_mfma_f32_16x16x32_bf16 v[112:115], v[212:215], a[184:187], v[112:115]
s_add_u32 s61, s61, 8192
v_exp_f32 v34, v90 clamp
v_mfma_f32_16x16x32_bf16 v[116:119], v[208:211], a[172:175], v[116:119]
ds_read_b64_tr_b16 v[206:207], v15 offset:47104
v_max_f32 v90, 0x35c1a2a0, v90
v_mfma_f32_16x16x32_bf16 v[116:119], v[212:215], a[188:191], v[116:119]
s_waitcnt lgkmcnt(4)
v_exp_f32 v35, v91 clamp
v_mfma_f32_16x16x32_bf16 v[104:107], v[216:219], a[192:195], v[104:107]
ds_read_b64_tr_b16 v[208:209], v19 offset:0
v_fma_f32 v90, v90, v29, v34
v_mfma_f32_16x16x32_bf16 v[104:107], v[220:223], a[208:211], v[104:107]
buffer_load_dwordx4 v[192:195], v4, s[12:15], s61 offen offset:0 sc1
v_mfma_f32_16x16x32_bf16 v[108:111], v[216:219], a[196:199], v[108:111]
ds_read_b64_tr_b16 v[210:211], v19 offset:2048
v_max_f32 v91, 0x35c1a2a0, v91
v_mfma_f32_16x16x32_bf16 v[108:111], v[220:223], a[212:215], v[108:111]
buffer_load_dwordx4 v[196:199], v4, s[12:15], s61 offen offset:1024 sc1
v_mfma_f32_16x16x32_bf16 v[112:115], v[216:219], a[200:203], v[112:115]
ds_read_b64_tr_b16 v[212:213], v19 offset:4096
v_fma_f32 v91, v91, v29, v35
v_mfma_f32_16x16x32_bf16 v[112:115], v[220:223], a[216:219], v[112:115]
v_exp_f32 v36, v92 clamp
v_mfma_f32_16x16x32_bf16 v[116:119], v[216:219], a[204:207], v[116:119]
ds_read_b64_tr_b16 v[214:215], v19 offset:6144
v_max_f32 v92, 0x35c1a2a0, v92
v_mfma_f32_16x16x32_bf16 v[116:119], v[220:223], a[220:223], v[116:119]
s_waitcnt lgkmcnt(4)
v_exp_f32 v37, v93 clamp
v_mfma_f32_16x16x32_bf16 v[104:107], v[200:203], a[224:227], v[104:107]
ds_read_b64_tr_b16 v[216:217], v27 offset:2048
v_fma_f32 v92, v92, v29, v36
v_mfma_f32_16x16x32_bf16 v[104:107], v[204:207], a[240:243], v[104:107]
v_exp_f32 v38, v94 clamp
v_mfma_f32_16x16x32_bf16 v[108:111], v[200:203], a[228:231], v[108:111]
ds_read_b64_tr_b16 v[218:219], v27 offset:2304
v_max_f32 v93, 0x35c1a2a0, v93
v_mfma_f32_16x16x32_bf16 v[108:111], v[204:207], a[244:247], v[108:111]
v_exp_f32 v39, v95 clamp
v_mfma_f32_16x16x32_bf16 v[112:115], v[200:203], a[232:235], v[112:115]
ds_read_b64_tr_b16 v[220:221], v27 offset:2560
v_fma_f32 v93, v93, v29, v37
v_mfma_f32_16x16x32_bf16 v[112:115], v[204:207], a[248:251], v[112:115]
v_exp_f32 v32, v96 clamp
v_mfma_f32_16x16x32_bf16 v[116:119], v[200:203], a[236:239], v[116:119]
ds_read_b64_tr_b16 v[222:223], v27 offset:2816
v_max_f32 v94, 0x35c1a2a0, v94
v_mfma_f32_16x16x32_bf16 v[116:119], v[204:207], a[252:255], v[116:119]
s_waitcnt lgkmcnt(4)
v_exp_f32 v33, v97 clamp
v_mfma_f32_16x16x32_bf16 v[104:107], v[208:211], v[224:227], v[104:107]
ds_read_b64_tr_b16 v[200:201], v27 offset:3072
v_fma_f32 v94, v94, v29, v38
v_mfma_f32_16x16x32_bf16 v[104:107], v[212:215], v[240:243], v[104:107]
v_exp_f32 v34, v98 clamp
v_mfma_f32_16x16x32_bf16 v[108:111], v[208:211], v[228:231], v[108:111]
ds_read_b64_tr_b16 v[202:203], v27 offset:3328
v_max_f32 v95, 0x35c1a2a0, v95
v_mfma_f32_16x16x32_bf16 v[108:111], v[212:215], v[244:247], v[108:111]
v_exp_f32 v35, v99 clamp
v_mfma_f32_16x16x32_bf16 v[112:115], v[208:211], v[232:235], v[112:115]
ds_read_b64_tr_b16 v[204:205], v27 offset:3584
v_fma_f32 v95, v95, v29, v39
v_mfma_f32_16x16x32_bf16 v[112:115], v[212:215], v[248:251], v[112:115]
v_exp_f32 v36, v100 clamp
v_mfma_f32_16x16x32_bf16 v[116:119], v[208:211], v[236:239], v[116:119]
ds_read_b64_tr_b16 v[206:207], v27 offset:3840
v_max_f32 v96, 0x35c1a2a0, v96
v_mfma_f32_16x16x32_bf16 v[116:119], v[212:215], v[252:255], v[116:119]
s_waitcnt lgkmcnt(4)
v_exp_f32 v37, v101 clamp
v_mfma_f32_16x16x32_bf16 v[120:123], v[216:219], a[64:67], v[120:123]
s_barrier
v_fma_f32 v96, v96, v29, v32
v_mfma_f32_16x16x32_bf16 v[120:123], v[220:223], a[80:83], v[120:123]
ds_read_b64_tr_b16 v[208:209], v27 offset:4096
v_max_f32 v97, 0x35c1a2a0, v97
v_mfma_f32_16x16x32_bf16 v[124:127], v[216:219], a[68:71], v[124:127]
ds_read_b64_tr_b16 v[210:211], v27 offset:4352
v_fma_f32 v97, v97, v29, v33
v_mfma_f32_16x16x32_bf16 v[124:127], v[220:223], a[84:87], v[124:127]
v_exp_f32 v38, v102 clamp
v_mfma_f32_16x16x32_bf16 v[128:131], v[216:219], a[72:75], v[128:131]
ds_read_b64_tr_b16 v[212:213], v27 offset:4608
v_max_f32 v98, 0x35c1a2a0, v98
v_mfma_f32_16x16x32_bf16 v[128:131], v[220:223], a[88:91], v[128:131]
v_exp_f32 v39, v103 clamp
v_mfma_f32_16x16x32_bf16 v[132:135], v[216:219], a[76:79], v[132:135]
ds_read_b64_tr_b16 v[214:215], v27 offset:4864
v_fma_f32 v98, v98, v29, v34
v_mfma_f32_16x16x32_bf16 v[132:135], v[220:223], a[92:95], v[132:135]
s_waitcnt lgkmcnt(4)
v_max_f32 v99, 0x35c1a2a0, v99
v_fma_f32 v99, v99, v29, v35
v_mfma_f32_16x16x32_bf16 v[120:123], v[200:203], a[96:99], v[120:123]
ds_read_b64_tr_b16 v[216:217], v27 offset:5120
v_max_f32 v100, 0x35c1a2a0, v100
v_mfma_f32_16x16x32_bf16 v[120:123], v[204:207], a[112:115], v[120:123]
v_fma_f32 v100, v100, v29, v36
v_max_f32 v101, 0x35c1a2a0, v101
v_mfma_f32_16x16x32_bf16 v[124:127], v[200:203], a[100:103], v[124:127]
ds_read_b64_tr_b16 v[218:219], v27 offset:5376
v_fma_f32 v101, v101, v29, v37
v_mfma_f32_16x16x32_bf16 v[124:127], v[204:207], a[116:119], v[124:127]
v_max_f32 v102, 0x35c1a2a0, v102
v_fma_f32 v102, v102, v29, v38
v_mfma_f32_16x16x32_bf16 v[128:131], v[200:203], a[104:107], v[128:131]
ds_read_b64_tr_b16 v[220:221], v27 offset:5632
v_max_f32 v103, 0x35c1a2a0, v103
v_mfma_f32_16x16x32_bf16 v[128:131], v[204:207], a[120:123], v[128:131]
v_fma_f32 v103, v103, v29, v39
v_mfma_f32_16x16x32_bf16 v[132:135], v[200:203], a[108:111], v[132:135]
ds_read_b64_tr_b16 v[222:223], v27 offset:5888
v_mfma_f32_16x16x32_bf16 v[132:135], v[204:207], a[124:127], v[132:135]
s_waitcnt lgkmcnt(4)
v_exp_f32 v32, v104 clamp
v_mfma_f32_16x16x32_bf16 v[120:123], v[208:211], a[128:131], v[120:123]
ds_read_b64_tr_b16 v[200:201], v27 offset:6144
v_max_f32 v104, 0x35c1a2a0, v104
v_mfma_f32_16x16x32_bf16 v[120:123], v[212:215], a[144:147], v[120:123]
v_exp_f32 v33, v105 clamp
v_mfma_f32_16x16x32_bf16 v[124:127], v[208:211], a[132:135], v[124:127]
ds_read_b64_tr_b16 v[202:203], v27 offset:6400
v_fma_f32 v104, v104, v29, v32
v_mfma_f32_16x16x32_bf16 v[124:127], v[212:215], a[148:151], v[124:127]
v_exp_f32 v34, v106 clamp
v_mfma_f32_16x16x32_bf16 v[128:131], v[208:211], a[136:139], v[128:131]
ds_read_b64_tr_b16 v[204:205], v27 offset:6656
v_max_f32 v105, 0x35c1a2a0, v105
v_mfma_f32_16x16x32_bf16 v[128:131], v[212:215], a[152:155], v[128:131]
v_exp_f32 v35, v107 clamp
v_mfma_f32_16x16x32_bf16 v[132:135], v[208:211], a[140:143], v[132:135]
ds_read_b64_tr_b16 v[206:207], v27 offset:6912
v_fma_f32 v105, v105, v29, v33
v_mfma_f32_16x16x32_bf16 v[132:135], v[212:215], a[156:159], v[132:135]
s_waitcnt lgkmcnt(4)
v_exp_f32 v36, v108 clamp
v_mfma_f32_16x16x32_bf16 v[120:123], v[216:219], a[160:163], v[120:123]
ds_read_b64_tr_b16 v[208:209], v27 offset:7168
v_max_f32 v106, 0x35c1a2a0, v106
v_mfma_f32_16x16x32_bf16 v[120:123], v[220:223], a[176:179], v[120:123]
v_exp_f32 v37, v109 clamp
v_mfma_f32_16x16x32_bf16 v[124:127], v[216:219], a[164:167], v[124:127]
ds_read_b64_tr_b16 v[210:211], v27 offset:7424
v_fma_f32 v106, v106, v29, v34
v_mfma_f32_16x16x32_bf16 v[124:127], v[220:223], a[180:183], v[124:127]
v_exp_f32 v38, v110 clamp
v_mfma_f32_16x16x32_bf16 v[128:131], v[216:219], a[168:171], v[128:131]
ds_read_b64_tr_b16 v[212:213], v27 offset:7680
v_max_f32 v107, 0x35c1a2a0, v107
v_mfma_f32_16x16x32_bf16 v[128:131], v[220:223], a[184:187], v[128:131]
v_exp_f32 v39, v111 clamp
v_mfma_f32_16x16x32_bf16 v[132:135], v[216:219], a[172:175], v[132:135]
ds_read_b64_tr_b16 v[214:215], v27 offset:7936
v_fma_f32 v107, v107, v29, v35
v_mfma_f32_16x16x32_bf16 v[132:135], v[220:223], a[188:191], v[132:135]
s_waitcnt lgkmcnt(4)
v_exp_f32 v32, v112 clamp
v_mfma_f32_16x16x32_bf16 v[120:123], v[200:203], a[192:195], v[120:123]
ds_read_b64_tr_b16 v[216:217], v27 offset:8192
v_max_f32 v108, 0x35c1a2a0, v108
v_mfma_f32_16x16x32_bf16 v[120:123], v[204:207], a[208:211], v[120:123]
v_exp_f32 v33, v113 clamp
v_mfma_f32_16x16x32_bf16 v[124:127], v[200:203], a[196:199], v[124:127]
ds_read_b64_tr_b16 v[218:219], v27 offset:8448
v_fma_f32 v108, v108, v29, v36
v_mfma_f32_16x16x32_bf16 v[124:127], v[204:207], a[212:215], v[124:127]
v_exp_f32 v34, v114 clamp
v_mfma_f32_16x16x32_bf16 v[128:131], v[200:203], a[200:203], v[128:131]
ds_read_b64_tr_b16 v[220:221], v27 offset:8704
v_max_f32 v109, 0x35c1a2a0, v109
v_mfma_f32_16x16x32_bf16 v[128:131], v[204:207], a[216:219], v[128:131]
v_exp_f32 v35, v115 clamp
v_mfma_f32_16x16x32_bf16 v[132:135], v[200:203], a[204:207], v[132:135]
ds_read_b64_tr_b16 v[222:223], v27 offset:8960
v_fma_f32 v109, v109, v29, v37
v_mfma_f32_16x16x32_bf16 v[132:135], v[204:207], a[220:223], v[132:135]
s_waitcnt lgkmcnt(4)
v_exp_f32 v36, v116 clamp
v_mfma_f32_16x16x32_bf16 v[120:123], v[208:211], a[224:227], v[120:123]
v_exp_f32 v37, v117 clamp
v_mfma_f32_16x16x32_bf16 v[120:123], v[212:215], a[240:243], v[120:123]
v_max_f32 v110, 0x35c1a2a0, v110
v_fma_f32 v110, v110, v29, v38
v_mfma_f32_16x16x32_bf16 v[124:127], v[208:211], a[228:231], v[124:127]
v_exp_f32 v38, v118 clamp
v_mfma_f32_16x16x32_bf16 v[124:127], v[212:215], a[244:247], v[124:127]
v_max_f32 v111, 0x35c1a2a0, v111
v_fma_f32 v111, v111, v29, v39
v_mfma_f32_16x16x32_bf16 v[128:131], v[208:211], a[232:235], v[128:131]
v_exp_f32 v39, v119 clamp
v_mfma_f32_16x16x32_bf16 v[128:131], v[212:215], a[248:251], v[128:131]
v_max_f32 v112, 0x35c1a2a0, v112
v_fma_f32 v112, v112, v29, v32
v_mfma_f32_16x16x32_bf16 v[132:135], v[208:211], a[236:239], v[132:135]
v_max_f32 v113, 0x35c1a2a0, v113
v_fma_f32 v113, v113, v29, v33
v_mfma_f32_16x16x32_bf16 v[132:135], v[212:215], a[252:255], v[132:135]
s_waitcnt lgkmcnt(0)
v_max_f32 v114, 0x35c1a2a0, v114
v_fma_f32 v114, v114, v29, v34
v_mfma_f32_16x16x32_bf16 v[120:123], v[216:219], v[224:227], v[120:123]
v_max_f32 v115, 0x35c1a2a0, v115
v_fma_f32 v115, v115, v29, v35
v_mfma_f32_16x16x32_bf16 v[120:123], v[220:223], v[240:243], v[120:123]
v_max_f32 v116, 0x35c1a2a0, v116
v_fma_f32 v116, v116, v29, v36
v_mfma_f32_16x16x32_bf16 v[124:127], v[216:219], v[228:231], v[124:127]
v_max_f32 v117, 0x35c1a2a0, v117
v_fma_f32 v117, v117, v29, v37
v_mfma_f32_16x16x32_bf16 v[124:127], v[220:223], v[244:247], v[124:127]
v_max_f32 v118, 0x35c1a2a0, v118
v_fma_f32 v118, v118, v29, v38
v_mfma_f32_16x16x32_bf16 v[128:131], v[216:219], v[232:235], v[128:131]
v_max_f32 v119, 0x35c1a2a0, v119
v_fma_f32 v119, v119, v29, v39
v_mfma_f32_16x16x32_bf16 v[128:131], v[220:223], v[248:251], v[128:131]
v_cvt_pk_bf16_f32 v88, v88, v89
v_cvt_pk_bf16_f32 v89, v90, v91
v_mfma_f32_16x16x32_bf16 v[132:135], v[216:219], v[236:239], v[132:135]
v_cvt_pk_bf16_f32 v90, v104, v105
v_cvt_pk_bf16_f32 v91, v106, v107
v_mfma_f32_16x16x32_bf16 v[132:135], v[220:223], v[252:255], v[132:135]
v_cvt_pk_bf16_f32 v92, v92, v93
v_cvt_pk_bf16_f32 v93, v94, v95
v_cvt_pk_bf16_f32 v94, v108, v109
v_cvt_pk_bf16_f32 v95, v110, v111
v_cvt_pk_bf16_f32 v96, v96, v97
v_cvt_pk_bf16_f32 v97, v98, v99
v_cvt_pk_bf16_f32 v98, v112, v113
v_cvt_pk_bf16_f32 v99, v114, v115
v_cvt_pk_bf16_f32 v100, v100, v101
v_cvt_pk_bf16_f32 v101, v102, v103
v_cvt_pk_bf16_f32 v102, v116, v117
v_cvt_pk_bf16_f32 v103, v118, v119
buffer_load_dword v55, v10, s[12:15], s5 offen offset:0 sc1
s_mov_b32 s38, 0x3f80
s_mov_b32 s39, 0x3f800000
s_waitcnt vmcnt(16)
v_lshlrev_b32 v200, 16, v136
v_and_b32 v201, 0xffff0000, v136
v_lshlrev_b32 v202, 16, v137
v_and_b32 v203, 0xffff0000, v137
v_lshlrev_b32 v204, 16, v138
v_and_b32 v205, 0xffff0000, v138
v_lshlrev_b32 v206, 16, v139
v_and_b32 v207, 0xffff0000, v139
s_waitcnt vmcnt(15)
v_lshlrev_b32 v208, 16, v140
v_and_b32 v209, 0xffff0000, v140
v_lshlrev_b32 v210, 16, v141
v_and_b32 v211, 0xffff0000, v141
v_lshlrev_b32 v212, 16, v142
v_and_b32 v213, 0xffff0000, v142
v_lshlrev_b32 v214, 16, v143
v_and_b32 v215, 0xffff0000, v143
s_waitcnt vmcnt(14)
v_dot2_f32_bf16 v200, v144, s38, v200
v_dot2_f32_bf16 v201, v144, s39, v201
v_dot2_f32_bf16 v202, v145, s38, v202
v_dot2_f32_bf16 v203, v145, s39, v203
v_dot2_f32_bf16 v204, v146, s38, v204
v_dot2_f32_bf16 v205, v146, s39, v205
v_dot2_f32_bf16 v206, v147, s38, v206
v_dot2_f32_bf16 v207, v147, s39, v207
s_waitcnt vmcnt(13)
v_dot2_f32_bf16 v208, v148, s38, v208
v_dot2_f32_bf16 v209, v148, s39, v209
v_dot2_f32_bf16 v210, v149, s38, v210
v_dot2_f32_bf16 v211, v149, s39, v211
v_dot2_f32_bf16 v212, v150, s38, v212
v_dot2_f32_bf16 v213, v150, s39, v213
v_dot2_f32_bf16 v214, v151, s38, v214
v_dot2_f32_bf16 v215, v151, s39, v215
s_waitcnt vmcnt(12)
v_dot2_f32_bf16 v200, v152, s38, v200
v_dot2_f32_bf16 v201, v152, s39, v201
v_dot2_f32_bf16 v202, v153, s38, v202
v_dot2_f32_bf16 v203, v153, s39, v203
v_dot2_f32_bf16 v204, v154, s38, v204
v_dot2_f32_bf16 v205, v154, s39, v205
v_dot2_f32_bf16 v206, v155, s38, v206
v_dot2_f32_bf16 v207, v155, s39, v207
s_waitcnt vmcnt(11)
v_dot2_f32_bf16 v208, v156, s38, v208
v_dot2_f32_bf16 v209, v156, s39, v209
v_dot2_f32_bf16 v210, v157, s38, v210
v_dot2_f32_bf16 v211, v157, s39, v211
v_dot2_f32_bf16 v212, v158, s38, v212
v_dot2_f32_bf16 v213, v158, s39, v213
v_dot2_f32_bf16 v214, v159, s38, v214
v_dot2_f32_bf16 v215, v159, s39, v215
s_waitcnt vmcnt(10)
v_dot2_f32_bf16 v200, v160, s38, v200
v_dot2_f32_bf16 v201, v160, s39, v201
v_dot2_f32_bf16 v202, v161, s38, v202
v_dot2_f32_bf16 v203, v161, s39, v203
v_dot2_f32_bf16 v204, v162, s38, v204
v_dot2_f32_bf16 v205, v162, s39, v205
v_dot2_f32_bf16 v206, v163, s38, v206
v_dot2_f32_bf16 v207, v163, s39, v207
s_waitcnt vmcnt(9)
v_dot2_f32_bf16 v208, v164, s38, v208
v_dot2_f32_bf16 v209, v164, s39, v209
v_dot2_f32_bf16 v210, v165, s38, v210
v_dot2_f32_bf16 v211, v165, s39, v211
v_dot2_f32_bf16 v212, v166, s38, v212
v_dot2_f32_bf16 v213, v166, s39, v213
v_dot2_f32_bf16 v214, v167, s38, v214
v_dot2_f32_bf16 v215, v167, s39, v215
s_waitcnt vmcnt(8)
v_dot2_f32_bf16 v200, v168, s38, v200
v_dot2_f32_bf16 v201, v168, s39, v201
v_dot2_f32_bf16 v202, v169, s38, v202
v_dot2_f32_bf16 v203, v169, s39, v203
v_dot2_f32_bf16 v204, v170, s38, v204
v_dot2_f32_bf16 v205, v170, s39, v205
v_dot2_f32_bf16 v206, v171, s38, v206
v_dot2_f32_bf16 v207, v171, s39, v207
s_waitcnt vmcnt(7)
v_dot2_f32_bf16 v208, v172, s38, v208
v_dot2_f32_bf16 v209, v172, s39, v209
v_dot2_f32_bf16 v210, v173, s38, v210
v_dot2_f32_bf16 v211, v173, s39, v211
v_dot2_f32_bf16 v212, v174, s38, v212
v_dot2_f32_bf16 v213, v174, s39, v213
v_dot2_f32_bf16 v214, v175, s38, v214
v_dot2_f32_bf16 v215, v175, s39, v215
s_waitcnt vmcnt(6)
v_dot2_f32_bf16 v200, v176, s38, v200
v_dot2_f32_bf16 v201, v176, s39, v201
v_dot2_f32_bf16 v202, v177, s38, v202
v_dot2_f32_bf16 v203, v177, s39, v203
v_dot2_f32_bf16 v204, v178, s38, v204
v_dot2_f32_bf16 v205, v178, s39, v205
v_dot2_f32_bf16 v206, v179, s38, v206
v_dot2_f32_bf16 v207, v179, s39, v207
s_waitcnt vmcnt(5)
v_dot2_f32_bf16 v208, v180, s38, v208
v_dot2_f32_bf16 v209, v180, s39, v209
v_dot2_f32_bf16 v210, v181, s38, v210
v_dot2_f32_bf16 v211, v181, s39, v211
v_dot2_f32_bf16 v212, v182, s38, v212
v_dot2_f32_bf16 v213, v182, s39, v213
v_dot2_f32_bf16 v214, v183, s38, v214
v_dot2_f32_bf16 v215, v183, s39, v215
s_waitcnt vmcnt(4)
v_dot2_f32_bf16 v200, v184, s38, v200
v_dot2_f32_bf16 v201, v184, s39, v201
v_dot2_f32_bf16 v202, v185, s38, v202
v_dot2_f32_bf16 v203, v185, s39, v203
v_dot2_f32_bf16 v204, v186, s38, v204
v_dot2_f32_bf16 v205, v186, s39, v205
v_dot2_f32_bf16 v206, v187, s38, v206
v_dot2_f32_bf16 v207, v187, s39, v207
s_waitcnt vmcnt(3)
v_dot2_f32_bf16 v208, v188, s38, v208
v_dot2_f32_bf16 v209, v188, s39, v209
v_dot2_f32_bf16 v210, v189, s38, v210
v_dot2_f32_bf16 v211, v189, s39, v211
v_dot2_f32_bf16 v212, v190, s38, v212
v_dot2_f32_bf16 v213, v190, s39, v213
v_dot2_f32_bf16 v214, v191, s38, v214
v_dot2_f32_bf16 v215, v191, s39, v215
s_waitcnt vmcnt(2)
v_dot2_f32_bf16 v200, v192, s38, v200
v_dot2_f32_bf16 v201, v192, s39, v201
v_dot2_f32_bf16 v202, v193, s38, v202
v_dot2_f32_bf16 v203, v193, s39, v203
v_dot2_f32_bf16 v204, v194, s38, v204
v_dot2_f32_bf16 v205, v194, s39, v205
v_dot2_f32_bf16 v206, v195, s38, v206
v_dot2_f32_bf16 v207, v195, s39, v207
s_waitcnt vmcnt(1)
v_dot2_f32_bf16 v208, v196, s38, v208
v_dot2_f32_bf16 v209, v196, s39, v209
v_dot2_f32_bf16 v210, v197, s38, v210
v_dot2_f32_bf16 v211, v197, s39, v211
v_dot2_f32_bf16 v212, v198, s38, v212
v_dot2_f32_bf16 v213, v198, s39, v213
v_dot2_f32_bf16 v214, v199, s38, v214
v_dot2_f32_bf16 v215, v199, s39, v215
ds_write_b128 v26, v[200:203] offset:0
ds_write_b128 v26, v[204:207] offset:1024
ds_write_b128 v26, v[208:211] offset:2048
ds_write_b128 v26, v[212:215] offset:3072
v_lshlrev_b32 v24, 4, v1
v_add_u32 v24, 94208, v24
v_and_b32 v25, 48, v1
v_lshlrev_b32 v25, 4, v25
v_add_u32 v25, 94208, v25
s_waitcnt lgkmcnt(0)
s_barrier
ds_read_b128 v[184:187], v24 offset:0
ds_read_b128 v[188:191], v24 offset:1024
ds_read_b128 v[192:195], v24 offset:2048
ds_read_b128 v[196:199], v24 offset:3072
ds_read_b128 v[200:203], v24 offset:4096
ds_read_b128 v[204:207], v24 offset:5120
ds_read_b128 v[208:211], v24 offset:6144
ds_read_b128 v[212:215], v24 offset:7168
ds_read_b128 v[216:219], v24 offset:8192
ds_read_b128 v[220:223], v24 offset:9216
ds_read_b128 v[224:227], v24 offset:10240
ds_read_b128 v[228:231], v24 offset:11264
ds_read_b128 v[232:235], v24 offset:12288
ds_read_b128 v[236:239], v25 offset:13312
ds_read_b128 v[240:243], v25 offset:14336
ds_read_b128 v[244:247], v25 offset:15360
ds_read_b128 v[248:251], v25 offset:11264
ds_read_b128 v[252:255], v25 offset:12288
s_waitcnt vmcnt(0)
v_cmp_ne_u32 vcc, s76, v55
s_nop 1
s_cbranch_vccnz slow_a2
back_a2:
v_exp_f32 v32, v120 clamp
v_exp_f32 v33, v121 clamp
v_max_f32 v120, 0x35c1a2a0, v120
v_exp_f32 v34, v122 clamp
v_max_f32 v121, 0x35c1a2a0, v121
v_fma_f32 v120, v120, v29, v32
v_exp_f32 v35, v123 clamp
v_max_f32 v122, 0x35c1a2a0, v122
s_add_u32 s6, s62, 4423680
v_fma_f32 v121, v121, v29, v33
v_max_f32 v123, 0x35c1a2a0, v123
v_fma_f32 v122, v122, v29, v34
v_fma_f32 v123, v123, v29, v35
v_cvt_pk_bf16_f32 v120, v120, v121
v_cvt_pk_bf16_f32 v121, v122, v123
v_mov_b32 v122, 0
v_mov_b32 v123, 0
s_add_u32 m0, s17, 0
v_exp_f32 v32, v124 clamp
v_exp_f32 v33, v125 clamp
v_max_f32 v124, 0x35c1a2a0, v124
v_exp_f32 v34, v126 clamp
v_max_f32 v125, 0x35c1a2a0, v125
v_fma_f32 v124, v124, v29, v32
v_exp_f32 v35, v127 clamp
v_max_f32 v126, 0x35c1a2a0, v126
buffer_load_dwordx4 v3, s[28:31], s6 offen offset:0 lds
v_fma_f32 v125, v125, v29, v33
v_max_f32 v127, 0x35c1a2a0, v127
v_fma_f32 v126, v126, v29, v34
v_fma_f32 v127, v127, v29, v35
v_cvt_pk_bf16_f32 v124, v124, v125
v_cvt_pk_bf16_f32 v125, v126, v127
v_mov_b32 v126, 0
v_mov_b32 v127, 0
s_add_u32 m0, s17, 3968
v_exp_f32 v32, v128 clamp
v_exp_f32 v33, v129 clamp
v_max_f32 v128, 0x35c1a2a0, v128
v_exp_f32 v34, v130 clamp
v_max_f32 v129, 0x35c1a2a0, v129
v_fma_f32 v128, v128, v29, v32
v_exp_f32 v35, v131 clamp
v_max_f32 v130, 0x35c1a2a0, v130
buffer_load_dwordx4 v3, s[28:31], s6 offen offset:128 lds
v_fma_f32 v129, v129, v29, v33
v_max_f32 v131, 0x35c1a2a0, v131
v_fma_f32 v130, v130, v29, v34
v_fma_f32 v131, v131, v29, v35
v_cvt_pk_bf16_f32 v128, v128, v129
v_cvt_pk_bf16_f32 v129, v130, v131
v_mov_b32 v130, 0
v_mov_b32 v131, 0
s_add_u32 m0, s17, 7936
v_exp_f32 v32, v132 clamp
v_exp_f32 v33, v133 clamp
v_max_f32 v132, 0x35c1a2a0, v132
v_exp_f32 v34, v134 clamp
v_max_f32 v133, 0x35c1a2a0, v133
v_fma_f32 v132, v132, v29, v32
v_exp_f32 v35, v135 clamp
v_max_f32 v134, 0x35c1a2a0, v134
buffer_load_dwordx4 v3, s[28:31], s6 offen offset:256 lds
v_fma_f32 v133, v133, v29, v33
v_max_f32 v135, 0x35c1a2a0, v135
v_fma_f32 v134, v134, v29, v34
v_fma_f32 v135, v135, v29, v35
v_cvt_pk_bf16_f32 v132, v132, v133
v_cvt_pk_bf16_f32 v133, v134, v135
v_mov_b32 v134, 0
v_mov_b32 v135, 0
s_add_u32 s3, s60, 122880
s_waitcnt lgkmcnt(15)
v_cvt_pk_bf16_f32 v136, v184, v185
v_cvt_pk_bf16_f32 v137, v186, v187
v_cvt_pk_bf16_f32 v138, v188, v189
v_cvt_pk_bf16_f32 v139, v190, v191
v_cvt_pk_bf16_f32 v140, v192, v193
v_cvt_pk_bf16_f32 v141, v194, v195
s_waitcnt lgkmcnt(14)
v_cvt_pk_bf16_f32 v142, v196, v197
v_cvt_pk_bf16_f32 v143, v198, v199
buffer_load_dwordx4 a[0:3], v8, s[12:15], s3 offen offset:0 sc1
s_waitcnt lgkmcnt(13)
v_cvt_pk_bf16_f32 v144, v200, v201
v_cvt_pk_bf16_f32 v145, v202, v203
s_waitcnt lgkmcnt(12)
v_cvt_pk_bf16_f32 v150, v204, v205
v_cvt_pk_bf16_f32 v151, v206, v207
s_waitcnt lgkmcnt(11)
v_cvt_pk_bf16_f32 v152, v208, v209
v_cvt_pk_bf16_f32 v153, v210, v211
s_waitcnt lgkmcnt(10)
v_cvt_pk_bf16_f32 v154, v212, v213
v_cvt_pk_bf16_f32 v155, v214, v215
buffer_load_dwordx4 a[4:7], v9, s[12:15], s3 offen offset:0 sc1
s_waitcnt lgkmcnt(9)
v_cvt_pk_bf16_f32 v156, v216, v217
v_cvt_pk_bf16_f32 v157, v218, v219
s_waitcnt lgkmcnt(8)
v_cvt_pk_bf16_f32 v158, v220, v221
v_cvt_pk_bf16_f32 v159, v222, v223
s_waitcnt lgkmcnt(7)
v_cvt_pk_bf16_f32 v160, v224, v225
v_cvt_pk_bf16_f32 v161, v226, v227
s_waitcnt lgkmcnt(6)
v_cvt_pk_bf16_f32 v166, v228, v229
v_cvt_pk_bf16_f32 v167, v230, v231
s_add_u32 s6, s62, 4460544
s_waitcnt lgkmcnt(5)
v_cvt_pk_bf16_f32 v168, v232, v233
v_cvt_pk_bf16_f32 v169, v234, v235
s_waitcnt lgkmcnt(4)
v_mul_f32 v236, v236, v29
v_mul_f32 v237, v237, v29
v_mul_f32 v238, v238, v29
v_mul_f32 v239, v239, v29
v_cvt_pk_bf16_f32 v172, v236, v237
v_cvt_pk_bf16_f32 v173, v238, v239
s_add_u32 m0, s17, 12288
s_waitcnt lgkmcnt(3)
v_mul_f32 v240, v240, v29
v_mul_f32 v241, v241, v29
v_mul_f32 v242, v242, v29
v_mul_f32 v243, v243, v29
v_cvt_pk_bf16_f32 v174, v240, v241
v_cvt_pk_bf16_f32 v175, v242, v243
s_waitcnt lgkmcnt(2)
v_mul_f32 v244, v244, v29
v_mul_f32 v245, v245, v29
buffer_load_dwordx4 v3, s[28:31], s6 offen offset:0 lds
v_mul_f32 v246, v246, v29
v_mul_f32 v247, v247, v29
v_cvt_pk_bf16_f32 v176, v244, v245
v_cvt_pk_bf16_f32 v177, v246, v247
s_waitcnt lgkmcnt(1)
v_mul_f32 v248, v248, v29
v_mul_f32 v249, v249, v29
v_mul_f32 v250, v250, v29
v_mul_f32 v251, v251, v29
s_add_u32 m0, s17, 16256
v_cvt_pk_bf16_f32 v178, v248, v249
v_cvt_pk_bf16_f32 v179, v250, v251
s_waitcnt lgkmcnt(0)
v_mul_f32 v252, v252, v29
v_mul_f32 v253, v253, v29
v_mul_f32 v254, v254, v29
v_mul_f32 v255, v255, v29
v_cvt_pk_bf16_f32 v180, v252, v253
buffer_load_dwordx4 v3, s[28:31], s6 offen offset:128 lds
v_cvt_pk_bf16_f32 v181, v254, v255
v_sub_u32 v36, 0, v49
v_sub_u32 v37, 2, v49
v_cmp_gt_u32 s[44:45], 18, v36
v_cmp_gt_u32 s[46:47], 18, v37
v_sub_u32 v36, 16, v49
v_sub_u32 v37, 18, v49
v_cmp_gt_u32 s[48:49], 18, v36
s_add_u32 m0, s17, 20224
v_cmp_gt_u32 s[50:51], 18, v37
v_cndmask_b32 v136, 0, v136, s[44:45]
v_cndmask_b32 v184, 0, v172, s[44:45]
v_cndmask_b32 v137, 0, v137, s[46:47]
v_cndmask_b32 v185, 0, v173, s[46:47]
v_sub_u32 v36, 0, v50
v_sub_u32 v37, 2, v50
v_cmp_gt_u32 s[44:45], 18, v36
buffer_load_dwordx4 v3, s[28:31], s6 offen offset:256 lds
v_cmp_gt_u32 s[46:47], 18, v37
v_cndmask_b32 v138, 0, v138, s[48:49]
v_cndmask_b32 v186, 0, v174, s[48:49]
v_cndmask_b32 v139, 0, v139, s[50:51]
v_cndmask_b32 v187, 0, v175, s[50:51]
v_sub_u32 v36, 16, v50
v_sub_u32 v37, 18, v50
v_cmp_gt_u32 s[48:49], 18, v36
buffer_load_dwordx4 a[8:11], v8, s[12:15], s3 offen offset:1024 sc1
v_cmp_gt_u32 s[50:51], 18, v37
v_cndmask_b32 v140, 0, v140, s[44:45]
v_cndmask_b32 v188, 0, v172, s[44:45]
v_cndmask_b32 v141, 0, v141, s[46:47]
v_cndmask_b32 v189, 0, v173, s[46:47]
v_sub_u32 v36, 32, v50
v_sub_u32 v37, 34, v50
v_cmp_gt_u32 s[44:45], 18, v36
buffer_load_dwordx4 a[12:15], v9, s[12:15], s3 offen offset:1024 sc1
v_cmp_gt_u32 s[46:47], 18, v37
v_cndmask_b32 v142, 0, v142, s[48:49]
v_cndmask_b32 v190, 0, v174, s[48:49]
v_cndmask_b32 v143, 0, v143, s[50:51]
v_cndmask_b32 v191, 0, v175, s[50:51]
v_mov_b32 v146, 0
v_mov_b32 v194, 0
v_mov_b32 v147, 0
s_add_u32 s6, s62, 4644864
v_mov_b32 v195, 0
v_mov_b32 v148, 0
v_mov_b32 v196, 0
v_mov_b32 v149, 0
v_mov_b32 v197, 0
v_sub_u32 v36, 16, v51
v_sub_u32 v37, 18, v51
v_cmp_gt_u32 s[48:49], 18, v36
s_add_u32 m0, s17, 24576
v_cmp_gt_u32 s[50:51], 18, v37
v_cndmask_b32 v144, 0, v144, s[44:45]
v_cndmask_b32 v192, 0, v176, s[44:45]
v_cndmask_b32 v145, 0, v145, s[46:47]
v_cndmask_b32 v193, 0, v177, s[46:47]
v_sub_u32 v36, 32, v51
v_sub_u32 v37, 34, v51
v_cmp_gt_u32 s[44:45], 18, v36
buffer_load_dwordx4 v3, s[28:31], s6 offen offset:0 lds
v_cmp_gt_u32 s[46:47], 18, v37
v_cndmask_b32 v150, 0, v150, s[48:49]
v_cndmask_b32 v198, 0, v174, s[48:49]
v_cndmask_b32 v151, 0, v151, s[50:51]
v_cndmask_b32 v199, 0, v175, s[50:51]
v_sub_u32 v36, 48, v51
v_sub_u32 v37, 50, v51
v_cmp_gt_u32 s[48:49], 18, v36
s_add_u32 m0, s17, 28544
v_cmp_gt_u32 s[50:51], 18, v37
v_cndmask_b32 v152, 0, v152, s[44:45]
v_cndmask_b32 v200, 0, v176, s[44:45]
v_cndmask_b32 v153, 0, v153, s[46:47]
v_cndmask_b32 v201, 0, v177, s[46:47]
v_sub_u32 v36, 32, v52
v_sub_u32 v37, 34, v52
v_cmp_gt_u32 s[44:45], 18, v36
buffer_load_dwordx4 v3, s[28:31], s6 offen offset:128 lds
v_cmp_gt_u32 s[46:47], 18, v37
v_cndmask_b32 v154, 0, v154, s[48:49]
v_cndmask_b32 v202, 0, v178, s[48:49]
v_cndmask_b32 v155, 0, v155, s[50:51]
v_cndmask_b32 v203, 0, v179, s[50:51]
v_sub_u32 v36, 48, v52
v_sub_u32 v37, 50, v52
v_cmp_gt_u32 s[48:49], 18, v36
s_add_u32 m0, s17, 32512
v_cmp_gt_u32 s[50:51], 18, v37
v_cndmask_b32 v156, 0, v156, s[44:45]
v_cndmask_b32 v204, 0, v176, s[44:45]
v_cndmask_b32 v157, 0, v157, s[46:47]
v_cndmask_b32 v205, 0, v177, s[46:47]
v_sub_u32 v36, 64, v52
v_sub_u32 v37, 66, v52
v_cmp_gt_u32 s[44:45], 18, v36
buffer_load_dwordx4 v3, s[28:31], s6 offen offset:256 lds
v_cmp_gt_u32 s[46:47], 18, v37
v_cndmask_b32 v158, 0, v158, s[48:49]
v_cndmask_b32 v206, 0, v178, s[48:49]
v_cndmask_b32 v159, 0, v159, s[50:51]
v_cndmask_b32 v207, 0, v179, s[50:51]
v_mov_b32 v162, 0
v_mov_b32 v210, 0
v_mov_b32 v163, 0
s_add_u32 s3, s60, 129024
v_mov_b32 v211, 0
v_mov_b32 v164, 0
v_mov_b32 v212, 0
v_mov_b32 v165, 0
v_mov_b32 v213, 0
v_sub_u32 v36, 48, v53
v_sub_u32 v37, 50, v53
v_cmp_gt_u32 s[48:49], 18, v36
buffer_load_dwordx4 a[16:19], v8, s[12:15], s3 offen offset:0 sc1
v_cmp_gt_u32 s[50:51], 18, v37
v_cndmask_b32 v160, 0, v160, s[44:45]
v_cndmask_b32 v208, 0, v180, s[44:45]
v_cndmask_b32 v161, 0, v161, s[46:47]
v_cndmask_b32 v209, 0, v181, s[46:47]
v_sub_u32 v36, 64, v53
v_sub_u32 v37, 66, v53
buffer_load_dwordx4 a[20:23], v9, s[12:15], s3 offen offset:0 sc1
v_cmp_gt_u32 s[44:45], 18, v36
v_cmp_gt_u32 s[46:47], 18, v37
v_cndmask_b32 v166, 0, v166, s[48:49]
v_cndmask_b32 v214, 0, v178, s[48:49]
v_cndmask_b32 v167, 0, v167, s[50:51]
v_cndmask_b32 v215, 0, v179, s[50:51]
v_mov_b32 v170, 0
v_mov_b32 v218, 0
s_add_u32 s6, s62, 4681728
v_mov_b32 v171, 0
v_mov_b32 v219, 0
v_cndmask_b32 v168, 0, v168, s[44:45]
v_cndmask_b32 v216, 0, v180, s[44:45]
v_cndmask_b32 v169, 0, v169, s[46:47]
v_cndmask_b32 v217, 0, v181, s[46:47]
v_mov_b32 v40, 0x353a10b6
v_mov_b32 v41, 0x353a10b6
s_add_u32 m0, s17, 36864
v_mov_b32 v42, 0x353a10b6
v_mov_b32 v43, 0x353a10b6
v_mfma_f32_16x16x32_bf16 v[220:223], v[136:139], v[56:59], 0
s_nop 0
v_mfma_f32_16x16x32_bf16 v[224:227], v[184:187], v[56:59], v[40:43]
v_mfma_f32_16x16x32_bf16 v[228:231], v[140:143], v[56:59], 0
v_mfma_f32_16x16x32_bf16 v[232:235], v[188:191], v[56:59], v[40:43]
v_mfma_f32_16x16x32_bf16 v[228:231], v[144:147], v[88:91], v[228:231]
v_mfma_f32_16x16x32_bf16 v[232:235], v[192:195], v[88:91], v[232:235]
buffer_load_dwordx4 v3, s[28:31], s6 offen offset:0 lds
v_mfma_f32_16x16x32_bf16 v[236:239], v[148:151], v[56:59], 0
v_mfma_f32_16x16x32_bf16 v[240:243], v[196:199], v[56:59], v[40:43]
v_mfma_f32_16x16x32_bf16 v[236:239], v[152:155], v[88:91], v[236:239]
v_mfma_f32_16x16x32_bf16 v[240:243], v[200:203], v[88:91], v[240:243]
v_mfma_f32_16x16x32_bf16 v[244:247], v[156:159], v[88:91], 0
v_mfma_f32_16x16x32_bf16 v[248:251], v[204:207], v[88:91], v[40:43]
v_mfma_f32_16x16x32_bf16 v[244:247], v[160:163], v[120:123], v[244:247]
v_mfma_f32_16x16x32_bf16 v[248:251], v[208:211], v[120:123], v[248:251]
s_add_u32 m0, s17, 40832
v_mfma_f32_16x16x32_bf16 v[252:255], v[164:167], v[88:91], 0
v_mfma_f32_16x16x32_bf16 v[172:175], v[212:215], v[88:91], v[40:43]
v_mfma_f32_16x16x32_bf16 v[252:255], v[168:171], v[120:123], v[252:255]
v_mfma_f32_16x16x32_bf16 v[172:175], v[216:219], v[120:123], v[172:175]
v_mfma_f32_16x16x32_bf16 v[176:179], v[136:139], v[60:63], 0
v_rcp_f32 v224, v224
v_rcp_f32 v225, v225
v_mfma_f32_16x16x32_bf16 v[180:183], v[184:187], v[60:63], v[40:43]
buffer_load_dwordx4 v3, s[28:31], s6 offen offset:128 lds
v_mul_f32 v220, v220, v224
v_rcp_f32 v226, v226
v_mfma_f32_16x16x32_bf16 v[72:75], v[140:143], v[60:63], 0
v_mul_f32 v221, v221, v225
v_rcp_f32 v227, v227
v_mfma_f32_16x16x32_bf16 v[76:79], v[188:191], v[60:63], v[40:43]
v_mul_f32 v222, v222, v226
v_rcp_f32 v232, v232
s_add_u32 m0, s17, 44800
v_mfma_f32_16x16x32_bf16 v[72:75], v[144:147], v[92:95], v[72:75]
v_mul_f32 v223, v223, v227
v_rcp_f32 v233, v233
v_mfma_f32_16x16x32_bf16 v[76:79], v[192:195], v[92:95], v[76:79]
v_mul_f32 v228, v228, v232
v_rcp_f32 v234, v234
v_mfma_f32_16x16x32_bf16 v[80:83], v[148:151], v[60:63], 0
v_mul_f32 v229, v229, v233
buffer_load_dwordx4 v3, s[28:31], s6 offen offset:256 lds
v_rcp_f32 v235, v235
v_mfma_f32_16x16x32_bf16 v[84:87], v[196:199], v[60:63], v[40:43]
v_mul_f32 v230, v230, v234
v_rcp_f32 v240, v240
v_mfma_f32_16x16x32_bf16 v[80:83], v[152:155], v[92:95], v[80:83]
v_mul_f32 v231, v231, v235
v_rcp_f32 v241, v241
v_mfma_f32_16x16x32_bf16 v[84:87], v[200:203], v[92:95], v[84:87]
buffer_load_dwordx4 a[24:27], v8, s[12:15], s3 offen offset:1024 sc1
v_mul_f32 v236, v236, v240
v_rcp_f32 v242, v242
v_mfma_f32_16x16x32_bf16 v[104:107], v[156:159], v[92:95], 0
v_mul_f32 v237, v237, v241
v_rcp_f32 v243, v243
v_mfma_f32_16x16x32_bf16 v[108:111], v[204:207], v[92:95], v[40:43]
v_mul_f32 v238, v238, v242
v_rcp_f32 v248, v248
buffer_load_dwordx4 a[28:31], v9, s[12:15], s3 offen offset:1024 sc1
v_mfma_f32_16x16x32_bf16 v[104:107], v[160:163], v[124:127], v[104:107]
v_mul_f32 v239, v239, v243
v_rcp_f32 v249, v249
v_mfma_f32_16x16x32_bf16 v[108:111], v[208:211], v[124:127], v[108:111]
v_mul_f32 v244, v244, v248
v_rcp_f32 v250, v250
v_mfma_f32_16x16x32_bf16 v[112:115], v[164:167], v[92:95], 0
v_mul_f32 v245, v245, v249
s_add_u32 s6, s62, 4866048
v_rcp_f32 v251, v251
v_mfma_f32_16x16x32_bf16 v[116:119], v[212:215], v[92:95], v[40:43]
v_mul_f32 v246, v246, v250
v_rcp_f32 v172, v172
v_mfma_f32_16x16x32_bf16 v[112:115], v[168:171], v[124:127], v[112:115]
v_mul_f32 v247, v247, v251
v_rcp_f32 v173, v173
v_mfma_f32_16x16x32_bf16 v[116:119], v[216:219], v[124:127], v[116:119]
s_add_u32 m0, s17, 49152
v_mul_f32 v252, v252, v172
v_rcp_f32 v174, v174
v_mul_f32 v253, v253, v173
v_rcp_f32 v175, v175
v_mul_f32 v254, v254, v174
v_mul_f32 v255, v255, v175
v_cvt_pk_bf16_f32 v220, v220, v221
v_cvt_pk_bf16_f32 v221, v222, v223
buffer_load_dwordx4 v3, s[28:31], s6 offen offset:0 lds
v_cvt_pk_bf16_f32 v222, v228, v229
v_cvt_pk_bf16_f32 v223, v230, v231
buffer_store_dwordx4 v[220:223], v4, s[12:15], s40 offen offset:0 sc1
v_cvt_pk_bf16_f32 v236, v236, v237
v_cvt_pk_bf16_f32 v237, v238, v239
v_cvt_pk_bf16_f32 v238, v244, v245
v_cvt_pk_bf16_f32 v239, v246, v247
buffer_store_dwordx4 v[236:239], v4, s[12:15], s40 offen offset:1024 sc1
s_add_u32 m0, s17, 53120
v_cvt_pk_bf16_f32 v252, v252, v253
v_cvt_pk_bf16_f32 v253, v254, v255
buffer_store_dwordx2 v[252:253], v44, s[12:15], s40 offen sc1
v_mfma_f32_16x16x32_bf16 v[220:223], v[136:139], v[64:67], 0
v_rcp_f32 v180, v180
v_rcp_f32 v181, v181
v_mfma_f32_16x16x32_bf16 v[224:227], v[184:187], v[64:67], v[40:43]
buffer_load_dwordx4 v3, s[28:31], s6 offen offset:128 lds
v_mul_f32 v176, v176, v180
v_rcp_f32 v182, v182
v_mfma_f32_16x16x32_bf16 v[228:231], v[140:143], v[64:67], 0
v_mul_f32 v177, v177, v181
v_rcp_f32 v183, v183
v_mfma_f32_16x16x32_bf16 v[232:235], v[188:191], v[64:67], v[40:43]
v_mul_f32 v178, v178, v182
v_rcp_f32 v76, v76
s_add_u32 m0, s17, 57088
v_mfma_f32_16x16x32_bf16 v[228:231], v[144:147], v[96:99], v[228:231]
v_mul_f32 v179, v179, v183
v_rcp_f32 v77, v77
v_mfma_f32_16x16x32_bf16 v[232:235], v[192:195], v[96:99], v[232:235]
v_mul_f32 v72, v72, v76
v_rcp_f32 v78, v78
v_mfma_f32_16x16x32_bf16 v[236:239], v[148:151], v[64:67], 0
v_mul_f32 v73, v73, v77
buffer_load_dwordx4 v3, s[28:31], s6 offen offset:256 lds
v_rcp_f32 v79, v79
v_mfma_f32_16x16x32_bf16 v[240:243], v[196:199], v[64:67], v[40:43]
v_mul_f32 v74, v74, v78
v_rcp_f32 v84, v84
v_mfma_f32_16x16x32_bf16 v[236:239], v[152:155], v[96:99], v[236:239]
v_mul_f32 v75, v75, v79
v_rcp_f32 v85, v85
v_mfma_f32_16x16x32_bf16 v[240:243], v[200:203], v[96:99], v[240:243]
s_add_u32 s3, s60, 135168
v_mul_f32 v80, v80, v84
v_rcp_f32 v86, v86
v_mfma_f32_16x16x32_bf16 v[244:247], v[156:159], v[96:99], 0
v_mul_f32 v81, v81, v85
v_rcp_f32 v87, v87
v_mfma_f32_16x16x32_bf16 v[248:251], v[204:207], v[96:99], v[40:43]
v_mul_f32 v82, v82, v86
v_rcp_f32 v108, v108
buffer_load_dwordx4 a[32:35], v8, s[12:15], s3 offen offset:0 sc1
v_mfma_f32_16x16x32_bf16 v[244:247], v[160:163], v[128:131], v[244:247]
v_mul_f32 v83, v83, v87
v_rcp_f32 v109, v109
v_mfma_f32_16x16x32_bf16 v[248:251], v[208:211], v[128:131], v[248:251]
v_mul_f32 v104, v104, v108
v_rcp_f32 v110, v110
v_mfma_f32_16x16x32_bf16 v[252:255], v[164:167], v[96:99], 0
v_mul_f32 v105, v105, v109
buffer_load_dwordx4 a[36:39], v9, s[12:15], s3 offen offset:0 sc1
v_rcp_f32 v111, v111
v_mfma_f32_16x16x32_bf16 v[172:175], v[212:215], v[96:99], v[40:43]
v_mul_f32 v106, v106, v110
v_rcp_f32 v116, v116
v_mfma_f32_16x16x32_bf16 v[252:255], v[168:171], v[128:131], v[252:255]
v_mul_f32 v107, v107, v111
v_rcp_f32 v117, v117
v_mfma_f32_16x16x32_bf16 v[172:175], v[216:219], v[128:131], v[172:175]
s_add_u32 s6, s62, 4902912
v_mul_f32 v112, v112, v116
v_rcp_f32 v118, v118
v_mul_f32 v113, v113, v117
v_rcp_f32 v119, v119
v_mul_f32 v114, v114, v118
v_mul_f32 v115, v115, v119
v_cvt_pk_bf16_f32 v176, v176, v177
v_cvt_pk_bf16_f32 v177, v178, v179
s_add_u32 m0, s17, 61440
v_cvt_pk_bf16_f32 v178, v72, v73
v_cvt_pk_bf16_f32 v179, v74, v75
buffer_store_dwordx4 v[176:179], v4, s[12:15], s41 offen offset:0 sc1
v_cvt_pk_bf16_f32 v80, v80, v81
v_cvt_pk_bf16_f32 v81, v82, v83
v_cvt_pk_bf16_f32 v82, v104, v105
v_cvt_pk_bf16_f32 v83, v106, v107
buffer_store_dwordx4 v[80:83], v4, s[12:15], s41 offen offset:1024 sc1
buffer_load_dwordx4 v3, s[28:31], s6 offen offset:0 lds
v_cvt_pk_bf16_f32 v112, v112, v113
v_cvt_pk_bf16_f32 v113, v114, v115
buffer_store_dwordx2 v[112:113], v44, s[12:15], s41 offen sc1
v_mfma_f32_16x16x32_bf16 v[176:179], v[136:139], v[68:71], 0
v_rcp_f32 v224, v224
v_rcp_f32 v225, v225
v_mfma_f32_16x16x32_bf16 v[180:183], v[184:187], v[68:71], v[40:43]
v_mul_f32 v220, v220, v224
s_add_u32 m0, s17, 65408
v_rcp_f32 v226, v226
v_mfma_f32_16x16x32_bf16 v[72:75], v[140:143], v[68:71], 0
v_mul_f32 v221, v221, v225
v_rcp_f32 v227, v227
v_mfma_f32_16x16x32_bf16 v[76:79], v[188:191], v[68:71], v[40:43]
v_mul_f32 v222, v222, v226
v_rcp_f32 v232, v232
v_mfma_f32_16x16x32_bf16 v[72:75], v[144:147], v[100:103], v[72:75]
buffer_load_dwordx4 v3, s[28:31], s6 offen offset:128 lds
v_mul_f32 v223, v223, v227
v_rcp_f32 v233, v233
v_mfma_f32_16x16x32_bf16 v[76:79], v[192:195], v[100:103], v[76:79]
v_mul_f32 v228, v228, v232
v_rcp_f32 v234, v234
v_mfma_f32_16x16x32_bf16 v[80:83], v[148:151], v[68:71], 0
v_mul_f32 v229, v229, v233
v_rcp_f32 v235, v235
s_add_u32 m0, s17, 69376
v_mfma_f32_16x16x32_bf16 v[84:87], v[196:199], v[68:71], v[40:43]
v_mul_f32 v230, v230, v234
v_rcp_f32 v240, v240
v_mfma_f32_16x16x32_bf16 v[80:83], v[152:155], v[100:103], v[80:83]
v_mul_f32 v231, v231, v235
v_rcp_f32 v241, v241
v_mfma_f32_16x16x32_bf16 v[84:87], v[200:203], v[100:103], v[84:87]
v_mul_f32 v236, v236, v240
buffer_load_dwordx4 v3, s[28:31], s6 offen offset:256 lds
v_rcp_f32 v242, v242
v_mfma_f32_16x16x32_bf16 v[104:107], v[156:159], v[100:103], 0
v_mul_f32 v237, v237, v241
v_rcp_f32 v243, v243
v_mfma_f32_16x16x32_bf16 v[108:111], v[204:207], v[100:103], v[40:43]
v_mul_f32 v238, v238, v242
v_rcp_f32 v248, v248
v_mfma_f32_16x16x32_bf16 v[104:107], v[160:163], v[132:135], v[104:107]
buffer_load_dwordx4 a[40:43], v8, s[12:15], s3 offen offset:1024 sc1
v_mul_f32 v239, v239, v243
v_rcp_f32 v249, v249
v_mfma_f32_16x16x32_bf16 v[108:111], v[208:211], v[132:135], v[108:111]
v_mul_f32 v244, v244, v248
v_rcp_f32 v250, v250
v_mfma_f32_16x16x32_bf16 v[112:115], v[164:167], v[100:103], 0
v_mul_f32 v245, v245, v249
buffer_load_dwordx4 a[44:47], v9, s[12:15], s3 offen offset:1024 sc1
v_rcp_f32 v251, v251
v_mfma_f32_16x16x32_bf16 v[116:119], v[212:215], v[100:103], v[40:43]
v_mul_f32 v246, v246, v250
v_rcp_f32 v172, v172
v_mfma_f32_16x16x32_bf16 v[112:115], v[168:171], v[132:135], v[112:115]
v_mul_f32 v247, v247, v251
v_rcp_f32 v173, v173
v_mfma_f32_16x16x32_bf16 v[116:119], v[216:219], v[132:135], v[116:119]
v_mul_f32 v252, v252, v172
v_rcp_f32 v174, v174
v_mul_f32 v253, v253, v173
v_rcp_f32 v175, v175
v_mul_f32 v254, v254, v174
v_mul_f32 v255, v255, v175
v_cvt_pk_bf16_f32 v220, v220, v221
v_cvt_pk_bf16_f32 v221, v222, v223
v_cvt_pk_bf16_f32 v222, v228, v229
v_cvt_pk_bf16_f32 v223, v230, v231
buffer_store_dwordx4 v[220:223], v4, s[12:15], s24 offen offset:0 sc1
v_cvt_pk_bf16_f32 v236, v236, v237
v_cvt_pk_bf16_f32 v237, v238, v239
v_cvt_pk_bf16_f32 v238, v244, v245
v_cvt_pk_bf16_f32 v239, v246, v247
buffer_store_dwordx4 v[236:239], v4, s[12:15], s24 offen offset:1024 sc1
v_cvt_pk_bf16_f32 v252, v252, v253
v_cvt_pk_bf16_f32 v253, v254, v255
buffer_store_dwordx2 v[252:253], v44, s[12:15], s24 offen sc1
v_rcp_f32 v180, v180
v_rcp_f32 v181, v181
v_mul_f32 v176, v176, v180
v_rcp_f32 v182, v182
v_mul_f32 v177, v177, v181
v_rcp_f32 v183, v183
v_mul_f32 v178, v178, v182
v_rcp_f32 v76, v76
v_mul_f32 v179, v179, v183
v_rcp_f32 v77, v77
v_mul_f32 v72, v72, v76
v_rcp_f32 v78, v78
v_mul_f32 v73, v73, v77
v_rcp_f32 v79, v79
v_mul_f32 v74, v74, v78
v_rcp_f32 v84, v84
v_mul_f32 v75, v75, v79
v_rcp_f32 v85, v85
v_mul_f32 v80, v80, v84
v_rcp_f32 v86, v86
v_mul_f32 v81, v81, v85
v_rcp_f32 v87, v87
v_mul_f32 v82, v82, v86
v_rcp_f32 v108, v108
v_mul_f32 v83, v83, v87
v_rcp_f32 v109, v109
v_mul_f32 v104, v104, v108
v_rcp_f32 v110, v110
v_mul_f32 v105, v105, v109
v_rcp_f32 v111, v111
v_mul_f32 v106, v106, v110
v_rcp_f32 v116, v116
v_mul_f32 v107, v107, v111
v_rcp_f32 v117, v117
v_mul_f32 v112, v112, v116
v_rcp_f32 v118, v118
v_mul_f32 v113, v113, v117
v_rcp_f32 v119, v119
v_mul_f32 v114, v114, v118
v_mul_f32 v115, v115, v119
v_cvt_pk_bf16_f32 v176, v176, v177
v_cvt_pk_bf16_f32 v177, v178, v179
v_cvt_pk_bf16_f32 v178, v72, v73
v_cvt_pk_bf16_f32 v179, v74, v75
buffer_store_dwordx4 v[176:179], v4, s[12:15], s25 offen offset:0 sc1
v_cvt_pk_bf16_f32 v80, v80, v81
v_cvt_pk_bf16_f32 v81, v82, v83
v_cvt_pk_bf16_f32 v82, v104, v105
v_cvt_pk_bf16_f32 v83, v106, v107
buffer_store_dwordx4 v[80:83], v4, s[12:15], s25 offen offset:1024 sc1
v_cvt_pk_bf16_f32 v112, v112, v113
v_cvt_pk_bf16_f32 v113, v114, v115
buffer_store_dwordx2 v[112:113], v44, s[12:15], s25 offen sc1
s_cmp_lt_u32 s2, 48
s_cbranch_scc1 att_down
s_waitcnt vmcnt(0)
buffer_store_dword v31, v28, s[12:15], s37 offen offset:384 sc1
s_endpgm
att_down:
s_waitcnt vmcnt(32)
s_barrier
ds_read_b64_tr_b16 v[184:185], v12 offset:0
ds_read_b64_tr_b16 v[186:187], v12 offset:2048
ds_read_b64_tr_b16 v[188:189], v12 offset:12288
ds_read_b64_tr_b16 v[190:191], v12 offset:14336
ds_read_b64_tr_b16 v[192:193], v13 offset:0
ds_read_b64_tr_b16 v[194:195], v13 offset:2048
ds_read_b64_tr_b16 v[196:197], v13 offset:12288
ds_read_b64_tr_b16 v[198:199], v13 offset:14336
ds_read_b64_tr_b16 v[200:201], v14 offset:0
ds_read_b64_tr_b16 v[202:203], v14 offset:2048
ds_read_b64_tr_b16 v[204:205], v14 offset:12288
ds_read_b64_tr_b16 v[206:207], v14 offset:14336
s_waitcnt lgkmcnt(8)
v_mfma_f32_16x16x32_bf16 v[56:59], v[184:187], a[0:3], 0
ds_read_b64_tr_b16 v[208:209], v15 offset:0
v_mfma_f32_16x16x32_bf16 v[56:59], v[188:191], a[8:11], v[56:59]
buffer_load_dword v55, v10, s[12:15], s5 offen offset:128 sc1
v_mfma_f32_16x16x32_bf16 v[60:63], v[184:187], a[4:7], 0
ds_read_b64_tr_b16 v[210:211], v15 offset:2048
ds_read_b64_tr_b16 v[212:213], v15 offset:12288
v_mfma_f32_16x16x32_bf16 v[60:63], v[188:191], a[12:15], v[60:63]
s_waitcnt lgkmcnt(7)
ds_read_b64_tr_b16 v[214:215], v15 offset:14336
v_mfma_f32_16x16x32_bf16 v[64:67], v[192:195], a[0:3], 0
s_add_u32 s6, s62, 5087232
s_add_u32 m0, s17, 73728
ds_read_b64_tr_b16 v[216:217], v12 offset:4096
v_mfma_f32_16x16x32_bf16 v[64:67], v[196:199], a[8:11], v[64:67]
buffer_load_dwordx4 v3, s[28:31], s6 offen offset:0 lds
v_mfma_f32_16x16x32_bf16 v[68:71], v[192:195], a[4:7], 0
ds_read_b64_tr_b16 v[218:219], v12 offset:6144
ds_read_b64_tr_b16 v[220:221], v12 offset:16384
v_mfma_f32_16x16x32_bf16 v[68:71], v[196:199], a[12:15], v[68:71]
s_waitcnt lgkmcnt(7)
ds_read_b64_tr_b16 v[222:223], v12 offset:18432
v_mfma_f32_16x16x32_bf16 v[72:75], v[200:203], a[0:3], 0
s_add_u32 m0, s17, 77696
ds_read_b64_tr_b16 v[184:185], v13 offset:4096
v_mfma_f32_16x16x32_bf16 v[72:75], v[204:207], a[8:11], v[72:75]
buffer_load_dwordx4 v3, s[28:31], s6 offen offset:128 lds
v_mfma_f32_16x16x32_bf16 v[76:79], v[200:203], a[4:7], 0
ds_read_b64_tr_b16 v[186:187], v13 offset:6144
ds_read_b64_tr_b16 v[188:189], v13 offset:16384
v_mfma_f32_16x16x32_bf16 v[76:79], v[204:207], a[12:15], v[76:79]
s_waitcnt lgkmcnt(7)
ds_read_b64_tr_b16 v[190:191], v13 offset:18432
v_mfma_f32_16x16x32_bf16 v[80:83], v[208:211], a[0:3], 0
s_add_u32 m0, s17, 81664
ds_read_b64_tr_b16 v[192:193], v14 offset:4096
v_mfma_f32_16x16x32_bf16 v[80:83], v[212:215], a[8:11], v[80:83]
buffer_load_dwordx4 v3, s[28:31], s6 offen offset:256 lds
v_mfma_f32_16x16x32_bf16 v[84:87], v[208:211], a[4:7], 0
ds_read_b64_tr_b16 v[194:195], v14 offset:6144
ds_read_b64_tr_b16 v[196:197], v14 offset:16384
v_mfma_f32_16x16x32_bf16 v[84:87], v[212:215], a[12:15], v[84:87]
s_waitcnt lgkmcnt(7)
ds_read_b64_tr_b16 v[198:199], v14 offset:18432
v_mfma_f32_16x16x32_bf16 v[224:227], v[216:219], a[0:3], 0
s_add_u32 s3, s60, 141312
ds_read_b64_tr_b16 v[200:201], v15 offset:4096
v_mfma_f32_16x16x32_bf16 v[224:227], v[220:223], a[8:11], v[224:227]
buffer_load_dwordx4 a[48:51], v8, s[12:15], s3 offen offset:0 sc1
v_mfma_f32_16x16x32_bf16 v[228:231], v[216:219], a[4:7], 0
ds_read_b64_tr_b16 v[202:203], v15 offset:6144
ds_read_b64_tr_b16 v[204:205], v15 offset:16384
v_mfma_f32_16x16x32_bf16 v[228:231], v[220:223], a[12:15], v[228:231]
s_waitcnt lgkmcnt(7)
ds_read_b64_tr_b16 v[206:207], v15 offset:18432
v_mfma_f32_16x16x32_bf16 v[232:235], v[184:187], a[0:3], 0
s_add_u32 s6, s62, 5124096
ds_read_b64_tr_b16 v[208:209], v12 offset:8192
v_mfma_f32_16x16x32_bf16 v[232:235], v[188:191], a[8:11], v[232:235]
buffer_load_dwordx4 a[52:55], v9, s[12:15], s3 offen offset:0 sc1
v_mfma_f32_16x16x32_bf16 v[236:239], v[184:187], a[4:7], 0
ds_read_b64_tr_b16 v[210:211], v12 offset:10240
ds_read_b64_tr_b16 v[212:213], v12 offset:20480
v_mfma_f32_16x16x32_bf16 v[236:239], v[188:191], a[12:15], v[236:239]
s_waitcnt lgkmcnt(7)
ds_read_b64_tr_b16 v[214:215], v12 offset:22528
v_mfma_f32_16x16x32_bf16 v[240:243], v[192:195], a[0:3], 0
s_add_u32 m0, s17, 86016
ds_read_b64_tr_b16 v[216:217], v13 offset:8192
v_mfma_f32_16x16x32_bf16 v[240:243], v[196:199], a[8:11], v[240:243]
buffer_load_dwordx4 v3, s[28:31], s6 offen offset:0 lds
v_mfma_f32_16x16x32_bf16 v[244:247], v[192:195], a[4:7], 0
ds_read_b64_tr_b16 v[218:219], v13 offset:10240
ds_read_b64_tr_b16 v[220:221], v13 offset:20480
v_mfma_f32_16x16x32_bf16 v[244:247], v[196:199], a[12:15], v[244:247]
s_waitcnt lgkmcnt(7)
ds_read_b64_tr_b16 v[222:223], v13 offset:22528
v_mfma_f32_16x16x32_bf16 v[248:251], v[200:203], a[0:3], 0
s_add_u32 m0, s17, 89984
ds_read_b64_tr_b16 v[184:185], v14 offset:8192
v_mfma_f32_16x16x32_bf16 v[248:251], v[204:207], a[8:11], v[248:251]
buffer_load_dwordx4 v3, s[28:31], s6 offen offset:128 lds
v_mfma_f32_16x16x32_bf16 v[252:255], v[200:203], a[4:7], 0
ds_read_b64_tr_b16 v[186:187], v14 offset:10240
ds_read_b64_tr_b16 v[188:189], v14 offset:20480
v_mfma_f32_16x16x32_bf16 v[252:255], v[204:207], a[12:15], v[252:255]
s_waitcnt lgkmcnt(7)
ds_read_b64_tr_b16 v[190:191], v14 offset:22528
v_mfma_f32_16x16x32_bf16 v[88:91], v[208:211], a[0:3], 0
s_add_u32 m0, s17, 93952
ds_read_b64_tr_b16 v[192:193], v15 offset:8192
v_mfma_f32_16x16x32_bf16 v[88:91], v[212:215], a[8:11], v[88:91]
buffer_load_dwordx4 v3, s[28:31], s6 offen offset:256 lds
v_mfma_f32_16x16x32_bf16 v[92:95], v[208:211], a[4:7], 0
ds_read_b64_tr_b16 v[194:195], v15 offset:10240
ds_read_b64_tr_b16 v[196:197], v15 offset:20480
v_mfma_f32_16x16x32_bf16 v[92:95], v[212:215], a[12:15], v[92:95]
s_waitcnt lgkmcnt(7)
ds_read_b64_tr_b16 v[198:199], v15 offset:22528
v_mfma_f32_16x16x32_bf16 v[96:99], v[216:219], a[0:3], 0
s_waitcnt vmcnt(31)
s_barrier
v_mfma_f32_16x16x32_bf16 v[96:99], v[220:223], a[8:11], v[96:99]
ds_read_b64_tr_b16 v[200:201], v12 offset:24576
v_mfma_f32_16x16x32_bf16 v[100:103], v[216:219], a[4:7], 0
ds_read_b64_tr_b16 v[202:203], v12 offset:26624
ds_read_b64_tr_b16 v[204:205], v12 offset:36864
v_mfma_f32_16x16x32_bf16 v[100:103], v[220:223], a[12:15], v[100:103]
s_waitcnt lgkmcnt(7)
ds_read_b64_tr_b16 v[206:207], v12 offset:38912
v_mfma_f32_16x16x32_bf16 v[104:107], v[184:187], a[0:3], 0
ds_read_b64_tr_b16 v[208:209], v13 offset:24576
v_mfma_f32_16x16x32_bf16 v[104:107], v[188:191], a[8:11], v[104:107]
buffer_load_dwordx4 a[56:59], v8, s[12:15], s3 offen offset:1024 sc1
v_mfma_f32_16x16x32_bf16 v[108:111], v[184:187], a[4:7], 0
ds_read_b64_tr_b16 v[210:211], v13 offset:26624
ds_read_b64_tr_b16 v[212:213], v13 offset:36864
v_mfma_f32_16x16x32_bf16 v[108:111], v[188:191], a[12:15], v[108:111]
s_waitcnt lgkmcnt(7)
ds_read_b64_tr_b16 v[214:215], v13 offset:38912
v_mfma_f32_16x16x32_bf16 v[112:115], v[192:195], a[0:3], 0
s_add_u32 s6, s62, 4497408
ds_read_b64_tr_b16 v[216:217], v14 offset:24576
v_mfma_f32_16x16x32_bf16 v[112:115], v[196:199], a[8:11], v[112:115]
buffer_load_dwordx4 a[60:63], v9, s[12:15], s3 offen offset:1024 sc1
v_mfma_f32_16x16x32_bf16 v[116:119], v[192:195], a[4:7], 0
ds_read_b64_tr_b16 v[218:219], v14 offset:26624
ds_read_b64_tr_b16 v[220:221], v14 offset:36864
v_mfma_f32_16x16x32_bf16 v[116:119], v[196:199], a[12:15], v[116:119]
s_waitcnt lgkmcnt(7)
ds_read_b64_tr_b16 v[222:223], v14 offset:38912
v_mfma_f32_16x16x32_bf16 v[56:59], v[200:203], a[16:19], v[56:59]
s_add_u32 m0, s17, 98304
ds_read_b64_tr_b16 v[184:185], v15 offset:24576
v_mfma_f32_16x16x32_bf16 v[56:59], v[204:207], a[24:27], v[56:59]
buffer_load_dwordx4 v3, s[28:31], s6 offen offset:0 lds
v_mfma_f32_16x16x32_bf16 v[60:63], v[200:203], a[20:23], v[60:63]
ds_read_b64_tr_b16 v[186:187], v15 offset:26624
ds_read_b64_tr_b16 v[188:189], v15 offset:36864
v_mfma_f32_16x16x32_bf16 v[60:63], v[204:207], a[28:31], v[60:63]
s_waitcnt lgkmcnt(7)
ds_read_b64_tr_b16 v[190:191], v15 offset:38912
v_mfma_f32_16x16x32_bf16 v[64:67], v[208:211], a[16:19], v[64:67]
s_add_u32 m0, s17, 102272
ds_read_b64_tr_b16 v[192:193], v12 offset:28672
v_mfma_f32_16x16x32_bf16 v[64:67], v[212:215], a[24:27], v[64:67]
buffer_load_dwordx4 v3, s[28:31], s6 offen offset:128 lds
v_mfma_f32_16x16x32_bf16 v[68:71], v[208:211], a[20:23], v[68:71]
ds_read_b64_tr_b16 v[194:195], v12 offset:30720
ds_read_b64_tr_b16 v[196:197], v12 offset:40960
v_mfma_f32_16x16x32_bf16 v[68:71], v[212:215], a[28:31], v[68:71]
s_waitcnt lgkmcnt(7)
ds_read_b64_tr_b16 v[198:199], v12 offset:43008
v_mfma_f32_16x16x32_bf16 v[72:75], v[216:219], a[16:19], v[72:75]
s_add_u32 m0, s17, 106240
ds_read_b64_tr_b16 v[200:201], v13 offset:28672
v_mfma_f32_16x16x32_bf16 v[72:75], v[220:223], a[24:27], v[72:75]
buffer_load_dwordx4 v3, s[28:31], s6 offen offset:256 lds
v_mfma_f32_16x16x32_bf16 v[76:79], v[216:219], a[20:23], v[76:79]
ds_read_b64_tr_b16 v[202:203], v13 offset:30720
ds_read_b64_tr_b16 v[204:205], v13 offset:40960
v_mfma_f32_16x16x32_bf16 v[76:79], v[220:223], a[28:31], v[76:79]
s_waitcnt lgkmcnt(7)
ds_read_b64_tr_b16 v[206:207], v13 offset:43008
v_mfma_f32_16x16x32_bf16 v[80:83], v[184:187], a[16:19], v[80:83]
ds_read_b64_tr_b16 v[208:209], v14 offset:28672
v_mfma_f32_16x16x32_bf16 v[80:83], v[188:191], a[24:27], v[80:83]
s_waitcnt vmcnt(13)
v_cmp_ne_u32 vcc, s76, v55
s_nop 1
s_cbranch_vccnz slow_a3
back_a3:
v_mfma_f32_16x16x32_bf16 v[84:87], v[184:187], a[20:23], v[84:87]
ds_read_b64_tr_b16 v[210:211], v14 offset:30720
ds_read_b64_tr_b16 v[212:213], v14 offset:40960
v_mfma_f32_16x16x32_bf16 v[84:87], v[188:191], a[28:31], v[84:87]
s_waitcnt lgkmcnt(7)
ds_read_b64_tr_b16 v[214:215], v14 offset:43008
v_mfma_f32_16x16x32_bf16 v[224:227], v[192:195], a[16:19], v[224:227]
s_add_u32 s3, s60, 124928
ds_read_b64_tr_b16 v[216:217], v15 offset:28672
v_mfma_f32_16x16x32_bf16 v[224:227], v[196:199], a[24:27], v[224:227]
buffer_load_dwordx4 a[64:67], v8, s[12:15], s3 offen offset:0 sc1
v_mfma_f32_16x16x32_bf16 v[228:231], v[192:195], a[20:23], v[228:231]
ds_read_b64_tr_b16 v[218:219], v15 offset:30720
ds_read_b64_tr_b16 v[220:221], v15 offset:40960
v_mfma_f32_16x16x32_bf16 v[228:231], v[196:199], a[28:31], v[228:231]
s_waitcnt lgkmcnt(7)
ds_read_b64_tr_b16 v[222:223], v15 offset:43008
v_mfma_f32_16x16x32_bf16 v[232:235], v[200:203], a[16:19], v[232:235]
s_add_u32 s6, s62, 4534272
ds_read_b64_tr_b16 v[184:185], v12 offset:32768
v_mfma_f32_16x16x32_bf16 v[232:235], v[204:207], a[24:27], v[232:235]
buffer_load_dwordx4 a[68:71], v9, s[12:15], s3 offen offset:0 sc1
v_mfma_f32_16x16x32_bf16 v[236:239], v[200:203], a[20:23], v[236:239]
ds_read_b64_tr_b16 v[186:187], v12 offset:34816
ds_read_b64_tr_b16 v[188:189], v12 offset:45056
v_mfma_f32_16x16x32_bf16 v[236:239], v[204:207], a[28:31], v[236:239]
s_waitcnt lgkmcnt(7)
ds_read_b64_tr_b16 v[190:191], v12 offset:47104
v_mfma_f32_16x16x32_bf16 v[240:243], v[208:211], a[16:19], v[240:243]
s_add_u32 m0, s17, 110592
ds_read_b64_tr_b16 v[192:193], v13 offset:32768
v_mfma_f32_16x16x32_bf16 v[240:243], v[212:215], a[24:27], v[240:243]
buffer_load_dwordx4 v3, s[28:31], s6 offen offset:0 lds
v_mfma_f32_16x16x32_bf16 v[244:247], v[208:211], a[20:23], v[244:247]
ds_read_b64_tr_b16 v[194:195], v13 offset:34816
ds_read_b64_tr_b16 v[196:197], v13 offset:45056
v_mfma_f32_16x16x32_bf16 v[244:247], v[212:215], a[28:31], v[244:247]
s_waitcnt lgkmcnt(7)
ds_read_b64_tr_b16 v[198:199], v13 offset:47104
v_mfma_f32_16x16x32_bf16 v[248:251], v[216:219], a[16:19], v[248:251]
s_add_u32 m0, s17, 114560
ds_read_b64_tr_b16 v[200:201], v14 offset:32768
v_mfma_f32_16x16x32_bf16 v[248:251], v[220:223], a[24:27], v[248:251]
buffer_load_dwordx4 v3, s[28:31], s6 offen offset:128 lds
v_mfma_f32_16x16x32_bf16 v[252:255], v[216:219], a[20:23], v[252:255]
ds_read_b64_tr_b16 v[202:203], v14 offset:34816
ds_read_b64_tr_b16 v[204:205], v14 offset:45056
v_mfma_f32_16x16x32_bf16 v[252:255], v[220:223], a[28:31], v[252:255]
s_waitcnt lgkmcnt(7)
ds_read_b64_tr_b16 v[206:207], v14 offset:47104
v_mfma_f32_16x16x32_bf16 v[88:91], v[184:187], a[16:19], v[88:91]
s_add_u32 m0, s17, 118528
ds_read_b64_tr_b16 v[208:209], v15 offset:32768
v_mfma_f32_16x16x32_bf16 v[88:91], v[188:191], a[24:27], v[88:91]
buffer_load_dwordx4 v3, s[28:31], s6 offen offset:256 lds
v_mfma_f32_16x16x32_bf16 v[92:95], v[184:187], a[20:23], v[92:95]
ds_read_b64_tr_b16 v[210:211], v15 offset:34816
ds_read_b64_tr_b16 v[212:213], v15 offset:45056
v_mfma_f32_16x16x32_bf16 v[92:95], v[188:191], a[28:31], v[92:95]
s_waitcnt lgkmcnt(7)
ds_read_b64_tr_b16 v[214:215], v15 offset:47104
v_mfma_f32_16x16x32_bf16 v[96:99], v[192:195], a[16:19], v[96:99]
s_barrier
v_mfma_f32_16x16x32_bf16 v[96:99], v[196:199], a[24:27], v[96:99]
ds_read_b64_tr_b16 v[216:217], v16 offset:0
v_mfma_f32_16x16x32_bf16 v[100:103], v[192:195], a[20:23], v[100:103]
ds_read_b64_tr_b16 v[218:219], v16 offset:2048
ds_read_b64_tr_b16 v[220:221], v16 offset:12288
v_mfma_f32_16x16x32_bf16 v[100:103], v[196:199], a[28:31], v[100:103]
s_waitcnt lgkmcnt(7)
ds_read_b64_tr_b16 v[222:223], v16 offset:14336
v_mfma_f32_16x16x32_bf16 v[104:107], v[200:203], a[16:19], v[104:107]
ds_read_b64_tr_b16 v[184:185], v17 offset:0
v_mfma_f32_16x16x32_bf16 v[104:107], v[204:207], a[24:27], v[104:107]
buffer_load_dwordx4 a[72:75], v8, s[12:15], s3 offen offset:1024 sc1
v_mfma_f32_16x16x32_bf16 v[108:111], v[200:203], a[20:23], v[108:111]
ds_read_b64_tr_b16 v[186:187], v17 offset:2048
ds_read_b64_tr_b16 v[188:189], v17 offset:12288
v_mfma_f32_16x16x32_bf16 v[108:111], v[204:207], a[28:31], v[108:111]
s_waitcnt lgkmcnt(7)
ds_read_b64_tr_b16 v[190:191], v17 offset:14336
v_mfma_f32_16x16x32_bf16 v[112:115], v[208:211], a[16:19], v[112:115]
s_add_u32 s6, s62, 4718592
ds_read_b64_tr_b16 v[192:193], v18 offset:0
v_mfma_f32_16x16x32_bf16 v[112:115], v[212:215], a[24:27], v[112:115]
buffer_load_dwordx4 a[76:79], v9, s[12:15], s3 offen offset:1024 sc1
v_mfma_f32_16x16x32_bf16 v[116:119], v[208:211], a[20:23], v[116:119]
ds_read_b64_tr_b16 v[194:195], v18 offset:2048
ds_read_b64_tr_b16 v[196:197], v18 offset:12288
v_mfma_f32_16x16x32_bf16 v[116:119], v[212:215], a[28:31], v[116:119]
s_waitcnt lgkmcnt(7)
ds_read_b64_tr_b16 v[198:199], v18 offset:14336
v_mfma_f32_16x16x32_bf16 v[56:59], v[216:219], a[32:35], v[56:59]
s_add_u32 m0, s17, 122880
ds_read_b64_tr_b16 v[200:201], v19 offset:0
v_mfma_f32_16x16x32_bf16 v[56:59], v[220:223], a[40:43], v[56:59]
buffer_load_dwordx4 v3, s[28:31], s6 offen offset:0 lds
v_mfma_f32_16x16x32_bf16 v[60:63], v[216:219], a[36:39], v[60:63]
ds_read_b64_tr_b16 v[202:203], v19 offset:2048
ds_read_b64_tr_b16 v[204:205], v19 offset:12288
v_mfma_f32_16x16x32_bf16 v[60:63], v[220:223], a[44:47], v[60:63]
s_waitcnt lgkmcnt(7)
ds_read_b64_tr_b16 v[206:207], v19 offset:14336
v_mfma_f32_16x16x32_bf16 v[64:67], v[184:187], a[32:35], v[64:67]
s_add_u32 m0, s17, 126848
ds_read_b64_tr_b16 v[208:209], v16 offset:4096
v_mfma_f32_16x16x32_bf16 v[64:67], v[188:191], a[40:43], v[64:67]
buffer_load_dwordx4 v3, s[28:31], s6 offen offset:128 lds
v_mfma_f32_16x16x32_bf16 v[68:71], v[184:187], a[36:39], v[68:71]
ds_read_b64_tr_b16 v[210:211], v16 offset:6144
ds_read_b64_tr_b16 v[212:213], v16 offset:16384
v_mfma_f32_16x16x32_bf16 v[68:71], v[188:191], a[44:47], v[68:71]
s_waitcnt lgkmcnt(7)
ds_read_b64_tr_b16 v[214:215], v16 offset:18432
v_mfma_f32_16x16x32_bf16 v[72:75], v[192:195], a[32:35], v[72:75]
s_add_u32 m0, s17, 130816
ds_read_b64_tr_b16 v[216:217], v17 offset:4096
v_mfma_f32_16x16x32_bf16 v[72:75], v[196:199], a[40:43], v[72:75]
buffer_load_dwordx4 v3, s[28:31], s6 offen offset:256 lds
v_mfma_f32_16x16x32_bf16 v[76:79], v[192:195], a[36:39], v[76:79]
ds_read_b64_tr_b16 v[218:219], v17 offset:6144
ds_read_b64_tr_b16 v[220:221], v17 offset:16384
v_mfma_f32_16x16x32_bf16 v[76:79], v[196:199], a[44:47], v[76:79]
s_waitcnt lgkmcnt(7)
ds_read_b64_tr_b16 v[222:223], v17 offset:18432
v_mfma_f32_16x16x32_bf16 v[80:83], v[200:203], a[32:35], v[80:83]
s_add_u32 s3, s60, 131072
ds_read_b64_tr_b16 v[184:185], v18 offset:4096
v_mfma_f32_16x16x32_bf16 v[80:83], v[204:207], a[40:43], v[80:83]
buffer_load_dwordx4 a[80:83], v8, s[12:15], s3 offen offset:0 sc1
v_mfma_f32_16x16x32_bf16 v[84:87], v[200:203], a[36:39], v[84:87]
ds_read_b64_tr_b16 v[186:187], v18 offset:6144
ds_read_b64_tr_b16 v[188:189], v18 offset:16384
v_mfma_f32_16x16x32_bf16 v[84:87], v[204:207], a[44:47], v[84:87]
s_waitcnt lgkmcnt(7)
ds_read_b64_tr_b16 v[190:191], v18 offset:18432
v_mfma_f32_16x16x32_bf16 v[224:227], v[208:211], a[32:35], v[224:227]
ds_read_b64_tr_b16 v[192:193], v19 offset:4096
v_mfma_f32_16x16x32_bf16 v[224:227], v[212:215], a[40:43], v[224:227]
buffer_store_dword v31, v28, s[12:15], s37 offen offset:384 sc1
v_mfma_f32_16x16x32_bf16 v[228:231], v[208:211], a[36:39], v[228:231]
ds_read_b64_tr_b16 v[194:195], v19 offset:6144
ds_read_b64_tr_b16 v[196:197], v19 offset:16384
v_mfma_f32_16x16x32_bf16 v[228:231], v[212:215], a[44:47], v[228:231]
s_waitcnt lgkmcnt(7)
ds_read_b64_tr_b16 v[198:199], v19 offset:18432
v_mfma_f32_16x16x32_bf16 v[232:235], v[216:219], a[32:35], v[232:235]
s_add_u32 s6, s62, 4755456
ds_read_b64_tr_b16 v[200:201], v16 offset:8192
v_mfma_f32_16x16x32_bf16 v[232:235], v[220:223], a[40:43], v[232:235]
buffer_load_dwordx4 a[84:87], v9, s[12:15], s3 offen offset:0 sc1
v_mfma_f32_16x16x32_bf16 v[236:239], v[216:219], a[36:39], v[236:239]
ds_read_b64_tr_b16 v[202:203], v16 offset:10240
ds_read_b64_tr_b16 v[204:205], v16 offset:20480
v_mfma_f32_16x16x32_bf16 v[236:239], v[220:223], a[44:47], v[236:239]
s_waitcnt lgkmcnt(7)
ds_read_b64_tr_b16 v[206:207], v16 offset:22528
v_mfma_f32_16x16x32_bf16 v[240:243], v[184:187], a[32:35], v[240:243]
s_add_u32 m0, s17, 135168
ds_read_b64_tr_b16 v[208:209], v17 offset:8192
v_mfma_f32_16x16x32_bf16 v[240:243], v[188:191], a[40:43], v[240:243]
buffer_load_dwordx4 v3, s[28:31], s6 offen offset:0 lds
v_mfma_f32_16x16x32_bf16 v[244:247], v[184:187], a[36:39], v[244:247]
ds_read_b64_tr_b16 v[210:211], v17 offset:10240
ds_read_b64_tr_b16 v[212:213], v17 offset:20480
v_mfma_f32_16x16x32_bf16 v[244:247], v[188:191], a[44:47], v[244:247]
s_waitcnt lgkmcnt(7)
ds_read_b64_tr_b16 v[214:215], v17 offset:22528
v_mfma_f32_16x16x32_bf16 v[248:251], v[192:195], a[32:35], v[248:251]
s_add_u32 m0, s17, 139136
ds_read_b64_tr_b16 v[216:217], v18 offset:8192
v_mfma_f32_16x16x32_bf16 v[248:251], v[196:199], a[40:43], v[248:251]
buffer_load_dwordx4 v3, s[28:31], s6 offen offset:128 lds
v_mfma_f32_16x16x32_bf16 v[252:255], v[192:195], a[36:39], v[252:255]
ds_read_b64_tr_b16 v[218:219], v18 offset:10240
ds_read_b64_tr_b16 v[220:221], v18 offset:20480
v_mfma_f32_16x16x32_bf16 v[252:255], v[196:199], a[44:47], v[252:255]
s_waitcnt lgkmcnt(7)
ds_read_b64_tr_b16 v[222:223], v18 offset:22528
v_mfma_f32_16x16x32_bf16 v[88:91], v[200:203], a[32:35], v[88:91]
s_add_u32 m0, s17, 143104
ds_read_b64_tr_b16 v[184:185], v19 offset:8192
v_mfma_f32_16x16x32_bf16 v[88:91], v[204:207], a[40:43], v[88:91]
buffer_load_dwordx4 v3, s[28:31], s6 offen offset:256 lds
v_mfma_f32_16x16x32_bf16 v[92:95], v[200:203], a[36:39], v[92:95]
ds_read_b64_tr_b16 v[186:187], v19 offset:10240
ds_read_b64_tr_b16 v[188:189], v19 offset:20480
v_mfma_f32_16x16x32_bf16 v[92:95], v[204:207], a[44:47], v[92:95]
s_waitcnt lgkmcnt(7)
ds_read_b64_tr_b16 v[190:191], v19 offset:22528
v_mfma_f32_16x16x32_bf16 v[96:99], v[208:211], a[32:35], v[96:99]
s_waitcnt vmcnt(19)
s_barrier
v_mfma_f32_16x16x32_bf16 v[96:99], v[212:215], a[40:43], v[96:99]
ds_read_b64_tr_b16 v[192:193], v16 offset:24576
v_mfma_f32_16x16x32_bf16 v[100:103], v[208:211], a[36:39], v[100:103]
ds_read_b64_tr_b16 v[194:195], v16 offset:26624
ds_read_b64_tr_b16 v[196:197], v16 offset:36864
v_mfma_f32_16x16x32_bf16 v[100:103], v[212:215], a[44:47], v[100:103]
s_waitcnt lgkmcnt(7)
ds_read_b64_tr_b16 v[198:199], v16 offset:38912
v_mfma_f32_16x16x32_bf16 v[104:107], v[216:219], a[32:35], v[104:107]
ds_read_b64_tr_b16 v[200:201], v17 offset:24576
v_mfma_f32_16x16x32_bf16 v[104:107], v[220:223], a[40:43], v[104:107]
buffer_load_dwordx4 a[88:91], v8, s[12:15], s3 offen offset:1024 sc1
v_mfma_f32_16x16x32_bf16 v[108:111], v[216:219], a[36:39], v[108:111]
ds_read_b64_tr_b16 v[202:203], v17 offset:26624
ds_read_b64_tr_b16 v[204:205], v17 offset:36864
v_mfma_f32_16x16x32_bf16 v[108:111], v[220:223], a[44:47], v[108:111]
s_waitcnt lgkmcnt(7)
ds_read_b64_tr_b16 v[206:207], v17 offset:38912
v_mfma_f32_16x16x32_bf16 v[112:115], v[184:187], a[32:35], v[112:115]
s_add_u32 s6, s62, 4939776
ds_read_b64_tr_b16 v[208:209], v18 offset:24576
v_mfma_f32_16x16x32_bf16 v[112:115], v[188:191], a[40:43], v[112:115]
buffer_load_dwordx4 a[92:95], v9, s[12:15], s3 offen offset:1024 sc1
v_mfma_f32_16x16x32_bf16 v[116:119], v[184:187], a[36:39], v[116:119]
ds_read_b64_tr_b16 v[210:211], v18 offset:26624
ds_read_b64_tr_b16 v[212:213], v18 offset:36864
v_mfma_f32_16x16x32_bf16 v[116:119], v[188:191], a[44:47], v[116:119]
s_waitcnt lgkmcnt(7)
ds_read_b64_tr_b16 v[214:215], v18 offset:38912
v_mfma_f32_16x16x32_bf16 v[56:59], v[192:195], a[48:51], v[56:59]
s_add_u32 m0, s17, 0
ds_read_b64_tr_b16 v[216:217], v19 offset:24576
v_mfma_f32_16x16x32_bf16 v[56:59], v[196:199], a[56:59], v[56:59]
buffer_load_dwordx4 v3, s[28:31], s6 offen offset:0 lds
v_mfma_f32_16x16x32_bf16 v[60:63], v[192:195], a[52:55], v[60:63]
ds_read_b64_tr_b16 v[218:219], v19 offset:26624
ds_read_b64_tr_b16 v[220:221], v19 offset:36864
v_mfma_f32_16x16x32_bf16 v[60:63], v[196:199], a[60:63], v[60:63]
s_waitcnt lgkmcnt(7)
ds_read_b64_tr_b16 v[222:223], v19 offset:38912
v_mfma_f32_16x16x32_bf16 v[64:67], v[200:203], a[48:51], v[64:67]
s_add_u32 m0, s17, 3968
ds_read_b64_tr_b16 v[184:185], v16 offset:28672
v_mfma_f32_16x16x32_bf16 v[64:67], v[204:207], a[56:59], v[64:67]
buffer_load_dwordx4 v3, s[28:31], s6 offen offset:128 lds
v_mfma_f32_16x16x32_bf16 v[68:71], v[200:203], a[52:55], v[68:71]
ds_read_b64_tr_b16 v[186:187], v16 offset:30720
ds_read_b64_tr_b16 v[188:189], v16 offset:40960
v_mfma_f32_16x16x32_bf16 v[68:71], v[204:207], a[60:63], v[68:71]
s_waitcnt lgkmcnt(7)
ds_read_b64_tr_b16 v[190:191], v16 offset:43008
v_mfma_f32_16x16x32_bf16 v[72:75], v[208:211], a[48:51], v[72:75]
s_add_u32 m0, s17, 7936
ds_read_b64_tr_b16 v[192:193], v17 offset:28672
v_mfma_f32_16x16x32_bf16 v[72:75], v[212:215], a[56:59], v[72:75]
buffer_load_dwordx4 v3, s[28:31], s6 offen offset:256 lds
v_mfma_f32_16x16x32_bf16 v[76:79], v[208:211], a[52:55], v[76:79]
ds_read_b64_tr_b16 v[194:195], v17 offset:30720
ds_read_b64_tr_b16 v[196:197], v17 offset:40960
v_mfma_f32_16x16x32_bf16 v[76:79], v[212:215], a[60:63], v[76:79]
s_waitcnt lgkmcnt(7)
ds_read_b64_tr_b16 v[198:199], v17 offset:43008
v_mfma_f32_16x16x32_bf16 v[80:83], v[216:219], a[48:51], v[80:83]
s_add_u32 s3, s60, 137216
ds_read_b64_tr_b16 v[200:201], v18 offset:28672
v_mfma_f32_16x16x32_bf16 v[80:83], v[220:223], a[56:59], v[80:83]
buffer_load_dwordx4 a[96:99], v8, s[12:15], s3 offen offset:0 sc1
v_mfma_f32_16x16x32_bf16 v[84:87], v[216:219], a[52:55], v[84:87]
ds_read_b64_tr_b16 v[202:203], v18 offset:30720
ds_read_b64_tr_b16 v[204:205], v18 offset:40960
v_mfma_f32_16x16x32_bf16 v[84:87], v[220:223], a[60:63], v[84:87]
s_waitcnt lgkmcnt(7)
ds_read_b64_tr_b16 v[206:207], v18 offset:43008
v_mfma_f32_16x16x32_bf16 v[224:227], v[184:187], a[48:51], v[224:227]
s_add_u32 s6, s62, 4976640
ds_read_b64_tr_b16 v[208:209], v19 offset:28672
v_mfma_f32_16x16x32_bf16 v[224:227], v[188:191], a[56:59], v[224:227]
buffer_load_dwordx4 a[100:103], v9, s[12:15], s3 offen offset:0 sc1
v_mfma_f32_16x16x32_bf16 v[228:231], v[184:187], a[52:55], v[228:231]
ds_read_b64_tr_b16 v[210:211], v19 offset:30720
ds_read_b64_tr_b16 v[212:213], v19 offset:40960
v_mfma_f32_16x16x32_bf16 v[228:231], v[188:191], a[60:63], v[228:231]
s_waitcnt lgkmcnt(7)
ds_read_b64_tr_b16 v[214:215], v19 offset:43008
v_mfma_f32_16x16x32_bf16 v[232:235], v[192:195], a[48:51], v[232:235]
s_add_u32 m0, s17, 12288
ds_read_b64_tr_b16 v[216:217], v16 offset:32768
v_mfma_f32_16x16x32_bf16 v[232:235], v[196:199], a[56:59], v[232:235]
buffer_load_dwordx4 v3, s[28:31], s6 offen offset:0 lds
v_mfma_f32_16x16x32_bf16 v[236:239], v[192:195], a[52:55], v[236:239]
ds_read_b64_tr_b16 v[218:219], v16 offset:34816
ds_read_b64_tr_b16 v[220:221], v16 offset:45056
v_mfma_f32_16x16x32_bf16 v[236:239], v[196:199], a[60:63], v[236:239]
s_waitcnt lgkmcnt(7)
ds_read_b64_tr_b16 v[222:223], v16 offset:47104
v_mfma_f32_16x16x32_bf16 v[240:243], v[200:203], a[48:51], v[240:243]
s_add_u32 m0, s17, 16256
ds_read_b64_tr_b16 v[184:185], v17 offset:32768
v_mfma_f32_16x16x32_bf16 v[240:243], v[204:207], a[56:59], v[240:243]
buffer_load_dwordx4 v3, s[28:31], s6 offen offset:128 lds
v_mfma_f32_16x16x32_bf16 v[244:247], v[200:203], a[52:55], v[244:247]
ds_read_b64_tr_b16 v[186:187], v17 offset:34816
ds_read_b64_tr_b16 v[188:189], v17 offset:45056
v_mfma_f32_16x16x32_bf16 v[244:247], v[204:207], a[60:63], v[244:247]
s_waitcnt lgkmcnt(7)
ds_read_b64_tr_b16 v[190:191], v17 offset:47104
v_mfma_f32_16x16x32_bf16 v[248:251], v[208:211], a[48:51], v[248:251]
ds_read_b64_tr_b16 v[192:193], v18 offset:32768
v_mfma_f32_16x16x32_bf16 v[248:251], v[212:215], a[56:59], v[248:251]
buffer_load_dword v55, v11, s[12:15], s5 offen offset:384 sc1
v_mfma_f32_16x16x32_bf16 v[252:255], v[208:211], a[52:55], v[252:255]
ds_read_b64_tr_b16 v[194:195], v18 offset:34816
ds_read_b64_tr_b16 v[196:197], v18 offset:45056
v_mfma_f32_16x16x32_bf16 v[252:255], v[212:215], a[60:63], v[252:255]
s_waitcnt lgkmcnt(7)
ds_read_b64_tr_b16 v[198:199], v18 offset:47104
v_mfma_f32_16x16x32_bf16 v[88:91], v[216:219], a[48:51], v[88:91]
s_add_u32 m0, s17, 20224
ds_read_b64_tr_b16 v[200:201], v19 offset:32768
v_mfma_f32_16x16x32_bf16 v[88:91], v[220:223], a[56:59], v[88:91]
buffer_load_dwordx4 v3, s[28:31], s6 offen offset:256 lds
v_mfma_f32_16x16x32_bf16 v[92:95], v[216:219], a[52:55], v[92:95]
ds_read_b64_tr_b16 v[202:203], v19 offset:34816
ds_read_b64_tr_b16 v[204:205], v19 offset:45056
v_mfma_f32_16x16x32_bf16 v[92:95], v[220:223], a[60:63], v[92:95]
s_waitcnt lgkmcnt(7)
ds_read_b64_tr_b16 v[206:207], v19 offset:47104
v_mfma_f32_16x16x32_bf16 v[96:99], v[184:187], a[48:51], v[96:99]
s_waitcnt vmcnt(20)
s_barrier
v_mfma_f32_16x16x32_bf16 v[96:99], v[188:191], a[56:59], v[96:99]
ds_read_b64_tr_b16 v[208:209], v20 offset:0
v_mfma_f32_16x16x32_bf16 v[100:103], v[184:187], a[52:55], v[100:103]
ds_read_b64_tr_b16 v[210:211], v20 offset:2048
ds_read_b64_tr_b16 v[212:213], v20 offset:12288
v_mfma_f32_16x16x32_bf16 v[100:103], v[188:191], a[60:63], v[100:103]
s_waitcnt lgkmcnt(7)
ds_read_b64_tr_b16 v[214:215], v20 offset:14336
v_mfma_f32_16x16x32_bf16 v[104:107], v[192:195], a[48:51], v[104:107]
ds_read_b64_tr_b16 v[216:217], v21 offset:0
v_mfma_f32_16x16x32_bf16 v[104:107], v[196:199], a[56:59], v[104:107]
buffer_load_dwordx4 a[104:107], v8, s[12:15], s3 offen offset:1024 sc1
v_mfma_f32_16x16x32_bf16 v[108:111], v[192:195], a[52:55], v[108:111]
ds_read_b64_tr_b16 v[218:219], v21 offset:2048
ds_read_b64_tr_b16 v[220:221], v21 offset:12288
v_mfma_f32_16x16x32_bf16 v[108:111], v[196:199], a[60:63], v[108:111]
s_waitcnt lgkmcnt(7)
ds_read_b64_tr_b16 v[222:223], v21 offset:14336
v_mfma_f32_16x16x32_bf16 v[112:115], v[200:203], a[48:51], v[112:115]
s_add_u32 s6, s62, 5160960
ds_read_b64_tr_b16 v[184:185], v22 offset:0
v_mfma_f32_16x16x32_bf16 v[112:115], v[204:207], a[56:59], v[112:115]
buffer_load_dwordx4 a[108:111], v9, s[12:15], s3 offen offset:1024 sc1
v_mfma_f32_16x16x32_bf16 v[116:119], v[200:203], a[52:55], v[116:119]
ds_read_b64_tr_b16 v[186:187], v22 offset:2048
ds_read_b64_tr_b16 v[188:189], v22 offset:12288
v_mfma_f32_16x16x32_bf16 v[116:119], v[204:207], a[60:63], v[116:119]
s_waitcnt lgkmcnt(7)
ds_read_b64_tr_b16 v[190:191], v22 offset:14336
v_mfma_f32_16x16x32_bf16 v[56:59], v[208:211], a[64:67], v[56:59]
s_add_u32 m0, s17, 24576
ds_read_b64_tr_b16 v[192:193], v23 offset:0
v_mfma_f32_16x16x32_bf16 v[56:59], v[212:215], a[72:75], v[56:59]
buffer_load_dwordx4 v3, s[28:31], s6 offen offset:0 lds
v_mfma_f32_16x16x32_bf16 v[60:63], v[208:211], a[68:71], v[60:63]
ds_read_b64_tr_b16 v[194:195], v23 offset:2048
ds_read_b64_tr_b16 v[196:197], v23 offset:12288
v_mfma_f32_16x16x32_bf16 v[60:63], v[212:215], a[76:79], v[60:63]
s_waitcnt lgkmcnt(7)
ds_read_b64_tr_b16 v[198:199], v23 offset:14336
v_mfma_f32_16x16x32_bf16 v[64:67], v[216:219], a[64:67], v[64:67]
s_add_u32 m0, s17, 28544
ds_read_b64_tr_b16 v[200:201], v20 offset:4096
v_mfma_f32_16x16x32_bf16 v[64:67], v[220:223], a[72:75], v[64:67]
buffer_load_dwordx4 v3, s[28:31], s6 offen offset:128 lds
v_mfma_f32_16x16x32_bf16 v[68:71], v[216:219], a[68:71], v[68:71]
ds_read_b64_tr_b16 v[202:203], v20 offset:6144
ds_read_b64_tr_b16 v[204:205], v20 offset:16384
v_mfma_f32_16x16x32_bf16 v[68:71], v[220:223], a[76:79], v[68:71]
s_waitcnt lgkmcnt(7)
ds_read_b64_tr_b16 v[206:207], v20 offset:18432
v_mfma_f32_16x16x32_bf16 v[72:75], v[184:187], a[64:67], v[72:75]
s_add_u32 m0, s17, 32512
ds_read_b64_tr_b16 v[208:209], v21 offset:4096
v_mfma_f32_16x16x32_bf16 v[72:75], v[188:191], a[72:75], v[72:75]
buffer_load_dwordx4 v3, s[28:31], s6 offen offset:256 lds
v_mfma_f32_16x16x32_bf16 v[76:79], v[184:187], a[68:71], v[76:79]
ds_read_b64_tr_b16 v[210:211], v21 offset:6144
ds_read_b64_tr_b16 v[212:213], v21 offset:16384
v_mfma_f32_16x16x32_bf16 v[76:79], v[188:191], a[76:79], v[76:79]
s_waitcnt lgkmcnt(7)
ds_read_b64_tr_b16 v[214:215], v21 offset:18432
v_mfma_f32_16x16x32_bf16 v[80:83], v[192:195], a[64:67], v[80:83]
s_add_u32 s3, s60, 143360
ds_read_b64_tr_b16 v[216:217], v22 offset:4096
v_mfma_f32_16x16x32_bf16 v[80:83], v[196:199], a[72:75], v[80:83]
buffer_load_dwordx4 a[112:115], v8, s[12:15], s3 offen offset:0 sc1
v_mfma_f32_16x16x32_bf16 v[84:87], v[192:195], a[68:71], v[84:87]
ds_read_b64_tr_b16 v[218:219], v22 offset:6144
ds_read_b64_tr_b16 v[220:221], v22 offset:16384
v_mfma_f32_16x16x32_bf16 v[84:87], v[196:199], a[76:79], v[84:87]
s_waitcnt lgkmcnt(7)
ds_read_b64_tr_b16 v[222:223], v22 offset:18432
v_mfma_f32_16x16x32_bf16 v[224:227], v[200:203], a[64:67], v[224:227]
s_add_u32 s6, s62, 5197824
ds_read_b64_tr_b16 v[184:185], v23 offset:4096
v_mfma_f32_16x16x32_bf16 v[224:227], v[204:207], a[72:75], v[224:227]
buffer_load_dwordx4 a[116:119], v9, s[12:15], s3 offen offset:0 sc1
v_mfma_f32_16x16x32_bf16 v[228:231], v[200:203], a[68:71], v[228:231]
ds_read_b64_tr_b16 v[186:187], v23 offset:6144
ds_read_b64_tr_b16 v[188:189], v23 offset:16384
v_mfma_f32_16x16x32_bf16 v[228:231], v[204:207], a[76:79], v[228:231]
s_waitcnt lgkmcnt(7)
ds_read_b64_tr_b16 v[190:191], v23 offset:18432
v_mfma_f32_16x16x32_bf16 v[232:235], v[208:211], a[64:67], v[232:235]
s_add_u32 m0, s17, 36864
ds_read_b64_tr_b16 v[192:193], v20 offset:8192
v_mfma_f32_16x16x32_bf16 v[232:235], v[212:215], a[72:75], v[232:235]
buffer_load_dwordx4 v3, s[28:31], s6 offen offset:0 lds
v_mfma_f32_16x16x32_bf16 v[236:239], v[208:211], a[68:71], v[236:239]
ds_read_b64_tr_b16 v[194:195], v20 offset:10240
ds_read_b64_tr_b16 v[196:197], v20 offset:20480
v_mfma_f32_16x16x32_bf16 v[236:239], v[212:215], a[76:79], v[236:239]
s_waitcnt lgkmcnt(7)
ds_read_b64_tr_b16 v[198:199], v20 offset:22528
v_mfma_f32_16x16x32_bf16 v[240:243], v[216:219], a[64:67], v[240:243]
s_add_u32 m0, s17, 40832
ds_read_b64_tr_b16 v[200:201], v21 offset:8192
v_mfma_f32_16x16x32_bf16 v[240:243], v[220:223], a[72:75], v[240:243]
buffer_load_dwordx4 v3, s[28:31], s6 offen offset:128 lds
v_mfma_f32_16x16x32_bf16 v[244:247], v[216:219], a[68:71], v[244:247]
ds_read_b64_tr_b16 v[202:203], v21 offset:10240
ds_read_b64_tr_b16 v[204:205], v21 offset:20480
v_mfma_f32_16x16x32_bf16 v[244:247], v[220:223], a[76:79], v[244:247]
s_waitcnt lgkmcnt(7)
ds_read_b64_tr_b16 v[206:207], v21 offset:22528
v_mfma_f32_16x16x32_bf16 v[248:251], v[184:187], a[64:67], v[248:251]
s_add_u32 m0, s17, 44800
ds_read_b64_tr_b16 v[208:209], v22 offset:8192
v_mfma_f32_16x16x32_bf16 v[248:251], v[188:191], a[72:75], v[248:251]
buffer_load_dwordx4 v3, s[28:31], s6 offen offset:256 lds
v_mfma_f32_16x16x32_bf16 v[252:255], v[184:187], a[68:71], v[252:255]
ds_read_b64_tr_b16 v[210:211], v22 offset:10240
ds_read_b64_tr_b16 v[212:213], v22 offset:20480
v_mfma_f32_16x16x32_bf16 v[252:255], v[188:191], a[76:79], v[252:255]
s_waitcnt lgkmcnt(7)
ds_read_b64_tr_b16 v[214:215], v22 offset:22528
v_mfma_f32_16x16x32_bf16 v[88:91], v[192:195], a[64:67], v[88:91]
ds_read_b64_tr_b16 v[216:217], v23 offset:8192
v_mfma_f32_16x16x32_bf16 v[88:91], v[196:199], a[72:75], v[88:91]
buffer_load_dwordx4 a[120:123], v8, s[12:15], s3 offen offset:1024 sc1
v_mfma_f32_16x16x32_bf16 v[92:95], v[192:195], a[68:71], v[92:95]
ds_read_b64_tr_b16 v[218:219], v23 offset:10240
ds_read_b64_tr_b16 v[220:221], v23 offset:20480
v_mfma_f32_16x16x32_bf16 v[92:95], v[196:199], a[76:79], v[92:95]
s_waitcnt lgkmcnt(7)
ds_read_b64_tr_b16 v[222:223], v23 offset:22528
v_mfma_f32_16x16x32_bf16 v[96:99], v[200:203], a[64:67], v[96:99]
s_waitcnt vmcnt(20)
s_barrier
v_mfma_f32_16x16x32_bf16 v[96:99], v[204:207], a[72:75], v[96:99]
ds_read_b64_tr_b16 v[184:185], v20 offset:24576
v_mfma_f32_16x16x32_bf16 v[100:103], v[200:203], a[68:71], v[100:103]
ds_read_b64_tr_b16 v[186:187], v20 offset:26624
ds_read_b64_tr_b16 v[188:189], v20 offset:36864
v_mfma_f32_16x16x32_bf16 v[100:103], v[204:207], a[76:79], v[100:103]
s_waitcnt lgkmcnt(7)
ds_read_b64_tr_b16 v[190:191], v20 offset:38912
v_mfma_f32_16x16x32_bf16 v[104:107], v[208:211], a[64:67], v[104:107]
s_add_u32 s6, s62, 0
ds_read_b64_tr_b16 v[192:193], v21 offset:24576
v_mfma_f32_16x16x32_bf16 v[104:107], v[212:215], a[72:75], v[104:107]
buffer_load_dwordx4 a[124:127], v9, s[12:15], s3 offen offset:1024 sc1
v_mfma_f32_16x16x32_bf16 v[108:111], v[208:211], a[68:71], v[108:111]
ds_read_b64_tr_b16 v[194:195], v21 offset:26624
ds_read_b64_tr_b16 v[196:197], v21 offset:36864
v_mfma_f32_16x16x32_bf16 v[108:111], v[212:215], a[76:79], v[108:111]
s_waitcnt lgkmcnt(7)
ds_read_b64_tr_b16 v[198:199], v21 offset:38912
v_mfma_f32_16x16x32_bf16 v[112:115], v[216:219], a[64:67], v[112:115]
s_add_u32 m0, s17, 49152
ds_read_b64_tr_b16 v[200:201], v22 offset:24576
v_mfma_f32_16x16x32_bf16 v[112:115], v[220:223], a[72:75], v[112:115]
buffer_load_dwordx4 v3, s[56:59], s6 offen offset:0 lds
v_mfma_f32_16x16x32_bf16 v[116:119], v[216:219], a[68:71], v[116:119]
ds_read_b64_tr_b16 v[202:203], v22 offset:26624
ds_read_b64_tr_b16 v[204:205], v22 offset:36864
v_mfma_f32_16x16x32_bf16 v[116:119], v[220:223], a[76:79], v[116:119]
s_waitcnt lgkmcnt(7)
ds_read_b64_tr_b16 v[206:207], v22 offset:38912
v_mfma_f32_16x16x32_bf16 v[56:59], v[184:187], a[80:83], v[56:59]
s_add_u32 m0, s17, 53120
ds_read_b64_tr_b16 v[208:209], v23 offset:24576
v_mfma_f32_16x16x32_bf16 v[56:59], v[188:191], a[88:91], v[56:59]
buffer_load_dwordx4 v3, s[56:59], s6 offen offset:128 lds
v_mfma_f32_16x16x32_bf16 v[60:63], v[184:187], a[84:87], v[60:63]
ds_read_b64_tr_b16 v[210:211], v23 offset:26624
ds_read_b64_tr_b16 v[212:213], v23 offset:36864
v_mfma_f32_16x16x32_bf16 v[60:63], v[188:191], a[92:95], v[60:63]
s_waitcnt lgkmcnt(7)
ds_read_b64_tr_b16 v[214:215], v23 offset:38912
v_mfma_f32_16x16x32_bf16 v[64:67], v[192:195], a[80:83], v[64:67]
s_add_u32 m0, s17, 57088
ds_read_b64_tr_b16 v[216:217], v20 offset:28672
v_mfma_f32_16x16x32_bf16 v[64:67], v[196:199], a[88:91], v[64:67]
buffer_load_dwordx4 v3, s[56:59], s6 offen offset:256 lds
v_mfma_f32_16x16x32_bf16 v[68:71], v[192:195], a[84:87], v[68:71]
ds_read_b64_tr_b16 v[218:219], v20 offset:30720
ds_read_b64_tr_b16 v[220:221], v20 offset:40960
v_mfma_f32_16x16x32_bf16 v[68:71], v[196:199], a[92:95], v[68:71]
s_waitcnt lgkmcnt(7)
ds_read_b64_tr_b16 v[222:223], v20 offset:43008
v_mfma_f32_16x16x32_bf16 v[72:75], v[200:203], a[80:83], v[72:75]
ds_read_b64_tr_b16 v[184:185], v21 offset:28672
v_mfma_f32_16x16x32_bf16 v[72:75], v[204:207], a[88:91], v[72:75]
s_waitcnt vmcnt(16)
v_cmp_ne_u32 vcc, s76, v55
s_nop 1
s_cbranch_vccnz slow_a4
back_a4:
v_mfma_f32_16x16x32_bf16 v[76:79], v[200:203], a[84:87], v[76:79]
ds_read_b64_tr_b16 v[186:187], v21 offset:30720
ds_read_b64_tr_b16 v[188:189], v21 offset:40960
v_mfma_f32_16x16x32_bf16 v[76:79], v[204:207], a[92:95], v[76:79]
s_waitcnt lgkmcnt(7)
ds_read_b64_tr_b16 v[190:191], v21 offset:43008
v_mfma_f32_16x16x32_bf16 v[80:83], v[208:211], a[80:83], v[80:83]
s_add_u32 s3, s60, 147456
ds_read_b64_tr_b16 v[192:193], v22 offset:28672
v_mfma_f32_16x16x32_bf16 v[80:83], v[212:215], a[88:91], v[80:83]
buffer_load_dwordx4 a[128:131], v8, s[12:15], s3 offen offset:0 sc1
v_mfma_f32_16x16x32_bf16 v[84:87], v[208:211], a[84:87], v[84:87]
ds_read_b64_tr_b16 v[194:195], v22 offset:30720
ds_read_b64_tr_b16 v[196:197], v22 offset:40960
v_mfma_f32_16x16x32_bf16 v[84:87], v[212:215], a[92:95], v[84:87]
s_waitcnt lgkmcnt(7)
ds_read_b64_tr_b16 v[198:199], v22 offset:43008
v_mfma_f32_16x16x32_bf16 v[224:227], v[216:219], a[80:83], v[224:227]
s_add_u32 s6, s62, 36864
ds_read_b64_tr_b16 v[200:201], v23 offset:28672
v_mfma_f32_16x16x32_bf16 v[224:227], v[220:223], a[88:91], v[224:227]
buffer_load_dwordx4 a[132:135], v9, s[12:15], s3 offen offset:0 sc1
v_mfma_f32_16x16x32_bf16 v[228:231], v[216:219], a[84:87], v[228:231]
ds_read_b64_tr_b16 v[202:203], v23 offset:30720
ds_read_b64_tr_b16 v[204:205], v23 offset:40960
v_mfma_f32_16x16x32_bf16 v[228:231], v[220:223], a[92:95], v[228:231]
s_waitcnt lgkmcnt(7)
ds_read_b64_tr_b16 v[206:207], v23 offset:43008
v_mfma_f32_16x16x32_bf16 v[232:235], v[184:187], a[80:83], v[232:235]
s_add_u32 m0, s17, 61440
ds_read_b64_tr_b16 v[208:209], v20 offset:32768
v_mfma_f32_16x16x32_bf16 v[232:235], v[188:191], a[88:91], v[232:235]
buffer_load_dwordx4 v3, s[56:59], s6 offen offset:0 lds
v_mfma_f32_16x16x32_bf16 v[236:239], v[184:187], a[84:87], v[236:239]
ds_read_b64_tr_b16 v[210:211], v20 offset:34816
ds_read_b64_tr_b16 v[212:213], v20 offset:45056
v_mfma_f32_16x16x32_bf16 v[236:239], v[188:191], a[92:95], v[236:239]
s_waitcnt lgkmcnt(7)
ds_read_b64_tr_b16 v[214:215], v20 offset:47104
v_mfma_f32_16x16x32_bf16 v[240:243], v[192:195], a[80:83], v[240:243]
s_add_u32 m0, s17, 65408
ds_read_b64_tr_b16 v[216:217], v21 offset:32768
v_mfma_f32_16x16x32_bf16 v[240:243], v[196:199], a[88:91], v[240:243]
buffer_load_dwordx4 v3, s[56:59], s6 offen offset:128 lds
v_mfma_f32_16x16x32_bf16 v[244:247], v[192:195], a[84:87], v[244:247]
ds_read_b64_tr_b16 v[218:219], v21 offset:34816
ds_read_b64_tr_b16 v[220:221], v21 offset:45056
v_mfma_f32_16x16x32_bf16 v[244:247], v[196:199], a[92:95], v[244:247]
s_waitcnt lgkmcnt(7)
ds_read_b64_tr_b16 v[222:223], v21 offset:47104
v_mfma_f32_16x16x32_bf16 v[248:251], v[200:203], a[80:83], v[248:251]
s_add_u32 m0, s17, 69376
ds_read_b64_tr_b16 v[184:185], v22 offset:32768
v_mfma_f32_16x16x32_bf16 v[248:251], v[204:207], a[88:91], v[248:251]
buffer_load_dwordx4 v3, s[56:59], s6 offen offset:256 lds
v_mfma_f32_16x16x32_bf16 v[252:255], v[200:203], a[84:87], v[252:255]
ds_read_b64_tr_b16 v[186:187], v22 offset:34816
ds_read_b64_tr_b16 v[188:189], v22 offset:45056
v_mfma_f32_16x16x32_bf16 v[252:255], v[204:207], a[92:95], v[252:255]
s_waitcnt lgkmcnt(7)
ds_read_b64_tr_b16 v[190:191], v22 offset:47104
v_mfma_f32_16x16x32_bf16 v[88:91], v[208:211], a[80:83], v[88:91]
ds_read_b64_tr_b16 v[192:193], v23 offset:32768
v_mfma_f32_16x16x32_bf16 v[88:91], v[212:215], a[88:91], v[88:91]
buffer_load_dwordx4 a[136:139], v8, s[12:15], s3 offen offset:1024 sc1
v_mfma_f32_16x16x32_bf16 v[92:95], v[208:211], a[84:87], v[92:95]
ds_read_b64_tr_b16 v[194:195], v23 offset:34816
ds_read_b64_tr_b16 v[196:197], v23 offset:45056
v_mfma_f32_16x16x32_bf16 v[92:95], v[212:215], a[92:95], v[92:95]
s_waitcnt lgkmcnt(7)
ds_read_b64_tr_b16 v[198:199], v23 offset:47104
v_mfma_f32_16x16x32_bf16 v[96:99], v[216:219], a[80:83], v[96:99]
s_waitcnt vmcnt(19)
s_barrier
v_mfma_f32_16x16x32_bf16 v[96:99], v[220:223], a[88:91], v[96:99]
ds_read_b64_tr_b16 v[200:201], v12 offset:0
v_mfma_f32_16x16x32_bf16 v[100:103], v[216:219], a[84:87], v[100:103]
ds_read_b64_tr_b16 v[202:203], v12 offset:2048
ds_read_b64_tr_b16 v[204:205], v12 offset:12288
v_mfma_f32_16x16x32_bf16 v[100:103], v[220:223], a[92:95], v[100:103]
s_waitcnt lgkmcnt(7)
ds_read_b64_tr_b16 v[206:207], v12 offset:14336
v_mfma_f32_16x16x32_bf16 v[104:107], v[184:187], a[80:83], v[104:107]
s_add_u32 s6, s62, 82944
ds_read_b64_tr_b16 v[208:209], v13 offset:0
v_mfma_f32_16x16x32_bf16 v[104:107], v[188:191], a[88:91], v[104:107]
buffer_load_dwordx4 a[140:143], v9, s[12:15], s3 offen offset:1024 sc1
v_mfma_f32_16x16x32_bf16 v[108:111], v[184:187], a[84:87], v[108:111]
ds_read_b64_tr_b16 v[210:211], v13 offset:2048
ds_read_b64_tr_b16 v[212:213], v13 offset:12288
v_mfma_f32_16x16x32_bf16 v[108:111], v[188:191], a[92:95], v[108:111]
s_waitcnt lgkmcnt(7)
ds_read_b64_tr_b16 v[214:215], v13 offset:14336
v_mfma_f32_16x16x32_bf16 v[112:115], v[192:195], a[80:83], v[112:115]
s_add_u32 m0, s17, 73728
ds_read_b64_tr_b16 v[216:217], v14 offset:0
v_mfma_f32_16x16x32_bf16 v[112:115], v[196:199], a[88:91], v[112:115]
buffer_load_dwordx4 v3, s[56:59], s6 offen offset:0 lds
v_mfma_f32_16x16x32_bf16 v[116:119], v[192:195], a[84:87], v[116:119]
ds_read_b64_tr_b16 v[218:219], v14 offset:2048
ds_read_b64_tr_b16 v[220:221], v14 offset:12288
v_mfma_f32_16x16x32_bf16 v[116:119], v[196:199], a[92:95], v[116:119]
s_waitcnt lgkmcnt(7)
ds_read_b64_tr_b16 v[222:223], v14 offset:14336
v_mfma_f32_16x16x32_bf16 v[56:59], v[200:203], a[96:99], v[56:59]
s_add_u32 m0, s17, 77696
ds_read_b64_tr_b16 v[184:185], v15 offset:0
v_mfma_f32_16x16x32_bf16 v[56:59], v[204:207], a[104:107], v[56:59]
buffer_load_dwordx4 v3, s[56:59], s6 offen offset:128 lds
v_mfma_f32_16x16x32_bf16 v[60:63], v[200:203], a[100:103], v[60:63]
ds_read_b64_tr_b16 v[186:187], v15 offset:2048
ds_read_b64_tr_b16 v[188:189], v15 offset:12288
v_mfma_f32_16x16x32_bf16 v[60:63], v[204:207], a[108:111], v[60:63]
s_waitcnt lgkmcnt(7)
ds_read_b64_tr_b16 v[190:191], v15 offset:14336
v_mfma_f32_16x16x32_bf16 v[64:67], v[208:211], a[96:99], v[64:67]
s_add_u32 m0, s17, 81664
ds_read_b64_tr_b16 v[192:193], v12 offset:4096
v_mfma_f32_16x16x32_bf16 v[64:67], v[212:215], a[104:107], v[64:67]
buffer_load_dwordx4 v3, s[56:59], s6 offen offset:256 lds
v_mfma_f32_16x16x32_bf16 v[68:71], v[208:211], a[100:103], v[68:71]
ds_read_b64_tr_b16 v[194:195], v12 offset:6144
ds_read_b64_tr_b16 v[196:197], v12 offset:16384
v_mfma_f32_16x16x32_bf16 v[68:71], v[212:215], a[108:111], v[68:71]
s_waitcnt lgkmcnt(7)
ds_read_b64_tr_b16 v[198:199], v12 offset:18432
v_mfma_f32_16x16x32_bf16 v[72:75], v[216:219], a[96:99], v[72:75]
s_add_u32 s3, s60, 149504
ds_read_b64_tr_b16 v[200:201], v13 offset:4096
v_mfma_f32_16x16x32_bf16 v[72:75], v[220:223], a[104:107], v[72:75]
buffer_load_dwordx4 a[144:147], v8, s[12:15], s3 offen offset:0 sc1
v_mfma_f32_16x16x32_bf16 v[76:79], v[216:219], a[100:103], v[76:79]
ds_read_b64_tr_b16 v[202:203], v13 offset:6144
ds_read_b64_tr_b16 v[204:205], v13 offset:16384
v_mfma_f32_16x16x32_bf16 v[76:79], v[220:223], a[108:111], v[76:79]
s_waitcnt lgkmcnt(7)
ds_read_b64_tr_b16 v[206:207], v13 offset:18432
v_mfma_f32_16x16x32_bf16 v[80:83], v[184:187], a[96:99], v[80:83]
s_add_u32 s6, s62, 119808
ds_read_b64_tr_b16 v[208:209], v14 offset:4096
v_mfma_f32_16x16x32_bf16 v[80:83], v[188:191], a[104:107], v[80:83]
buffer_load_dwordx4 a[148:151], v9, s[12:15], s3 offen offset:0 sc1
v_mfma_f32_16x16x32_bf16 v[84:87], v[184:187], a[100:103], v[84:87]
ds_read_b64_tr_b16 v[210:211], v14 offset:6144
ds_read_b64_tr_b16 v[212:213], v14 offset:16384
v_mfma_f32_16x16x32_bf16 v[84:87], v[188:191], a[108:111], v[84:87]
s_waitcnt lgkmcnt(7)
ds_read_b64_tr_b16 v[214:215], v14 offset:18432
v_mfma_f32_16x16x32_bf16 v[224:227], v[192:195], a[96:99], v[224:227]
s_add_u32 m0, s17, 86016
ds_read_b64_tr_b16 v[216:217], v15 offset:4096
v_mfma_f32_16x16x32_bf16 v[224:227], v[196:199], a[104:107], v[224:227]
buffer_load_dwordx4 v3, s[56:59], s6 offen offset:0 lds
v_mfma_f32_16x16x32_bf16 v[228:231], v[192:195], a[100:103], v[228:231]
ds_read_b64_tr_b16 v[218:219], v15 offset:6144
ds_read_b64_tr_b16 v[220:221], v15 offset:16384
v_mfma_f32_16x16x32_bf16 v[228:231], v[196:199], a[108:111], v[228:231]
s_waitcnt lgkmcnt(7)
ds_read_b64_tr_b16 v[222:223], v15 offset:18432
v_mfma_f32_16x16x32_bf16 v[232:235], v[200:203], a[96:99], v[232:235]
s_add_u32 m0, s17, 89984
ds_read_b64_tr_b16 v[184:185], v12 offset:8192
v_mfma_f32_16x16x32_bf16 v[232:235], v[204:207], a[104:107], v[232:235]
buffer_load_dwordx4 v3, s[56:59], s6 offen offset:128 lds
v_mfma_f32_16x16x32_bf16 v[236:239], v[200:203], a[100:103], v[236:239]
ds_read_b64_tr_b16 v[186:187], v12 offset:10240
ds_read_b64_tr_b16 v[188:189], v12 offset:20480
v_mfma_f32_16x16x32_bf16 v[236:239], v[204:207], a[108:111], v[236:239]
s_waitcnt lgkmcnt(7)
ds_read_b64_tr_b16 v[190:191], v12 offset:22528
v_mfma_f32_16x16x32_bf16 v[240:243], v[208:211], a[96:99], v[240:243]
s_add_u32 m0, s17, 93952
ds_read_b64_tr_b16 v[192:193], v13 offset:8192
v_mfma_f32_16x16x32_bf16 v[240:243], v[212:215], a[104:107], v[240:243]
buffer_load_dwordx4 v3, s[56:59], s6 offen offset:256 lds
v_mfma_f32_16x16x32_bf16 v[244:247], v[208:211], a[100:103], v[244:247]
ds_read_b64_tr_b16 v[194:195], v13 offset:10240
ds_read_b64_tr_b16 v[196:197], v13 offset:20480
v_mfma_f32_16x16x32_bf16 v[244:247], v[212:215], a[108:111], v[244:247]
s_waitcnt lgkmcnt(7)
ds_read_b64_tr_b16 v[198:199], v13 offset:22528
v_mfma_f32_16x16x32_bf16 v[248:251], v[216:219], a[96:99], v[248:251]
ds_read_b64_tr_b16 v[200:201], v14 offset:8192
v_mfma_f32_16x16x32_bf16 v[248:251], v[220:223], a[104:107], v[248:251]
buffer_load_dwordx4 a[152:155], v8, s[12:15], s3 offen offset:1024 sc1
v_mfma_f32_16x16x32_bf16 v[252:255], v[216:219], a[100:103], v[252:255]
ds_read_b64_tr_b16 v[202:203], v14 offset:10240
ds_read_b64_tr_b16 v[204:205], v14 offset:20480
v_mfma_f32_16x16x32_bf16 v[252:255], v[220:223], a[108:111], v[252:255]
s_waitcnt lgkmcnt(7)
ds_read_b64_tr_b16 v[206:207], v14 offset:22528
v_mfma_f32_16x16x32_bf16 v[88:91], v[184:187], a[96:99], v[88:91]
s_add_u32 s6, s62, 165888
ds_read_b64_tr_b16 v[208:209], v15 offset:8192
v_mfma_f32_16x16x32_bf16 v[88:91], v[188:191], a[104:107], v[88:91]
buffer_load_dwordx4 a[156:159], v9, s[12:15], s3 offen offset:1024 sc1
v_mfma_f32_16x16x32_bf16 v[92:95], v[184:187], a[100:103], v[92:95]
ds_read_b64_tr_b16 v[210:211], v15 offset:10240
ds_read_b64_tr_b16 v[212:213], v15 offset:20480
v_mfma_f32_16x16x32_bf16 v[92:95], v[188:191], a[108:111], v[92:95]
s_waitcnt lgkmcnt(7)
ds_read_b64_tr_b16 v[214:215], v15 offset:22528
v_mfma_f32_16x16x32_bf16 v[96:99], v[192:195], a[96:99], v[96:99]
s_waitcnt vmcnt(20)
s_barrier
v_mfma_f32_16x16x32_bf16 v[96:99], v[196:199], a[104:107], v[96:99]
ds_read_b64_tr_b16 v[216:217], v12 offset:24576
v_mfma_f32_16x16x32_bf16 v[100:103], v[192:195], a[100:103], v[100:103]
ds_read_b64_tr_b16 v[218:219], v12 offset:26624
ds_read_b64_tr_b16 v[220:221], v12 offset:36864
v_mfma_f32_16x16x32_bf16 v[100:103], v[196:199], a[108:111], v[100:103]
s_waitcnt lgkmcnt(7)
ds_read_b64_tr_b16 v[222:223], v12 offset:38912
v_mfma_f32_16x16x32_bf16 v[104:107], v[200:203], a[96:99], v[104:107]
s_add_u32 m0, s17, 98304
ds_read_b64_tr_b16 v[184:185], v13 offset:24576
v_mfma_f32_16x16x32_bf16 v[104:107], v[204:207], a[104:107], v[104:107]
buffer_load_dwordx4 v3, s[56:59], s6 offen offset:0 lds
v_mfma_f32_16x16x32_bf16 v[108:111], v[200:203], a[100:103], v[108:111]
ds_read_b64_tr_b16 v[186:187], v13 offset:26624
ds_read_b64_tr_b16 v[188:189], v13 offset:36864
v_mfma_f32_16x16x32_bf16 v[108:111], v[204:207], a[108:111], v[108:111]
s_waitcnt lgkmcnt(7)
ds_read_b64_tr_b16 v[190:191], v13 offset:38912
v_mfma_f32_16x16x32_bf16 v[112:115], v[208:211], a[96:99], v[112:115]
s_add_u32 m0, s17, 102272
ds_read_b64_tr_b16 v[192:193], v14 offset:24576
v_mfma_f32_16x16x32_bf16 v[112:115], v[212:215], a[104:107], v[112:115]
buffer_load_dwordx4 v3, s[56:59], s6 offen offset:128 lds
v_mfma_f32_16x16x32_bf16 v[116:119], v[208:211], a[100:103], v[116:119]
ds_read_b64_tr_b16 v[194:195], v14 offset:26624
ds_read_b64_tr_b16 v[196:197], v14 offset:36864
v_mfma_f32_16x16x32_bf16 v[116:119], v[212:215], a[108:111], v[116:119]
s_waitcnt lgkmcnt(7)
ds_read_b64_tr_b16 v[198:199], v14 offset:38912
v_mfma_f32_16x16x32_bf16 v[56:59], v[216:219], a[112:115], v[56:59]
s_add_u32 m0, s17, 106240
ds_read_b64_tr_b16 v[200:201], v15 offset:24576
v_mfma_f32_16x16x32_bf16 v[56:59], v[220:223], a[120:123], v[56:59]
buffer_load_dwordx4 v3, s[56:59], s6 offen offset:256 lds
v_mfma_f32_16x16x32_bf16 v[60:63], v[216:219], a[116:119], v[60:63]
ds_read_b64_tr_b16 v[202:203], v15 offset:26624
ds_read_b64_tr_b16 v[204:205], v15 offset:36864
v_mfma_f32_16x16x32_bf16 v[60:63], v[220:223], a[124:127], v[60:63]
s_waitcnt lgkmcnt(7)
ds_read_b64_tr_b16 v[206:207], v15 offset:38912
v_mfma_f32_16x16x32_bf16 v[64:67], v[184:187], a[112:115], v[64:67]
s_add_u32 s3, s60, 151552
ds_read_b64_tr_b16 v[208:209], v12 offset:28672
v_mfma_f32_16x16x32_bf16 v[64:67], v[188:191], a[120:123], v[64:67]
buffer_load_dwordx4 a[160:163], v8, s[12:15], s3 offen offset:0 sc1
v_mfma_f32_16x16x32_bf16 v[68:71], v[184:187], a[116:119], v[68:71]
ds_read_b64_tr_b16 v[210:211], v12 offset:30720
ds_read_b64_tr_b16 v[212:213], v12 offset:40960
v_mfma_f32_16x16x32_bf16 v[68:71], v[188:191], a[124:127], v[68:71]
s_waitcnt lgkmcnt(7)
ds_read_b64_tr_b16 v[214:215], v12 offset:43008
v_mfma_f32_16x16x32_bf16 v[72:75], v[192:195], a[112:115], v[72:75]
s_add_u32 s6, s62, 202752
ds_read_b64_tr_b16 v[216:217], v13 offset:28672
v_mfma_f32_16x16x32_bf16 v[72:75], v[196:199], a[120:123], v[72:75]
buffer_load_dwordx4 a[164:167], v9, s[12:15], s3 offen offset:0 sc1
v_mfma_f32_16x16x32_bf16 v[76:79], v[192:195], a[116:119], v[76:79]
ds_read_b64_tr_b16 v[218:219], v13 offset:30720
ds_read_b64_tr_b16 v[220:221], v13 offset:40960
v_mfma_f32_16x16x32_bf16 v[76:79], v[196:199], a[124:127], v[76:79]
s_waitcnt lgkmcnt(7)
ds_read_b64_tr_b16 v[222:223], v13 offset:43008
v_mfma_f32_16x16x32_bf16 v[80:83], v[200:203], a[112:115], v[80:83]
s_add_u32 m0, s17, 110592
ds_read_b64_tr_b16 v[184:185], v14 offset:28672
v_mfma_f32_16x16x32_bf16 v[80:83], v[204:207], a[120:123], v[80:83]
buffer_load_dwordx4 v3, s[56:59], s6 offen offset:0 lds
v_mfma_f32_16x16x32_bf16 v[84:87], v[200:203], a[116:119], v[84:87]
ds_read_b64_tr_b16 v[186:187], v14 offset:30720
ds_read_b64_tr_b16 v[188:189], v14 offset:40960
v_mfma_f32_16x16x32_bf16 v[84:87], v[204:207], a[124:127], v[84:87]
s_waitcnt lgkmcnt(7)
ds_read_b64_tr_b16 v[190:191], v14 offset:43008
v_mfma_f32_16x16x32_bf16 v[224:227], v[208:211], a[112:115], v[224:227]
s_add_u32 m0, s17, 114560
ds_read_b64_tr_b16 v[192:193], v15 offset:28672
v_mfma_f32_16x16x32_bf16 v[224:227], v[212:215], a[120:123], v[224:227]
buffer_load_dwordx4 v3, s[56:59], s6 offen offset:128 lds
v_mfma_f32_16x16x32_bf16 v[228:231], v[208:211], a[116:119], v[228:231]
ds_read_b64_tr_b16 v[194:195], v15 offset:30720
ds_read_b64_tr_b16 v[196:197], v15 offset:40960
v_mfma_f32_16x16x32_bf16 v[228:231], v[212:215], a[124:127], v[228:231]
s_waitcnt lgkmcnt(7)
ds_read_b64_tr_b16 v[198:199], v15 offset:43008
v_mfma_f32_16x16x32_bf16 v[232:235], v[216:219], a[112:115], v[232:235]
s_add_u32 m0, s17, 118528
ds_read_b64_tr_b16 v[200:201], v12 offset:32768
v_mfma_f32_16x16x32_bf16 v[232:235], v[220:223], a[120:123], v[232:235]
buffer_load_dwordx4 v3, s[56:59], s6 offen offset:256 lds
v_mfma_f32_16x16x32_bf16 v[236:239], v[216:219], a[116:119], v[236:239]
ds_read_b64_tr_b16 v[202:203], v12 offset:34816
ds_read_b64_tr_b16 v[204:205], v12 offset:45056
v_mfma_f32_16x16x32_bf16 v[236:239], v[220:223], a[124:127], v[236:239]
s_waitcnt lgkmcnt(7)
ds_read_b64_tr_b16 v[206:207], v12 offset:47104
v_mfma_f32_16x16x32_bf16 v[240:243], v[184:187], a[112:115], v[240:243]
ds_read_b64_tr_b16 v[208:209], v13 offset:32768
v_mfma_f32_16x16x32_bf16 v[240:243], v[188:191], a[120:123], v[240:243]
buffer_load_dwordx4 a[168:171], v8, s[12:15], s3 offen offset:1024 sc1
v_mfma_f32_16x16x32_bf16 v[244:247], v[184:187], a[116:119], v[244:247]
ds_read_b64_tr_b16 v[210:211], v13 offset:34816
ds_read_b64_tr_b16 v[212:213], v13 offset:45056
v_mfma_f32_16x16x32_bf16 v[244:247], v[188:191], a[124:127], v[244:247]
s_waitcnt lgkmcnt(7)
ds_read_b64_tr_b16 v[214:215], v13 offset:47104
v_mfma_f32_16x16x32_bf16 v[248:251], v[192:195], a[112:115], v[248:251]
s_add_u32 s6, s62, 248832
ds_read_b64_tr_b16 v[216:217], v14 offset:32768
v_mfma_f32_16x16x32_bf16 v[248:251], v[196:199], a[120:123], v[248:251]
buffer_load_dwordx4 a[172:175], v9, s[12:15], s3 offen offset:1024 sc1
v_mfma_f32_16x16x32_bf16 v[252:255], v[192:195], a[116:119], v[252:255]
ds_read_b64_tr_b16 v[218:219], v14 offset:34816
ds_read_b64_tr_b16 v[220:221], v14 offset:45056
v_mfma_f32_16x16x32_bf16 v[252:255], v[196:199], a[124:127], v[252:255]
s_waitcnt lgkmcnt(7)
ds_read_b64_tr_b16 v[222:223], v14 offset:47104
v_mfma_f32_16x16x32_bf16 v[88:91], v[200:203], a[112:115], v[88:91]
ds_read_b64_tr_b16 v[184:185], v15 offset:32768
v_mfma_f32_16x16x32_bf16 v[88:91], v[204:207], a[120:123], v[88:91]
ds_read_b64_tr_b16 v[186:187], v15 offset:34816
v_mfma_f32_16x16x32_bf16 v[92:95], v[200:203], a[116:119], v[92:95]
ds_read_b64_tr_b16 v[188:189], v15 offset:45056
v_mfma_f32_16x16x32_bf16 v[92:95], v[204:207], a[124:127], v[92:95]
s_waitcnt lgkmcnt(7)
ds_read_b64_tr_b16 v[190:191], v15 offset:47104
v_mfma_f32_16x16x32_bf16 v[96:99], v[208:211], a[112:115], v[96:99]
s_waitcnt vmcnt(20)
s_barrier
v_mfma_f32_16x16x32_bf16 v[96:99], v[212:215], a[120:123], v[96:99]
ds_read_b64_tr_b16 v[192:193], v16 offset:0
v_mfma_f32_16x16x32_bf16 v[100:103], v[208:211], a[116:119], v[100:103]
ds_read_b64_tr_b16 v[194:195], v16 offset:2048
ds_read_b64_tr_b16 v[196:197], v16 offset:12288
v_mfma_f32_16x16x32_bf16 v[100:103], v[212:215], a[124:127], v[100:103]
s_waitcnt lgkmcnt(7)
ds_read_b64_tr_b16 v[198:199], v16 offset:14336
v_mfma_f32_16x16x32_bf16 v[104:107], v[216:219], a[112:115], v[104:107]
s_add_u32 m0, s17, 122880
ds_read_b64_tr_b16 v[200:201], v17 offset:0
v_mfma_f32_16x16x32_bf16 v[104:107], v[220:223], a[120:123], v[104:107]
buffer_load_dwordx4 v3, s[56:59], s6 offen offset:0 lds
v_mfma_f32_16x16x32_bf16 v[108:111], v[216:219], a[116:119], v[108:111]
ds_read_b64_tr_b16 v[202:203], v17 offset:2048
ds_read_b64_tr_b16 v[204:205], v17 offset:12288
v_mfma_f32_16x16x32_bf16 v[108:111], v[220:223], a[124:127], v[108:111]
s_waitcnt lgkmcnt(7)
ds_read_b64_tr_b16 v[206:207], v17 offset:14336
v_mfma_f32_16x16x32_bf16 v[112:115], v[184:187], a[112:115], v[112:115]
s_add_u32 m0, s17, 126848
ds_read_b64_tr_b16 v[208:209], v18 offset:0
v_mfma_f32_16x16x32_bf16 v[112:115], v[188:191], a[120:123], v[112:115]
buffer_load_dwordx4 v3, s[56:59], s6 offen offset:128 lds
v_mfma_f32_16x16x32_bf16 v[116:119], v[184:187], a[116:119], v[116:119]
ds_read_b64_tr_b16 v[210:211], v18 offset:2048
ds_read_b64_tr_b16 v[212:213], v18 offset:12288
v_mfma_f32_16x16x32_bf16 v[116:119], v[188:191], a[124:127], v[116:119]
s_waitcnt lgkmcnt(7)
ds_read_b64_tr_b16 v[214:215], v18 offset:14336
v_mfma_f32_16x16x32_bf16 v[56:59], v[192:195], a[128:131], v[56:59]
s_add_u32 m0, s17, 130816
ds_read_b64_tr_b16 v[216:217], v19 offset:0
v_mfma_f32_16x16x32_bf16 v[56:59], v[196:199], a[136:139], v[56:59]
buffer_load_dwordx4 v3, s[56:59], s6 offen offset:256 lds
v_mfma_f32_16x16x32_bf16 v[60:63], v[192:195], a[132:135], v[60:63]
ds_read_b64_tr_b16 v[218:219], v19 offset:2048
ds_read_b64_tr_b16 v[220:221], v19 offset:12288
v_mfma_f32_16x16x32_bf16 v[60:63], v[196:199], a[140:143], v[60:63]
s_waitcnt lgkmcnt(7)
ds_read_b64_tr_b16 v[222:223], v19 offset:14336
v_mfma_f32_16x16x32_bf16 v[64:67], v[200:203], a[128:131], v[64:67]
s_add_u32 s3, s60, 153600
ds_read_b64_tr_b16 v[184:185], v16 offset:4096
v_mfma_f32_16x16x32_bf16 v[64:67], v[204:207], a[136:139], v[64:67]
buffer_load_dwordx4 a[176:179], v8, s[12:15], s3 offen offset:0 sc1
v_mfma_f32_16x16x32_bf16 v[68:71], v[200:203], a[132:135], v[68:71]
ds_read_b64_tr_b16 v[186:187], v16 offset:6144
ds_read_b64_tr_b16 v[188:189], v16 offset:16384
v_mfma_f32_16x16x32_bf16 v[68:71], v[204:207], a[140:143], v[68:71]
s_waitcnt lgkmcnt(7)
ds_read_b64_tr_b16 v[190:191], v16 offset:18432
v_mfma_f32_16x16x32_bf16 v[72:75], v[208:211], a[128:131], v[72:75]
s_add_u32 s6, s62, 285696
ds_read_b64_tr_b16 v[192:193], v17 offset:4096
v_mfma_f32_16x16x32_bf16 v[72:75], v[212:215], a[136:139], v[72:75]
buffer_load_dwordx4 a[180:183], v9, s[12:15], s3 offen offset:0 sc1
v_mfma_f32_16x16x32_bf16 v[76:79], v[208:211], a[132:135], v[76:79]
ds_read_b64_tr_b16 v[194:195], v17 offset:6144
ds_read_b64_tr_b16 v[196:197], v17 offset:16384
v_mfma_f32_16x16x32_bf16 v[76:79], v[212:215], a[140:143], v[76:79]
s_waitcnt lgkmcnt(7)
ds_read_b64_tr_b16 v[198:199], v17 offset:18432
v_mfma_f32_16x16x32_bf16 v[80:83], v[216:219], a[128:131], v[80:83]
s_add_u32 m0, s17, 135168
ds_read_b64_tr_b16 v[200:201], v18 offset:4096
v_mfma_f32_16x16x32_bf16 v[80:83], v[220:223], a[136:139], v[80:83]
buffer_load_dwordx4 v3, s[56:59], s6 offen offset:0 lds
v_mfma_f32_16x16x32_bf16 v[84:87], v[216:219], a[132:135], v[84:87]
ds_read_b64_tr_b16 v[202:203], v18 offset:6144
ds_read_b64_tr_b16 v[204:205], v18 offset:16384
v_mfma_f32_16x16x32_bf16 v[84:87], v[220:223], a[140:143], v[84:87]
s_waitcnt lgkmcnt(7)
ds_read_b64_tr_b16 v[206:207], v18 offset:18432
v_mfma_f32_16x16x32_bf16 v[224:227], v[184:187], a[128:131], v[224:227]
s_add_u32 m0, s17, 139136
ds_read_b64_tr_b16 v[208:209], v19 offset:4096
v_mfma_f32_16x16x32_bf16 v[224:227], v[188:191], a[136:139], v[224:227]
buffer_load_dwordx4 v3, s[56:59], s6 offen offset:128 lds
v_mfma_f32_16x16x32_bf16 v[228:231], v[184:187], a[132:135], v[228:231]
ds_read_b64_tr_b16 v[210:211], v19 offset:6144
ds_read_b64_tr_b16 v[212:213], v19 offset:16384
v_mfma_f32_16x16x32_bf16 v[228:231], v[188:191], a[140:143], v[228:231]
s_waitcnt lgkmcnt(7)
ds_read_b64_tr_b16 v[214:215], v19 offset:18432
v_mfma_f32_16x16x32_bf16 v[232:235], v[192:195], a[128:131], v[232:235]
s_add_u32 m0, s17, 143104
ds_read_b64_tr_b16 v[216:217], v16 offset:8192
v_mfma_f32_16x16x32_bf16 v[232:235], v[196:199], a[136:139], v[232:235]
buffer_load_dwordx4 v3, s[56:59], s6 offen offset:256 lds
v_mfma_f32_16x16x32_bf16 v[236:239], v[192:195], a[132:135], v[236:239]
ds_read_b64_tr_b16 v[218:219], v16 offset:10240
ds_read_b64_tr_b16 v[220:221], v16 offset:20480
v_mfma_f32_16x16x32_bf16 v[236:239], v[196:199], a[140:143], v[236:239]
s_waitcnt lgkmcnt(7)
ds_read_b64_tr_b16 v[222:223], v16 offset:22528
v_mfma_f32_16x16x32_bf16 v[240:243], v[200:203], a[128:131], v[240:243]
ds_read_b64_tr_b16 v[184:185], v17 offset:8192
v_mfma_f32_16x16x32_bf16 v[240:243], v[204:207], a[136:139], v[240:243]
buffer_load_dwordx4 a[184:187], v8, s[12:15], s3 offen offset:1024 sc1
v_mfma_f32_16x16x32_bf16 v[244:247], v[200:203], a[132:135], v[244:247]
ds_read_b64_tr_b16 v[186:187], v17 offset:10240
ds_read_b64_tr_b16 v[188:189], v17 offset:20480
v_mfma_f32_16x16x32_bf16 v[244:247], v[204:207], a[140:143], v[244:247]
s_waitcnt lgkmcnt(7)
ds_read_b64_tr_b16 v[190:191], v17 offset:22528
v_mfma_f32_16x16x32_bf16 v[248:251], v[208:211], a[128:131], v[248:251]
s_add_u32 s6, s62, 331776
ds_read_b64_tr_b16 v[192:193], v18 offset:8192
v_mfma_f32_16x16x32_bf16 v[248:251], v[212:215], a[136:139], v[248:251]
buffer_load_dwordx4 a[188:191], v9, s[12:15], s3 offen offset:1024 sc1
v_mfma_f32_16x16x32_bf16 v[252:255], v[208:211], a[132:135], v[252:255]
ds_read_b64_tr_b16 v[194:195], v18 offset:10240
ds_read_b64_tr_b16 v[196:197], v18 offset:20480
v_mfma_f32_16x16x32_bf16 v[252:255], v[212:215], a[140:143], v[252:255]
s_waitcnt lgkmcnt(7)
ds_read_b64_tr_b16 v[198:199], v18 offset:22528
v_mfma_f32_16x16x32_bf16 v[88:91], v[216:219], a[128:131], v[88:91]
ds_read_b64_tr_b16 v[200:201], v19 offset:8192
v_mfma_f32_16x16x32_bf16 v[88:91], v[220:223], a[136:139], v[88:91]
ds_read_b64_tr_b16 v[202:203], v19 offset:10240
v_mfma_f32_16x16x32_bf16 v[92:95], v[216:219], a[132:135], v[92:95]
ds_read_b64_tr_b16 v[204:205], v19 offset:20480
v_mfma_f32_16x16x32_bf16 v[92:95], v[220:223], a[140:143], v[92:95]
s_waitcnt lgkmcnt(7)
ds_read_b64_tr_b16 v[206:207], v19 offset:22528
v_mfma_f32_16x16x32_bf16 v[96:99], v[184:187], a[128:131], v[96:99]
s_waitcnt vmcnt(20)
s_barrier
v_mfma_f32_16x16x32_bf16 v[96:99], v[188:191], a[136:139], v[96:99]
ds_read_b64_tr_b16 v[208:209], v16 offset:24576
v_mfma_f32_16x16x32_bf16 v[100:103], v[184:187], a[132:135], v[100:103]
ds_read_b64_tr_b16 v[210:211], v16 offset:26624
ds_read_b64_tr_b16 v[212:213], v16 offset:36864
v_mfma_f32_16x16x32_bf16 v[100:103], v[188:191], a[140:143], v[100:103]
s_waitcnt lgkmcnt(7)
ds_read_b64_tr_b16 v[214:215], v16 offset:38912
v_mfma_f32_16x16x32_bf16 v[104:107], v[192:195], a[128:131], v[104:107]
s_add_u32 m0, s17, 0
ds_read_b64_tr_b16 v[216:217], v17 offset:24576
v_mfma_f32_16x16x32_bf16 v[104:107], v[196:199], a[136:139], v[104:107]
buffer_load_dwordx4 v3, s[56:59], s6 offen offset:0 lds
v_mfma_f32_16x16x32_bf16 v[108:111], v[192:195], a[132:135], v[108:111]
ds_read_b64_tr_b16 v[218:219], v17 offset:26624
ds_read_b64_tr_b16 v[220:221], v17 offset:36864
v_mfma_f32_16x16x32_bf16 v[108:111], v[196:199], a[140:143], v[108:111]
s_waitcnt lgkmcnt(7)
ds_read_b64_tr_b16 v[222:223], v17 offset:38912
v_mfma_f32_16x16x32_bf16 v[112:115], v[200:203], a[128:131], v[112:115]
s_add_u32 m0, s17, 3968
ds_read_b64_tr_b16 v[184:185], v18 offset:24576
v_mfma_f32_16x16x32_bf16 v[112:115], v[204:207], a[136:139], v[112:115]
buffer_load_dwordx4 v3, s[56:59], s6 offen offset:128 lds
v_mfma_f32_16x16x32_bf16 v[116:119], v[200:203], a[132:135], v[116:119]
ds_read_b64_tr_b16 v[186:187], v18 offset:26624
ds_read_b64_tr_b16 v[188:189], v18 offset:36864
v_mfma_f32_16x16x32_bf16 v[116:119], v[204:207], a[140:143], v[116:119]
s_waitcnt lgkmcnt(7)
ds_read_b64_tr_b16 v[190:191], v18 offset:38912
v_mfma_f32_16x16x32_bf16 v[56:59], v[208:211], a[144:147], v[56:59]
s_add_u32 m0, s17, 7936
ds_read_b64_tr_b16 v[192:193], v19 offset:24576
v_mfma_f32_16x16x32_bf16 v[56:59], v[212:215], a[152:155], v[56:59]
buffer_load_dwordx4 v3, s[56:59], s6 offen offset:256 lds
v_mfma_f32_16x16x32_bf16 v[60:63], v[208:211], a[148:151], v[60:63]
ds_read_b64_tr_b16 v[194:195], v19 offset:26624
ds_read_b64_tr_b16 v[196:197], v19 offset:36864
v_mfma_f32_16x16x32_bf16 v[60:63], v[212:215], a[156:159], v[60:63]
s_waitcnt lgkmcnt(7)
ds_read_b64_tr_b16 v[198:199], v19 offset:38912
v_mfma_f32_16x16x32_bf16 v[64:67], v[216:219], a[144:147], v[64:67]
s_add_u32 s3, s60, 155648
ds_read_b64_tr_b16 v[200:201], v16 offset:28672
v_mfma_f32_16x16x32_bf16 v[64:67], v[220:223], a[152:155], v[64:67]
buffer_load_dwordx4 a[192:195], v8, s[12:15], s3 offen offset:0 sc1
v_mfma_f32_16x16x32_bf16 v[68:71], v[216:219], a[148:151], v[68:71]
ds_read_b64_tr_b16 v[202:203], v16 offset:30720
ds_read_b64_tr_b16 v[204:205], v16 offset:40960
v_mfma_f32_16x16x32_bf16 v[68:71], v[220:223], a[156:159], v[68:71]
s_waitcnt lgkmcnt(7)
ds_read_b64_tr_b16 v[206:207], v16 offset:43008
v_mfma_f32_16x16x32_bf16 v[72:75], v[184:187], a[144:147], v[72:75]
s_add_u32 s6, s62, 368640
ds_read_b64_tr_b16 v[208:209], v17 offset:28672
v_mfma_f32_16x16x32_bf16 v[72:75], v[188:191], a[152:155], v[72:75]
buffer_load_dwordx4 a[196:199], v9, s[12:15], s3 offen offset:0 sc1
v_mfma_f32_16x16x32_bf16 v[76:79], v[184:187], a[148:151], v[76:79]
ds_read_b64_tr_b16 v[210:211], v17 offset:30720
ds_read_b64_tr_b16 v[212:213], v17 offset:40960
v_mfma_f32_16x16x32_bf16 v[76:79], v[188:191], a[156:159], v[76:79]
s_waitcnt lgkmcnt(7)
ds_read_b64_tr_b16 v[214:215], v17 offset:43008
v_mfma_f32_16x16x32_bf16 v[80:83], v[192:195], a[144:147], v[80:83]
s_add_u32 m0, s17, 12288
ds_read_b64_tr_b16 v[216:217], v18 offset:28672
v_mfma_f32_16x16x32_bf16 v[80:83], v[196:199], a[152:155], v[80:83]
buffer_load_dwordx4 v3, s[56:59], s6 offen offset:0 lds
v_mfma_f32_16x16x32_bf16 v[84:87], v[192:195], a[148:151], v[84:87]
ds_read_b64_tr_b16 v[218:219], v18 offset:30720
ds_read_b64_tr_b16 v[220:221], v18 offset:40960
v_mfma_f32_16x16x32_bf16 v[84:87], v[196:199], a[156:159], v[84:87]
s_waitcnt lgkmcnt(7)
ds_read_b64_tr_b16 v[222:223], v18 offset:43008
v_mfma_f32_16x16x32_bf16 v[224:227], v[200:203], a[144:147], v[224:227]
s_add_u32 m0, s17, 16256
ds_read_b64_tr_b16 v[184:185], v19 offset:28672
v_mfma_f32_16x16x32_bf16 v[224:227], v[204:207], a[152:155], v[224:227]
buffer_load_dwordx4 v3, s[56:59], s6 offen offset:128 lds
v_mfma_f32_16x16x32_bf16 v[228:231], v[200:203], a[148:151], v[228:231]
ds_read_b64_tr_b16 v[186:187], v19 offset:30720
ds_read_b64_tr_b16 v[188:189], v19 offset:40960
v_mfma_f32_16x16x32_bf16 v[228:231], v[204:207], a[156:159], v[228:231]
s_waitcnt lgkmcnt(7)
ds_read_b64_tr_b16 v[190:191], v19 offset:43008
v_mfma_f32_16x16x32_bf16 v[232:235], v[208:211], a[144:147], v[232:235]
s_add_u32 m0, s17, 20224
ds_read_b64_tr_b16 v[192:193], v16 offset:32768
v_mfma_f32_16x16x32_bf16 v[232:235], v[212:215], a[152:155], v[232:235]
buffer_load_dwordx4 v3, s[56:59], s6 offen offset:256 lds
v_mfma_f32_16x16x32_bf16 v[236:239], v[208:211], a[148:151], v[236:239]
ds_read_b64_tr_b16 v[194:195], v16 offset:34816
ds_read_b64_tr_b16 v[196:197], v16 offset:45056
v_mfma_f32_16x16x32_bf16 v[236:239], v[212:215], a[156:159], v[236:239]
s_waitcnt lgkmcnt(7)
ds_read_b64_tr_b16 v[198:199], v16 offset:47104
v_mfma_f32_16x16x32_bf16 v[240:243], v[216:219], a[144:147], v[240:243]
ds_read_b64_tr_b16 v[200:201], v17 offset:32768
v_mfma_f32_16x16x32_bf16 v[240:243], v[220:223], a[152:155], v[240:243]
buffer_load_dwordx4 a[200:203], v8, s[12:15], s3 offen offset:1024 sc1
v_mfma_f32_16x16x32_bf16 v[244:247], v[216:219], a[148:151], v[244:247]
ds_read_b64_tr_b16 v[202:203], v17 offset:34816
ds_read_b64_tr_b16 v[204:205], v17 offset:45056
v_mfma_f32_16x16x32_bf16 v[244:247], v[220:223], a[156:159], v[244:247]
s_waitcnt lgkmcnt(7)
ds_read_b64_tr_b16 v[206:207], v17 offset:47104
v_mfma_f32_16x16x32_bf16 v[248:251], v[184:187], a[144:147], v[248:251]
s_add_u32 s6, s62, 414720
ds_read_b64_tr_b16 v[208:209], v18 offset:32768
v_mfma_f32_16x16x32_bf16 v[248:251], v[188:191], a[152:155], v[248:251]
buffer_load_dwordx4 a[204:207], v9, s[12:15], s3 offen offset:1024 sc1
v_mfma_f32_16x16x32_bf16 v[252:255], v[184:187], a[148:151], v[252:255]
ds_read_b64_tr_b16 v[210:211], v18 offset:34816
ds_read_b64_tr_b16 v[212:213], v18 offset:45056
v_mfma_f32_16x16x32_bf16 v[252:255], v[188:191], a[156:159], v[252:255]
s_waitcnt lgkmcnt(7)
ds_read_b64_tr_b16 v[214:215], v18 offset:47104
v_mfma_f32_16x16x32_bf16 v[88:91], v[192:195], a[144:147], v[88:91]
ds_read_b64_tr_b16 v[216:217], v19 offset:32768
v_mfma_f32_16x16x32_bf16 v[88:91], v[196:199], a[152:155], v[88:91]
ds_read_b64_tr_b16 v[218:219], v19 offset:34816
v_mfma_f32_16x16x32_bf16 v[92:95], v[192:195], a[148:151], v[92:95]
ds_read_b64_tr_b16 v[220:221], v19 offset:45056
v_mfma_f32_16x16x32_bf16 v[92:95], v[196:199], a[156:159], v[92:95]
s_waitcnt lgkmcnt(7)
ds_read_b64_tr_b16 v[222:223], v19 offset:47104
v_mfma_f32_16x16x32_bf16 v[96:99], v[200:203], a[144:147], v[96:99]
s_waitcnt vmcnt(20)
s_barrier
v_mfma_f32_16x16x32_bf16 v[96:99], v[204:207], a[152:155], v[96:99]
ds_read_b64_tr_b16 v[184:185], v20 offset:0
v_mfma_f32_16x16x32_bf16 v[100:103], v[200:203], a[148:151], v[100:103]
ds_read_b64_tr_b16 v[186:187], v20 offset:2048
ds_read_b64_tr_b16 v[188:189], v20 offset:12288
v_mfma_f32_16x16x32_bf16 v[100:103], v[204:207], a[156:159], v[100:103]
s_waitcnt lgkmcnt(7)
ds_read_b64_tr_b16 v[190:191], v20 offset:14336
v_mfma_f32_16x16x32_bf16 v[104:107], v[208:211], a[144:147], v[104:107]
s_add_u32 m0, s17, 24576
ds_read_b64_tr_b16 v[192:193], v21 offset:0
v_mfma_f32_16x16x32_bf16 v[104:107], v[212:215], a[152:155], v[104:107]
buffer_load_dwordx4 v3, s[56:59], s6 offen offset:0 lds
v_mfma_f32_16x16x32_bf16 v[108:111], v[208:211], a[148:151], v[108:111]
ds_read_b64_tr_b16 v[194:195], v21 offset:2048
ds_read_b64_tr_b16 v[196:197], v21 offset:12288
v_mfma_f32_16x16x32_bf16 v[108:111], v[212:215], a[156:159], v[108:111]
s_waitcnt lgkmcnt(7)
ds_read_b64_tr_b16 v[198:199], v21 offset:14336
v_mfma_f32_16x16x32_bf16 v[112:115], v[216:219], a[144:147], v[112:115]
s_add_u32 m0, s17, 28544
ds_read_b64_tr_b16 v[200:201], v22 offset:0
v_mfma_f32_16x16x32_bf16 v[112:115], v[220:223], a[152:155], v[112:115]
buffer_load_dwordx4 v3, s[56:59], s6 offen offset:128 lds
v_mfma_f32_16x16x32_bf16 v[116:119], v[216:219], a[148:151], v[116:119]
ds_read_b64_tr_b16 v[202:203], v22 offset:2048
ds_read_b64_tr_b16 v[204:205], v22 offset:12288
v_mfma_f32_16x16x32_bf16 v[116:119], v[220:223], a[156:159], v[116:119]
s_waitcnt lgkmcnt(7)
ds_read_b64_tr_b16 v[206:207], v22 offset:14336
v_mfma_f32_16x16x32_bf16 v[56:59], v[184:187], a[160:163], v[56:59]
s_add_u32 m0, s17, 32512
ds_read_b64_tr_b16 v[208:209], v23 offset:0
v_mfma_f32_16x16x32_bf16 v[56:59], v[188:191], a[168:171], v[56:59]
buffer_load_dwordx4 v3, s[56:59], s6 offen offset:256 lds
v_mfma_f32_16x16x32_bf16 v[60:63], v[184:187], a[164:167], v[60:63]
ds_read_b64_tr_b16 v[210:211], v23 offset:2048
ds_read_b64_tr_b16 v[212:213], v23 offset:12288
v_mfma_f32_16x16x32_bf16 v[60:63], v[188:191], a[172:175], v[60:63]
s_waitcnt lgkmcnt(7)
ds_read_b64_tr_b16 v[214:215], v23 offset:14336
v_mfma_f32_16x16x32_bf16 v[64:67], v[192:195], a[160:163], v[64:67]
s_add_u32 s3, s60, 157696
ds_read_b64_tr_b16 v[216:217], v20 offset:4096
v_mfma_f32_16x16x32_bf16 v[64:67], v[196:199], a[168:171], v[64:67]
buffer_load_dwordx4 a[208:211], v8, s[12:15], s3 offen offset:0 sc1
v_mfma_f32_16x16x32_bf16 v[68:71], v[192:195], a[164:167], v[68:71]
ds_read_b64_tr_b16 v[218:219], v20 offset:6144
ds_read_b64_tr_b16 v[220:221], v20 offset:16384
v_mfma_f32_16x16x32_bf16 v[68:71], v[196:199], a[172:175], v[68:71]
s_waitcnt lgkmcnt(7)
ds_read_b64_tr_b16 v[222:223], v20 offset:18432
v_mfma_f32_16x16x32_bf16 v[72:75], v[200:203], a[160:163], v[72:75]
s_add_u32 s6, s62, 451584
ds_read_b64_tr_b16 v[184:185], v21 offset:4096
v_mfma_f32_16x16x32_bf16 v[72:75], v[204:207], a[168:171], v[72:75]
buffer_load_dwordx4 a[212:215], v9, s[12:15], s3 offen offset:0 sc1
v_mfma_f32_16x16x32_bf16 v[76:79], v[200:203], a[164:167], v[76:79]
ds_read_b64_tr_b16 v[186:187], v21 offset:6144
ds_read_b64_tr_b16 v[188:189], v21 offset:16384
v_mfma_f32_16x16x32_bf16 v[76:79], v[204:207], a[172:175], v[76:79]
s_waitcnt lgkmcnt(7)
ds_read_b64_tr_b16 v[190:191], v21 offset:18432
v_mfma_f32_16x16x32_bf16 v[80:83], v[208:211], a[160:163], v[80:83]
s_add_u32 m0, s17, 36864
ds_read_b64_tr_b16 v[192:193], v22 offset:4096
v_mfma_f32_16x16x32_bf16 v[80:83], v[212:215], a[168:171], v[80:83]
buffer_load_dwordx4 v3, s[56:59], s6 offen offset:0 lds
v_mfma_f32_16x16x32_bf16 v[84:87], v[208:211], a[164:167], v[84:87]
ds_read_b64_tr_b16 v[194:195], v22 offset:6144
ds_read_b64_tr_b16 v[196:197], v22 offset:16384
v_mfma_f32_16x16x32_bf16 v[84:87], v[212:215], a[172:175], v[84:87]
s_waitcnt lgkmcnt(7)
ds_read_b64_tr_b16 v[198:199], v22 offset:18432
v_mfma_f32_16x16x32_bf16 v[224:227], v[216:219], a[160:163], v[224:227]
s_add_u32 m0, s17, 40832
ds_read_b64_tr_b16 v[200:201], v23 offset:4096
v_mfma_f32_16x16x32_bf16 v[224:227], v[220:223], a[168:171], v[224:227]
buffer_load_dwordx4 v3, s[56:59], s6 offen offset:128 lds
v_mfma_f32_16x16x32_bf16 v[228:231], v[216:219], a[164:167], v[228:231]
ds_read_b64_tr_b16 v[202:203], v23 offset:6144
ds_read_b64_tr_b16 v[204:205], v23 offset:16384
v_mfma_f32_16x16x32_bf16 v[228:231], v[220:223], a[172:175], v[228:231]
s_waitcnt lgkmcnt(7)
ds_read_b64_tr_b16 v[206:207], v23 offset:18432
v_mfma_f32_16x16x32_bf16 v[232:235], v[184:187], a[160:163], v[232:235]
s_add_u32 m0, s17, 44800
ds_read_b64_tr_b16 v[208:209], v20 offset:8192
v_mfma_f32_16x16x32_bf16 v[232:235], v[188:191], a[168:171], v[232:235]
buffer_load_dwordx4 v3, s[56:59], s6 offen offset:256 lds
v_mfma_f32_16x16x32_bf16 v[236:239], v[184:187], a[164:167], v[236:239]
ds_read_b64_tr_b16 v[210:211], v20 offset:10240
ds_read_b64_tr_b16 v[212:213], v20 offset:20480
v_mfma_f32_16x16x32_bf16 v[236:239], v[188:191], a[172:175], v[236:239]
s_waitcnt lgkmcnt(7)
ds_read_b64_tr_b16 v[214:215], v20 offset:22528
v_mfma_f32_16x16x32_bf16 v[240:243], v[192:195], a[160:163], v[240:243]
ds_read_b64_tr_b16 v[216:217], v21 offset:8192
v_mfma_f32_16x16x32_bf16 v[240:243], v[196:199], a[168:171], v[240:243]
buffer_load_dwordx4 a[216:219], v8, s[12:15], s3 offen offset:1024 sc1
v_mfma_f32_16x16x32_bf16 v[244:247], v[192:195], a[164:167], v[244:247]
ds_read_b64_tr_b16 v[218:219], v21 offset:10240
ds_read_b64_tr_b16 v[220:221], v21 offset:20480
v_mfma_f32_16x16x32_bf16 v[244:247], v[196:199], a[172:175], v[244:247]
s_waitcnt lgkmcnt(7)
ds_read_b64_tr_b16 v[222:223], v21 offset:22528
v_mfma_f32_16x16x32_bf16 v[248:251], v[200:203], a[160:163], v[248:251]
s_add_u32 s6, s62, 497664
ds_read_b64_tr_b16 v[184:185], v22 offset:8192
v_mfma_f32_16x16x32_bf16 v[248:251], v[204:207], a[168:171], v[248:251]
buffer_load_dwordx4 a[220:223], v9, s[12:15], s3 offen offset:1024 sc1
v_mfma_f32_16x16x32_bf16 v[252:255], v[200:203], a[164:167], v[252:255]
ds_read_b64_tr_b16 v[186:187], v22 offset:10240
ds_read_b64_tr_b16 v[188:189], v22 offset:20480
v_mfma_f32_16x16x32_bf16 v[252:255], v[204:207], a[172:175], v[252:255]
s_waitcnt lgkmcnt(7)
ds_read_b64_tr_b16 v[190:191], v22 offset:22528
v_mfma_f32_16x16x32_bf16 v[88:91], v[208:211], a[160:163], v[88:91]
ds_read_b64_tr_b16 v[192:193], v23 offset:8192
v_mfma_f32_16x16x32_bf16 v[88:91], v[212:215], a[168:171], v[88:91]
ds_read_b64_tr_b16 v[194:195], v23 offset:10240
v_mfma_f32_16x16x32_bf16 v[92:95], v[208:211], a[164:167], v[92:95]
ds_read_b64_tr_b16 v[196:197], v23 offset:20480
v_mfma_f32_16x16x32_bf16 v[92:95], v[212:215], a[172:175], v[92:95]
s_waitcnt lgkmcnt(7)
ds_read_b64_tr_b16 v[198:199], v23 offset:22528
v_mfma_f32_16x16x32_bf16 v[96:99], v[216:219], a[160:163], v[96:99]
s_waitcnt vmcnt(20)
s_barrier
v_mfma_f32_16x16x32_bf16 v[96:99], v[220:223], a[168:171], v[96:99]
ds_read_b64_tr_b16 v[200:201], v20 offset:24576
v_mfma_f32_16x16x32_bf16 v[100:103], v[216:219], a[164:167], v[100:103]
ds_read_b64_tr_b16 v[202:203], v20 offset:26624
ds_read_b64_tr_b16 v[204:205], v20 offset:36864
v_mfma_f32_16x16x32_bf16 v[100:103], v[220:223], a[172:175], v[100:103]
s_waitcnt lgkmcnt(7)
ds_read_b64_tr_b16 v[206:207], v20 offset:38912
v_mfma_f32_16x16x32_bf16 v[104:107], v[184:187], a[160:163], v[104:107]
s_add_u32 m0, s17, 49152
ds_read_b64_tr_b16 v[208:209], v21 offset:24576
v_mfma_f32_16x16x32_bf16 v[104:107], v[188:191], a[168:171], v[104:107]
buffer_load_dwordx4 v3, s[56:59], s6 offen offset:0 lds
v_mfma_f32_16x16x32_bf16 v[108:111], v[184:187], a[164:167], v[108:111]
ds_read_b64_tr_b16 v[210:211], v21 offset:26624
ds_read_b64_tr_b16 v[212:213], v21 offset:36864
v_mfma_f32_16x16x32_bf16 v[108:111], v[188:191], a[172:175], v[108:111]
s_waitcnt lgkmcnt(7)
ds_read_b64_tr_b16 v[214:215], v21 offset:38912
v_mfma_f32_16x16x32_bf16 v[112:115], v[192:195], a[160:163], v[112:115]
s_add_u32 m0, s17, 53120
ds_read_b64_tr_b16 v[216:217], v22 offset:24576
v_mfma_f32_16x16x32_bf16 v[112:115], v[196:199], a[168:171], v[112:115]
buffer_load_dwordx4 v3, s[56:59], s6 offen offset:128 lds
v_mfma_f32_16x16x32_bf16 v[116:119], v[192:195], a[164:167], v[116:119]
ds_read_b64_tr_b16 v[218:219], v22 offset:26624
ds_read_b64_tr_b16 v[220:221], v22 offset:36864
v_mfma_f32_16x16x32_bf16 v[116:119], v[196:199], a[172:175], v[116:119]
s_waitcnt lgkmcnt(7)
ds_read_b64_tr_b16 v[222:223], v22 offset:38912
v_mfma_f32_16x16x32_bf16 v[56:59], v[200:203], a[176:179], v[56:59]
s_add_u32 m0, s17, 57088
ds_read_b64_tr_b16 v[184:185], v23 offset:24576
v_mfma_f32_16x16x32_bf16 v[56:59], v[204:207], a[184:187], v[56:59]
buffer_load_dwordx4 v3, s[56:59], s6 offen offset:256 lds
v_mfma_f32_16x16x32_bf16 v[60:63], v[200:203], a[180:183], v[60:63]
ds_read_b64_tr_b16 v[186:187], v23 offset:26624
ds_read_b64_tr_b16 v[188:189], v23 offset:36864
v_mfma_f32_16x16x32_bf16 v[60:63], v[204:207], a[188:191], v[60:63]
s_waitcnt lgkmcnt(7)
ds_read_b64_tr_b16 v[190:191], v23 offset:38912
v_mfma_f32_16x16x32_bf16 v[64:67], v[208:211], a[176:179], v[64:67]
s_add_u32 s3, s60, 159744
ds_read_b64_tr_b16 v[192:193], v20 offset:28672
v_mfma_f32_16x16x32_bf16 v[64:67], v[212:215], a[184:187], v[64:67]
buffer_load_dwordx4 a[224:227], v8, s[12:15], s3 offen offset:0 sc1
v_mfma_f32_16x16x32_bf16 v[68:71], v[208:211], a[180:183], v[68:71]
ds_read_b64_tr_b16 v[194:195], v20 offset:30720
ds_read_b64_tr_b16 v[196:197], v20 offset:40960
v_mfma_f32_16x16x32_bf16 v[68:71], v[212:215], a[188:191], v[68:71]
s_waitcnt lgkmcnt(7)
ds_read_b64_tr_b16 v[198:199], v20 offset:43008
v_mfma_f32_16x16x32_bf16 v[72:75], v[216:219], a[176:179], v[72:75]
s_add_u32 s6, s62, 534528
ds_read_b64_tr_b16 v[200:201], v21 offset:28672
v_mfma_f32_16x16x32_bf16 v[72:75], v[220:223], a[184:187], v[72:75]
buffer_load_dwordx4 a[228:231], v9, s[12:15], s3 offen offset:0 sc1
v_mfma_f32_16x16x32_bf16 v[76:79], v[216:219], a[180:183], v[76:79]
ds_read_b64_tr_b16 v[202:203], v21 offset:30720
ds_read_b64_tr_b16 v[204:205], v21 offset:40960
v_mfma_f32_16x16x32_bf16 v[76:79], v[220:223], a[188:191], v[76:79]
s_waitcnt lgkmcnt(7)
ds_read_b64_tr_b16 v[206:207], v21 offset:43008
v_mfma_f32_16x16x32_bf16 v[80:83], v[184:187], a[176:179], v[80:83]
s_add_u32 m0, s17, 61440
ds_read_b64_tr_b16 v[208:209], v22 offset:28672
v_mfma_f32_16x16x32_bf16 v[80:83], v[188:191], a[184:187], v[80:83]
buffer_load_dwordx4 v3, s[56:59], s6 offen offset:0 lds
v_mfma_f32_16x16x32_bf16 v[84:87], v[184:187], a[180:183], v[84:87]
ds_read_b64_tr_b16 v[210:211], v22 offset:30720
ds_read_b64_tr_b16 v[212:213], v22 offset:40960
v_mfma_f32_16x16x32_bf16 v[84:87], v[188:191], a[188:191], v[84:87]
s_waitcnt lgkmcnt(7)
ds_read_b64_tr_b16 v[214:215], v22 offset:43008
v_mfma_f32_16x16x32_bf16 v[224:227], v[192:195], a[176:179], v[224:227]
s_add_u32 m0, s17, 65408
ds_read_b64_tr_b16 v[216:217], v23 offset:28672
v_mfma_f32_16x16x32_bf16 v[224:227], v[196:199], a[184:187], v[224:227]
buffer_load_dwordx4 v3, s[56:59], s6 offen offset:128 lds
v_mfma_f32_16x16x32_bf16 v[228:231], v[192:195], a[180:183], v[228:231]
ds_read_b64_tr_b16 v[218:219], v23 offset:30720
ds_read_b64_tr_b16 v[220:221], v23 offset:40960
v_mfma_f32_16x16x32_bf16 v[228:231], v[196:199], a[188:191], v[228:231]
s_waitcnt lgkmcnt(7)
ds_read_b64_tr_b16 v[222:223], v23 offset:43008
v_mfma_f32_16x16x32_bf16 v[232:235], v[200:203], a[176:179], v[232:235]
s_add_u32 m0, s17, 69376
ds_read_b64_tr_b16 v[184:185], v20 offset:32768
v_mfma_f32_16x16x32_bf16 v[232:235], v[204:207], a[184:187], v[232:235]
buffer_load_dwordx4 v3, s[56:59], s6 offen offset:256 lds
v_mfma_f32_16x16x32_bf16 v[236:239], v[200:203], a[180:183], v[236:239]
ds_read_b64_tr_b16 v[186:187], v20 offset:34816
ds_read_b64_tr_b16 v[188:189], v20 offset:45056
v_mfma_f32_16x16x32_bf16 v[236:239], v[204:207], a[188:191], v[236:239]
s_waitcnt lgkmcnt(7)
ds_read_b64_tr_b16 v[190:191], v20 offset:47104
v_mfma_f32_16x16x32_bf16 v[240:243], v[208:211], a[176:179], v[240:243]
ds_read_b64_tr_b16 v[192:193], v21 offset:32768
v_mfma_f32_16x16x32_bf16 v[240:243], v[212:215], a[184:187], v[240:243]
buffer_load_dwordx4 a[232:235], v8, s[12:15], s3 offen offset:1024 sc1
v_mfma_f32_16x16x32_bf16 v[244:247], v[208:211], a[180:183], v[244:247]
ds_read_b64_tr_b16 v[194:195], v21 offset:34816
ds_read_b64_tr_b16 v[196:197], v21 offset:45056
v_mfma_f32_16x16x32_bf16 v[244:247], v[212:215], a[188:191], v[244:247]
s_waitcnt lgkmcnt(7)
ds_read_b64_tr_b16 v[198:199], v21 offset:47104
v_mfma_f32_16x16x32_bf16 v[248:251], v[216:219], a[176:179], v[248:251]
s_add_u32 s6, s62, 580608
ds_read_b64_tr_b16 v[200:201], v22 offset:32768
v_mfma_f32_16x16x32_bf16 v[248:251], v[220:223], a[184:187], v[248:251]
buffer_load_dwordx4 a[236:239], v9, s[12:15], s3 offen offset:1024 sc1
v_mfma_f32_16x16x32_bf16 v[252:255], v[216:219], a[180:183], v[252:255]
ds_read_b64_tr_b16 v[202:203], v22 offset:34816
ds_read_b64_tr_b16 v[204:205], v22 offset:45056
v_mfma_f32_16x16x32_bf16 v[252:255], v[220:223], a[188:191], v[252:255]
s_waitcnt lgkmcnt(7)
ds_read_b64_tr_b16 v[206:207], v22 offset:47104
v_mfma_f32_16x16x32_bf16 v[88:91], v[184:187], a[176:179], v[88:91]
ds_read_b64_tr_b16 v[208:209], v23 offset:32768
v_mfma_f32_16x16x32_bf16 v[88:91], v[188:191], a[184:187], v[88:91]
ds_read_b64_tr_b16 v[210:211], v23 offset:34816
v_mfma_f32_16x16x32_bf16 v[92:95], v[184:187], a[180:183], v[92:95]
ds_read_b64_tr_b16 v[212:213], v23 offset:45056
v_mfma_f32_16x16x32_bf16 v[92:95], v[188:191], a[188:191], v[92:95]
s_waitcnt lgkmcnt(7)
ds_read_b64_tr_b16 v[214:215], v23 offset:47104
v_mfma_f32_16x16x32_bf16 v[96:99], v[192:195], a[176:179], v[96:99]
s_waitcnt vmcnt(20)
s_barrier
v_mfma_f32_16x16x32_bf16 v[96:99], v[196:199], a[184:187], v[96:99]
ds_read_b64_tr_b16 v[216:217], v12 offset:0
v_mfma_f32_16x16x32_bf16 v[100:103], v[192:195], a[180:183], v[100:103]
ds_read_b64_tr_b16 v[218:219], v12 offset:2048
ds_read_b64_tr_b16 v[220:221], v12 offset:12288
v_mfma_f32_16x16x32_bf16 v[100:103], v[196:199], a[188:191], v[100:103]
s_waitcnt lgkmcnt(7)
ds_read_b64_tr_b16 v[222:223], v12 offset:14336
v_mfma_f32_16x16x32_bf16 v[104:107], v[200:203], a[176:179], v[104:107]
s_add_u32 m0, s17, 73728
ds_read_b64_tr_b16 v[184:185], v13 offset:0
v_mfma_f32_16x16x32_bf16 v[104:107], v[204:207], a[184:187], v[104:107]
buffer_load_dwordx4 v3, s[56:59], s6 offen offset:0 lds
v_mfma_f32_16x16x32_bf16 v[108:111], v[200:203], a[180:183], v[108:111]
ds_read_b64_tr_b16 v[186:187], v13 offset:2048
ds_read_b64_tr_b16 v[188:189], v13 offset:12288
v_mfma_f32_16x16x32_bf16 v[108:111], v[204:207], a[188:191], v[108:111]
s_waitcnt lgkmcnt(7)
ds_read_b64_tr_b16 v[190:191], v13 offset:14336
v_mfma_f32_16x16x32_bf16 v[112:115], v[208:211], a[176:179], v[112:115]
s_add_u32 m0, s17, 77696
ds_read_b64_tr_b16 v[192:193], v14 offset:0
v_mfma_f32_16x16x32_bf16 v[112:115], v[212:215], a[184:187], v[112:115]
buffer_load_dwordx4 v3, s[56:59], s6 offen offset:128 lds
v_mfma_f32_16x16x32_bf16 v[116:119], v[208:211], a[180:183], v[116:119]
ds_read_b64_tr_b16 v[194:195], v14 offset:2048
ds_read_b64_tr_b16 v[196:197], v14 offset:12288
v_mfma_f32_16x16x32_bf16 v[116:119], v[212:215], a[188:191], v[116:119]
s_waitcnt lgkmcnt(7)
ds_read_b64_tr_b16 v[198:199], v14 offset:14336
v_mfma_f32_16x16x32_bf16 v[56:59], v[216:219], a[192:195], v[56:59]
s_add_u32 m0, s17, 81664
ds_read_b64_tr_b16 v[200:201], v15 offset:0
v_mfma_f32_16x16x32_bf16 v[56:59], v[220:223], a[200:203], v[56:59]
buffer_load_dwordx4 v3, s[56:59], s6 offen offset:256 lds
v_mfma_f32_16x16x32_bf16 v[60:63], v[216:219], a[196:199], v[60:63]
ds_read_b64_tr_b16 v[202:203], v15 offset:2048
ds_read_b64_tr_b16 v[204:205], v15 offset:12288
v_mfma_f32_16x16x32_bf16 v[60:63], v[220:223], a[204:207], v[60:63]
s_waitcnt lgkmcnt(7)
ds_read_b64_tr_b16 v[206:207], v15 offset:14336
v_mfma_f32_16x16x32_bf16 v[64:67], v[184:187], a[192:195], v[64:67]
s_add_u32 s3, s60, 161792
ds_read_b64_tr_b16 v[208:209], v12 offset:4096
v_mfma_f32_16x16x32_bf16 v[64:67], v[188:191], a[200:203], v[64:67]
buffer_load_dwordx4 a[240:243], v8, s[12:15], s3 offen offset:0 sc1
v_mfma_f32_16x16x32_bf16 v[68:71], v[184:187], a[196:199], v[68:71]
ds_read_b64_tr_b16 v[210:211], v12 offset:6144
ds_read_b64_tr_b16 v[212:213], v12 offset:16384
v_mfma_f32_16x16x32_bf16 v[68:71], v[188:191], a[204:207], v[68:71]
s_waitcnt lgkmcnt(7)
ds_read_b64_tr_b16 v[214:215], v12 offset:18432
v_mfma_f32_16x16x32_bf16 v[72:75], v[192:195], a[192:195], v[72:75]
s_add_u32 s6, s62, 617472
ds_read_b64_tr_b16 v[216:217], v13 offset:4096
v_mfma_f32_16x16x32_bf16 v[72:75], v[196:199], a[200:203], v[72:75]
buffer_load_dwordx4 a[244:247], v9, s[12:15], s3 offen offset:0 sc1
v_mfma_f32_16x16x32_bf16 v[76:79], v[192:195], a[196:199], v[76:79]
ds_read_b64_tr_b16 v[218:219], v13 offset:6144
ds_read_b64_tr_b16 v[220:221], v13 offset:16384
v_mfma_f32_16x16x32_bf16 v[76:79], v[196:199], a[204:207], v[76:79]
s_waitcnt lgkmcnt(7)
ds_read_b64_tr_b16 v[222:223], v13 offset:18432
v_mfma_f32_16x16x32_bf16 v[80:83], v[200:203], a[192:195], v[80:83]
s_add_u32 m0, s17, 86016
ds_read_b64_tr_b16 v[184:185], v14 offset:4096
v_mfma_f32_16x16x32_bf16 v[80:83], v[204:207], a[200:203], v[80:83]
buffer_load_dwordx4 v3, s[56:59], s6 offen offset:0 lds
v_mfma_f32_16x16x32_bf16 v[84:87], v[200:203], a[196:199], v[84:87]
ds_read_b64_tr_b16 v[186:187], v14 offset:6144
ds_read_b64_tr_b16 v[188:189], v14 offset:16384
v_mfma_f32_16x16x32_bf16 v[84:87], v[204:207], a[204:207], v[84:87]
s_waitcnt lgkmcnt(7)
ds_read_b64_tr_b16 v[190:191], v14 offset:18432
v_mfma_f32_16x16x32_bf16 v[224:227], v[208:211], a[192:195], v[224:227]
s_add_u32 m0, s17, 89984
ds_read_b64_tr_b16 v[192:193], v15 offset:4096
v_mfma_f32_16x16x32_bf16 v[224:227], v[212:215], a[200:203], v[224:227]
buffer_load_dwordx4 v3, s[56:59], s6 offen offset:128 lds
v_mfma_f32_16x16x32_bf16 v[228:231], v[208:211], a[196:199], v[228:231]
ds_read_b64_tr_b16 v[194:195], v15 offset:6144
ds_read_b64_tr_b16 v[196:197], v15 offset:16384
v_mfma_f32_16x16x32_bf16 v[228:231], v[212:215], a[204:207], v[228:231]
s_waitcnt lgkmcnt(7)
ds_read_b64_tr_b16 v[198:199], v15 offset:18432
v_mfma_f32_16x16x32_bf16 v[232:235], v[216:219], a[192:195], v[232:235]
s_add_u32 m0, s17, 93952
ds_read_b64_tr_b16 v[200:201], v12 offset:8192
v_mfma_f32_16x16x32_bf16 v[232:235], v[220:223], a[200:203], v[232:235]
buffer_load_dwordx4 v3, s[56:59], s6 offen offset:256 lds
v_mfma_f32_16x16x32_bf16 v[236:239], v[216:219], a[196:199], v[236:239]
ds_read_b64_tr_b16 v[202:203], v12 offset:10240
ds_read_b64_tr_b16 v[204:205], v12 offset:20480
v_mfma_f32_16x16x32_bf16 v[236:239], v[220:223], a[204:207], v[236:239]
s_waitcnt lgkmcnt(7)
ds_read_b64_tr_b16 v[206:207], v12 offset:22528
v_mfma_f32_16x16x32_bf16 v[240:243], v[184:187], a[192:195], v[240:243]
ds_read_b64_tr_b16 v[208:209], v13 offset:8192
v_mfma_f32_16x16x32_bf16 v[240:243], v[188:191], a[200:203], v[240:243]
buffer_load_dwordx4 a[248:251], v8, s[12:15], s3 offen offset:1024 sc1
v_mfma_f32_16x16x32_bf16 v[244:247], v[184:187], a[196:199], v[244:247]
ds_read_b64_tr_b16 v[210:211], v13 offset:10240
ds_read_b64_tr_b16 v[212:213], v13 offset:20480
v_mfma_f32_16x16x32_bf16 v[244:247], v[188:191], a[204:207], v[244:247]
s_waitcnt lgkmcnt(7)
ds_read_b64_tr_b16 v[214:215], v13 offset:22528
v_mfma_f32_16x16x32_bf16 v[248:251], v[192:195], a[192:195], v[248:251]
s_add_u32 s6, s62, 0
ds_read_b64_tr_b16 v[216:217], v14 offset:8192
v_mfma_f32_16x16x32_bf16 v[248:251], v[196:199], a[200:203], v[248:251]
buffer_load_dwordx4 a[252:255], v9, s[12:15], s3 offen offset:1024 sc1
v_mfma_f32_16x16x32_bf16 v[252:255], v[192:195], a[196:199], v[252:255]
ds_read_b64_tr_b16 v[218:219], v14 offset:10240
ds_read_b64_tr_b16 v[220:221], v14 offset:20480
v_mfma_f32_16x16x32_bf16 v[252:255], v[196:199], a[204:207], v[252:255]
s_waitcnt lgkmcnt(7)
ds_read_b64_tr_b16 v[222:223], v14 offset:22528
v_mfma_f32_16x16x32_bf16 v[88:91], v[200:203], a[192:195], v[88:91]
ds_read_b64_tr_b16 v[184:185], v15 offset:8192
v_mfma_f32_16x16x32_bf16 v[88:91], v[204:207], a[200:203], v[88:91]
ds_read_b64_tr_b16 v[186:187], v15 offset:10240
v_mfma_f32_16x16x32_bf16 v[92:95], v[200:203], a[196:199], v[92:95]
ds_read_b64_tr_b16 v[188:189], v15 offset:20480
v_mfma_f32_16x16x32_bf16 v[92:95], v[204:207], a[204:207], v[92:95]
s_waitcnt lgkmcnt(7)
ds_read_b64_tr_b16 v[190:191], v15 offset:22528
v_mfma_f32_16x16x32_bf16 v[96:99], v[208:211], a[192:195], v[96:99]
s_waitcnt vmcnt(20)
s_barrier
v_mfma_f32_16x16x32_bf16 v[96:99], v[212:215], a[200:203], v[96:99]
ds_read_b64_tr_b16 v[192:193], v12 offset:24576
v_mfma_f32_16x16x32_bf16 v[100:103], v[208:211], a[196:199], v[100:103]
ds_read_b64_tr_b16 v[194:195], v12 offset:26624
ds_read_b64_tr_b16 v[196:197], v12 offset:36864
v_mfma_f32_16x16x32_bf16 v[100:103], v[212:215], a[204:207], v[100:103]
s_waitcnt lgkmcnt(7)
ds_read_b64_tr_b16 v[198:199], v12 offset:38912
v_mfma_f32_16x16x32_bf16 v[104:107], v[216:219], a[192:195], v[104:107]
s_add_u32 m0, s17, 98304
ds_read_b64_tr_b16 v[200:201], v13 offset:24576
v_mfma_f32_16x16x32_bf16 v[104:107], v[220:223], a[200:203], v[104:107]
buffer_load_dwordx4 v48, s[56:59], s6 offen offset:0 lds
v_mfma_f32_16x16x32_bf16 v[108:111], v[216:219], a[196:199], v[108:111]
ds_read_b64_tr_b16 v[202:203], v13 offset:26624
ds_read_b64_tr_b16 v[204:205], v13 offset:36864
v_mfma_f32_16x16x32_bf16 v[108:111], v[220:223], a[204:207], v[108:111]
s_waitcnt lgkmcnt(7)
ds_read_b64_tr_b16 v[206:207], v13 offset:38912
v_mfma_f32_16x16x32_bf16 v[112:115], v[184:187], a[192:195], v[112:115]
s_add_u32 m0, s17, 102272
ds_read_b64_tr_b16 v[208:209], v14 offset:24576
v_mfma_f32_16x16x32_bf16 v[112:115], v[188:191], a[200:203], v[112:115]
buffer_load_dwordx4 v48, s[56:59], s6 offen offset:128 lds
v_mfma_f32_16x16x32_bf16 v[116:119], v[184:187], a[196:199], v[116:119]
ds_read_b64_tr_b16 v[210:211], v14 offset:26624
ds_read_b64_tr_b16 v[212:213], v14 offset:36864
v_mfma_f32_16x16x32_bf16 v[116:119], v[188:191], a[204:207], v[116:119]
s_waitcnt lgkmcnt(7)
ds_read_b64_tr_b16 v[214:215], v14 offset:38912
v_mfma_f32_16x16x32_bf16 v[56:59], v[192:195], a[208:211], v[56:59]
s_add_u32 m0, s17, 106240
ds_read_b64_tr_b16 v[216:217], v15 offset:24576
v_mfma_f32_16x16x32_bf16 v[56:59], v[196:199], a[216:219], v[56:59]
buffer_load_dwordx4 v48, s[56:59], s6 offen offset:256 lds
v_mfma_f32_16x16x32_bf16 v[60:63], v[192:195], a[212:215], v[60:63]
ds_read_b64_tr_b16 v[218:219], v15 offset:26624
ds_read_b64_tr_b16 v[220:221], v15 offset:36864
v_mfma_f32_16x16x32_bf16 v[60:63], v[196:199], a[220:223], v[60:63]
s_waitcnt lgkmcnt(7)
ds_read_b64_tr_b16 v[222:223], v15 offset:38912
v_mfma_f32_16x16x32_bf16 v[64:67], v[200:203], a[208:211], v[64:67]
s_add_u32 s3, s60, 163840
ds_read_b64_tr_b16 v[184:185], v12 offset:28672
v_mfma_f32_16x16x32_bf16 v[64:67], v[204:207], a[216:219], v[64:67]
buffer_load_dwordx4 a[0:3], v8, s[12:15], s3 offen offset:0 sc1
v_mfma_f32_16x16x32_bf16 v[68:71], v[200:203], a[212:215], v[68:71]
ds_read_b64_tr_b16 v[186:187], v12 offset:30720
ds_read_b64_tr_b16 v[188:189], v12 offset:40960
v_mfma_f32_16x16x32_bf16 v[68:71], v[204:207], a[220:223], v[68:71]
s_waitcnt lgkmcnt(7)
ds_read_b64_tr_b16 v[190:191], v12 offset:43008
v_mfma_f32_16x16x32_bf16 v[72:75], v[208:211], a[208:211], v[72:75]
s_add_u32 s6, s62, 331776
ds_read_b64_tr_b16 v[192:193], v13 offset:28672
v_mfma_f32_16x16x32_bf16 v[72:75], v[212:215], a[216:219], v[72:75]
buffer_load_dwordx4 a[4:7], v9, s[12:15], s3 offen offset:0 sc1
v_mfma_f32_16x16x32_bf16 v[76:79], v[208:211], a[212:215], v[76:79]
ds_read_b64_tr_b16 v[194:195], v13 offset:30720
ds_read_b64_tr_b16 v[196:197], v13 offset:40960
v_mfma_f32_16x16x32_bf16 v[76:79], v[212:215], a[220:223], v[76:79]
s_waitcnt lgkmcnt(7)
ds_read_b64_tr_b16 v[198:199], v13 offset:43008
v_mfma_f32_16x16x32_bf16 v[80:83], v[216:219], a[208:211], v[80:83]
s_add_u32 m0, s17, 110592
ds_read_b64_tr_b16 v[200:201], v14 offset:28672
v_mfma_f32_16x16x32_bf16 v[80:83], v[220:223], a[216:219], v[80:83]
buffer_load_dwordx4 v48, s[56:59], s6 offen offset:0 lds
v_mfma_f32_16x16x32_bf16 v[84:87], v[216:219], a[212:215], v[84:87]
ds_read_b64_tr_b16 v[202:203], v14 offset:30720
ds_read_b64_tr_b16 v[204:205], v14 offset:40960
v_mfma_f32_16x16x32_bf16 v[84:87], v[220:223], a[220:223], v[84:87]
s_waitcnt lgkmcnt(7)
ds_read_b64_tr_b16 v[206:207], v14 offset:43008
v_mfma_f32_16x16x32_bf16 v[224:227], v[184:187], a[208:211], v[224:227]
s_add_u32 m0, s17, 114560
ds_read_b64_tr_b16 v[208:209], v15 offset:28672
v_mfma_f32_16x16x32_bf16 v[224:227], v[188:191], a[216:219], v[224:227]
buffer_load_dwordx4 v48, s[56:59], s6 offen offset:128 lds
v_mfma_f32_16x16x32_bf16 v[228:231], v[184:187], a[212:215], v[228:231]
ds_read_b64_tr_b16 v[210:211], v15 offset:30720
ds_read_b64_tr_b16 v[212:213], v15 offset:40960
v_mfma_f32_16x16x32_bf16 v[228:231], v[188:191], a[220:223], v[228:231]
s_waitcnt lgkmcnt(7)
ds_read_b64_tr_b16 v[214:215], v15 offset:43008
v_mfma_f32_16x16x32_bf16 v[232:235], v[192:195], a[208:211], v[232:235]
s_add_u32 m0, s17, 118528
ds_read_b64_tr_b16 v[216:217], v12 offset:32768
v_mfma_f32_16x16x32_bf16 v[232:235], v[196:199], a[216:219], v[232:235]
buffer_load_dwordx4 v48, s[56:59], s6 offen offset:256 lds
v_mfma_f32_16x16x32_bf16 v[236:239], v[192:195], a[212:215], v[236:239]
ds_read_b64_tr_b16 v[218:219], v12 offset:34816
ds_read_b64_tr_b16 v[220:221], v12 offset:45056
v_mfma_f32_16x16x32_bf16 v[236:239], v[196:199], a[220:223], v[236:239]
s_waitcnt lgkmcnt(7)
ds_read_b64_tr_b16 v[222:223], v12 offset:47104
v_mfma_f32_16x16x32_bf16 v[240:243], v[200:203], a[208:211], v[240:243]
ds_read_b64_tr_b16 v[184:185], v13 offset:32768
v_mfma_f32_16x16x32_bf16 v[240:243], v[204:207], a[216:219], v[240:243]
buffer_load_dwordx4 a[8:11], v8, s[12:15], s3 offen offset:1024 sc1
v_mfma_f32_16x16x32_bf16 v[244:247], v[200:203], a[212:215], v[244:247]
ds_read_b64_tr_b16 v[186:187], v13 offset:34816
ds_read_b64_tr_b16 v[188:189], v13 offset:45056
v_mfma_f32_16x16x32_bf16 v[244:247], v[204:207], a[220:223], v[244:247]
s_waitcnt lgkmcnt(7)
ds_read_b64_tr_b16 v[190:191], v13 offset:47104
v_mfma_f32_16x16x32_bf16 v[248:251], v[208:211], a[208:211], v[248:251]
ds_read_b64_tr_b16 v[192:193], v14 offset:32768
v_mfma_f32_16x16x32_bf16 v[248:251], v[212:215], a[216:219], v[248:251]
buffer_load_dwordx4 a[12:15], v9, s[12:15], s3 offen offset:1024 sc1
v_mfma_f32_16x16x32_bf16 v[252:255], v[208:211], a[212:215], v[252:255]
ds_read_b64_tr_b16 v[194:195], v14 offset:34816
ds_read_b64_tr_b16 v[196:197], v14 offset:45056
v_mfma_f32_16x16x32_bf16 v[252:255], v[212:215], a[220:223], v[252:255]
s_waitcnt lgkmcnt(7)
ds_read_b64_tr_b16 v[198:199], v14 offset:47104
v_mfma_f32_16x16x32_bf16 v[88:91], v[216:219], a[208:211], v[88:91]
ds_read_b64_tr_b16 v[200:201], v15 offset:32768
v_mfma_f32_16x16x32_bf16 v[88:91], v[220:223], a[216:219], v[88:91]
ds_read_b64_tr_b16 v[202:203], v15 offset:34816
v_mfma_f32_16x16x32_bf16 v[92:95], v[216:219], a[212:215], v[92:95]
ds_read_b64_tr_b16 v[204:205], v15 offset:45056
v_mfma_f32_16x16x32_bf16 v[92:95], v[220:223], a[220:223], v[92:95]
s_waitcnt lgkmcnt(7)
ds_read_b64_tr_b16 v[206:207], v15 offset:47104
v_mfma_f32_16x16x32_bf16 v[96:99], v[184:187], a[208:211], v[96:99]
s_waitcnt vmcnt(0)
s_barrier
v_mfma_f32_16x16x32_bf16 v[96:99], v[188:191], a[216:219], v[96:99]
ds_read_b64_tr_b16 v[208:209], v16 offset:0
v_mfma_f32_16x16x32_bf16 v[100:103], v[184:187], a[212:215], v[100:103]
ds_read_b64_tr_b16 v[210:211], v16 offset:2048
ds_read_b64_tr_b16 v[212:213], v16 offset:12288
v_mfma_f32_16x16x32_bf16 v[100:103], v[188:191], a[220:223], v[100:103]
s_waitcnt lgkmcnt(7)
ds_read_b64_tr_b16 v[214:215], v16 offset:14336
v_mfma_f32_16x16x32_bf16 v[104:107], v[192:195], a[208:211], v[104:107]
ds_read_b64_tr_b16 v[216:217], v16 offset:24576
v_mfma_f32_16x16x32_bf16 v[104:107], v[196:199], a[216:219], v[104:107]
ds_read_b64_tr_b16 v[218:219], v16 offset:26624
v_mfma_f32_16x16x32_bf16 v[108:111], v[192:195], a[212:215], v[108:111]
ds_read_b64_tr_b16 v[220:221], v16 offset:36864
v_mfma_f32_16x16x32_bf16 v[108:111], v[196:199], a[220:223], v[108:111]
s_waitcnt lgkmcnt(7)
ds_read_b64_tr_b16 v[222:223], v16 offset:38912
v_mfma_f32_16x16x32_bf16 v[112:115], v[200:203], a[208:211], v[112:115]
ds_read_b64_tr_b16 v[184:185], v20 offset:0
v_mfma_f32_16x16x32_bf16 v[112:115], v[204:207], a[216:219], v[112:115]
ds_read_b64_tr_b16 v[186:187], v20 offset:2048
v_mfma_f32_16x16x32_bf16 v[116:119], v[200:203], a[212:215], v[116:119]
ds_read_b64_tr_b16 v[188:189], v20 offset:12288
v_mfma_f32_16x16x32_bf16 v[116:119], v[204:207], a[220:223], v[116:119]
s_waitcnt lgkmcnt(7)
ds_read_b64_tr_b16 v[190:191], v20 offset:14336
v_mfma_f32_16x16x32_bf16 v[56:59], v[208:211], a[224:227], v[56:59]
ds_read_b64_tr_b16 v[192:193], v17 offset:0
v_mfma_f32_16x16x32_bf16 v[56:59], v[212:215], a[232:235], v[56:59]
ds_read_b64_tr_b16 v[194:195], v17 offset:2048
v_mfma_f32_16x16x32_bf16 v[60:63], v[208:211], a[228:231], v[60:63]
ds_read_b64_tr_b16 v[196:197], v17 offset:12288
v_mfma_f32_16x16x32_bf16 v[60:63], v[212:215], a[236:239], v[60:63]
s_waitcnt lgkmcnt(7)
ds_read_b64_tr_b16 v[198:199], v17 offset:14336
v_mfma_f32_16x16x32_bf16 v[56:59], v[216:219], a[240:243], v[56:59]
ds_read_b64_tr_b16 v[200:201], v17 offset:24576
v_mfma_f32_16x16x32_bf16 v[56:59], v[220:223], a[248:251], v[56:59]
ds_read_b64_tr_b16 v[202:203], v17 offset:26624
v_mfma_f32_16x16x32_bf16 v[60:63], v[216:219], a[244:247], v[60:63]
ds_read_b64_tr_b16 v[204:205], v17 offset:36864
v_mfma_f32_16x16x32_bf16 v[60:63], v[220:223], a[252:255], v[60:63]
s_waitcnt lgkmcnt(7)
ds_read_b64_tr_b16 v[206:207], v17 offset:38912
v_mfma_f32_16x16x32_bf16 v[56:59], v[184:187], a[0:3], v[56:59]
ds_read_b64_tr_b16 v[208:209], v21 offset:0
v_mfma_f32_16x16x32_bf16 v[56:59], v[188:191], a[8:11], v[56:59]
ds_read_b64_tr_b16 v[210:211], v21 offset:2048
v_mfma_f32_16x16x32_bf16 v[60:63], v[184:187], a[4:7], v[60:63]
ds_read_b64_tr_b16 v[212:213], v21 offset:12288
v_mfma_f32_16x16x32_bf16 v[60:63], v[188:191], a[12:15], v[60:63]
s_waitcnt lgkmcnt(7)
ds_read_b64_tr_b16 v[214:215], v21 offset:14336
v_mfma_f32_16x16x32_bf16 v[64:67], v[192:195], a[224:227], v[64:67]
ds_read_b64_tr_b16 v[216:217], v16 offset:4096
v_mfma_f32_16x16x32_bf16 v[64:67], v[196:199], a[232:235], v[64:67]
ds_read_b64_tr_b16 v[218:219], v16 offset:6144
v_mfma_f32_16x16x32_bf16 v[68:71], v[192:195], a[228:231], v[68:71]
ds_read_b64_tr_b16 v[220:221], v16 offset:16384
v_mfma_f32_16x16x32_bf16 v[68:71], v[196:199], a[236:239], v[68:71]
s_waitcnt lgkmcnt(7)
ds_read_b64_tr_b16 v[222:223], v16 offset:18432
v_mfma_f32_16x16x32_bf16 v[64:67], v[200:203], a[240:243], v[64:67]
ds_read_b64_tr_b16 v[184:185], v16 offset:28672
v_cvt_pk_bf16_f32 v120, v56, v57
v_mfma_f32_16x16x32_bf16 v[64:67], v[204:207], a[248:251], v[64:67]
ds_read_b64_tr_b16 v[186:187], v16 offset:30720
v_cvt_pk_bf16_f32 v121, v58, v59
v_mfma_f32_16x16x32_bf16 v[68:71], v[200:203], a[244:247], v[68:71]
ds_read_b64_tr_b16 v[188:189], v16 offset:40960
v_cvt_pk_bf16_f32 v136, v60, v61
v_mfma_f32_16x16x32_bf16 v[68:71], v[204:207], a[252:255], v[68:71]
s_waitcnt lgkmcnt(7)
ds_read_b64_tr_b16 v[190:191], v16 offset:43008
v_cvt_pk_bf16_f32 v137, v62, v63
v_mfma_f32_16x16x32_bf16 v[64:67], v[208:211], a[0:3], v[64:67]
ds_read_b64_tr_b16 v[192:193], v20 offset:4096
v_mfma_f32_16x16x32_bf16 v[64:67], v[212:215], a[8:11], v[64:67]
ds_read_b64_tr_b16 v[194:195], v20 offset:6144
v_mfma_f32_16x16x32_bf16 v[68:71], v[208:211], a[4:7], v[68:71]
ds_read_b64_tr_b16 v[196:197], v20 offset:16384
v_mfma_f32_16x16x32_bf16 v[68:71], v[212:215], a[12:15], v[68:71]
s_waitcnt lgkmcnt(7)
ds_read_b64_tr_b16 v[198:199], v20 offset:18432
v_mfma_f32_16x16x32_bf16 v[224:227], v[216:219], a[224:227], v[224:227]
ds_read_b64_tr_b16 v[200:201], v17 offset:4096
v_mfma_f32_16x16x32_bf16 v[224:227], v[220:223], a[232:235], v[224:227]
ds_read_b64_tr_b16 v[202:203], v17 offset:6144
v_mfma_f32_16x16x32_bf16 v[228:231], v[216:219], a[228:231], v[228:231]
ds_read_b64_tr_b16 v[204:205], v17 offset:16384
v_mfma_f32_16x16x32_bf16 v[228:231], v[220:223], a[236:239], v[228:231]
s_waitcnt lgkmcnt(7)
ds_read_b64_tr_b16 v[206:207], v17 offset:18432
v_mfma_f32_16x16x32_bf16 v[224:227], v[184:187], a[240:243], v[224:227]
ds_read_b64_tr_b16 v[208:209], v17 offset:28672
v_cvt_pk_bf16_f32 v122, v64, v65
v_mfma_f32_16x16x32_bf16 v[224:227], v[188:191], a[248:251], v[224:227]
ds_read_b64_tr_b16 v[210:211], v17 offset:30720
v_cvt_pk_bf16_f32 v123, v66, v67
v_mfma_f32_16x16x32_bf16 v[228:231], v[184:187], a[244:247], v[228:231]
ds_read_b64_tr_b16 v[212:213], v17 offset:40960
v_cvt_pk_bf16_f32 v138, v68, v69
v_mfma_f32_16x16x32_bf16 v[228:231], v[188:191], a[252:255], v[228:231]
s_waitcnt lgkmcnt(7)
ds_read_b64_tr_b16 v[214:215], v17 offset:43008
v_cvt_pk_bf16_f32 v139, v70, v71
v_mfma_f32_16x16x32_bf16 v[224:227], v[192:195], a[0:3], v[224:227]
ds_read_b64_tr_b16 v[216:217], v21 offset:4096
v_mfma_f32_16x16x32_bf16 v[224:227], v[196:199], a[8:11], v[224:227]
buffer_store_dwordx4 v[120:123], v4, s[12:15], s7 offen offset:0 sc1
v_mfma_f32_16x16x32_bf16 v[228:231], v[192:195], a[4:7], v[228:231]
ds_read_b64_tr_b16 v[218:219], v21 offset:6144
ds_read_b64_tr_b16 v[220:221], v21 offset:16384
v_mfma_f32_16x16x32_bf16 v[228:231], v[196:199], a[12:15], v[228:231]
s_waitcnt lgkmcnt(7)
ds_read_b64_tr_b16 v[222:223], v21 offset:18432
v_mfma_f32_16x16x32_bf16 v[232:235], v[200:203], a[224:227], v[232:235]
ds_read_b64_tr_b16 v[184:185], v16 offset:8192
v_mfma_f32_16x16x32_bf16 v[232:235], v[204:207], a[232:235], v[232:235]
buffer_store_dwordx4 v[136:139], v4, s[12:15], s52 offen offset:0 sc1
v_mfma_f32_16x16x32_bf16 v[236:239], v[200:203], a[228:231], v[236:239]
ds_read_b64_tr_b16 v[186:187], v16 offset:10240
ds_read_b64_tr_b16 v[188:189], v16 offset:20480
v_mfma_f32_16x16x32_bf16 v[236:239], v[204:207], a[236:239], v[236:239]
s_waitcnt lgkmcnt(7)
ds_read_b64_tr_b16 v[190:191], v16 offset:22528
v_mfma_f32_16x16x32_bf16 v[232:235], v[208:211], a[240:243], v[232:235]
ds_read_b64_tr_b16 v[192:193], v16 offset:32768
v_cvt_pk_bf16_f32 v124, v224, v225
v_mfma_f32_16x16x32_bf16 v[232:235], v[212:215], a[248:251], v[232:235]
ds_read_b64_tr_b16 v[194:195], v16 offset:34816
v_cvt_pk_bf16_f32 v125, v226, v227
v_mfma_f32_16x16x32_bf16 v[236:239], v[208:211], a[244:247], v[236:239]
ds_read_b64_tr_b16 v[196:197], v16 offset:45056
v_cvt_pk_bf16_f32 v140, v228, v229
v_mfma_f32_16x16x32_bf16 v[236:239], v[212:215], a[252:255], v[236:239]
s_waitcnt lgkmcnt(7)
ds_read_b64_tr_b16 v[198:199], v16 offset:47104
v_cvt_pk_bf16_f32 v141, v230, v231
v_mfma_f32_16x16x32_bf16 v[232:235], v[216:219], a[0:3], v[232:235]
ds_read_b64_tr_b16 v[200:201], v20 offset:8192
v_mfma_f32_16x16x32_bf16 v[232:235], v[220:223], a[8:11], v[232:235]
ds_read_b64_tr_b16 v[202:203], v20 offset:10240
v_mfma_f32_16x16x32_bf16 v[236:239], v[216:219], a[4:7], v[236:239]
ds_read_b64_tr_b16 v[204:205], v20 offset:20480
v_mfma_f32_16x16x32_bf16 v[236:239], v[220:223], a[12:15], v[236:239]
s_waitcnt lgkmcnt(7)
ds_read_b64_tr_b16 v[206:207], v20 offset:22528
v_mfma_f32_16x16x32_bf16 v[88:91], v[184:187], a[224:227], v[88:91]
ds_read_b64_tr_b16 v[208:209], v17 offset:8192
v_mfma_f32_16x16x32_bf16 v[88:91], v[188:191], a[232:235], v[88:91]
ds_read_b64_tr_b16 v[210:211], v17 offset:10240
v_mfma_f32_16x16x32_bf16 v[92:95], v[184:187], a[228:231], v[92:95]
ds_read_b64_tr_b16 v[212:213], v17 offset:20480
v_mfma_f32_16x16x32_bf16 v[92:95], v[188:191], a[236:239], v[92:95]
s_waitcnt lgkmcnt(7)
ds_read_b64_tr_b16 v[214:215], v17 offset:22528
v_mfma_f32_16x16x32_bf16 v[88:91], v[192:195], a[240:243], v[88:91]
ds_read_b64_tr_b16 v[216:217], v17 offset:32768
v_cvt_pk_bf16_f32 v126, v232, v233
v_mfma_f32_16x16x32_bf16 v[88:91], v[196:199], a[248:251], v[88:91]
ds_read_b64_tr_b16 v[218:219], v17 offset:34816
v_cvt_pk_bf16_f32 v127, v234, v235
v_mfma_f32_16x16x32_bf16 v[92:95], v[192:195], a[244:247], v[92:95]
ds_read_b64_tr_b16 v[220:221], v17 offset:45056
v_cvt_pk_bf16_f32 v142, v236, v237
v_mfma_f32_16x16x32_bf16 v[92:95], v[196:199], a[252:255], v[92:95]
s_waitcnt lgkmcnt(7)
ds_read_b64_tr_b16 v[222:223], v17 offset:47104
v_cvt_pk_bf16_f32 v143, v238, v239
v_mfma_f32_16x16x32_bf16 v[88:91], v[200:203], a[0:3], v[88:91]
ds_read_b64_tr_b16 v[184:185], v21 offset:8192
v_mfma_f32_16x16x32_bf16 v[88:91], v[204:207], a[8:11], v[88:91]
buffer_store_dwordx4 v[124:127], v4, s[12:15], s7 offen offset:1024 sc1
v_mfma_f32_16x16x32_bf16 v[92:95], v[200:203], a[4:7], v[92:95]
ds_read_b64_tr_b16 v[186:187], v21 offset:10240
ds_read_b64_tr_b16 v[188:189], v21 offset:20480
v_mfma_f32_16x16x32_bf16 v[92:95], v[204:207], a[12:15], v[92:95]
s_waitcnt lgkmcnt(7)
ds_read_b64_tr_b16 v[190:191], v21 offset:22528
v_mfma_f32_16x16x32_bf16 v[96:99], v[208:211], a[224:227], v[96:99]
ds_read_b64_tr_b16 v[192:193], v18 offset:0
v_mfma_f32_16x16x32_bf16 v[96:99], v[212:215], a[232:235], v[96:99]
buffer_store_dwordx4 v[140:143], v4, s[12:15], s52 offen offset:1024 sc1
v_mfma_f32_16x16x32_bf16 v[100:103], v[208:211], a[228:231], v[100:103]
ds_read_b64_tr_b16 v[194:195], v18 offset:2048
ds_read_b64_tr_b16 v[196:197], v18 offset:12288
v_mfma_f32_16x16x32_bf16 v[100:103], v[212:215], a[236:239], v[100:103]
s_waitcnt lgkmcnt(7)
ds_read_b64_tr_b16 v[198:199], v18 offset:14336
v_mfma_f32_16x16x32_bf16 v[96:99], v[216:219], a[240:243], v[96:99]
ds_read_b64_tr_b16 v[200:201], v18 offset:24576
v_cvt_pk_bf16_f32 v128, v88, v89
v_mfma_f32_16x16x32_bf16 v[96:99], v[220:223], a[248:251], v[96:99]
ds_read_b64_tr_b16 v[202:203], v18 offset:26624
v_cvt_pk_bf16_f32 v129, v90, v91
v_mfma_f32_16x16x32_bf16 v[100:103], v[216:219], a[244:247], v[100:103]
ds_read_b64_tr_b16 v[204:205], v18 offset:36864
v_cvt_pk_bf16_f32 v144, v92, v93
v_mfma_f32_16x16x32_bf16 v[100:103], v[220:223], a[252:255], v[100:103]
s_waitcnt lgkmcnt(7)
ds_read_b64_tr_b16 v[206:207], v18 offset:38912
v_cvt_pk_bf16_f32 v145, v94, v95
v_mfma_f32_16x16x32_bf16 v[96:99], v[184:187], a[0:3], v[96:99]
ds_read_b64_tr_b16 v[208:209], v22 offset:0
v_mfma_f32_16x16x32_bf16 v[96:99], v[188:191], a[8:11], v[96:99]
ds_read_b64_tr_b16 v[210:211], v22 offset:2048
v_mfma_f32_16x16x32_bf16 v[100:103], v[184:187], a[4:7], v[100:103]
ds_read_b64_tr_b16 v[212:213], v22 offset:12288
v_mfma_f32_16x16x32_bf16 v[100:103], v[188:191], a[12:15], v[100:103]
s_waitcnt lgkmcnt(7)
ds_read_b64_tr_b16 v[214:215], v22 offset:14336
v_mfma_f32_16x16x32_bf16 v[72:75], v[192:195], a[224:227], v[72:75]
ds_read_b64_tr_b16 v[216:217], v19 offset:0
v_mfma_f32_16x16x32_bf16 v[72:75], v[196:199], a[232:235], v[72:75]
ds_read_b64_tr_b16 v[218:219], v19 offset:2048
v_mfma_f32_16x16x32_bf16 v[76:79], v[192:195], a[228:231], v[76:79]
ds_read_b64_tr_b16 v[220:221], v19 offset:12288
v_mfma_f32_16x16x32_bf16 v[76:79], v[196:199], a[236:239], v[76:79]
s_waitcnt lgkmcnt(7)
ds_read_b64_tr_b16 v[222:223], v19 offset:14336
v_mfma_f32_16x16x32_bf16 v[72:75], v[200:203], a[240:243], v[72:75]
ds_read_b64_tr_b16 v[184:185], v19 offset:24576
v_cvt_pk_bf16_f32 v130, v96, v97
v_mfma_f32_16x16x32_bf16 v[72:75], v[204:207], a[248:251], v[72:75]
ds_read_b64_tr_b16 v[186:187], v19 offset:26624
v_cvt_pk_bf16_f32 v131, v98, v99
v_mfma_f32_16x16x32_bf16 v[76:79], v[200:203], a[244:247], v[76:79]
ds_read_b64_tr_b16 v[188:189], v19 offset:36864
v_cvt_pk_bf16_f32 v146, v100, v101
v_mfma_f32_16x16x32_bf16 v[76:79], v[204:207], a[252:255], v[76:79]
s_waitcnt lgkmcnt(7)
ds_read_b64_tr_b16 v[190:191], v19 offset:38912
v_cvt_pk_bf16_f32 v147, v102, v103
v_mfma_f32_16x16x32_bf16 v[72:75], v[208:211], a[0:3], v[72:75]
ds_read_b64_tr_b16 v[192:193], v23 offset:0
v_mfma_f32_16x16x32_bf16 v[72:75], v[212:215], a[8:11], v[72:75]
buffer_store_dwordx4 v[128:131], v4, s[12:15], s7 offen offset:2048 sc1
v_mfma_f32_16x16x32_bf16 v[76:79], v[208:211], a[4:7], v[76:79]
ds_read_b64_tr_b16 v[194:195], v23 offset:2048
ds_read_b64_tr_b16 v[196:197], v23 offset:12288
v_mfma_f32_16x16x32_bf16 v[76:79], v[212:215], a[12:15], v[76:79]
s_waitcnt lgkmcnt(7)
ds_read_b64_tr_b16 v[198:199], v23 offset:14336
v_mfma_f32_16x16x32_bf16 v[80:83], v[216:219], a[224:227], v[80:83]
ds_read_b64_tr_b16 v[200:201], v18 offset:4096
v_mfma_f32_16x16x32_bf16 v[80:83], v[220:223], a[232:235], v[80:83]
buffer_store_dwordx4 v[144:147], v4, s[12:15], s52 offen offset:2048 sc1
v_mfma_f32_16x16x32_bf16 v[84:87], v[216:219], a[228:231], v[84:87]
ds_read_b64_tr_b16 v[202:203], v18 offset:6144
ds_read_b64_tr_b16 v[204:205], v18 offset:16384
v_mfma_f32_16x16x32_bf16 v[84:87], v[220:223], a[236:239], v[84:87]
s_waitcnt lgkmcnt(7)
ds_read_b64_tr_b16 v[206:207], v18 offset:18432
v_mfma_f32_16x16x32_bf16 v[80:83], v[184:187], a[240:243], v[80:83]
ds_read_b64_tr_b16 v[208:209], v18 offset:28672
v_cvt_pk_bf16_f32 v152, v72, v73
v_mfma_f32_16x16x32_bf16 v[80:83], v[188:191], a[248:251], v[80:83]
ds_read_b64_tr_b16 v[210:211], v18 offset:30720
v_cvt_pk_bf16_f32 v153, v74, v75
v_mfma_f32_16x16x32_bf16 v[84:87], v[184:187], a[244:247], v[84:87]
ds_read_b64_tr_b16 v[212:213], v18 offset:40960
v_cvt_pk_bf16_f32 v168, v76, v77
v_mfma_f32_16x16x32_bf16 v[84:87], v[188:191], a[252:255], v[84:87]
s_waitcnt lgkmcnt(7)
ds_read_b64_tr_b16 v[214:215], v18 offset:43008
v_cvt_pk_bf16_f32 v169, v78, v79
v_mfma_f32_16x16x32_bf16 v[80:83], v[192:195], a[0:3], v[80:83]
ds_read_b64_tr_b16 v[216:217], v22 offset:4096
v_mfma_f32_16x16x32_bf16 v[80:83], v[196:199], a[8:11], v[80:83]
ds_read_b64_tr_b16 v[218:219], v22 offset:6144
v_mfma_f32_16x16x32_bf16 v[84:87], v[192:195], a[4:7], v[84:87]
ds_read_b64_tr_b16 v[220:221], v22 offset:16384
v_mfma_f32_16x16x32_bf16 v[84:87], v[196:199], a[12:15], v[84:87]
s_waitcnt lgkmcnt(7)
ds_read_b64_tr_b16 v[222:223], v22 offset:18432
v_mfma_f32_16x16x32_bf16 v[240:243], v[200:203], a[224:227], v[240:243]
ds_read_b64_tr_b16 v[184:185], v19 offset:4096
v_mfma_f32_16x16x32_bf16 v[240:243], v[204:207], a[232:235], v[240:243]
ds_read_b64_tr_b16 v[186:187], v19 offset:6144
v_mfma_f32_16x16x32_bf16 v[244:247], v[200:203], a[228:231], v[244:247]
ds_read_b64_tr_b16 v[188:189], v19 offset:16384
v_mfma_f32_16x16x32_bf16 v[244:247], v[204:207], a[236:239], v[244:247]
s_waitcnt lgkmcnt(7)
ds_read_b64_tr_b16 v[190:191], v19 offset:18432
v_mfma_f32_16x16x32_bf16 v[240:243], v[208:211], a[240:243], v[240:243]
ds_read_b64_tr_b16 v[192:193], v19 offset:28672
v_cvt_pk_bf16_f32 v154, v80, v81
v_mfma_f32_16x16x32_bf16 v[240:243], v[212:215], a[248:251], v[240:243]
ds_read_b64_tr_b16 v[194:195], v19 offset:30720
v_cvt_pk_bf16_f32 v155, v82, v83
v_mfma_f32_16x16x32_bf16 v[244:247], v[208:211], a[244:247], v[244:247]
ds_read_b64_tr_b16 v[196:197], v19 offset:40960
v_cvt_pk_bf16_f32 v170, v84, v85
v_mfma_f32_16x16x32_bf16 v[244:247], v[212:215], a[252:255], v[244:247]
s_waitcnt lgkmcnt(7)
ds_read_b64_tr_b16 v[198:199], v19 offset:43008
v_cvt_pk_bf16_f32 v171, v86, v87
v_mfma_f32_16x16x32_bf16 v[240:243], v[216:219], a[0:3], v[240:243]
ds_read_b64_tr_b16 v[200:201], v23 offset:4096
v_mfma_f32_16x16x32_bf16 v[240:243], v[220:223], a[8:11], v[240:243]
buffer_store_dwordx4 v[152:155], v4, s[12:15], s53 offen offset:0 sc1
v_mfma_f32_16x16x32_bf16 v[244:247], v[216:219], a[4:7], v[244:247]
ds_read_b64_tr_b16 v[202:203], v23 offset:6144
ds_read_b64_tr_b16 v[204:205], v23 offset:16384
v_mfma_f32_16x16x32_bf16 v[244:247], v[220:223], a[12:15], v[244:247]
s_waitcnt lgkmcnt(7)
ds_read_b64_tr_b16 v[206:207], v23 offset:18432
v_mfma_f32_16x16x32_bf16 v[248:251], v[184:187], a[224:227], v[248:251]
ds_read_b64_tr_b16 v[208:209], v18 offset:8192
v_mfma_f32_16x16x32_bf16 v[248:251], v[188:191], a[232:235], v[248:251]
buffer_store_dwordx4 v[168:171], v4, s[12:15], s79 offen offset:0 sc1
v_mfma_f32_16x16x32_bf16 v[252:255], v[184:187], a[228:231], v[252:255]
ds_read_b64_tr_b16 v[210:211], v18 offset:10240
ds_read_b64_tr_b16 v[212:213], v18 offset:20480
v_mfma_f32_16x16x32_bf16 v[252:255], v[188:191], a[236:239], v[252:255]
s_waitcnt lgkmcnt(7)
ds_read_b64_tr_b16 v[214:215], v18 offset:22528
v_mfma_f32_16x16x32_bf16 v[248:251], v[192:195], a[240:243], v[248:251]
ds_read_b64_tr_b16 v[216:217], v18 offset:32768
v_cvt_pk_bf16_f32 v156, v240, v241
v_mfma_f32_16x16x32_bf16 v[248:251], v[196:199], a[248:251], v[248:251]
ds_read_b64_tr_b16 v[218:219], v18 offset:34816
v_cvt_pk_bf16_f32 v157, v242, v243
v_mfma_f32_16x16x32_bf16 v[252:255], v[192:195], a[244:247], v[252:255]
ds_read_b64_tr_b16 v[220:221], v18 offset:45056
v_cvt_pk_bf16_f32 v172, v244, v245
v_mfma_f32_16x16x32_bf16 v[252:255], v[196:199], a[252:255], v[252:255]
s_waitcnt lgkmcnt(7)
ds_read_b64_tr_b16 v[222:223], v18 offset:47104
v_cvt_pk_bf16_f32 v173, v246, v247
v_mfma_f32_16x16x32_bf16 v[248:251], v[200:203], a[0:3], v[248:251]
ds_read_b64_tr_b16 v[184:185], v22 offset:8192
v_mfma_f32_16x16x32_bf16 v[248:251], v[204:207], a[8:11], v[248:251]
ds_read_b64_tr_b16 v[186:187], v22 offset:10240
v_mfma_f32_16x16x32_bf16 v[252:255], v[200:203], a[4:7], v[252:255]
ds_read_b64_tr_b16 v[188:189], v22 offset:20480
v_mfma_f32_16x16x32_bf16 v[252:255], v[204:207], a[12:15], v[252:255]
s_waitcnt lgkmcnt(7)
ds_read_b64_tr_b16 v[190:191], v22 offset:22528
v_mfma_f32_16x16x32_bf16 v[104:107], v[208:211], a[224:227], v[104:107]
ds_read_b64_tr_b16 v[192:193], v19 offset:8192
v_mfma_f32_16x16x32_bf16 v[104:107], v[212:215], a[232:235], v[104:107]
s_waitcnt vmcnt(3)
buffer_store_dword v31, v28, s[12:15], s7 offen offset:4092 sc1
v_mfma_f32_16x16x32_bf16 v[108:111], v[208:211], a[228:231], v[108:111]
ds_read_b64_tr_b16 v[194:195], v19 offset:10240
ds_read_b64_tr_b16 v[196:197], v19 offset:20480
v_mfma_f32_16x16x32_bf16 v[108:111], v[212:215], a[236:239], v[108:111]
s_waitcnt lgkmcnt(7)
ds_read_b64_tr_b16 v[198:199], v19 offset:22528
v_mfma_f32_16x16x32_bf16 v[104:107], v[216:219], a[240:243], v[104:107]
ds_read_b64_tr_b16 v[200:201], v19 offset:32768
v_cvt_pk_bf16_f32 v158, v248, v249
v_mfma_f32_16x16x32_bf16 v[104:107], v[220:223], a[248:251], v[104:107]
s_waitcnt vmcnt(3)
buffer_store_dword v31, v28, s[12:15], s52 offen offset:4092 sc1
v_cvt_pk_bf16_f32 v159, v250, v251
v_mfma_f32_16x16x32_bf16 v[108:111], v[216:219], a[244:247], v[108:111]
ds_read_b64_tr_b16 v[202:203], v19 offset:34816
ds_read_b64_tr_b16 v[204:205], v19 offset:45056
v_cvt_pk_bf16_f32 v174, v252, v253
v_mfma_f32_16x16x32_bf16 v[108:111], v[220:223], a[252:255], v[108:111]
s_waitcnt lgkmcnt(7)
ds_read_b64_tr_b16 v[206:207], v19 offset:47104
v_cvt_pk_bf16_f32 v175, v254, v255
v_mfma_f32_16x16x32_bf16 v[104:107], v[184:187], a[0:3], v[104:107]
ds_read_b64_tr_b16 v[208:209], v23 offset:8192
v_mfma_f32_16x16x32_bf16 v[104:107], v[188:191], a[8:11], v[104:107]
buffer_store_dwordx4 v[156:159], v4, s[12:15], s53 offen offset:1024 sc1
v_mfma_f32_16x16x32_bf16 v[108:111], v[184:187], a[4:7], v[108:111]
ds_read_b64_tr_b16 v[210:211], v23 offset:10240
ds_read_b64_tr_b16 v[212:213], v23 offset:20480
v_mfma_f32_16x16x32_bf16 v[108:111], v[188:191], a[12:15], v[108:111]
s_waitcnt lgkmcnt(7)
ds_read_b64_tr_b16 v[214:215], v23 offset:22528
v_mfma_f32_16x16x32_bf16 v[112:115], v[192:195], a[224:227], v[112:115]
v_mfma_f32_16x16x32_bf16 v[112:115], v[196:199], a[232:235], v[112:115]
buffer_store_dwordx4 v[172:175], v4, s[12:15], s79 offen offset:1024 sc1
v_mfma_f32_16x16x32_bf16 v[116:119], v[192:195], a[228:231], v[116:119]
v_mfma_f32_16x16x32_bf16 v[116:119], v[196:199], a[236:239], v[116:119]
s_waitcnt lgkmcnt(4)
v_mfma_f32_16x16x32_bf16 v[112:115], v[200:203], a[240:243], v[112:115]
v_cvt_pk_bf16_f32 v160, v104, v105
v_mfma_f32_16x16x32_bf16 v[112:115], v[204:207], a[248:251], v[112:115]
v_cvt_pk_bf16_f32 v161, v106, v107
v_mfma_f32_16x16x32_bf16 v[116:119], v[200:203], a[244:247], v[116:119]
v_cvt_pk_bf16_f32 v176, v108, v109
v_mfma_f32_16x16x32_bf16 v[116:119], v[204:207], a[252:255], v[116:119]
s_waitcnt lgkmcnt(0)
v_cvt_pk_bf16_f32 v177, v110, v111
v_mfma_f32_16x16x32_bf16 v[112:115], v[208:211], a[0:3], v[112:115]
v_mfma_f32_16x16x32_bf16 v[112:115], v[212:215], a[8:11], v[112:115]
v_mfma_f32_16x16x32_bf16 v[116:119], v[208:211], a[4:7], v[116:119]
v_mfma_f32_16x16x32_bf16 v[116:119], v[212:215], a[12:15], v[116:119]
s_nop 5
v_cvt_pk_bf16_f32 v162, v112, v113
v_cvt_pk_bf16_f32 v163, v114, v115
v_cvt_pk_bf16_f32 v178, v116, v117
v_cvt_pk_bf16_f32 v179, v118, v119
buffer_store_dwordx4 v[160:163], v4, s[12:15], s53 offen offset:2048 sc1
buffer_store_dwordx4 v[176:179], v4, s[12:15], s79 offen offset:2048 sc1
s_waitcnt vmcnt(1)
buffer_store_dword v31, v28, s[12:15], s53 offen offset:4092 sc1
s_waitcnt vmcnt(1)
buffer_store_dword v31, v28, s[12:15], s79 offen offset:4092 sc1
s_endpgm
slow_a0:
s_mov_b32 s4, 0
spin_a0:
buffer_load_dword v55, v39, s[12:15], s6 offen offset:0 sc1
s_waitcnt vmcnt(0)
v_cmp_ne_u32 vcc, s76, v55
s_nop 1
s_cbranch_vccz back_a0
s_add_u32 s4, s4, 1
s_cmp_lt_u32 s4, 0x4000
s_cbranch_scc1 spin_a0
s_branch back_a0
slow_taga:
s_mov_b32 s4, 0
spin_taga:
buffer_load_dword v38, v31, s[72:75], 0 offen sc1
s_waitcnt vmcnt(0)
v_readfirstlane_b32 s76, v38
s_add_u32 s4, s4, 1
s_nop 0
s_cmp_lg_u32 s76, 0
s_cbranch_scc1 back_taga
s_cmp_lt_u32 s4, 0x4000
s_cbranch_scc1 spin_taga
s_branch back_taga
slow_a1:
s_mov_b32 s4, 0
spin_a1:
buffer_load_dword v55, v54, s[12:15], s6 offen offset:0 sc1
s_waitcnt vmcnt(0)
v_cmp_ne_u32 vcc, s76, v55
s_nop 1
s_cbranch_vccz back_a1
s_add_u32 s4, s4, 1
s_cmp_lt_u32 s4, 0x4000
s_cbranch_scc1 spin_a1
s_branch back_a1
slow_a2:
s_mov_b32 s4, 0
spin_a2:
buffer_load_dword v55, v10, s[12:15], s5 offen offset:0 sc1
s_waitcnt vmcnt(0)
v_cmp_ne_u32 vcc, s76, v55
s_nop 1
s_cbranch_vccz back_a2
s_add_u32 s4, s4, 1
s_cmp_lt_u32 s4, 0x4000
s_cbranch_scc1 spin_a2
s_branch back_a2
slow_a3:
s_mov_b32 s4, 0
spin_a3:
buffer_load_dword v55, v10, s[12:15], s5 offen offset:128 sc1
s_waitcnt vmcnt(0)
v_cmp_ne_u32 vcc, s76, v55
s_nop 1
s_cbranch_vccz back_a3
s_add_u32 s4, s4, 1
s_cmp_lt_u32 s4, 0x4000
s_cbranch_scc1 spin_a3
s_branch back_a3
slow_a4:
s_mov_b32 s4, 0
spin_a4:
buffer_load_dword v55, v11, s[12:15], s5 offen offset:384 sc1
s_waitcnt vmcnt(0)
v_cmp_ne_u32 vcc, s76, v55
s_nop 1
s_cbranch_vccz back_a4
s_add_u32 s4, s4, 1
s_cmp_lt_u32 s4, 0x4000
s_cbranch_scc1 spin_a4
s_branch back_a4
code_end:
.section .rodata,"a"
.p2align 6
.amdhsa_kernel parallel_sum__linear_attn_block__glu_gated_swiglu__prompt_kernel
  .amdhsa_next_free_vgpr 512
  .amdhsa_next_free_sgpr 80
  .amdhsa_accum_offset 256
  .amdhsa_group_segment_fixed_size 0
  .amdhsa_kernarg_size 80
  .amdhsa_user_sgpr_count 2
  .amdhsa_user_sgpr_kernarg_segment_ptr 1
  .amdhsa_system_sgpr_workgroup_id_x 1
  .amdhsa_float_denorm_mode_32 3
.end_amdhsa_kernel
```
